```python
import torch

def _softmax(x, axis=-1):
    return torch.softmax(x, dim=axis)

def _gelu(x):
    return torch.nn.functional.gelu(x, approximate='tanh')

def _silu(x):
    return torch.nn.functional.silu(x)

def _sigmoid(x):
    return torch.sigmoid(x)

def _layernorm(x, axis=-1, eps=1e-05):
    m = x.mean(dim=axis, keepdim=True)
    v = x.var(dim=axis, keepdim=True, unbiased=False)
    return (x - m) / torch.sqrt(v + eps)

def _scatter_add(tgt, idx, src, axis=0):
    return tgt.clone().index_add_(axis, idx, src)

def _segment_sum(src, seg, n):
    out = torch.zeros((n,) + src.shape[1:], dtype=src.dtype)
    return out.index_add_(0, seg, src)

def _pad(x, pw):
    flat = tuple((v for pair in reversed(pw) for v in pair))
    return torch.nn.functional.pad(x, flat)
kernel_name = 'adaLN_cond__memory_aug_recurrent_mem_tr__dense_activation_gelu__prompt'

def setup_inputs():

    _w = lambda a: (lambda t: t.to(torch.bfloat16) if t.is_floating_point() else t)(torch.as_tensor(a))

    def _A_setup():
        B, S, Dm = (1, 2048, 640)
        H, Dh = (32, 192)
        M, seg = (8, 32)
        seg = min(seg, S)
        S = S // seg * seg
        return {'x': _w((lambda *s: torch.randn(*s, dtype=torch.bfloat16) * 0.05)(B, S, Dm)), 'mem0': _w((lambda *s: torch.randn(*s, dtype=torch.bfloat16) * 0.8)(B, M, Dm)), 'Wq': _w((lambda *s: torch.randn(*s, dtype=torch.bfloat16) * 1.6)(Dm, H, Dh) * Dm ** (-0.5)), 'Wk': _w((lambda *s: torch.randn(*s, dtype=torch.bfloat16) * 1.6)(Dm, H, Dh) * Dm ** (-0.5)), 'Wv': _w((lambda *s: torch.randn(*s, dtype=torch.bfloat16) * 0.8)(Dm, H, Dh) * Dm ** (-0.5)), 'Wo': _w((lambda *s: torch.randn(*s, dtype=torch.bfloat16) * 0.8)(H, Dh, Dm) * (H * Dh) ** (-0.5)), 'seg_len': seg}
    _A_in = _A_setup()

    def _B_setup():
        B, S, D, F = (1, 2048, 640, 1536)
        return {'x': _w((lambda *s: torch.randn(*s, dtype=torch.bfloat16) * 0.05)(B, S, D)), 'w1': _w((lambda *s: torch.randn(*s, dtype=torch.bfloat16) * 1.6)(D, F) * D ** (-0.5)), 'b1': _w((lambda *s: torch.randn(*s, dtype=torch.bfloat16) * 1.6)(F) * 0.01), 'w2': _w((lambda *s: torch.randn(*s, dtype=torch.bfloat16) * 0.2)(F, D) * F ** (-0.5)), 'b2': _w((lambda *s: torch.randn(*s, dtype=torch.bfloat16) * 0.2)(D) * 0.01)}
    _B_in = _B_setup()
    return {'A_x': _A_in['x'], 'A_mem0': _A_in['mem0'], 'A_Wq': _A_in['Wq'], 'A_Wk': _A_in['Wk'], 'A_Wv': _A_in['Wv'], 'A_Wo': _A_in['Wo'], 'A_seg_len': _A_in['seg_len'], 'B_x': _B_in['x'], 'B_w1': _B_in['w1'], 'B_b1': _B_in['b1'], 'B_w2': _B_in['w2'], 'B_b2': _B_in['b2'], 'c': _w((lambda *s: torch.randn(*s, dtype=torch.bfloat16) * 0.05)(1, 640) * 8.0), 'w_mod': _w((lambda *s: torch.randn(*s, dtype=torch.bfloat16) * 0.05)(640, 6 * 640) * 640 ** (-0.5) * 8.0)}

def reference(A_x, A_mem0, A_Wq, A_Wk, A_Wv, A_Wo, A_seg_len, B_x, B_w1, B_b1, B_w2, B_b2, c, w_mod):

    def _A_ref(x, mem0, Wq, Wk, Wv, Wo, seg_len):
        B, S, Dm = x.shape
        H, Dh = (Wq.shape[1], Wq.shape[2])
        M = mem0.shape[1]
        scale = Dh ** (-0.5)
        n_seg = S // seg_len
        L = M + seg_len
        idx = torch.arange(L)
        mask = (idx[:, None] < M) | (idx[:, None] >= idx[None, :])
        mem = mem0
        outs = []
        for s in range(n_seg):
            xs = x[:, s * seg_len:(s + 1) * seg_len, :].clone()
            h = torch.concatenate([mem, xs], axis=1)
            q = torch.einsum('btd,dhe->bhte', h, Wq)
            k = torch.einsum('btd,dhe->bhte', h, Wk)
            v = torch.einsum('btd,dhe->bhte', h, Wv)
            scores = torch.einsum('bhqe,bhke->bhqk', q, k) * scale
            scores = torch.where(mask[None, None], scores, -1000000000.0)
            p = _softmax(scores, axis=-1)
            o = torch.einsum('bhqk,bhke->bhqe', p, v)
            o = torch.einsum('bhte,hed->btd', o, Wo)
            mem = o[:, :M, :].clone()
            outs.append(o[:, M:, :])
        return torch.concatenate(outs, axis=1)

    def _B_ref(x, w1, b1, w2, b2):
        h = torch.einsum('bsd,df->bsf', x, w1) + b1
        h = _gelu(h)
        return torch.einsum('bsf,fd->bsd', h, w2) + b2
    x = A_x
    mod = (_silu(c) @ w_mod).reshape(c.shape[0], 6, 1, -1)
    sa, ca, ga, sb, cb, gb = (mod[:, 0].clone(), mod[:, 1].clone(), mod[:, 2].clone(), mod[:, 3].clone(), mod[:, 4].clone(), mod[:, 5].clone())
    h = _layernorm(x, axis=-1) * (1 + ca) + sa
    x = x + ga * _A_ref(h, A_mem0, A_Wq, A_Wk, A_Wv, A_Wo, A_seg_len)
    h = _layernorm(x, axis=-1) * (1 + cb) + sb
    x = x + gb * _B_ref(h, B_w1, B_b1, B_w2, B_b2)
    return x
```

```asm
; @launch grid=(256,1,1) block=(256,1,1) lds=163840
.amdgcn_target "amdgcn-amd-amdhsa--gfx950"
.text
.globl adaLN_cond__memory_aug_recurrent_mem_tr__dense_activation_gelu__prompt_kernel
.p2align 8
.type adaLN_cond__memory_aug_recurrent_mem_tr__dense_activation_gelu__prompt_kernel,@function
adaLN_cond__memory_aug_recurrent_mem_tr__dense_activation_gelu__prompt_kernel:
  s_cmp_ge_u32 s2, 256
  s_cbranch_scc1 L_exit
  s_getpc_b64 s[8:9]
L_pc:
  s_mov_b32 s10, L_codeend-L_pc
  s_mov_b32 s11, 0x20000
  s_lshr_b32 s3, s2, 3
  s_lshl_b32 s3, s3, 12
  v_lshlrev_b32 v1, 4, v0
  buffer_load_dwordx4 v[248:251], v1, s[8:11], s3 offen
  s_load_dwordx2 s[24:25], s[0:1], 128
  s_load_dwordx2 s[96:97], s[0:1], 120
  s_load_dwordx8 s[68:75], s[0:1], 16
  s_lshr_b32 s16, s2, 3
  s_lshl_b32 s16, s16, 2
  s_and_b32 s3, s2, 3
  s_or_b32 s16, s16, s3
  s_and_b32 s3, s2, 4
  s_lshl_b32 s3, s3, 5
  s_or_b32 s16, s16, s3
  v_lshrrev_b32 v1, 6, v0
  s_nop 0
  v_readfirstlane_b32 s17, v1
  s_waitcnt lgkmcnt(0)
  s_mov_b32 s98, 256
  s_mov_b32 s99, 0x20000
  s_mov_b32 s39, 0
  s_mov_b32 s4, s24
  s_mov_b32 s5, s25
  s_mov_b32 s6, 268435456
  s_mov_b32 s7, 0x20000
  v_and_b32 v1, 63, v0
  v_lshrrev_b32 v2, 4, v1
  v_and_b32 v3, 15, v1
  s_getreg_b32 s95, hwreg(HW_REG_XCC_ID, 0, 4)
  s_and_b32 s95, s95, 7
  s_mul_i32 s22, s95, s95
  s_lshl_b32 s22, s22, 16
  s_lshl_b32 s95, s95, 8
  s_add_u32 s95, s95, s22
  s_add_u32 s95, s95, 1
  s_and_b32 s94, s16, 3
  s_lshl_b32 s94, s94, 2
  s_add_u32 s94, s94, 192
  s_cmp_ge_u32 s16, 104
  s_cbranch_scc1 L_nogrp
  s_cmp_lg_u32 s17, 0
  s_cbranch_scc1 L_nogrp
  v_mov_b32 v4, s95
  s_mov_b64 exec, 1
  buffer_atomic_add v4, off, s[96:99], s94
  s_mov_b64 exec, -1
L_nogrp:
  s_and_b32 s18, s16, 3
  s_lshl_b32 s18, s18, 3
  s_bfe_u32 s22, s16, 0x30002
  s_add_u32 s18, s18, s22
  s_lshr_b32 s27, s16, 5
  s_mov_b32 s10, 7864320
  s_mov_b32 s11, 0x20000
  s_mov_b32 s14, 7864320
  s_mov_b32 s15, 0x20000
  s_mov_b64 s[8:9], s[68:69]
  s_mov_b64 s[12:13], s[70:71]
  s_cmp_eq_u32 s27, 0
  s_cbranch_scc1 L_A
  s_mov_b64 s[8:9], s[72:73]
  s_mov_b64 s[12:13], s[74:75]
  s_cmp_eq_u32 s27, 1
  s_cbranch_scc1 L_V
  s_cmp_ge_u32 s27, 4
  s_cbranch_scc1 L_work
  s_sub_u32 s18, s16, 64
L_H:
  s_load_dwordx4 s[28:31], s[0:1], 0
  s_load_dwordx4 s[32:35], s[0:1], 96
  s_mov_b32 s39, 0
  s_mov_b32 s43, 1
  s_waitcnt lgkmcnt(0)
  s_mov_b32 s8, s28
  s_mov_b32 s9, s29
  s_mov_b32 s10, 2621440
  s_mov_b32 s11, 0x20000
  s_mov_b32 s12, s30
  s_mov_b32 s13, s31
  s_mov_b32 s14, 10240
  s_mov_b32 s15, 0x20000
  s_mov_b32 s44, s32
  s_mov_b32 s45, s33
  s_mov_b32 s46, 1280
  s_mov_b32 s47, 0x20000
  s_mov_b32 s48, s34
  s_mov_b32 s49, s35
  s_mov_b32 s50, 4915200
  s_mov_b32 s51, 0x20000
  v_lshrrev_b32 v4, 4, v0
  v_mul_u32_u24 v5, 1280, v4
  v_lshl_add_u32 v5, v3, 4, v5
  s_mul_i32 s36, s18, 40960
  s_add_u32 s37, s36, 20480
  s_cmp_ge_u32 s18, 60
  s_cbranch_scc1 L_H_nomod
  s_mul_i32 s38, s18, 3277
  s_lshr_b32 s38, s38, 16
  s_mul_i32 s3, s38, 20
  s_sub_u32 s3, s18, s3
  s_lshl_b32 s3, s3, 7
  s_mul_i32 s38, s38, 224
  v_lshrrev_b32 v6, 3, v0
  v_add_u32 v6, s38, v6
  v_and_b32 v7, 7, v0
  v_mul_u32_u24 v28, 7680, v6
  v_lshl_add_u32 v28, v7, 4, v28
  v_lshlrev_b32 v29, 1, v6
  s_add_u32 s24, s3, 0
  buffer_load_dwordx4 v[32:35], v28, s[48:51], s24 offen
  s_add_u32 s24, s3, 245760
  buffer_load_dwordx4 v[36:39], v28, s[48:51], s24 offen
  s_add_u32 s24, s3, 491520
  buffer_load_dwordx4 v[40:43], v28, s[48:51], s24 offen
  s_add_u32 s24, s3, 737280
  buffer_load_dwordx4 v[44:47], v28, s[48:51], s24 offen
  s_add_u32 s24, s3, 983040
  buffer_load_dwordx4 v[48:51], v28, s[48:51], s24 offen
  s_add_u32 s24, s3, 1228800
  buffer_load_dwordx4 v[52:55], v28, s[48:51], s24 offen
  s_add_u32 s24, s3, 1474560
  buffer_load_dwordx4 v[56:59], v28, s[48:51], s24 offen
  buffer_load_ushort v8, v29, s[44:47], 0 offen offset:0
  buffer_load_ushort v9, v29, s[44:47], 0 offen offset:64
  buffer_load_ushort v10, v29, s[44:47], 0 offen offset:128
  buffer_load_ushort v11, v29, s[44:47], 0 offen offset:192
  buffer_load_ushort v12, v29, s[44:47], 0 offen offset:256
  buffer_load_ushort v13, v29, s[44:47], 0 offen offset:320
  buffer_load_ushort v14, v29, s[44:47], 0 offen offset:384
  buffer_load_dwordx4 v[200:203], v5, s[8:11], s36 offen offset:0
  buffer_load_dwordx4 v[204:207], v5, s[8:11], s36 offen offset:256
  buffer_load_dwordx4 v[208:211], v5, s[8:11], s36 offen offset:512
  buffer_load_dwordx4 v[212:215], v5, s[8:11], s36 offen offset:768
  buffer_load_dwordx4 v[216:219], v5, s[8:11], s36 offen offset:1024
  buffer_load_dwordx4 v[220:223], v5, s[8:11], s37 offen offset:0
  buffer_load_dwordx4 v[224:227], v5, s[8:11], s37 offen offset:256
  buffer_load_dwordx4 v[228:231], v5, s[8:11], s37 offen offset:512
  buffer_load_dwordx4 v[232:235], v5, s[8:11], s37 offen offset:768
  buffer_load_dwordx4 v[236:239], v5, s[8:11], s37 offen offset:1024
  s_waitcnt vmcnt(16)
  v_lshlrev_b32 v8, 16, v8
  v_mul_f32 v30, 0xbfb8aa3b, v8
  v_exp_f32 v30, v30
  s_nop 0
  v_add_f32 v30, 1.0, v30
  v_rcp_f32 v30, v30
  s_nop 0
  v_mul_f32 v8, v8, v30
  v_cvt_pk_bf16_f32 v30, v8, v8
  v_lshlrev_b32 v8, 16, v30
  s_waitcnt vmcnt(15)
  v_lshlrev_b32 v9, 16, v9
  v_mul_f32 v30, 0xbfb8aa3b, v9
  v_exp_f32 v30, v30
  s_nop 0
  v_add_f32 v30, 1.0, v30
  v_rcp_f32 v30, v30
  s_nop 0
  v_mul_f32 v9, v9, v30
  v_cvt_pk_bf16_f32 v30, v9, v9
  v_lshlrev_b32 v9, 16, v30
  s_waitcnt vmcnt(14)
  v_lshlrev_b32 v10, 16, v10
  v_mul_f32 v30, 0xbfb8aa3b, v10
  v_exp_f32 v30, v30
  s_nop 0
  v_add_f32 v30, 1.0, v30
  v_rcp_f32 v30, v30
  s_nop 0
  v_mul_f32 v10, v10, v30
  v_cvt_pk_bf16_f32 v30, v10, v10
  v_lshlrev_b32 v10, 16, v30
  s_waitcnt vmcnt(13)
  v_lshlrev_b32 v11, 16, v11
  v_mul_f32 v30, 0xbfb8aa3b, v11
  v_exp_f32 v30, v30
  s_nop 0
  v_add_f32 v30, 1.0, v30
  v_rcp_f32 v30, v30
  s_nop 0
  v_mul_f32 v11, v11, v30
  v_cvt_pk_bf16_f32 v30, v11, v11
  v_lshlrev_b32 v11, 16, v30
  s_waitcnt vmcnt(12)
  v_lshlrev_b32 v12, 16, v12
  v_mul_f32 v30, 0xbfb8aa3b, v12
  v_exp_f32 v30, v30
  s_nop 0
  v_add_f32 v30, 1.0, v30
  v_rcp_f32 v30, v30
  s_nop 0
  v_mul_f32 v12, v12, v30
  v_cvt_pk_bf16_f32 v30, v12, v12
  v_lshlrev_b32 v12, 16, v30
  s_waitcnt vmcnt(11)
  v_lshlrev_b32 v13, 16, v13
  v_mul_f32 v30, 0xbfb8aa3b, v13
  v_exp_f32 v30, v30
  s_nop 0
  v_add_f32 v30, 1.0, v30
  v_rcp_f32 v30, v30
  s_nop 0
  v_mul_f32 v13, v13, v30
  v_cvt_pk_bf16_f32 v30, v13, v13
  v_lshlrev_b32 v13, 16, v30
  s_waitcnt vmcnt(10)
  v_lshlrev_b32 v14, 16, v14
  v_mul_f32 v30, 0xbfb8aa3b, v14
  v_exp_f32 v30, v30
  s_nop 0
  v_add_f32 v30, 1.0, v30
  v_rcp_f32 v30, v30
  s_nop 0
  v_mul_f32 v14, v14, v30
  v_cvt_pk_bf16_f32 v30, v14, v14
  v_lshlrev_b32 v14, 16, v30
  v_mov_b32 v112, 0
  v_mov_b32 v113, 0
  v_mov_b32 v114, 0
  v_mov_b32 v115, 0
  v_mov_b32 v116, 0
  v_mov_b32 v117, 0
  v_mov_b32 v118, 0
  v_mov_b32 v119, 0
  v_lshlrev_b32 v30, 16, v32
  v_and_b32 v31, 0xffff0000, v32
  v_fmac_f32 v112, v30, v8
  v_fmac_f32 v113, v31, v8
  v_lshlrev_b32 v30, 16, v33
  v_and_b32 v31, 0xffff0000, v33
  v_fmac_f32 v114, v30, v8
  v_fmac_f32 v115, v31, v8
  v_lshlrev_b32 v30, 16, v34
  v_and_b32 v31, 0xffff0000, v34
  v_fmac_f32 v116, v30, v8
  v_fmac_f32 v117, v31, v8
  v_lshlrev_b32 v30, 16, v35
  v_and_b32 v31, 0xffff0000, v35
  v_fmac_f32 v118, v30, v8
  v_fmac_f32 v119, v31, v8
  v_lshlrev_b32 v30, 16, v36
  v_and_b32 v31, 0xffff0000, v36
  v_fmac_f32 v112, v30, v9
  v_fmac_f32 v113, v31, v9
  v_lshlrev_b32 v30, 16, v37
  v_and_b32 v31, 0xffff0000, v37
  v_fmac_f32 v114, v30, v9
  v_fmac_f32 v115, v31, v9
  v_lshlrev_b32 v30, 16, v38
  v_and_b32 v31, 0xffff0000, v38
  v_fmac_f32 v116, v30, v9
  v_fmac_f32 v117, v31, v9
  v_lshlrev_b32 v30, 16, v39
  v_and_b32 v31, 0xffff0000, v39
  v_fmac_f32 v118, v30, v9
  v_fmac_f32 v119, v31, v9
  v_lshlrev_b32 v30, 16, v40
  v_and_b32 v31, 0xffff0000, v40
  v_fmac_f32 v112, v30, v10
  v_fmac_f32 v113, v31, v10
  v_lshlrev_b32 v30, 16, v41
  v_and_b32 v31, 0xffff0000, v41
  v_fmac_f32 v114, v30, v10
  v_fmac_f32 v115, v31, v10
  v_lshlrev_b32 v30, 16, v42
  v_and_b32 v31, 0xffff0000, v42
  v_fmac_f32 v116, v30, v10
  v_fmac_f32 v117, v31, v10
  v_lshlrev_b32 v30, 16, v43
  v_and_b32 v31, 0xffff0000, v43
  v_fmac_f32 v118, v30, v10
  v_fmac_f32 v119, v31, v10
  v_lshlrev_b32 v30, 16, v44
  v_and_b32 v31, 0xffff0000, v44
  v_fmac_f32 v112, v30, v11
  v_fmac_f32 v113, v31, v11
  v_lshlrev_b32 v30, 16, v45
  v_and_b32 v31, 0xffff0000, v45
  v_fmac_f32 v114, v30, v11
  v_fmac_f32 v115, v31, v11
  v_lshlrev_b32 v30, 16, v46
  v_and_b32 v31, 0xffff0000, v46
  v_fmac_f32 v116, v30, v11
  v_fmac_f32 v117, v31, v11
  v_lshlrev_b32 v30, 16, v47
  v_and_b32 v31, 0xffff0000, v47
  v_fmac_f32 v118, v30, v11
  v_fmac_f32 v119, v31, v11
  v_lshlrev_b32 v30, 16, v48
  v_and_b32 v31, 0xffff0000, v48
  v_fmac_f32 v112, v30, v12
  v_fmac_f32 v113, v31, v12
  v_lshlrev_b32 v30, 16, v49
  v_and_b32 v31, 0xffff0000, v49
  v_fmac_f32 v114, v30, v12
  v_fmac_f32 v115, v31, v12
  v_lshlrev_b32 v30, 16, v50
  v_and_b32 v31, 0xffff0000, v50
  v_fmac_f32 v116, v30, v12
  v_fmac_f32 v117, v31, v12
  v_lshlrev_b32 v30, 16, v51
  v_and_b32 v31, 0xffff0000, v51
  v_fmac_f32 v118, v30, v12
  v_fmac_f32 v119, v31, v12
  v_lshlrev_b32 v30, 16, v52
  v_and_b32 v31, 0xffff0000, v52
  v_fmac_f32 v112, v30, v13
  v_fmac_f32 v113, v31, v13
  v_lshlrev_b32 v30, 16, v53
  v_and_b32 v31, 0xffff0000, v53
  v_fmac_f32 v114, v30, v13
  v_fmac_f32 v115, v31, v13
  v_lshlrev_b32 v30, 16, v54
  v_and_b32 v31, 0xffff0000, v54
  v_fmac_f32 v116, v30, v13
  v_fmac_f32 v117, v31, v13
  v_lshlrev_b32 v30, 16, v55
  v_and_b32 v31, 0xffff0000, v55
  v_fmac_f32 v118, v30, v13
  v_fmac_f32 v119, v31, v13
  v_lshlrev_b32 v30, 16, v56
  v_and_b32 v31, 0xffff0000, v56
  v_fmac_f32 v112, v30, v14
  v_fmac_f32 v113, v31, v14
  v_lshlrev_b32 v30, 16, v57
  v_and_b32 v31, 0xffff0000, v57
  v_fmac_f32 v114, v30, v14
  v_fmac_f32 v115, v31, v14
  v_lshlrev_b32 v30, 16, v58
  v_and_b32 v31, 0xffff0000, v58
  v_fmac_f32 v116, v30, v14
  v_fmac_f32 v117, v31, v14
  v_lshlrev_b32 v30, 16, v59
  v_and_b32 v31, 0xffff0000, v59
  v_fmac_f32 v118, v30, v14
  v_fmac_f32 v119, v31, v14
  v_lshlrev_b32 v30, 5, v0
  ds_write_b128 v30, v[112:115]
  ds_write_b128 v30, v[116:119] offset:16
  s_waitcnt lgkmcnt(0)
  s_barrier
  s_cmp_lg_u32 s17, 0
  s_cbranch_scc1 L_H_init
  v_lshlrev_b32 v30, 2, v0
  ds_read_b32 v32, v30 offset:0
  ds_read_b32 v33, v30 offset:256
  ds_read_b32 v34, v30 offset:512
  ds_read_b32 v35, v30 offset:768
  ds_read_b32 v36, v30 offset:1024
  ds_read_b32 v37, v30 offset:1280
  ds_read_b32 v38, v30 offset:1536
  ds_read_b32 v39, v30 offset:1792
  ds_read_b32 v40, v30 offset:2048
  ds_read_b32 v41, v30 offset:2304
  ds_read_b32 v42, v30 offset:2560
  ds_read_b32 v43, v30 offset:2816
  ds_read_b32 v44, v30 offset:3072
  ds_read_b32 v45, v30 offset:3328
  ds_read_b32 v46, v30 offset:3584
  ds_read_b32 v47, v30 offset:3840
  ds_read_b32 v48, v30 offset:4096
  ds_read_b32 v49, v30 offset:4352
  ds_read_b32 v50, v30 offset:4608
  ds_read_b32 v51, v30 offset:4864
  ds_read_b32 v52, v30 offset:5120
  ds_read_b32 v53, v30 offset:5376
  ds_read_b32 v54, v30 offset:5632
  ds_read_b32 v55, v30 offset:5888
  ds_read_b32 v56, v30 offset:6144
  ds_read_b32 v57, v30 offset:6400
  ds_read_b32 v58, v30 offset:6656
  ds_read_b32 v59, v30 offset:6912
  ds_read_b32 v60, v30 offset:7168
  ds_read_b32 v61, v30 offset:7424
  ds_read_b32 v62, v30 offset:7680
  ds_read_b32 v63, v30 offset:7936
  s_waitcnt lgkmcnt(14)
  v_pk_add_f32 v[32:33], v[32:33], v[48:49]
  s_waitcnt lgkmcnt(12)
  v_pk_add_f32 v[34:35], v[34:35], v[50:51]
  s_waitcnt lgkmcnt(10)
  v_pk_add_f32 v[36:37], v[36:37], v[52:53]
  s_waitcnt lgkmcnt(8)
  v_pk_add_f32 v[38:39], v[38:39], v[54:55]
  s_waitcnt lgkmcnt(6)
  v_pk_add_f32 v[40:41], v[40:41], v[56:57]
  s_waitcnt lgkmcnt(4)
  v_pk_add_f32 v[42:43], v[42:43], v[58:59]
  s_waitcnt lgkmcnt(2)
  v_pk_add_f32 v[44:45], v[44:45], v[60:61]
  s_waitcnt lgkmcnt(0)
  v_pk_add_f32 v[46:47], v[46:47], v[62:63]
  v_pk_add_f32 v[32:33], v[32:33], v[40:41]
  v_pk_add_f32 v[34:35], v[34:35], v[42:43]
  v_pk_add_f32 v[36:37], v[36:37], v[44:45]
  v_pk_add_f32 v[38:39], v[38:39], v[46:47]
  v_pk_add_f32 v[32:33], v[32:33], v[36:37]
  v_pk_add_f32 v[34:35], v[34:35], v[38:39]
  v_pk_add_f32 v[32:33], v[32:33], v[34:35]
  v_add_f32 v32, v32, v33
  s_lshl_b32 s3, s18, 8
  s_add_u32 s3, s3, 16384
  buffer_store_dword v32, v30, s[4:7], s3 offen sc1
  v_mov_b32 v31, 1
  s_waitcnt vmcnt(0)
  s_mov_b64 exec, 1
  buffer_atomic_add v31, off, s[96:99], 0 offset:0
  s_mov_b64 exec, -1
  s_branch L_H_init
L_H_nomod:
  s_cmp_lt_u32 s18, 61
  s_cbranch_scc1 L_H_nocal
  v_and_b32 v6, 3, v0
  v_lshlrev_b32 v6, 8, v6
  v_bfe_u32 v7, v0, 2, 1
  v_lshl_add_u32 v6, v7, 13, v6
  s_lshl_b32 s42, s17, 10
  s_and_b32 s22, s18, 3
  s_lshl_b32 s22, s22, 14
  s_add_u32 s42, s42, s22
  s_add_u32 s42, s42, 7340032
  buffer_load_dword v7, v6, s[4:7], s42 offen sc1
  s_waitcnt vmcnt(0)
  buffer_store_dword v7, v6, s[4:7], s42 offen sc1
  s_waitcnt vmcnt(0)
  s_mov_b32 s40, -1
  s_mov_b32 s41, -1
  s_add_u32 s38, s42, 1024
  s_mov_b64 exec, 1
L_H_cal:
  s_add_u32 s24, s42, 0
  s_memtime s[52:53]
  s_waitcnt lgkmcnt(0)
  buffer_load_dword v7, off, s[4:7], s24 sc1
  s_waitcnt vmcnt(0)
  s_memtime s[54:55]
  s_waitcnt lgkmcnt(0)
  s_sub_u32 s54, s54, s52
  s_min_u32 s40, s40, s54
  s_add_u32 s24, s42, 8192
  s_memtime s[52:53]
  s_waitcnt lgkmcnt(0)
  buffer_load_dword v7, off, s[4:7], s24 sc1
  s_waitcnt vmcnt(0)
  s_memtime s[54:55]
  s_waitcnt lgkmcnt(0)
  s_sub_u32 s54, s54, s52
  s_min_u32 s41, s41, s54
  s_add_u32 s42, s42, 256
  s_cmp_lt_u32 s42, s38
  s_cbranch_scc1 L_H_cal
  v_mov_b32 v6, s40
  v_mov_b32 v7, s41
  s_lshl_b32 s24, s17, 3
  v_mov_b32 v8, s24
  ds_write_b64 v8, v[6:7]
  s_waitcnt lgkmcnt(0)
  s_mov_b64 exec, -1
L_H_nocal:
  v_lshlrev_b32 v6, 4, v0
  v_mov_b32 v8, 0xff81ff81
  s_sub_u32 s24, s18, 60
  s_lshl_b32 s24, s24, 19
  s_add_u32 s24, s24, 4194304
  v_add_u32 v13, 0, v0
  v_bfe_u32 v14, v13, 1, 3
  v_mul_u32_u24 v14, 1280, v14
  v_lshrrev_b32 v15, 4, v13
  v_lshl_add_u32 v14, v15, 5, v14
  v_and_b32 v15, 1, v13
  v_lshl_add_u32 v14, v15, 4, v14
  v_cmp_gt_u32 vcc, 640, v13
  s_nop 1
  v_cndmask_b32 v14, -1, v14, vcc
  buffer_load_dwordx4 v[16:19], v14, s[12:15], 0 offen
  v_add_u32 v13, 256, v0
  v_bfe_u32 v14, v13, 1, 3
  v_mul_u32_u24 v14, 1280, v14
  v_lshrrev_b32 v15, 4, v13
  v_lshl_add_u32 v14, v15, 5, v14
  v_and_b32 v15, 1, v13
  v_lshl_add_u32 v14, v15, 4, v14
  v_cmp_gt_u32 vcc, 640, v13
  s_nop 1
  v_cndmask_b32 v14, -1, v14, vcc
  buffer_load_dwordx4 v[20:23], v14, s[12:15], 0 offen
  v_add_u32 v13, 512, v0
  v_bfe_u32 v14, v13, 1, 3
  v_mul_u32_u24 v14, 1280, v14
  v_lshrrev_b32 v15, 4, v13
  v_lshl_add_u32 v14, v15, 5, v14
  v_and_b32 v15, 1, v13
  v_lshl_add_u32 v14, v15, 4, v14
  v_cmp_gt_u32 vcc, 640, v13
  s_nop 1
  v_cndmask_b32 v14, -1, v14, vcc
  buffer_load_dwordx4 v[24:27], v14, s[12:15], 0 offen
  v_mov_b32 v13, 0xffc0ffc0
  s_waitcnt vmcnt(2)
  v_cmp_eq_u32 vcc, v16, v8
  s_nop 1
  v_cndmask_b32 v16, v16, v13, vcc
  v_cmp_eq_u32 vcc, v17, v8
  s_nop 1
  v_cndmask_b32 v17, v17, v13, vcc
  v_cmp_eq_u32 vcc, v18, v8
  s_nop 1
  v_cndmask_b32 v18, v18, v13, vcc
  v_cmp_eq_u32 vcc, v19, v8
  s_nop 1
  v_cndmask_b32 v19, v19, v13, vcc
  s_waitcnt vmcnt(1)
  v_cmp_eq_u32 vcc, v20, v8
  s_nop 1
  v_cndmask_b32 v20, v20, v13, vcc
  v_cmp_eq_u32 vcc, v21, v8
  s_nop 1
  v_cndmask_b32 v21, v21, v13, vcc
  v_cmp_eq_u32 vcc, v22, v8
  s_nop 1
  v_cndmask_b32 v22, v22, v13, vcc
  v_cmp_eq_u32 vcc, v23, v8
  s_nop 1
  v_cndmask_b32 v23, v23, v13, vcc
  s_waitcnt vmcnt(0)
  v_cmp_eq_u32 vcc, v24, v8
  s_nop 1
  v_cndmask_b32 v24, v24, v13, vcc
  v_cmp_eq_u32 vcc, v25, v8
  s_nop 1
  v_cndmask_b32 v25, v25, v13, vcc
  v_cmp_eq_u32 vcc, v26, v8
  s_nop 1
  v_cndmask_b32 v26, v26, v13, vcc
  v_cmp_eq_u32 vcc, v27, v8
  s_nop 1
  v_cndmask_b32 v27, v27, v13, vcc
  v_cmp_gt_u32 vcc, 128, v0
  s_nop 1
  v_cndmask_b32 v24, v8, v24, vcc
  v_cndmask_b32 v25, v8, v25, vcc
  v_cndmask_b32 v26, v8, v26, vcc
  v_cndmask_b32 v27, v8, v27, vcc
  s_add_u32 s25, s24, 0
  buffer_store_dwordx4 v[16:19], v6, s[4:7], s25 offen sc1
  s_add_u32 s25, s24, 4096
  buffer_store_dwordx4 v[20:23], v6, s[4:7], s25 offen sc1
  s_add_u32 s25, s24, 8192
  buffer_store_dwordx4 v[24:27], v6, s[4:7], s25 offen sc1
L_H_armed:
  buffer_load_dwordx4 v[200:203], v5, s[8:11], s36 offen offset:0
  buffer_load_dwordx4 v[204:207], v5, s[8:11], s36 offen offset:256
  buffer_load_dwordx4 v[208:211], v5, s[8:11], s36 offen offset:512
  buffer_load_dwordx4 v[212:215], v5, s[8:11], s36 offen offset:768
  buffer_load_dwordx4 v[216:219], v5, s[8:11], s36 offen offset:1024
  buffer_load_dwordx4 v[220:223], v5, s[8:11], s37 offen offset:0
  buffer_load_dwordx4 v[224:227], v5, s[8:11], s37 offen offset:256
  buffer_load_dwordx4 v[228:231], v5, s[8:11], s37 offen offset:512
  buffer_load_dwordx4 v[232:235], v5, s[8:11], s37 offen offset:768
  buffer_load_dwordx4 v[236:239], v5, s[8:11], s37 offen offset:1024
L_H_init:
  v_lshlrev_b32 v7, 3, v0
  v_mov_b32 v12, 0
  v_mov_b32 v13, 0
  s_lshl_b32 s24, s18, 11
  s_add_u32 s24, s24, 7405568
  buffer_store_dwordx2 v[12:13], v7, s[4:7], s24 offen sc1
  v_lshlrev_b32 v7, 2, v0
  s_lshl_b32 s24, s18, 10
  s_add_u32 s24, s24, 196608
  buffer_store_dword v12, v7, s[4:7], s24 offen sc1
  s_waitcnt vmcnt(2)
  v_lshlrev_b32 v32, 16, v200
  v_and_b32 v33, 0xffff0000, v200
  v_lshlrev_b32 v34, 16, v201
  v_and_b32 v35, 0xffff0000, v201
  v_lshlrev_b32 v36, 16, v202
  v_and_b32 v37, 0xffff0000, v202
  v_lshlrev_b32 v38, 16, v203
  v_and_b32 v39, 0xffff0000, v203
  v_lshlrev_b32 v40, 16, v204
  v_and_b32 v41, 0xffff0000, v204
  v_lshlrev_b32 v42, 16, v205
  v_and_b32 v43, 0xffff0000, v205
  v_lshlrev_b32 v44, 16, v206
  v_and_b32 v45, 0xffff0000, v206
  v_lshlrev_b32 v46, 16, v207
  v_and_b32 v47, 0xffff0000, v207
  v_lshlrev_b32 v48, 16, v208
  v_and_b32 v49, 0xffff0000, v208
  v_lshlrev_b32 v50, 16, v209
  v_and_b32 v51, 0xffff0000, v209
  v_lshlrev_b32 v52, 16, v210
  v_and_b32 v53, 0xffff0000, v210
  v_lshlrev_b32 v54, 16, v211
  v_and_b32 v55, 0xffff0000, v211
  v_lshlrev_b32 v56, 16, v212
  v_and_b32 v57, 0xffff0000, v212
  v_lshlrev_b32 v58, 16, v213
  v_and_b32 v59, 0xffff0000, v213
  v_lshlrev_b32 v60, 16, v214
  v_and_b32 v61, 0xffff0000, v214
  v_lshlrev_b32 v62, 16, v215
  v_and_b32 v63, 0xffff0000, v215
  v_lshlrev_b32 v64, 16, v216
  v_and_b32 v65, 0xffff0000, v216
  v_lshlrev_b32 v66, 16, v217
  v_and_b32 v67, 0xffff0000, v217
  v_lshlrev_b32 v68, 16, v218
  v_and_b32 v69, 0xffff0000, v218
  v_lshlrev_b32 v70, 16, v219
  v_and_b32 v71, 0xffff0000, v219
  v_pk_add_f32 v[28:29], v[32:33], v[34:35]
  v_pk_add_f32 v[28:29], v[28:29], v[36:37]
  v_pk_add_f32 v[28:29], v[28:29], v[38:39]
  v_pk_add_f32 v[28:29], v[28:29], v[40:41]
  v_pk_add_f32 v[28:29], v[28:29], v[42:43]
  v_pk_add_f32 v[28:29], v[28:29], v[44:45]
  v_pk_add_f32 v[28:29], v[28:29], v[46:47]
  v_pk_add_f32 v[28:29], v[28:29], v[48:49]
  v_pk_add_f32 v[28:29], v[28:29], v[50:51]
  v_pk_add_f32 v[28:29], v[28:29], v[52:53]
  v_pk_add_f32 v[28:29], v[28:29], v[54:55]
  v_pk_add_f32 v[28:29], v[28:29], v[56:57]
  v_pk_add_f32 v[28:29], v[28:29], v[58:59]
  v_pk_add_f32 v[28:29], v[28:29], v[60:61]
  v_pk_add_f32 v[28:29], v[28:29], v[62:63]
  v_pk_add_f32 v[28:29], v[28:29], v[64:65]
  v_pk_add_f32 v[28:29], v[28:29], v[66:67]
  v_pk_add_f32 v[28:29], v[28:29], v[68:69]
  v_pk_add_f32 v[28:29], v[28:29], v[70:71]
  v_add_f32 v28, v28, v29
  s_nop 1
  v_add_f32_dpp v28, v28, v28 row_ror:8 row_mask:0xf bank_mask:0xf
  s_nop 1
  v_add_f32_dpp v28, v28, v28 row_ror:4 row_mask:0xf bank_mask:0xf
  s_nop 1
  v_add_f32_dpp v28, v28, v28 row_ror:2 row_mask:0xf bank_mask:0xf
  s_nop 1
  v_add_f32_dpp v28, v28, v28 row_ror:1 row_mask:0xf bank_mask:0xf
  v_mul_f32 v28, 0xbacccccd, v28
  v_pk_add_f32 v[32:33], v[32:33], v[28:29] op_sel_hi:[1,0]
  v_pk_add_f32 v[34:35], v[34:35], v[28:29] op_sel_hi:[1,0]
  v_pk_add_f32 v[36:37], v[36:37], v[28:29] op_sel_hi:[1,0]
  v_pk_add_f32 v[38:39], v[38:39], v[28:29] op_sel_hi:[1,0]
  v_pk_add_f32 v[40:41], v[40:41], v[28:29] op_sel_hi:[1,0]
  v_pk_add_f32 v[42:43], v[42:43], v[28:29] op_sel_hi:[1,0]
  v_pk_add_f32 v[44:45], v[44:45], v[28:29] op_sel_hi:[1,0]
  v_pk_add_f32 v[46:47], v[46:47], v[28:29] op_sel_hi:[1,0]
  v_pk_add_f32 v[48:49], v[48:49], v[28:29] op_sel_hi:[1,0]
  v_pk_add_f32 v[50:51], v[50:51], v[28:29] op_sel_hi:[1,0]
  v_pk_add_f32 v[52:53], v[52:53], v[28:29] op_sel_hi:[1,0]
  v_pk_add_f32 v[54:55], v[54:55], v[28:29] op_sel_hi:[1,0]
  v_pk_add_f32 v[56:57], v[56:57], v[28:29] op_sel_hi:[1,0]
  v_pk_add_f32 v[58:59], v[58:59], v[28:29] op_sel_hi:[1,0]
  v_pk_add_f32 v[60:61], v[60:61], v[28:29] op_sel_hi:[1,0]
  v_pk_add_f32 v[62:63], v[62:63], v[28:29] op_sel_hi:[1,0]
  v_pk_add_f32 v[64:65], v[64:65], v[28:29] op_sel_hi:[1,0]
  v_pk_add_f32 v[66:67], v[66:67], v[28:29] op_sel_hi:[1,0]
  v_pk_add_f32 v[68:69], v[68:69], v[28:29] op_sel_hi:[1,0]
  v_pk_add_f32 v[70:71], v[70:71], v[28:29] op_sel_hi:[1,0]
  v_pk_mul_f32 v[28:29], v[32:33], v[32:33]
  v_pk_fma_f32 v[28:29], v[34:35], v[34:35], v[28:29]
  v_pk_fma_f32 v[28:29], v[36:37], v[36:37], v[28:29]
  v_pk_fma_f32 v[28:29], v[38:39], v[38:39], v[28:29]
  v_pk_fma_f32 v[28:29], v[40:41], v[40:41], v[28:29]
  v_pk_fma_f32 v[28:29], v[42:43], v[42:43], v[28:29]
  v_pk_fma_f32 v[28:29], v[44:45], v[44:45], v[28:29]
  v_pk_fma_f32 v[28:29], v[46:47], v[46:47], v[28:29]
  v_pk_fma_f32 v[28:29], v[48:49], v[48:49], v[28:29]
  v_pk_fma_f32 v[28:29], v[50:51], v[50:51], v[28:29]
  v_pk_fma_f32 v[28:29], v[52:53], v[52:53], v[28:29]
  v_pk_fma_f32 v[28:29], v[54:55], v[54:55], v[28:29]
  v_pk_fma_f32 v[28:29], v[56:57], v[56:57], v[28:29]
  v_pk_fma_f32 v[28:29], v[58:59], v[58:59], v[28:29]
  v_pk_fma_f32 v[28:29], v[60:61], v[60:61], v[28:29]
  v_pk_fma_f32 v[28:29], v[62:63], v[62:63], v[28:29]
  v_pk_fma_f32 v[28:29], v[64:65], v[64:65], v[28:29]
  v_pk_fma_f32 v[28:29], v[66:67], v[66:67], v[28:29]
  v_pk_fma_f32 v[28:29], v[68:69], v[68:69], v[28:29]
  v_pk_fma_f32 v[28:29], v[70:71], v[70:71], v[28:29]
  v_add_f32 v28, v28, v29
  s_nop 1
  v_add_f32_dpp v28, v28, v28 row_ror:8 row_mask:0xf bank_mask:0xf
  s_nop 1
  v_add_f32_dpp v28, v28, v28 row_ror:4 row_mask:0xf bank_mask:0xf
  s_nop 1
  v_add_f32_dpp v28, v28, v28 row_ror:2 row_mask:0xf bank_mask:0xf
  s_nop 1
  v_add_f32_dpp v28, v28, v28 row_ror:1 row_mask:0xf bank_mask:0xf
  v_mov_b32 v30, 0x3727c5ac
  v_fmac_f32 v30, 0x3acccccd, v28
  v_rsq_f32 v30, v30
  s_nop 0
  v_pk_mul_f32 v[32:33], v[32:33], v[30:31] op_sel_hi:[1,0]
  v_pk_mul_f32 v[34:35], v[34:35], v[30:31] op_sel_hi:[1,0]
  v_pk_mul_f32 v[36:37], v[36:37], v[30:31] op_sel_hi:[1,0]
  v_pk_mul_f32 v[38:39], v[38:39], v[30:31] op_sel_hi:[1,0]
  v_pk_mul_f32 v[40:41], v[40:41], v[30:31] op_sel_hi:[1,0]
  v_pk_mul_f32 v[42:43], v[42:43], v[30:31] op_sel_hi:[1,0]
  v_pk_mul_f32 v[44:45], v[44:45], v[30:31] op_sel_hi:[1,0]
  v_pk_mul_f32 v[46:47], v[46:47], v[30:31] op_sel_hi:[1,0]
  v_pk_mul_f32 v[48:49], v[48:49], v[30:31] op_sel_hi:[1,0]
  v_pk_mul_f32 v[50:51], v[50:51], v[30:31] op_sel_hi:[1,0]
  v_pk_mul_f32 v[52:53], v[52:53], v[30:31] op_sel_hi:[1,0]
  v_pk_mul_f32 v[54:55], v[54:55], v[30:31] op_sel_hi:[1,0]
  v_pk_mul_f32 v[56:57], v[56:57], v[30:31] op_sel_hi:[1,0]
  v_pk_mul_f32 v[58:59], v[58:59], v[30:31] op_sel_hi:[1,0]
  v_pk_mul_f32 v[60:61], v[60:61], v[30:31] op_sel_hi:[1,0]
  v_pk_mul_f32 v[62:63], v[62:63], v[30:31] op_sel_hi:[1,0]
  v_pk_mul_f32 v[64:65], v[64:65], v[30:31] op_sel_hi:[1,0]
  v_pk_mul_f32 v[66:67], v[66:67], v[30:31] op_sel_hi:[1,0]
  v_pk_mul_f32 v[68:69], v[68:69], v[30:31] op_sel_hi:[1,0]
  v_pk_mul_f32 v[70:71], v[70:71], v[30:31] op_sel_hi:[1,0]
  v_lshlrev_b32 v72, 16, v220
  v_and_b32 v73, 0xffff0000, v220
  v_lshlrev_b32 v74, 16, v221
  v_and_b32 v75, 0xffff0000, v221
  v_lshlrev_b32 v76, 16, v222
  v_and_b32 v77, 0xffff0000, v222
  v_lshlrev_b32 v78, 16, v223
  v_and_b32 v79, 0xffff0000, v223
  v_lshlrev_b32 v80, 16, v224
  v_and_b32 v81, 0xffff0000, v224
  v_lshlrev_b32 v82, 16, v225
  v_and_b32 v83, 0xffff0000, v225
  v_lshlrev_b32 v84, 16, v226
  v_and_b32 v85, 0xffff0000, v226
  v_lshlrev_b32 v86, 16, v227
  v_and_b32 v87, 0xffff0000, v227
  v_lshlrev_b32 v88, 16, v228
  v_and_b32 v89, 0xffff0000, v228
  v_lshlrev_b32 v90, 16, v229
  v_and_b32 v91, 0xffff0000, v229
  v_lshlrev_b32 v92, 16, v230
  v_and_b32 v93, 0xffff0000, v230
  v_lshlrev_b32 v94, 16, v231
  v_and_b32 v95, 0xffff0000, v231
  v_lshlrev_b32 v96, 16, v232
  v_and_b32 v97, 0xffff0000, v232
  v_lshlrev_b32 v98, 16, v233
  v_and_b32 v99, 0xffff0000, v233
  v_lshlrev_b32 v100, 16, v234
  v_and_b32 v101, 0xffff0000, v234
  v_lshlrev_b32 v102, 16, v235
  v_and_b32 v103, 0xffff0000, v235
  v_lshlrev_b32 v104, 16, v236
  v_and_b32 v105, 0xffff0000, v236
  v_lshlrev_b32 v106, 16, v237
  v_and_b32 v107, 0xffff0000, v237
  v_lshlrev_b32 v108, 16, v238
  v_and_b32 v109, 0xffff0000, v238
  v_lshlrev_b32 v110, 16, v239
  v_and_b32 v111, 0xffff0000, v239
  v_pk_add_f32 v[28:29], v[72:73], v[74:75]
  v_pk_add_f32 v[28:29], v[28:29], v[76:77]
  v_pk_add_f32 v[28:29], v[28:29], v[78:79]
  v_pk_add_f32 v[28:29], v[28:29], v[80:81]
  v_pk_add_f32 v[28:29], v[28:29], v[82:83]
  v_pk_add_f32 v[28:29], v[28:29], v[84:85]
  v_pk_add_f32 v[28:29], v[28:29], v[86:87]
  v_pk_add_f32 v[28:29], v[28:29], v[88:89]
  v_pk_add_f32 v[28:29], v[28:29], v[90:91]
  v_pk_add_f32 v[28:29], v[28:29], v[92:93]
  v_pk_add_f32 v[28:29], v[28:29], v[94:95]
  v_pk_add_f32 v[28:29], v[28:29], v[96:97]
  v_pk_add_f32 v[28:29], v[28:29], v[98:99]
  v_pk_add_f32 v[28:29], v[28:29], v[100:101]
  v_pk_add_f32 v[28:29], v[28:29], v[102:103]
  v_pk_add_f32 v[28:29], v[28:29], v[104:105]
  v_pk_add_f32 v[28:29], v[28:29], v[106:107]
  v_pk_add_f32 v[28:29], v[28:29], v[108:109]
  v_pk_add_f32 v[28:29], v[28:29], v[110:111]
  v_add_f32 v28, v28, v29
  s_nop 1
  v_add_f32_dpp v28, v28, v28 row_ror:8 row_mask:0xf bank_mask:0xf
  s_nop 1
  v_add_f32_dpp v28, v28, v28 row_ror:4 row_mask:0xf bank_mask:0xf
  s_nop 1
  v_add_f32_dpp v28, v28, v28 row_ror:2 row_mask:0xf bank_mask:0xf
  s_nop 1
  v_add_f32_dpp v28, v28, v28 row_ror:1 row_mask:0xf bank_mask:0xf
  v_mul_f32 v28, 0xbacccccd, v28
  v_pk_add_f32 v[72:73], v[72:73], v[28:29] op_sel_hi:[1,0]
  v_pk_add_f32 v[74:75], v[74:75], v[28:29] op_sel_hi:[1,0]
  v_pk_add_f32 v[76:77], v[76:77], v[28:29] op_sel_hi:[1,0]
  v_pk_add_f32 v[78:79], v[78:79], v[28:29] op_sel_hi:[1,0]
  v_pk_add_f32 v[80:81], v[80:81], v[28:29] op_sel_hi:[1,0]
  v_pk_add_f32 v[82:83], v[82:83], v[28:29] op_sel_hi:[1,0]
  v_pk_add_f32 v[84:85], v[84:85], v[28:29] op_sel_hi:[1,0]
  v_pk_add_f32 v[86:87], v[86:87], v[28:29] op_sel_hi:[1,0]
  v_pk_add_f32 v[88:89], v[88:89], v[28:29] op_sel_hi:[1,0]
  v_pk_add_f32 v[90:91], v[90:91], v[28:29] op_sel_hi:[1,0]
  v_pk_add_f32 v[92:93], v[92:93], v[28:29] op_sel_hi:[1,0]
  v_pk_add_f32 v[94:95], v[94:95], v[28:29] op_sel_hi:[1,0]
  v_pk_add_f32 v[96:97], v[96:97], v[28:29] op_sel_hi:[1,0]
  v_pk_add_f32 v[98:99], v[98:99], v[28:29] op_sel_hi:[1,0]
  v_pk_add_f32 v[100:101], v[100:101], v[28:29] op_sel_hi:[1,0]
  v_pk_add_f32 v[102:103], v[102:103], v[28:29] op_sel_hi:[1,0]
  v_pk_add_f32 v[104:105], v[104:105], v[28:29] op_sel_hi:[1,0]
  v_pk_add_f32 v[106:107], v[106:107], v[28:29] op_sel_hi:[1,0]
  v_pk_add_f32 v[108:109], v[108:109], v[28:29] op_sel_hi:[1,0]
  v_pk_add_f32 v[110:111], v[110:111], v[28:29] op_sel_hi:[1,0]
  v_pk_mul_f32 v[28:29], v[72:73], v[72:73]
  v_pk_fma_f32 v[28:29], v[74:75], v[74:75], v[28:29]
  v_pk_fma_f32 v[28:29], v[76:77], v[76:77], v[28:29]
  v_pk_fma_f32 v[28:29], v[78:79], v[78:79], v[28:29]
  v_pk_fma_f32 v[28:29], v[80:81], v[80:81], v[28:29]
  v_pk_fma_f32 v[28:29], v[82:83], v[82:83], v[28:29]
  v_pk_fma_f32 v[28:29], v[84:85], v[84:85], v[28:29]
  v_pk_fma_f32 v[28:29], v[86:87], v[86:87], v[28:29]
  v_pk_fma_f32 v[28:29], v[88:89], v[88:89], v[28:29]
  v_pk_fma_f32 v[28:29], v[90:91], v[90:91], v[28:29]
  v_pk_fma_f32 v[28:29], v[92:93], v[92:93], v[28:29]
  v_pk_fma_f32 v[28:29], v[94:95], v[94:95], v[28:29]
  v_pk_fma_f32 v[28:29], v[96:97], v[96:97], v[28:29]
  v_pk_fma_f32 v[28:29], v[98:99], v[98:99], v[28:29]
  v_pk_fma_f32 v[28:29], v[100:101], v[100:101], v[28:29]
  v_pk_fma_f32 v[28:29], v[102:103], v[102:103], v[28:29]
  v_pk_fma_f32 v[28:29], v[104:105], v[104:105], v[28:29]
  v_pk_fma_f32 v[28:29], v[106:107], v[106:107], v[28:29]
  v_pk_fma_f32 v[28:29], v[108:109], v[108:109], v[28:29]
  v_pk_fma_f32 v[28:29], v[110:111], v[110:111], v[28:29]
  v_add_f32 v28, v28, v29
  s_nop 1
  v_add_f32_dpp v28, v28, v28 row_ror:8 row_mask:0xf bank_mask:0xf
  s_nop 1
  v_add_f32_dpp v28, v28, v28 row_ror:4 row_mask:0xf bank_mask:0xf
  s_nop 1
  v_add_f32_dpp v28, v28, v28 row_ror:2 row_mask:0xf bank_mask:0xf
  s_nop 1
  v_add_f32_dpp v28, v28, v28 row_ror:1 row_mask:0xf bank_mask:0xf
  v_mov_b32 v30, 0x3727c5ac
  v_fmac_f32 v30, 0x3acccccd, v28
  v_rsq_f32 v30, v30
  s_nop 0
  v_pk_mul_f32 v[72:73], v[72:73], v[30:31] op_sel_hi:[1,0]
  v_pk_mul_f32 v[74:75], v[74:75], v[30:31] op_sel_hi:[1,0]
  v_pk_mul_f32 v[76:77], v[76:77], v[30:31] op_sel_hi:[1,0]
  v_pk_mul_f32 v[78:79], v[78:79], v[30:31] op_sel_hi:[1,0]
  v_pk_mul_f32 v[80:81], v[80:81], v[30:31] op_sel_hi:[1,0]
  v_pk_mul_f32 v[82:83], v[82:83], v[30:31] op_sel_hi:[1,0]
  v_pk_mul_f32 v[84:85], v[84:85], v[30:31] op_sel_hi:[1,0]
  v_pk_mul_f32 v[86:87], v[86:87], v[30:31] op_sel_hi:[1,0]
  v_pk_mul_f32 v[88:89], v[88:89], v[30:31] op_sel_hi:[1,0]
  v_pk_mul_f32 v[90:91], v[90:91], v[30:31] op_sel_hi:[1,0]
  v_pk_mul_f32 v[92:93], v[92:93], v[30:31] op_sel_hi:[1,0]
  v_pk_mul_f32 v[94:95], v[94:95], v[30:31] op_sel_hi:[1,0]
  v_pk_mul_f32 v[96:97], v[96:97], v[30:31] op_sel_hi:[1,0]
  v_pk_mul_f32 v[98:99], v[98:99], v[30:31] op_sel_hi:[1,0]
  v_pk_mul_f32 v[100:101], v[100:101], v[30:31] op_sel_hi:[1,0]
  v_pk_mul_f32 v[102:103], v[102:103], v[30:31] op_sel_hi:[1,0]
  v_pk_mul_f32 v[104:105], v[104:105], v[30:31] op_sel_hi:[1,0]
  v_pk_mul_f32 v[106:107], v[106:107], v[30:31] op_sel_hi:[1,0]
  v_pk_mul_f32 v[108:109], v[108:109], v[30:31] op_sel_hi:[1,0]
  v_pk_mul_f32 v[110:111], v[110:111], v[30:31] op_sel_hi:[1,0]
  s_cmp_lg_u32 s17, 0
  s_cbranch_scc1 L_H_wm_b
  s_branch L_H_wm_in
L_H_wm:
  s_sleep 4
L_H_wm_in:
  buffer_load_dword v28, off, s[96:99], 0 offset:0 sc1
  s_add_u32 s39, s39, 1
  s_cmp_gt_u32 s39, 200000
  s_cbranch_scc1 L_exit
  s_waitcnt vmcnt(0)
  v_cmp_gt_u32 vcc, 60, v28
  s_cbranch_vccnz L_H_wm
L_H_wm_b:
  s_barrier
  v_lshlrev_b32 v28, 2, v0
  s_mov_b32 s24, 16384
  buffer_load_dword v112, v28, s[4:7], s24 offen offset:0 sc1
  buffer_load_dword v113, v28, s[4:7], s24 offen offset:1024 sc1
  buffer_load_dword v114, v28, s[4:7], s24 offen offset:2048 sc1
  buffer_load_dword v115, v28, s[4:7], s24 offen offset:3072 sc1
  s_mov_b32 s24, 20480
  buffer_load_dword v116, v28, s[4:7], s24 offen sc1
  s_mov_b32 s24, 21504
  buffer_load_dword v117, v28, s[4:7], s24 offen offset:0 sc1
  buffer_load_dword v118, v28, s[4:7], s24 offen offset:1024 sc1
  buffer_load_dword v119, v28, s[4:7], s24 offen offset:2048 sc1
  buffer_load_dword v120, v28, s[4:7], s24 offen offset:3072 sc1
  s_mov_b32 s24, 25600
  buffer_load_dword v121, v28, s[4:7], s24 offen sc1
  s_mov_b32 s24, 26624
  buffer_load_dword v122, v28, s[4:7], s24 offen offset:0 sc1
  buffer_load_dword v123, v28, s[4:7], s24 offen offset:1024 sc1
  buffer_load_dword v124, v28, s[4:7], s24 offen offset:2048 sc1
  buffer_load_dword v125, v28, s[4:7], s24 offen offset:3072 sc1
  s_mov_b32 s24, 30720
  buffer_load_dword v126, v28, s[4:7], s24 offen sc1
  v_lshlrev_b32 v6, 4, v0
  v_mov_b32 v8, 0xff81ff81
  v_mov_b32 v9, v8
  v_mov_b32 v10, v8
  v_mov_b32 v11, v8
  s_lshl_b32 s24, s18, 13
  s_add_u32 s24, s24, 6291456
  buffer_store_dwordx4 v[8:11], v6, s[4:7], s24 offen sc1
  s_add_u32 s24, s24, 4096
  buffer_store_dwordx4 v[8:11], v6, s[4:7], s24 offen sc1
  s_lshr_b32 s24, s18, 4
  s_lshl_b32 s24, s24, 19
  s_bfe_u32 s25, s18, 0x10003
  s_lshl_b32 s25, s25, 17
  s_add_u32 s24, s24, s25
  s_and_b32 s25, s18, 7
  s_mul_i32 s25, s25, 12288
  s_add_u32 s24, s24, s25
  s_add_u32 s24, s24, 4194304
  s_and_b32 s25, s18, 15
  s_cmp_eq_u32 s25, 0
  s_cselect_b32 s24, 6291456, s24
  s_add_u32 s25, s24, 0
  buffer_store_dwordx4 v[8:11], v6, s[4:7], s25 offen sc1
  s_add_u32 s25, s24, 4096
  buffer_store_dwordx4 v[8:11], v6, s[4:7], s25 offen sc1
  s_add_u32 s25, s24, 8192
  buffer_store_dwordx4 v[8:11], v6, s[4:7], s25 offen sc1
  v_cmp_le_u32 vcc, 128, v0
  s_nop 1
  v_cndmask_b32 v130, 0, 1.0, vcc
  s_waitcnt vmcnt(14)
  v_add_f32 v112, v112, v117
  s_waitcnt vmcnt(9)
  v_add_f32 v112, v112, v122
  v_cvt_pk_bf16_f32 v29, v112, v112
  v_lshlrev_b32 v112, 16, v29
  ds_write_b32 v28, v112 offset:8192
  v_add_f32 v113, v113, v118
  s_waitcnt vmcnt(8)
  v_add_f32 v113, v113, v123
  v_cvt_pk_bf16_f32 v29, v113, v113
  v_lshlrev_b32 v113, 16, v29
  ds_write_b32 v28, v113 offset:9216
  v_add_f32 v114, v114, v119
  s_waitcnt vmcnt(7)
  v_add_f32 v114, v114, v124
  v_cvt_pk_bf16_f32 v29, v114, v114
  v_lshlrev_b32 v114, 16, v29
  v_add_f32 v114, v130, v114
  v_cvt_pk_bf16_f32 v29, v114, v114
  v_lshlrev_b32 v114, 16, v29
  ds_write_b32 v28, v114 offset:10240
  v_add_f32 v115, v115, v120
  s_waitcnt vmcnt(6)
  v_add_f32 v115, v115, v125
  v_cvt_pk_bf16_f32 v29, v115, v115
  v_lshlrev_b32 v115, 16, v29
  v_add_f32 v115, 1.0, v115
  v_cvt_pk_bf16_f32 v29, v115, v115
  v_lshlrev_b32 v115, 16, v29
  ds_write_b32 v28, v115 offset:11264
  v_add_f32 v116, v116, v121
  s_waitcnt vmcnt(5)
  v_add_f32 v116, v116, v126
  v_cvt_pk_bf16_f32 v29, v116, v116
  v_lshlrev_b32 v116, 16, v29
  v_add_f32 v116, 1.0, v116
  v_cvt_pk_bf16_f32 v29, v116, v116
  v_lshlrev_b32 v116, 16, v29
  ds_write_b32 v28, v116 offset:12288
  s_waitcnt lgkmcnt(0)
  s_barrier
  v_lshlrev_b32 v28, 5, v3
  ds_read_b128 v[112:115], v28 offset:8192
  ds_read_b128 v[152:155], v28 offset:10752
  ds_read_b128 v[116:119], v28 offset:8208
  ds_read_b128 v[156:159], v28 offset:10768
  ds_read_b128 v[120:123], v28 offset:8704
  ds_read_b128 v[160:163], v28 offset:11264
  ds_read_b128 v[124:127], v28 offset:8720
  ds_read_b128 v[164:167], v28 offset:11280
  ds_read_b128 v[128:131], v28 offset:9216
  ds_read_b128 v[168:171], v28 offset:11776
  ds_read_b128 v[132:135], v28 offset:9232
  ds_read_b128 v[172:175], v28 offset:11792
  ds_read_b128 v[136:139], v28 offset:9728
  ds_read_b128 v[176:179], v28 offset:12288
  ds_read_b128 v[140:143], v28 offset:9744
  ds_read_b128 v[180:183], v28 offset:12304
  ds_read_b128 v[144:147], v28 offset:10240
  ds_read_b128 v[184:187], v28 offset:12800
  ds_read_b128 v[148:151], v28 offset:10256
  ds_read_b128 v[188:191], v28 offset:12816
  v_lshrrev_b32 v6, 2, v3
  v_lshlrev_b32 v6, 10, v6
  v_and_b32 v7, 3, v3
  v_lshl_add_u32 v6, v7, 8, v6
  v_xor_b32 v7, v4, v3
  v_lshl_add_u32 v6, v7, 4, v6
  v_lshrrev_b32 v8, 4, v0
  v_xor_b32 v8, v8, v0
  v_and_b32 v8, 15, v8
  v_and_b32 v9, 0xf0, v0
  v_or_b32 v8, v8, v9
  v_lshlrev_b32 v8, 4, v8
  v_lshlrev_b32 v7, 4, v0
  s_mul_i32 s3, s18, 40960
  s_add_u32 s3, s3, 1048576
  s_waitcnt lgkmcnt(15)
  v_pk_fma_f32 v[32:33], v[32:33], v[152:153], v[112:113]
  v_pk_fma_f32 v[34:35], v[34:35], v[154:155], v[114:115]
  v_pk_fma_f32 v[36:37], v[36:37], v[156:157], v[116:117]
  v_pk_fma_f32 v[38:39], v[38:39], v[158:159], v[118:119]
  v_cvt_pk_bf16_f32 v200, v32, v33
  v_cvt_pk_bf16_f32 v201, v34, v35
  v_cvt_pk_bf16_f32 v202, v36, v37
  v_cvt_pk_bf16_f32 v203, v38, v39
  ds_write_b128 v6, v[200:203] offset:16384
  v_pk_fma_f32 v[72:73], v[72:73], v[152:153], v[112:113]
  v_pk_fma_f32 v[74:75], v[74:75], v[154:155], v[114:115]
  v_pk_fma_f32 v[76:77], v[76:77], v[156:157], v[116:117]
  v_pk_fma_f32 v[78:79], v[78:79], v[158:159], v[118:119]
  v_cvt_pk_bf16_f32 v220, v72, v73
  v_cvt_pk_bf16_f32 v221, v74, v75
  v_cvt_pk_bf16_f32 v222, v76, v77
  v_cvt_pk_bf16_f32 v223, v78, v79
  ds_write_b128 v6, v[220:223] offset:36864
  s_waitcnt lgkmcnt(15)
  v_pk_fma_f32 v[40:41], v[40:41], v[160:161], v[120:121]
  v_pk_fma_f32 v[42:43], v[42:43], v[162:163], v[122:123]
  s_waitcnt lgkmcnt(14)
  v_pk_fma_f32 v[44:45], v[44:45], v[164:165], v[124:125]
  v_pk_fma_f32 v[46:47], v[46:47], v[166:167], v[126:127]
  v_cvt_pk_bf16_f32 v204, v40, v41
  v_cvt_pk_bf16_f32 v205, v42, v43
  v_cvt_pk_bf16_f32 v206, v44, v45
  v_cvt_pk_bf16_f32 v207, v46, v47
  ds_write_b128 v6, v[204:207] offset:20480
  v_pk_fma_f32 v[80:81], v[80:81], v[160:161], v[120:121]
  v_pk_fma_f32 v[82:83], v[82:83], v[162:163], v[122:123]
  v_pk_fma_f32 v[84:85], v[84:85], v[164:165], v[124:125]
  v_pk_fma_f32 v[86:87], v[86:87], v[166:167], v[126:127]
  v_cvt_pk_bf16_f32 v224, v80, v81
  v_cvt_pk_bf16_f32 v225, v82, v83
  v_cvt_pk_bf16_f32 v226, v84, v85
  v_cvt_pk_bf16_f32 v227, v86, v87
  ds_write_b128 v6, v[224:227] offset:40960
  s_waitcnt lgkmcnt(14)
  v_pk_fma_f32 v[48:49], v[48:49], v[168:169], v[128:129]
  v_pk_fma_f32 v[50:51], v[50:51], v[170:171], v[130:131]
  s_waitcnt lgkmcnt(12)
  v_pk_fma_f32 v[52:53], v[52:53], v[172:173], v[132:133]
  v_pk_fma_f32 v[54:55], v[54:55], v[174:175], v[134:135]
  v_cvt_pk_bf16_f32 v208, v48, v49
  v_cvt_pk_bf16_f32 v209, v50, v51
  v_cvt_pk_bf16_f32 v210, v52, v53
  v_cvt_pk_bf16_f32 v211, v54, v55
  ds_write_b128 v6, v[208:211] offset:24576
  v_pk_fma_f32 v[88:89], v[88:89], v[168:169], v[128:129]
  v_pk_fma_f32 v[90:91], v[90:91], v[170:171], v[130:131]
  v_pk_fma_f32 v[92:93], v[92:93], v[172:173], v[132:133]
  v_pk_fma_f32 v[94:95], v[94:95], v[174:175], v[134:135]
  v_cvt_pk_bf16_f32 v228, v88, v89
  v_cvt_pk_bf16_f32 v229, v90, v91
  v_cvt_pk_bf16_f32 v230, v92, v93
  v_cvt_pk_bf16_f32 v231, v94, v95
  ds_write_b128 v6, v[228:231] offset:45056
  s_waitcnt lgkmcnt(12)
  v_pk_fma_f32 v[56:57], v[56:57], v[176:177], v[136:137]
  v_pk_fma_f32 v[58:59], v[58:59], v[178:179], v[138:139]
  s_waitcnt lgkmcnt(10)
  v_pk_fma_f32 v[60:61], v[60:61], v[180:181], v[140:141]
  v_pk_fma_f32 v[62:63], v[62:63], v[182:183], v[142:143]
  v_cvt_pk_bf16_f32 v212, v56, v57
  v_cvt_pk_bf16_f32 v213, v58, v59
  v_cvt_pk_bf16_f32 v214, v60, v61
  v_cvt_pk_bf16_f32 v215, v62, v63
  ds_write_b128 v6, v[212:215] offset:28672
  v_pk_fma_f32 v[96:97], v[96:97], v[176:177], v[136:137]
  v_pk_fma_f32 v[98:99], v[98:99], v[178:179], v[138:139]
  v_pk_fma_f32 v[100:101], v[100:101], v[180:181], v[140:141]
  v_pk_fma_f32 v[102:103], v[102:103], v[182:183], v[142:143]
  v_cvt_pk_bf16_f32 v232, v96, v97
  v_cvt_pk_bf16_f32 v233, v98, v99
  v_cvt_pk_bf16_f32 v234, v100, v101
  v_cvt_pk_bf16_f32 v235, v102, v103
  ds_write_b128 v6, v[232:235] offset:49152
  s_waitcnt lgkmcnt(10)
  v_pk_fma_f32 v[64:65], v[64:65], v[184:185], v[144:145]
  v_pk_fma_f32 v[66:67], v[66:67], v[186:187], v[146:147]
  s_waitcnt lgkmcnt(8)
  v_pk_fma_f32 v[68:69], v[68:69], v[188:189], v[148:149]
  v_pk_fma_f32 v[70:71], v[70:71], v[190:191], v[150:151]
  v_cvt_pk_bf16_f32 v216, v64, v65
  v_cvt_pk_bf16_f32 v217, v66, v67
  v_cvt_pk_bf16_f32 v218, v68, v69
  v_cvt_pk_bf16_f32 v219, v70, v71
  ds_write_b128 v6, v[216:219] offset:32768
  v_pk_fma_f32 v[104:105], v[104:105], v[184:185], v[144:145]
  v_pk_fma_f32 v[106:107], v[106:107], v[186:187], v[146:147]
  v_pk_fma_f32 v[108:109], v[108:109], v[188:189], v[148:149]
  v_pk_fma_f32 v[110:111], v[110:111], v[190:191], v[150:151]
  v_cvt_pk_bf16_f32 v236, v104, v105
  v_cvt_pk_bf16_f32 v237, v106, v107
  v_cvt_pk_bf16_f32 v238, v108, v109
  v_cvt_pk_bf16_f32 v239, v110, v111
  ds_write_b128 v6, v[236:239] offset:53248
  s_waitcnt lgkmcnt(0)
  s_barrier
  ds_read_b128 v[32:35], v8 offset:16384
  ds_read_b128 v[36:39], v8 offset:20480
  ds_read_b128 v[40:43], v8 offset:24576
  ds_read_b128 v[44:47], v8 offset:28672
  ds_read_b128 v[48:51], v8 offset:32768
  ds_read_b128 v[52:55], v8 offset:36864
  ds_read_b128 v[56:59], v8 offset:40960
  ds_read_b128 v[60:63], v8 offset:45056
  ds_read_b128 v[64:67], v8 offset:49152
  ds_read_b128 v[68:71], v8 offset:53248
  s_add_u32 s24, s3, 0
  s_waitcnt lgkmcnt(9)
  buffer_store_dwordx4 v[32:35], v7, s[4:7], s24 offen sc1
  s_add_u32 s24, s3, 4096
  s_waitcnt lgkmcnt(8)
  buffer_store_dwordx4 v[36:39], v7, s[4:7], s24 offen sc1
  s_add_u32 s24, s3, 8192
  s_waitcnt lgkmcnt(7)
  buffer_store_dwordx4 v[40:43], v7, s[4:7], s24 offen sc1
  s_add_u32 s24, s3, 12288
  s_waitcnt lgkmcnt(6)
  buffer_store_dwordx4 v[44:47], v7, s[4:7], s24 offen sc1
  s_add_u32 s24, s3, 16384
  s_waitcnt lgkmcnt(5)
  buffer_store_dwordx4 v[48:51], v7, s[4:7], s24 offen sc1
  s_add_u32 s24, s3, 20480
  s_waitcnt lgkmcnt(4)
  buffer_store_dwordx4 v[52:55], v7, s[4:7], s24 offen sc1
  s_add_u32 s24, s3, 24576
  s_waitcnt lgkmcnt(3)
  buffer_store_dwordx4 v[56:59], v7, s[4:7], s24 offen sc1
  s_add_u32 s24, s3, 28672
  s_waitcnt lgkmcnt(2)
  buffer_store_dwordx4 v[60:63], v7, s[4:7], s24 offen sc1
  s_add_u32 s24, s3, 32768
  s_waitcnt lgkmcnt(1)
  buffer_store_dwordx4 v[64:67], v7, s[4:7], s24 offen sc1
  s_add_u32 s24, s3, 36864
  s_waitcnt lgkmcnt(0)
  buffer_store_dwordx4 v[68:71], v7, s[4:7], s24 offen sc1
  s_cmp_lt_u32 s18, 61
  s_cbranch_scc1 L_H_fin
  v_mov_b32 v6, 0
  ds_read_b128 v[8:11], v6
  ds_read_b128 v[12:15], v6 offset:16
  s_waitcnt lgkmcnt(0)
  v_min3_u32 v8, v8, v10, v12
  v_min3_u32 v9, v9, v11, v13
  v_min_u32 v8, v8, v14
  v_min_u32 v9, v9, v15
  v_readfirstlane_b32 s40, v8
  v_readfirstlane_b32 s41, v9
  s_nop 0
  s_cmp_lt_u32 s40, s41
  s_cselect_b32 s43, 1, 257
L_H_fin:
  v_mov_b32 v31, s43
  s_waitcnt vmcnt(0)
  s_barrier
  s_cmp_lg_u32 s17, 0
  s_cbranch_scc1 L_H_done
  s_mov_b64 exec, 1
  buffer_atomic_add v31, off, s[96:99], 0 offset:96 sc0
  s_waitcnt vmcnt(0)
  v_add_u32 v31, s43, v31
  v_and_b32 v30, 255, v31
  v_cmp_eq_u32 vcc, 64, v30
  s_cbranch_vccz L_H_notlast
  buffer_store_dword v31, off, s[96:99], 0 offset:128 sc1
L_H_notlast:
  s_mov_b64 exec, -1
L_H_done:
  v_mov_b32 v30, 163824
  s_cmp_lg_u32 s17, 0
  s_cbranch_scc1 L_H_wh_b
  s_branch L_H_wh_in
L_H_wh:
  s_sleep 3
L_H_wh_in:
  buffer_load_dword v28, off, s[96:99], 0 offset:128 sc1
  buffer_load_dword v29, off, s[96:99], s94 sc1
  s_add_u32 s39, s39, 1
  s_cmp_gt_u32 s39, 200000
  s_cbranch_scc1 L_exit
  s_waitcnt vmcnt(0)
L_H_wh_t:
  v_readfirstlane_b32 s19, v28
  v_readfirstlane_b32 s74, v29
  s_nop 0
  s_and_b32 s22, s19, 255
  s_cmp_lt_u32 s22, 64
  s_cbranch_scc1 L_H_wh
  s_and_b32 s22, s74, 255
  s_cmp_lt_u32 s22, 26
  s_cbranch_scc1 L_H_wh
  ds_write_b64 v30, v[28:29]
  s_waitcnt lgkmcnt(0)
L_H_wh_b:
  s_barrier
  ds_read_b64 v[28:29], v30
  s_waitcnt lgkmcnt(0)
  v_readfirstlane_b32 s19, v28
  v_readfirstlane_b32 s74, v29
  s_nop 0
  s_and_b32 s19, s19, 512
  s_lshl_b32 s19, s19, 4
  s_mul_i32 s22, s95, 26
  s_sub_u32 s74, s74, s22
  s_cmp_lt_u32 s18, 40
  s_cbranch_scc1 L_H_r
  s_sub_u32 s36, s18, 40
  s_cmp_ge_u32 s36, 20
  s_cbranch_scc1 L_M_done
  s_add_u32 s36, s36, 20
  s_mov_b32 s37, 0
L_M_loop:
  s_lshl_b32 s3, s36, 7
  v_lshrrev_b32 v6, 3, v0
  v_add_u32 v6, s37, v6
  v_and_b32 v7, 7, v0
  v_mul_u32_u24 v28, 7680, v6
  v_lshl_add_u32 v28, v7, 4, v28
  v_lshlrev_b32 v29, 1, v6
  s_add_u32 s24, s3, 0
  buffer_load_dwordx4 v[32:35], v28, s[48:51], s24 offen
  s_add_u32 s24, s3, 245760
  buffer_load_dwordx4 v[36:39], v28, s[48:51], s24 offen
  s_add_u32 s24, s3, 491520
  buffer_load_dwordx4 v[40:43], v28, s[48:51], s24 offen
  s_add_u32 s24, s3, 737280
  buffer_load_dwordx4 v[44:47], v28, s[48:51], s24 offen
  s_add_u32 s24, s3, 983040
  buffer_load_dwordx4 v[48:51], v28, s[48:51], s24 offen
  s_add_u32 s24, s3, 1228800
  buffer_load_dwordx4 v[52:55], v28, s[48:51], s24 offen
  s_add_u32 s24, s3, 1474560
  buffer_load_dwordx4 v[56:59], v28, s[48:51], s24 offen
  s_add_u32 s24, s3, 1720320
  buffer_load_dwordx4 v[60:63], v28, s[48:51], s24 offen
  s_add_u32 s24, s3, 1966080
  buffer_load_dwordx4 v[64:67], v28, s[48:51], s24 offen
  s_add_u32 s24, s3, 2211840
  buffer_load_dwordx4 v[68:71], v28, s[48:51], s24 offen
  s_add_u32 s24, s3, 2457600
  buffer_load_dwordx4 v[72:75], v28, s[48:51], s24 offen
  s_add_u32 s24, s3, 2703360
  buffer_load_dwordx4 v[76:79], v28, s[48:51], s24 offen
  s_add_u32 s24, s3, 2949120
  buffer_load_dwordx4 v[80:83], v28, s[48:51], s24 offen
  s_add_u32 s24, s3, 3194880
  buffer_load_dwordx4 v[84:87], v28, s[48:51], s24 offen
  s_add_u32 s24, s3, 3440640
  buffer_load_dwordx4 v[88:91], v28, s[48:51], s24 offen
  s_add_u32 s24, s3, 3686400
  buffer_load_dwordx4 v[92:95], v28, s[48:51], s24 offen
  s_add_u32 s24, s3, 3932160
  buffer_load_dwordx4 v[96:99], v28, s[48:51], s24 offen
  s_add_u32 s24, s3, 4177920
  buffer_load_dwordx4 v[100:103], v28, s[48:51], s24 offen
  s_add_u32 s24, s3, 4423680
  buffer_load_dwordx4 v[104:107], v28, s[48:51], s24 offen
  s_add_u32 s24, s3, 4669440
  buffer_load_dwordx4 v[108:111], v28, s[48:51], s24 offen
  buffer_load_ushort v8, v29, s[44:47], 0 offen offset:0
  buffer_load_ushort v9, v29, s[44:47], 0 offen offset:64
  buffer_load_ushort v10, v29, s[44:47], 0 offen offset:128
  buffer_load_ushort v11, v29, s[44:47], 0 offen offset:192
  buffer_load_ushort v12, v29, s[44:47], 0 offen offset:256
  buffer_load_ushort v13, v29, s[44:47], 0 offen offset:320
  buffer_load_ushort v14, v29, s[44:47], 0 offen offset:384
  buffer_load_ushort v15, v29, s[44:47], 0 offen offset:448
  buffer_load_ushort v16, v29, s[44:47], 0 offen offset:512
  buffer_load_ushort v17, v29, s[44:47], 0 offen offset:576
  buffer_load_ushort v18, v29, s[44:47], 0 offen offset:640
  buffer_load_ushort v19, v29, s[44:47], 0 offen offset:704
  buffer_load_ushort v20, v29, s[44:47], 0 offen offset:768
  buffer_load_ushort v21, v29, s[44:47], 0 offen offset:832
  buffer_load_ushort v22, v29, s[44:47], 0 offen offset:896
  buffer_load_ushort v23, v29, s[44:47], 0 offen offset:960
  buffer_load_ushort v24, v29, s[44:47], 0 offen offset:1024
  buffer_load_ushort v25, v29, s[44:47], 0 offen offset:1088
  buffer_load_ushort v26, v29, s[44:47], 0 offen offset:1152
  buffer_load_ushort v27, v29, s[44:47], 0 offen offset:1216
  s_waitcnt vmcnt(19)
  v_lshlrev_b32 v8, 16, v8
  v_mul_f32 v30, 0xbfb8aa3b, v8
  v_exp_f32 v30, v30
  s_nop 0
  v_add_f32 v30, 1.0, v30
  v_rcp_f32 v30, v30
  s_nop 0
  v_mul_f32 v8, v8, v30
  v_cvt_pk_bf16_f32 v30, v8, v8
  v_lshlrev_b32 v8, 16, v30
  s_waitcnt vmcnt(18)
  v_lshlrev_b32 v9, 16, v9
  v_mul_f32 v30, 0xbfb8aa3b, v9
  v_exp_f32 v30, v30
  s_nop 0
  v_add_f32 v30, 1.0, v30
  v_rcp_f32 v30, v30
  s_nop 0
  v_mul_f32 v9, v9, v30
  v_cvt_pk_bf16_f32 v30, v9, v9
  v_lshlrev_b32 v9, 16, v30
  s_waitcnt vmcnt(17)
  v_lshlrev_b32 v10, 16, v10
  v_mul_f32 v30, 0xbfb8aa3b, v10
  v_exp_f32 v30, v30
  s_nop 0
  v_add_f32 v30, 1.0, v30
  v_rcp_f32 v30, v30
  s_nop 0
  v_mul_f32 v10, v10, v30
  v_cvt_pk_bf16_f32 v30, v10, v10
  v_lshlrev_b32 v10, 16, v30
  s_waitcnt vmcnt(16)
  v_lshlrev_b32 v11, 16, v11
  v_mul_f32 v30, 0xbfb8aa3b, v11
  v_exp_f32 v30, v30
  s_nop 0
  v_add_f32 v30, 1.0, v30
  v_rcp_f32 v30, v30
  s_nop 0
  v_mul_f32 v11, v11, v30
  v_cvt_pk_bf16_f32 v30, v11, v11
  v_lshlrev_b32 v11, 16, v30
  s_waitcnt vmcnt(15)
  v_lshlrev_b32 v12, 16, v12
  v_mul_f32 v30, 0xbfb8aa3b, v12
  v_exp_f32 v30, v30
  s_nop 0
  v_add_f32 v30, 1.0, v30
  v_rcp_f32 v30, v30
  s_nop 0
  v_mul_f32 v12, v12, v30
  v_cvt_pk_bf16_f32 v30, v12, v12
  v_lshlrev_b32 v12, 16, v30
  s_waitcnt vmcnt(14)
  v_lshlrev_b32 v13, 16, v13
  v_mul_f32 v30, 0xbfb8aa3b, v13
  v_exp_f32 v30, v30
  s_nop 0
  v_add_f32 v30, 1.0, v30
  v_rcp_f32 v30, v30
  s_nop 0
  v_mul_f32 v13, v13, v30
  v_cvt_pk_bf16_f32 v30, v13, v13
  v_lshlrev_b32 v13, 16, v30
  s_waitcnt vmcnt(13)
  v_lshlrev_b32 v14, 16, v14
  v_mul_f32 v30, 0xbfb8aa3b, v14
  v_exp_f32 v30, v30
  s_nop 0
  v_add_f32 v30, 1.0, v30
  v_rcp_f32 v30, v30
  s_nop 0
  v_mul_f32 v14, v14, v30
  v_cvt_pk_bf16_f32 v30, v14, v14
  v_lshlrev_b32 v14, 16, v30
  s_waitcnt vmcnt(12)
  v_lshlrev_b32 v15, 16, v15
  v_mul_f32 v30, 0xbfb8aa3b, v15
  v_exp_f32 v30, v30
  s_nop 0
  v_add_f32 v30, 1.0, v30
  v_rcp_f32 v30, v30
  s_nop 0
  v_mul_f32 v15, v15, v30
  v_cvt_pk_bf16_f32 v30, v15, v15
  v_lshlrev_b32 v15, 16, v30
  s_waitcnt vmcnt(11)
  v_lshlrev_b32 v16, 16, v16
  v_mul_f32 v30, 0xbfb8aa3b, v16
  v_exp_f32 v30, v30
  s_nop 0
  v_add_f32 v30, 1.0, v30
  v_rcp_f32 v30, v30
  s_nop 0
  v_mul_f32 v16, v16, v30
  v_cvt_pk_bf16_f32 v30, v16, v16
  v_lshlrev_b32 v16, 16, v30
  s_waitcnt vmcnt(10)
  v_lshlrev_b32 v17, 16, v17
  v_mul_f32 v30, 0xbfb8aa3b, v17
  v_exp_f32 v30, v30
  s_nop 0
  v_add_f32 v30, 1.0, v30
  v_rcp_f32 v30, v30
  s_nop 0
  v_mul_f32 v17, v17, v30
  v_cvt_pk_bf16_f32 v30, v17, v17
  v_lshlrev_b32 v17, 16, v30
  s_waitcnt vmcnt(9)
  v_lshlrev_b32 v18, 16, v18
  v_mul_f32 v30, 0xbfb8aa3b, v18
  v_exp_f32 v30, v30
  s_nop 0
  v_add_f32 v30, 1.0, v30
  v_rcp_f32 v30, v30
  s_nop 0
  v_mul_f32 v18, v18, v30
  v_cvt_pk_bf16_f32 v30, v18, v18
  v_lshlrev_b32 v18, 16, v30
  s_waitcnt vmcnt(8)
  v_lshlrev_b32 v19, 16, v19
  v_mul_f32 v30, 0xbfb8aa3b, v19
  v_exp_f32 v30, v30
  s_nop 0
  v_add_f32 v30, 1.0, v30
  v_rcp_f32 v30, v30
  s_nop 0
  v_mul_f32 v19, v19, v30
  v_cvt_pk_bf16_f32 v30, v19, v19
  v_lshlrev_b32 v19, 16, v30
  s_waitcnt vmcnt(7)
  v_lshlrev_b32 v20, 16, v20
  v_mul_f32 v30, 0xbfb8aa3b, v20
  v_exp_f32 v30, v30
  s_nop 0
  v_add_f32 v30, 1.0, v30
  v_rcp_f32 v30, v30
  s_nop 0
  v_mul_f32 v20, v20, v30
  v_cvt_pk_bf16_f32 v30, v20, v20
  v_lshlrev_b32 v20, 16, v30
  s_waitcnt vmcnt(6)
  v_lshlrev_b32 v21, 16, v21
  v_mul_f32 v30, 0xbfb8aa3b, v21
  v_exp_f32 v30, v30
  s_nop 0
  v_add_f32 v30, 1.0, v30
  v_rcp_f32 v30, v30
  s_nop 0
  v_mul_f32 v21, v21, v30
  v_cvt_pk_bf16_f32 v30, v21, v21
  v_lshlrev_b32 v21, 16, v30
  s_waitcnt vmcnt(5)
  v_lshlrev_b32 v22, 16, v22
  v_mul_f32 v30, 0xbfb8aa3b, v22
  v_exp_f32 v30, v30
  s_nop 0
  v_add_f32 v30, 1.0, v30
  v_rcp_f32 v30, v30
  s_nop 0
  v_mul_f32 v22, v22, v30
  v_cvt_pk_bf16_f32 v30, v22, v22
  v_lshlrev_b32 v22, 16, v30
  s_waitcnt vmcnt(4)
  v_lshlrev_b32 v23, 16, v23
  v_mul_f32 v30, 0xbfb8aa3b, v23
  v_exp_f32 v30, v30
  s_nop 0
  v_add_f32 v30, 1.0, v30
  v_rcp_f32 v30, v30
  s_nop 0
  v_mul_f32 v23, v23, v30
  v_cvt_pk_bf16_f32 v30, v23, v23
  v_lshlrev_b32 v23, 16, v30
  s_waitcnt vmcnt(3)
  v_lshlrev_b32 v24, 16, v24
  v_mul_f32 v30, 0xbfb8aa3b, v24
  v_exp_f32 v30, v30
  s_nop 0
  v_add_f32 v30, 1.0, v30
  v_rcp_f32 v30, v30
  s_nop 0
  v_mul_f32 v24, v24, v30
  v_cvt_pk_bf16_f32 v30, v24, v24
  v_lshlrev_b32 v24, 16, v30
  s_waitcnt vmcnt(2)
  v_lshlrev_b32 v25, 16, v25
  v_mul_f32 v30, 0xbfb8aa3b, v25
  v_exp_f32 v30, v30
  s_nop 0
  v_add_f32 v30, 1.0, v30
  v_rcp_f32 v30, v30
  s_nop 0
  v_mul_f32 v25, v25, v30
  v_cvt_pk_bf16_f32 v30, v25, v25
  v_lshlrev_b32 v25, 16, v30
  s_waitcnt vmcnt(1)
  v_lshlrev_b32 v26, 16, v26
  v_mul_f32 v30, 0xbfb8aa3b, v26
  v_exp_f32 v30, v30
  s_nop 0
  v_add_f32 v30, 1.0, v30
  v_rcp_f32 v30, v30
  s_nop 0
  v_mul_f32 v26, v26, v30
  v_cvt_pk_bf16_f32 v30, v26, v26
  v_lshlrev_b32 v26, 16, v30
  s_waitcnt vmcnt(0)
  v_lshlrev_b32 v27, 16, v27
  v_mul_f32 v30, 0xbfb8aa3b, v27
  v_exp_f32 v30, v30
  s_nop 0
  v_add_f32 v30, 1.0, v30
  v_rcp_f32 v30, v30
  s_nop 0
  v_mul_f32 v27, v27, v30
  v_cvt_pk_bf16_f32 v30, v27, v27
  v_lshlrev_b32 v27, 16, v30
  v_mov_b32 v112, 0
  v_mov_b32 v113, 0
  v_mov_b32 v114, 0
  v_mov_b32 v115, 0
  v_mov_b32 v116, 0
  v_mov_b32 v117, 0
  v_mov_b32 v118, 0
  v_mov_b32 v119, 0
  v_lshlrev_b32 v30, 16, v32
  v_and_b32 v31, 0xffff0000, v32
  v_fmac_f32 v112, v30, v8
  v_fmac_f32 v113, v31, v8
  v_lshlrev_b32 v30, 16, v33
  v_and_b32 v31, 0xffff0000, v33
  v_fmac_f32 v114, v30, v8
  v_fmac_f32 v115, v31, v8
  v_lshlrev_b32 v30, 16, v34
  v_and_b32 v31, 0xffff0000, v34
  v_fmac_f32 v116, v30, v8
  v_fmac_f32 v117, v31, v8
  v_lshlrev_b32 v30, 16, v35
  v_and_b32 v31, 0xffff0000, v35
  v_fmac_f32 v118, v30, v8
  v_fmac_f32 v119, v31, v8
  v_lshlrev_b32 v30, 16, v36
  v_and_b32 v31, 0xffff0000, v36
  v_fmac_f32 v112, v30, v9
  v_fmac_f32 v113, v31, v9
  v_lshlrev_b32 v30, 16, v37
  v_and_b32 v31, 0xffff0000, v37
  v_fmac_f32 v114, v30, v9
  v_fmac_f32 v115, v31, v9
  v_lshlrev_b32 v30, 16, v38
  v_and_b32 v31, 0xffff0000, v38
  v_fmac_f32 v116, v30, v9
  v_fmac_f32 v117, v31, v9
  v_lshlrev_b32 v30, 16, v39
  v_and_b32 v31, 0xffff0000, v39
  v_fmac_f32 v118, v30, v9
  v_fmac_f32 v119, v31, v9
  v_lshlrev_b32 v30, 16, v40
  v_and_b32 v31, 0xffff0000, v40
  v_fmac_f32 v112, v30, v10
  v_fmac_f32 v113, v31, v10
  v_lshlrev_b32 v30, 16, v41
  v_and_b32 v31, 0xffff0000, v41
  v_fmac_f32 v114, v30, v10
  v_fmac_f32 v115, v31, v10
  v_lshlrev_b32 v30, 16, v42
  v_and_b32 v31, 0xffff0000, v42
  v_fmac_f32 v116, v30, v10
  v_fmac_f32 v117, v31, v10
  v_lshlrev_b32 v30, 16, v43
  v_and_b32 v31, 0xffff0000, v43
  v_fmac_f32 v118, v30, v10
  v_fmac_f32 v119, v31, v10
  v_lshlrev_b32 v30, 16, v44
  v_and_b32 v31, 0xffff0000, v44
  v_fmac_f32 v112, v30, v11
  v_fmac_f32 v113, v31, v11
  v_lshlrev_b32 v30, 16, v45
  v_and_b32 v31, 0xffff0000, v45
  v_fmac_f32 v114, v30, v11
  v_fmac_f32 v115, v31, v11
  v_lshlrev_b32 v30, 16, v46
  v_and_b32 v31, 0xffff0000, v46
  v_fmac_f32 v116, v30, v11
  v_fmac_f32 v117, v31, v11
  v_lshlrev_b32 v30, 16, v47
  v_and_b32 v31, 0xffff0000, v47
  v_fmac_f32 v118, v30, v11
  v_fmac_f32 v119, v31, v11
  v_lshlrev_b32 v30, 16, v48
  v_and_b32 v31, 0xffff0000, v48
  v_fmac_f32 v112, v30, v12
  v_fmac_f32 v113, v31, v12
  v_lshlrev_b32 v30, 16, v49
  v_and_b32 v31, 0xffff0000, v49
  v_fmac_f32 v114, v30, v12
  v_fmac_f32 v115, v31, v12
  v_lshlrev_b32 v30, 16, v50
  v_and_b32 v31, 0xffff0000, v50
  v_fmac_f32 v116, v30, v12
  v_fmac_f32 v117, v31, v12
  v_lshlrev_b32 v30, 16, v51
  v_and_b32 v31, 0xffff0000, v51
  v_fmac_f32 v118, v30, v12
  v_fmac_f32 v119, v31, v12
  v_lshlrev_b32 v30, 16, v52
  v_and_b32 v31, 0xffff0000, v52
  v_fmac_f32 v112, v30, v13
  v_fmac_f32 v113, v31, v13
  v_lshlrev_b32 v30, 16, v53
  v_and_b32 v31, 0xffff0000, v53
  v_fmac_f32 v114, v30, v13
  v_fmac_f32 v115, v31, v13
  v_lshlrev_b32 v30, 16, v54
  v_and_b32 v31, 0xffff0000, v54
  v_fmac_f32 v116, v30, v13
  v_fmac_f32 v117, v31, v13
  v_lshlrev_b32 v30, 16, v55
  v_and_b32 v31, 0xffff0000, v55
  v_fmac_f32 v118, v30, v13
  v_fmac_f32 v119, v31, v13
  v_lshlrev_b32 v30, 16, v56
  v_and_b32 v31, 0xffff0000, v56
  v_fmac_f32 v112, v30, v14
  v_fmac_f32 v113, v31, v14
  v_lshlrev_b32 v30, 16, v57
  v_and_b32 v31, 0xffff0000, v57
  v_fmac_f32 v114, v30, v14
  v_fmac_f32 v115, v31, v14
  v_lshlrev_b32 v30, 16, v58
  v_and_b32 v31, 0xffff0000, v58
  v_fmac_f32 v116, v30, v14
  v_fmac_f32 v117, v31, v14
  v_lshlrev_b32 v30, 16, v59
  v_and_b32 v31, 0xffff0000, v59
  v_fmac_f32 v118, v30, v14
  v_fmac_f32 v119, v31, v14
  v_lshlrev_b32 v30, 16, v60
  v_and_b32 v31, 0xffff0000, v60
  v_fmac_f32 v112, v30, v15
  v_fmac_f32 v113, v31, v15
  v_lshlrev_b32 v30, 16, v61
  v_and_b32 v31, 0xffff0000, v61
  v_fmac_f32 v114, v30, v15
  v_fmac_f32 v115, v31, v15
  v_lshlrev_b32 v30, 16, v62
  v_and_b32 v31, 0xffff0000, v62
  v_fmac_f32 v116, v30, v15
  v_fmac_f32 v117, v31, v15
  v_lshlrev_b32 v30, 16, v63
  v_and_b32 v31, 0xffff0000, v63
  v_fmac_f32 v118, v30, v15
  v_fmac_f32 v119, v31, v15
  v_lshlrev_b32 v30, 16, v64
  v_and_b32 v31, 0xffff0000, v64
  v_fmac_f32 v112, v30, v16
  v_fmac_f32 v113, v31, v16
  v_lshlrev_b32 v30, 16, v65
  v_and_b32 v31, 0xffff0000, v65
  v_fmac_f32 v114, v30, v16
  v_fmac_f32 v115, v31, v16
  v_lshlrev_b32 v30, 16, v66
  v_and_b32 v31, 0xffff0000, v66
  v_fmac_f32 v116, v30, v16
  v_fmac_f32 v117, v31, v16
  v_lshlrev_b32 v30, 16, v67
  v_and_b32 v31, 0xffff0000, v67
  v_fmac_f32 v118, v30, v16
  v_fmac_f32 v119, v31, v16
  v_lshlrev_b32 v30, 16, v68
  v_and_b32 v31, 0xffff0000, v68
  v_fmac_f32 v112, v30, v17
  v_fmac_f32 v113, v31, v17
  v_lshlrev_b32 v30, 16, v69
  v_and_b32 v31, 0xffff0000, v69
  v_fmac_f32 v114, v30, v17
  v_fmac_f32 v115, v31, v17
  v_lshlrev_b32 v30, 16, v70
  v_and_b32 v31, 0xffff0000, v70
  v_fmac_f32 v116, v30, v17
  v_fmac_f32 v117, v31, v17
  v_lshlrev_b32 v30, 16, v71
  v_and_b32 v31, 0xffff0000, v71
  v_fmac_f32 v118, v30, v17
  v_fmac_f32 v119, v31, v17
  v_lshlrev_b32 v30, 16, v72
  v_and_b32 v31, 0xffff0000, v72
  v_fmac_f32 v112, v30, v18
  v_fmac_f32 v113, v31, v18
  v_lshlrev_b32 v30, 16, v73
  v_and_b32 v31, 0xffff0000, v73
  v_fmac_f32 v114, v30, v18
  v_fmac_f32 v115, v31, v18
  v_lshlrev_b32 v30, 16, v74
  v_and_b32 v31, 0xffff0000, v74
  v_fmac_f32 v116, v30, v18
  v_fmac_f32 v117, v31, v18
  v_lshlrev_b32 v30, 16, v75
  v_and_b32 v31, 0xffff0000, v75
  v_fmac_f32 v118, v30, v18
  v_fmac_f32 v119, v31, v18
  v_lshlrev_b32 v30, 16, v76
  v_and_b32 v31, 0xffff0000, v76
  v_fmac_f32 v112, v30, v19
  v_fmac_f32 v113, v31, v19
  v_lshlrev_b32 v30, 16, v77
  v_and_b32 v31, 0xffff0000, v77
  v_fmac_f32 v114, v30, v19
  v_fmac_f32 v115, v31, v19
  v_lshlrev_b32 v30, 16, v78
  v_and_b32 v31, 0xffff0000, v78
  v_fmac_f32 v116, v30, v19
  v_fmac_f32 v117, v31, v19
  v_lshlrev_b32 v30, 16, v79
  v_and_b32 v31, 0xffff0000, v79
  v_fmac_f32 v118, v30, v19
  v_fmac_f32 v119, v31, v19
  v_lshlrev_b32 v30, 16, v80
  v_and_b32 v31, 0xffff0000, v80
  v_fmac_f32 v112, v30, v20
  v_fmac_f32 v113, v31, v20
  v_lshlrev_b32 v30, 16, v81
  v_and_b32 v31, 0xffff0000, v81
  v_fmac_f32 v114, v30, v20
  v_fmac_f32 v115, v31, v20
  v_lshlrev_b32 v30, 16, v82
  v_and_b32 v31, 0xffff0000, v82
  v_fmac_f32 v116, v30, v20
  v_fmac_f32 v117, v31, v20
  v_lshlrev_b32 v30, 16, v83
  v_and_b32 v31, 0xffff0000, v83
  v_fmac_f32 v118, v30, v20
  v_fmac_f32 v119, v31, v20
  v_lshlrev_b32 v30, 16, v84
  v_and_b32 v31, 0xffff0000, v84
  v_fmac_f32 v112, v30, v21
  v_fmac_f32 v113, v31, v21
  v_lshlrev_b32 v30, 16, v85
  v_and_b32 v31, 0xffff0000, v85
  v_fmac_f32 v114, v30, v21
  v_fmac_f32 v115, v31, v21
  v_lshlrev_b32 v30, 16, v86
  v_and_b32 v31, 0xffff0000, v86
  v_fmac_f32 v116, v30, v21
  v_fmac_f32 v117, v31, v21
  v_lshlrev_b32 v30, 16, v87
  v_and_b32 v31, 0xffff0000, v87
  v_fmac_f32 v118, v30, v21
  v_fmac_f32 v119, v31, v21
  v_lshlrev_b32 v30, 16, v88
  v_and_b32 v31, 0xffff0000, v88
  v_fmac_f32 v112, v30, v22
  v_fmac_f32 v113, v31, v22
  v_lshlrev_b32 v30, 16, v89
  v_and_b32 v31, 0xffff0000, v89
  v_fmac_f32 v114, v30, v22
  v_fmac_f32 v115, v31, v22
  v_lshlrev_b32 v30, 16, v90
  v_and_b32 v31, 0xffff0000, v90
  v_fmac_f32 v116, v30, v22
  v_fmac_f32 v117, v31, v22
  v_lshlrev_b32 v30, 16, v91
  v_and_b32 v31, 0xffff0000, v91
  v_fmac_f32 v118, v30, v22
  v_fmac_f32 v119, v31, v22
  v_lshlrev_b32 v30, 16, v92
  v_and_b32 v31, 0xffff0000, v92
  v_fmac_f32 v112, v30, v23
  v_fmac_f32 v113, v31, v23
  v_lshlrev_b32 v30, 16, v93
  v_and_b32 v31, 0xffff0000, v93
  v_fmac_f32 v114, v30, v23
  v_fmac_f32 v115, v31, v23
  v_lshlrev_b32 v30, 16, v94
  v_and_b32 v31, 0xffff0000, v94
  v_fmac_f32 v116, v30, v23
  v_fmac_f32 v117, v31, v23
  v_lshlrev_b32 v30, 16, v95
  v_and_b32 v31, 0xffff0000, v95
  v_fmac_f32 v118, v30, v23
  v_fmac_f32 v119, v31, v23
  v_lshlrev_b32 v30, 16, v96
  v_and_b32 v31, 0xffff0000, v96
  v_fmac_f32 v112, v30, v24
  v_fmac_f32 v113, v31, v24
  v_lshlrev_b32 v30, 16, v97
  v_and_b32 v31, 0xffff0000, v97
  v_fmac_f32 v114, v30, v24
  v_fmac_f32 v115, v31, v24
  v_lshlrev_b32 v30, 16, v98
  v_and_b32 v31, 0xffff0000, v98
  v_fmac_f32 v116, v30, v24
  v_fmac_f32 v117, v31, v24
  v_lshlrev_b32 v30, 16, v99
  v_and_b32 v31, 0xffff0000, v99
  v_fmac_f32 v118, v30, v24
  v_fmac_f32 v119, v31, v24
  v_lshlrev_b32 v30, 16, v100
  v_and_b32 v31, 0xffff0000, v100
  v_fmac_f32 v112, v30, v25
  v_fmac_f32 v113, v31, v25
  v_lshlrev_b32 v30, 16, v101
  v_and_b32 v31, 0xffff0000, v101
  v_fmac_f32 v114, v30, v25
  v_fmac_f32 v115, v31, v25
  v_lshlrev_b32 v30, 16, v102
  v_and_b32 v31, 0xffff0000, v102
  v_fmac_f32 v116, v30, v25
  v_fmac_f32 v117, v31, v25
  v_lshlrev_b32 v30, 16, v103
  v_and_b32 v31, 0xffff0000, v103
  v_fmac_f32 v118, v30, v25
  v_fmac_f32 v119, v31, v25
  v_lshlrev_b32 v30, 16, v104
  v_and_b32 v31, 0xffff0000, v104
  v_fmac_f32 v112, v30, v26
  v_fmac_f32 v113, v31, v26
  v_lshlrev_b32 v30, 16, v105
  v_and_b32 v31, 0xffff0000, v105
  v_fmac_f32 v114, v30, v26
  v_fmac_f32 v115, v31, v26
  v_lshlrev_b32 v30, 16, v106
  v_and_b32 v31, 0xffff0000, v106
  v_fmac_f32 v116, v30, v26
  v_fmac_f32 v117, v31, v26
  v_lshlrev_b32 v30, 16, v107
  v_and_b32 v31, 0xffff0000, v107
  v_fmac_f32 v118, v30, v26
  v_fmac_f32 v119, v31, v26
  v_lshlrev_b32 v30, 16, v108
  v_and_b32 v31, 0xffff0000, v108
  v_fmac_f32 v112, v30, v27
  v_fmac_f32 v113, v31, v27
  v_lshlrev_b32 v30, 16, v109
  v_and_b32 v31, 0xffff0000, v109
  v_fmac_f32 v114, v30, v27
  v_fmac_f32 v115, v31, v27
  v_lshlrev_b32 v30, 16, v110
  v_and_b32 v31, 0xffff0000, v110
  v_fmac_f32 v116, v30, v27
  v_fmac_f32 v117, v31, v27
  v_lshlrev_b32 v30, 16, v111
  v_and_b32 v31, 0xffff0000, v111
  v_fmac_f32 v118, v30, v27
  v_fmac_f32 v119, v31, v27
  v_lshlrev_b32 v30, 5, v0
  ds_write_b128 v30, v[112:115]
  ds_write_b128 v30, v[116:119] offset:16
  s_waitcnt lgkmcnt(0)
  s_barrier
  s_cmp_lg_u32 s17, 0
  s_cbranch_scc1 L_M_next
  v_lshlrev_b32 v30, 2, v0
  ds_read_b32 v32, v30 offset:0
  ds_read_b32 v33, v30 offset:256
  ds_read_b32 v34, v30 offset:512
  ds_read_b32 v35, v30 offset:768
  ds_read_b32 v36, v30 offset:1024
  ds_read_b32 v37, v30 offset:1280
  ds_read_b32 v38, v30 offset:1536
  ds_read_b32 v39, v30 offset:1792
  ds_read_b32 v40, v30 offset:2048
  ds_read_b32 v41, v30 offset:2304
  ds_read_b32 v42, v30 offset:2560
  ds_read_b32 v43, v30 offset:2816
  ds_read_b32 v44, v30 offset:3072
  ds_read_b32 v45, v30 offset:3328
  ds_read_b32 v46, v30 offset:3584
  ds_read_b32 v47, v30 offset:3840
  ds_read_b32 v48, v30 offset:4096
  ds_read_b32 v49, v30 offset:4352
  ds_read_b32 v50, v30 offset:4608
  ds_read_b32 v51, v30 offset:4864
  ds_read_b32 v52, v30 offset:5120
  ds_read_b32 v53, v30 offset:5376
  ds_read_b32 v54, v30 offset:5632
  ds_read_b32 v55, v30 offset:5888
  ds_read_b32 v56, v30 offset:6144
  ds_read_b32 v57, v30 offset:6400
  ds_read_b32 v58, v30 offset:6656
  ds_read_b32 v59, v30 offset:6912
  ds_read_b32 v60, v30 offset:7168
  ds_read_b32 v61, v30 offset:7424
  ds_read_b32 v62, v30 offset:7680
  ds_read_b32 v63, v30 offset:7936
  s_waitcnt lgkmcnt(14)
  v_pk_add_f32 v[32:33], v[32:33], v[48:49]
  s_waitcnt lgkmcnt(12)
  v_pk_add_f32 v[34:35], v[34:35], v[50:51]
  s_waitcnt lgkmcnt(10)
  v_pk_add_f32 v[36:37], v[36:37], v[52:53]
  s_waitcnt lgkmcnt(8)
  v_pk_add_f32 v[38:39], v[38:39], v[54:55]
  s_waitcnt lgkmcnt(6)
  v_pk_add_f32 v[40:41], v[40:41], v[56:57]
  s_waitcnt lgkmcnt(4)
  v_pk_add_f32 v[42:43], v[42:43], v[58:59]
  s_waitcnt lgkmcnt(2)
  v_pk_add_f32 v[44:45], v[44:45], v[60:61]
  s_waitcnt lgkmcnt(0)
  v_pk_add_f32 v[46:47], v[46:47], v[62:63]
  v_pk_add_f32 v[32:33], v[32:33], v[40:41]
  v_pk_add_f32 v[34:35], v[34:35], v[42:43]
  v_pk_add_f32 v[36:37], v[36:37], v[44:45]
  v_pk_add_f32 v[38:39], v[38:39], v[46:47]
  v_pk_add_f32 v[32:33], v[32:33], v[36:37]
  v_pk_add_f32 v[34:35], v[34:35], v[38:39]
  v_pk_add_f32 v[32:33], v[32:33], v[34:35]
  v_add_f32 v32, v32, v33
  v_cvt_pk_bf16_f32 v31, v32, v32
  v_lshlrev_b32 v32, 16, v31
  s_sub_u32 s25, s36, 40
  s_cmp_lt_u32 s25, 10
  s_cselect_b32 s24, 1.0, 0
  v_add_f32 v32, s24, v32
  v_cvt_pk_bf16_f32 v31, v32, v32
  v_lshlrev_b32 v32, 16, v31
  s_lshl_b32 s3, s36, 8
  buffer_store_dword v32, v30, s[4:7], s3 offen offset:0 sc1
  v_mov_b32 v31, 1
  s_waitcnt vmcnt(0)
  s_mov_b64 exec, 1
  buffer_atomic_add v31, off, s[96:99], 0 offset:64
  s_mov_b64 exec, -1
L_M_next:
  s_barrier
  s_add_u32 s36, s36, 20
  s_cmp_lt_u32 s36, 60
  s_cbranch_scc1 L_M_loop
L_M_done:
  s_branch L_M_w_in
L_M_w:
  s_sleep 4
L_M_w_in:
  buffer_load_dword v28, off, s[96:99], 0 offset:64 sc1
  s_add_u32 s39, s39, 1
  s_cmp_gt_u32 s39, 200000
  s_cbranch_scc1 L_exit
  s_waitcnt vmcnt(0)
  v_cmp_gt_u32 vcc, 40, v28
  s_cbranch_vccnz L_M_w
L_H_r:
  s_sub_u32 s50, s16, 104
  s_mov_b32 s51, 24
  s_mov_b32 s52, 440
  s_sub_u32 s22, s16, 64
  s_cmp_ge_u32 s22, 40
  s_cbranch_scc1 L_T
  s_lshr_b32 s18, s22, 2
  s_branch L_R
L_exit:
  s_endpgm
L_work:
  s_sub_u32 s27, s27, 4
  s_cmp_eq_u32 s27, 1
  s_cbranch_scc1 L_proj
  s_mov_b64 s[8:9], s[70:71]
  s_cmp_eq_u32 s27, 0
  s_cbranch_scc1 L_proj
  s_mov_b64 s[8:9], s[68:69]
  s_cmp_eq_u32 s27, 3
  s_cbranch_scc1 L_proj
  s_mov_b64 s[8:9], s[74:75]
  s_branch L_ow
L_R:
  s_and_b32 s73, s16, 3
  s_lshl_b32 s73, s73, 19
  s_add_u32 s73, s73, 4194304
  s_and_b32 s44, s16, 3
  s_lshl_b32 s45, s18, 2
  s_add_u32 s45, s45, s17
  v_lshrrev_b32 v14, 5, v1
  v_mul_u32_u24 v14, 640, v14
  v_and_b32 v15, 31, v1
  v_lshl_add_u32 v4, v15, 4, v14
  v_add_u32 v4, 10240, v4
  v_mul_u32_u24 v14, 1280, v2
  v_lshl_add_u32 v8, v3, 3, v14
  v_add_u32 v8, 10752, v8
  s_lshl_b32 s23, s45, 11
  s_add_u32 s23, s23, 16384
  v_lshlrev_b32 v11, 4, v1
  v_add_u32 v10, s23, v11
  s_lshl_b32 s36, s45, 15
  s_lshl_b32 s24, s44, 13
  s_add_u32 s36, s36, s24
  s_add_u32 s36, s36, 100663296
  s_mul_i32 s24, s45, 6554
  s_lshr_b32 s24, s24, 16
  s_lshl_b32 s24, s24, 6
  s_lshl_b32 s22, s44, 11
  s_add_u32 s24, s24, s22
  v_and_b32 v12, 7, v1
  v_lshlrev_b32 v12, 8, v12
  v_add_u32 v12, s24, v12
  s_add_u32 s35, s19, 7438336
  s_mov_b32 s46, s19
  s_lshl_b32 s22, s18, 14
  s_add_u32 s46, s46, s22
  s_lshl_b32 s22, s17, 11
  s_add_u32 s46, s46, s22
  s_add_u32 s46, s46, 6291456
  v_lshlrev_b32 v14, 3, v1
  s_lshl_b32 s22, s44, 9
  v_add_u32 v18, s22, v14
  v_xor_b32 v19, 512, v18
  v_xor_b32 v28, 1024, v18
  v_xor_b32 v29, 1536, v18
  v_lshlrev_b32 v20, 6, v2
  v_and_b32 v15, 1, v1
  v_lshl_add_u32 v20, v15, 5, v20
  v_bfe_u32 v14, v1, 1, 3
  v_lshl_add_u32 v20, v14, 2, v20
  s_lshl_b32 s22, s45, 8
  v_add_u32 v20, s22, v20
  v_cmp_eq_u32 vcc, 0, v15
  v_mov_b32 v30, 0x03020706
  v_mov_b32 v31, 0x05040100
  v_cndmask_b32 v30, v30, v31, vcc
  s_mov_b32 s41, 0xff81ff81
  s_mov_b32 s39, 0
  s_mov_b32 s70, 0
  s_mov_b32 s20, 0
  v_and_b32 v16, 1, v1
  v_cmp_eq_u32 vcc, 0, v16
  v_mov_b32 v16, 0xeeee
  v_mov_b32 v17, 0x4444
  v_cndmask_b32 v16, v16, v17, vcc
  s_mul_i32 s22, s17, 1280
  v_add_u32 v5, s22, v4
  v_lshrrev_b32 v14, 5, v1
  v_mul_u32_u24 v14, 640, v14
  v_and_b32 v15, 31, v1
  v_lshl_add_u32 v6, v15, 2, v14
  v_add_u32 v6, s22, v6
  v_add_u32 v6, 10752, v6
  s_lshl_b32 s22, s17, 10
  v_add_u32 v7, s22, v11
  s_lshl_b32 s22, s17, 8
  v_lshlrev_b32 v9, 2, v1
  v_add_u32 v9, s22, v9
  v_add_u32 v9, 4096, v9
  v_mov_b32 v22, v11
  v_lshlrev_b32 v23, 8, v2
  v_lshl_add_u32 v23, v3, 3, v23
  v_add_u32 v23, 4096, v23
  s_add_u32 s22, s73, 0
  buffer_load_dwordx4 v[128:131], v10, s[4:7], s22 offen sc1
  buffer_load_dwordx4 v[132:135], v10, s[4:7], s22 offen offset:1024 sc1
  buffer_load_dwordx4 v[136:139], v5, s[4:7], s22 offen sc1
  buffer_load_dword v140, v6, s[4:7], s22 offen sc1
  buffer_load_dword v141, v20, s[4:7], s22 offen sc1
  s_add_u32 s22, s46, 0
  buffer_load_dwordx2 v[142:143], v18, s[4:7], s22 offen sc1
  s_add_u32 s22, s73, 131072
  buffer_load_dwordx4 v[144:147], v10, s[4:7], s22 offen sc1
  buffer_load_dwordx4 v[148:151], v10, s[4:7], s22 offen offset:1024 sc1
  buffer_load_dwordx4 v[152:155], v5, s[4:7], s22 offen sc1
  buffer_load_dword v156, v6, s[4:7], s22 offen sc1
  buffer_load_dword v157, v20, s[4:7], s22 offen sc1
  s_add_u32 s22, s46, 262144
  buffer_load_dwordx2 v[158:159], v18, s[4:7], s22 offen sc1
  s_add_u32 s22, s73, 262144
  buffer_load_dwordx4 v[160:163], v10, s[4:7], s22 offen sc1
  buffer_load_dwordx4 v[164:167], v10, s[4:7], s22 offen offset:1024 sc1
  buffer_load_dwordx4 v[168:171], v5, s[4:7], s22 offen sc1
  buffer_load_dword v172, v6, s[4:7], s22 offen sc1
  buffer_load_dword v173, v20, s[4:7], s22 offen sc1
  s_add_u32 s22, s46, 524288
  buffer_load_dwordx2 v[174:175], v18, s[4:7], s22 offen sc1
  s_add_u32 s22, s73, 393216
  buffer_load_dwordx4 v[176:179], v10, s[4:7], s22 offen sc1
  buffer_load_dwordx4 v[180:183], v10, s[4:7], s22 offen offset:1024 sc1
  buffer_load_dwordx4 v[184:187], v5, s[4:7], s22 offen sc1
  buffer_load_dword v188, v6, s[4:7], s22 offen sc1
  buffer_load_dword v189, v20, s[4:7], s22 offen sc1
  s_add_u32 s22, s46, 786432
  buffer_load_dwordx2 v[190:191], v18, s[4:7], s22 offen sc1
  s_waitcnt vmcnt(0)
  v_mov_b32 v21, s41
  v_mov_b32 v96, s41
  v_mov_b32 v97, s41
  s_cmp_lg_u32 s74, 0
  s_cbranch_scc1 L_R_safe
L_R_loop:
  s_add_u32 s43, s20, 2
  s_and_b32 s43, s43, 3
  s_lshl_b32 s43, s43, 17
  s_add_u32 s43, s43, s73
  buffer_store_dword v21, v20, s[4:7], s43 offen
  s_add_u32 s42, s20, 2
  s_and_b32 s42, s42, 3
  s_lshl_b32 s42, s42, 18
  s_add_u32 s42, s42, s46
  buffer_store_dwordx2 v[96:97], v18, s[4:7], s42 offen sc1
  s_xor_b32 s42, s42, 524288
  s_add_u32 s31, s20, 1
  s_cmp_ge_u32 s70, s31
  s_cbranch_scc1 L_R_fok
L_R_fl:
  buffer_load_dword v13, v12, s[4:7], s35 offen sc1
  s_add_u32 s39, s39, 1
  s_cmp_gt_u32 s39, 200000
  s_cbranch_scc1 L_exit
  s_waitcnt vmcnt(0)
  v_min_u32_dpp v13, v13, v13 quad_perm:[1,0,3,2] row_mask:0xf bank_mask:0xf
  s_nop 1
  v_min_u32_dpp v13, v13, v13 quad_perm:[2,3,0,1] row_mask:0xf bank_mask:0xf
  s_nop 1
  v_min_u32_dpp v13, v13, v13 row_half_mirror row_mask:0xf bank_mask:0xf
  s_nop 0
  v_readfirstlane_b32 s70, v13
  s_nop 0
  s_cmp_lt_u32 s70, s31
  s_cbranch_scc1 L_R_fl
L_R_fok:
  s_mul_i32 s23, s20, 1310720
  s_add_u32 s23, s23, s36
  s_add_u32 s24, s23, 4096
  buffer_load_dwordx4 v[64:67], v11, s[4:7], s23 offen offset:0 sc1
  buffer_load_dwordx4 v[68:71], v11, s[4:7], s23 offen offset:1024 sc1
  buffer_load_dwordx4 v[72:75], v11, s[4:7], s23 offen offset:2048 sc1
  buffer_load_dwordx4 v[76:79], v11, s[4:7], s23 offen offset:3072 sc1
  buffer_load_dwordx4 v[80:83], v11, s[4:7], s24 offen offset:0 sc1
  buffer_load_dwordx4 v[84:87], v11, s[4:7], s24 offen offset:1024 sc1
  buffer_load_dwordx4 v[88:91], v11, s[4:7], s24 offen offset:2048 sc1
  buffer_load_dwordx4 v[92:95], v11, s[4:7], s24 offen offset:3072 sc1
  s_add_u32 s22, s20, 2
  s_cmp_lt_u32 s70, s22
  s_cselect_b32 s22, s35, 0xf0000000
  buffer_load_dword v13, v12, s[4:7], s22 offen sc1
  s_add_u32 s40, s20, 0
  s_and_b32 s40, s40, 3
  s_lshl_b32 s40, s40, 17
  s_add_u32 s40, s40, s73
  s_add_u32 s43, s20, 1
  s_and_b32 s43, s43, 3
  s_lshl_b32 s43, s43, 17
  s_add_u32 s43, s43, s73
  s_waitcnt vmcnt(0)
  v_min_u32_dpp v13, v13, v13 quad_perm:[1,0,3,2] row_mask:0xf bank_mask:0xf
  s_nop 1
  v_min_u32_dpp v13, v13, v13 quad_perm:[2,3,0,1] row_mask:0xf bank_mask:0xf
  s_nop 1
  v_min_u32_dpp v13, v13, v13 row_half_mirror row_mask:0xf bank_mask:0xf
  s_nop 0
  v_readfirstlane_b32 s22, v13
  s_nop 0
  s_max_u32 s70, s70, s22
  v_mov_b64 v[24:25], 0
  v_mov_b64 v[26:27], 0
L_R_pollY:
  buffer_load_dwordx4 v[56:59], v10, s[4:7], s40 offen offset:0 sc1
  buffer_load_dwordx4 v[60:63], v10, s[4:7], s40 offen offset:1024 sc1
  s_sleep 1
  buffer_load_dwordx4 v[100:103], v5, s[4:7], s40 offen sc1
  buffer_load_dword v104, v6, s[4:7], s40 offen sc1
  s_add_u32 s39, s39, 1
  s_cmp_gt_u32 s39, 200000
  s_cbranch_scc1 L_exit
  s_waitcnt vmcnt(3)
  v_max3_u32 v14, v56, v57, v58
  s_waitcnt vmcnt(2)
  v_max3_u32 v14, v14, v59, v60
  v_max3_u32 v14, v14, v61, v62
  v_max_u32 v14, v14, v63
  v_cmp_eq_u32 vcc, s41, v14
  s_cbranch_vccnz L_R_pollY
L_R_pollP:
  buffer_load_dwordx4 v[108:111], v5, s[4:7], s40 offen sc1
  buffer_load_dword v112, v6, s[4:7], s40 offen sc1
  s_add_u32 s39, s39, 1
  s_cmp_gt_u32 s39, 200000
  s_cbranch_scc1 L_exit
  s_waitcnt vmcnt(3)
  ds_write_b128 v7, v[100:103]
  v_max3_u32 v15, v100, v101, v102
  s_waitcnt vmcnt(2)
  ds_write_b32 v9, v104
  v_max3_u32 v15, v15, v103, v104
  v_cmp_eq_u32 vcc, s41, v15
  s_cbranch_vccz L_R_pok
  buffer_load_dwordx4 v[100:103], v5, s[4:7], s40 offen sc1
  buffer_load_dword v104, v6, s[4:7], s40 offen sc1
  s_waitcnt vmcnt(3)
  ds_write_b128 v7, v[108:111]
  v_max3_u32 v15, v108, v109, v110
  s_waitcnt vmcnt(2)
  ds_write_b32 v9, v112
  v_max3_u32 v15, v15, v111, v112
  v_cmp_eq_u32 vcc, s41, v15
  s_cbranch_vccnz L_R_pollP
L_R_pok:
  s_waitcnt lgkmcnt(0)
  s_barrier
  ds_read_b128 v[32:35], v22 offset:0
  ds_read_b128 v[36:39], v22 offset:1024
  ds_read_b128 v[40:43], v22 offset:2048
  ds_read_b128 v[44:47], v22 offset:3072
  ds_read2_b64 v[48:51], v23 offset0:0 offset1:16
  s_waitcnt lgkmcnt(4)
  v_smfmac_f32_16x16x64_bf16 v[24:27], v[32:35], v[64:71], v16
  s_waitcnt lgkmcnt(3)
  v_smfmac_f32_16x16x64_bf16 v[24:27], v[36:39], v[72:79], v16
  s_waitcnt lgkmcnt(2)
  v_smfmac_f32_16x16x64_bf16 v[24:27], v[40:43], v[80:87], v16
  s_waitcnt lgkmcnt(1)
  v_smfmac_f32_16x16x64_bf16 v[24:27], v[44:47], v[88:95], v16
  s_waitcnt lgkmcnt(0)
  v_smfmac_f32_16x16x64_bf16 v[24:27], v[48:51], v[56:63], v16
  s_nop 7
  v_add_f32 v24, v24, v25
  v_add_f32 v25, v26, v27
  buffer_store_dwordx2 v[24:25], v18, s[4:7], s42 offen sc1
  s_sleep 6
L_R_pollX:
  buffer_load_dwordx2 v[32:33], v19, s[4:7], s42 offen sc1
  buffer_load_dwordx2 v[34:35], v28, s[4:7], s42 offen sc1
  buffer_load_dwordx2 v[36:37], v29, s[4:7], s42 offen sc1
  s_add_u32 s39, s39, 1
  s_cmp_gt_u32 s39, 200000
  s_cbranch_scc1 L_exit
  s_waitcnt vmcnt(2)
  v_pk_add_f32 v[40:41], v[24:25], v[32:33]
  s_waitcnt vmcnt(1)
  v_max3_u32 v14, v32, v33, v34
  s_waitcnt vmcnt(0)
  v_pk_add_f32 v[42:43], v[34:35], v[36:37]
  v_max3_u32 v15, v35, v36, v37
  v_pk_add_f32 v[40:41], v[40:41], v[42:43]
  v_cvt_pk_bf16_f32 v40, v40, v41
  v_max_u32 v14, v14, v15
  v_cmp_eq_u32 vcc, s41, v14
  v_mov_b32_dpp v41, v40 quad_perm:[1,0,3,2] row_mask:0xf bank_mask:0xf
  v_perm_b32 v40, v41, v40, v30
  s_cbranch_vccnz L_R_pollX
  buffer_store_dword v40, v20, s[4:7], s43 offen
  s_barrier
  s_add_u32 s20, s20, 1
  s_cmp_lt_u32 s20, 63
  s_cbranch_scc1 L_R_loop
  s_endpgm
L_R_safe:
L_R_loop_s:
  s_add_u32 s43, s20, 2
  s_and_b32 s43, s43, 3
  s_lshl_b32 s43, s43, 17
  s_add_u32 s43, s43, s73
  buffer_store_dword v21, v20, s[4:7], s43 offen sc1
  s_add_u32 s42, s20, 2
  s_and_b32 s42, s42, 3
  s_lshl_b32 s42, s42, 18
  s_add_u32 s42, s42, s46
  buffer_store_dwordx2 v[96:97], v18, s[4:7], s42 offen sc1
  s_xor_b32 s42, s42, 524288
  s_add_u32 s31, s20, 1
  s_cmp_ge_u32 s70, s31
  s_cbranch_scc1 L_R_fok_s
L_R_fl_s:
  buffer_load_dword v13, v12, s[4:7], s35 offen sc1
  s_add_u32 s39, s39, 1
  s_cmp_gt_u32 s39, 200000
  s_cbranch_scc1 L_exit
  s_waitcnt vmcnt(0)
  v_min_u32_dpp v13, v13, v13 quad_perm:[1,0,3,2] row_mask:0xf bank_mask:0xf
  s_nop 1
  v_min_u32_dpp v13, v13, v13 quad_perm:[2,3,0,1] row_mask:0xf bank_mask:0xf
  s_nop 1
  v_min_u32_dpp v13, v13, v13 row_half_mirror row_mask:0xf bank_mask:0xf
  s_nop 0
  v_readfirstlane_b32 s70, v13
  s_nop 0
  s_cmp_lt_u32 s70, s31
  s_cbranch_scc1 L_R_fl_s
L_R_fok_s:
  s_mul_i32 s23, s20, 1310720
  s_add_u32 s23, s23, s36
  s_add_u32 s24, s23, 4096
  buffer_load_dwordx4 v[64:67], v11, s[4:7], s23 offen offset:0 sc1
  buffer_load_dwordx4 v[68:71], v11, s[4:7], s23 offen offset:1024 sc1
  buffer_load_dwordx4 v[72:75], v11, s[4:7], s23 offen offset:2048 sc1
  buffer_load_dwordx4 v[76:79], v11, s[4:7], s23 offen offset:3072 sc1
  buffer_load_dwordx4 v[80:83], v11, s[4:7], s24 offen offset:0 sc1
  buffer_load_dwordx4 v[84:87], v11, s[4:7], s24 offen offset:1024 sc1
  buffer_load_dwordx4 v[88:91], v11, s[4:7], s24 offen offset:2048 sc1
  buffer_load_dwordx4 v[92:95], v11, s[4:7], s24 offen offset:3072 sc1
  s_add_u32 s22, s20, 2
  s_cmp_lt_u32 s70, s22
  s_cselect_b32 s22, s35, 0xf0000000
  buffer_load_dword v13, v12, s[4:7], s22 offen sc1
  s_add_u32 s40, s20, 0
  s_and_b32 s40, s40, 3
  s_lshl_b32 s40, s40, 17
  s_add_u32 s40, s40, s73
  s_add_u32 s43, s20, 1
  s_and_b32 s43, s43, 3
  s_lshl_b32 s43, s43, 17
  s_add_u32 s43, s43, s73
  s_waitcnt vmcnt(0)
  v_min_u32_dpp v13, v13, v13 quad_perm:[1,0,3,2] row_mask:0xf bank_mask:0xf
  s_nop 1
  v_min_u32_dpp v13, v13, v13 quad_perm:[2,3,0,1] row_mask:0xf bank_mask:0xf
  s_nop 1
  v_min_u32_dpp v13, v13, v13 row_half_mirror row_mask:0xf bank_mask:0xf
  s_nop 0
  v_readfirstlane_b32 s22, v13
  s_nop 0
  s_max_u32 s70, s70, s22
  v_mov_b64 v[24:25], 0
  v_mov_b64 v[26:27], 0
L_R_pollY_s:
  buffer_load_dwordx4 v[56:59], v10, s[4:7], s40 offen offset:0 sc1
  buffer_load_dwordx4 v[60:63], v10, s[4:7], s40 offen offset:1024 sc1
  s_sleep 1
  buffer_load_dwordx4 v[100:103], v5, s[4:7], s40 offen sc1
  buffer_load_dword v104, v6, s[4:7], s40 offen sc1
  s_add_u32 s39, s39, 1
  s_cmp_gt_u32 s39, 200000
  s_cbranch_scc1 L_exit
  s_waitcnt vmcnt(3)
  v_max3_u32 v14, v56, v57, v58
  s_waitcnt vmcnt(2)
  v_max3_u32 v14, v14, v59, v60
  v_max3_u32 v14, v14, v61, v62
  v_max_u32 v14, v14, v63
  v_cmp_eq_u32 vcc, s41, v14
  s_cbranch_vccnz L_R_pollY_s
L_R_pollP_s:
  buffer_load_dwordx4 v[108:111], v5, s[4:7], s40 offen sc1
  buffer_load_dword v112, v6, s[4:7], s40 offen sc1
  s_add_u32 s39, s39, 1
  s_cmp_gt_u32 s39, 200000
  s_cbranch_scc1 L_exit
  s_waitcnt vmcnt(3)
  ds_write_b128 v7, v[100:103]
  v_max3_u32 v15, v100, v101, v102
  s_waitcnt vmcnt(2)
  ds_write_b32 v9, v104
  v_max3_u32 v15, v15, v103, v104
  v_cmp_eq_u32 vcc, s41, v15
  s_cbranch_vccz L_R_pok_s
  buffer_load_dwordx4 v[100:103], v5, s[4:7], s40 offen sc1
  buffer_load_dword v104, v6, s[4:7], s40 offen sc1
  s_waitcnt vmcnt(3)
  ds_write_b128 v7, v[108:111]
  v_max3_u32 v15, v108, v109, v110
  s_waitcnt vmcnt(2)
  ds_write_b32 v9, v112
  v_max3_u32 v15, v15, v111, v112
  v_cmp_eq_u32 vcc, s41, v15
  s_cbranch_vccnz L_R_pollP_s
L_R_pok_s:
  s_waitcnt lgkmcnt(0)
  s_barrier
  ds_read_b128 v[32:35], v22 offset:0
  ds_read_b128 v[36:39], v22 offset:1024
  ds_read_b128 v[40:43], v22 offset:2048
  ds_read_b128 v[44:47], v22 offset:3072
  ds_read2_b64 v[48:51], v23 offset0:0 offset1:16
  s_waitcnt lgkmcnt(4)
  v_smfmac_f32_16x16x64_bf16 v[24:27], v[32:35], v[64:71], v16
  s_waitcnt lgkmcnt(3)
  v_smfmac_f32_16x16x64_bf16 v[24:27], v[36:39], v[72:79], v16
  s_waitcnt lgkmcnt(2)
  v_smfmac_f32_16x16x64_bf16 v[24:27], v[40:43], v[80:87], v16
  s_waitcnt lgkmcnt(1)
  v_smfmac_f32_16x16x64_bf16 v[24:27], v[44:47], v[88:95], v16
  s_waitcnt lgkmcnt(0)
  v_smfmac_f32_16x16x64_bf16 v[24:27], v[48:51], v[56:63], v16
  s_nop 7
  v_add_f32 v24, v24, v25
  v_add_f32 v25, v26, v27
  buffer_store_dwordx2 v[24:25], v18, s[4:7], s42 offen sc1
  s_sleep 6
L_R_pollX_s:
  buffer_load_dwordx2 v[32:33], v19, s[4:7], s42 offen sc1
  buffer_load_dwordx2 v[34:35], v28, s[4:7], s42 offen sc1
  buffer_load_dwordx2 v[36:37], v29, s[4:7], s42 offen sc1
  s_add_u32 s39, s39, 1
  s_cmp_gt_u32 s39, 200000
  s_cbranch_scc1 L_exit
  s_waitcnt vmcnt(2)
  v_pk_add_f32 v[40:41], v[24:25], v[32:33]
  s_waitcnt vmcnt(1)
  v_max3_u32 v14, v32, v33, v34
  s_waitcnt vmcnt(0)
  v_pk_add_f32 v[42:43], v[34:35], v[36:37]
  v_max3_u32 v15, v35, v36, v37
  v_pk_add_f32 v[40:41], v[40:41], v[42:43]
  v_cvt_pk_bf16_f32 v40, v40, v41
  v_max_u32 v14, v14, v15
  v_cmp_eq_u32 vcc, s41, v14
  v_mov_b32_dpp v41, v40 quad_perm:[1,0,3,2] row_mask:0xf bank_mask:0xf
  v_perm_b32 v40, v41, v40, v30
  s_cbranch_vccnz L_R_pollX_s
  buffer_store_dword v40, v20, s[4:7], s43 offen sc1
  s_barrier
  s_add_u32 s20, s20, 1
  s_cmp_lt_u32 s20, 63
  s_cbranch_scc1 L_R_loop_s
  s_endpgm
L_T:
  s_load_dwordx2 s[24:25], s[0:1], 0
  s_waitcnt lgkmcnt(0)
  s_mov_b32 s8, s24
  s_mov_b32 s9, s25
  s_mov_b32 s10, 2621440
  s_mov_b32 s11, 0x20000
  v_lshlrev_b32 v4, 4, v1
  v_mov_b32 v5, 0
  s_lshl_b32 s22, s17, 13
  s_add_u32 s28, s22, 100663296
  s_add_u32 s29, s22, 8388608
  s_lshl_b32 s22, s17, 11
  s_add_u32 s30, s22, 12582912
  s_mul_i32 s33, s17, 81920
  s_add_u32 s33, s33, 184549376
  v_and_b32 v6, 31, v1
  v_lshlrev_b32 v6, 6, v6
  v_add_u32 v6, s22, v6
  v_lshrrev_b32 v7, 5, v1
  v_mul_u32_u24 v7, 49152, v7
  v_add_u32 v7, v7, v6
  s_add_u32 s34, s19, 7438336
  s_add_u32 s35, s19, 7471104
  s_lshl_b32 s22, s17, 13
  v_add_u32 v8, s22, v4
  s_lshr_b32 s53, s17, 1
  s_and_b32 s54, s17, 1
  s_lshl_b32 s24, s53, 12
  s_lshl_b32 s25, s54, 10
  s_add_u32 s24, s24, s25
  v_add_u32 v9, s24, v4
  v_mul_u32_u24 v10, 1280, v3
  v_lshl_add_u32 v10, v2, 3, v10
  v_lshrrev_b32 v15, 1, v2
  v_lshlrev_b32 v11, 8, v15
  v_lshl_add_u32 v11, v3, 4, v11
  v_and_b32 v15, 1, v2
  v_lshl_add_u32 v11, v15, 9, v11
  v_lshlrev_b32 v12, 3, v3
  v_lshlrev_b32 v13, 4, v2
  s_mov_b32 s39, 0
  s_mov_b32 s46, 0
  s_mul_i32 s20, s50, 6554
  s_lshr_b32 s20, s20, 16
  s_mul_i32 s22, s20, 10
  s_sub_u32 s32, s50, s22
  s_add_u32 s31, s20, 1
  s_branch L_T_wu_in
L_T_wu:
  s_sleep 3
L_T_wu_in:
  buffer_load_dword v15, v6, s[4:7], s34 offen sc1
  s_add_u32 s39, s39, 1
  s_cmp_gt_u32 s39, 200000
  s_cbranch_scc1 L_exit
  s_waitcnt vmcnt(0)
  v_cmp_gt_u32 vcc, s31, v15
  s_cbranch_vccnz L_T_wu
  s_lshl_b32 s49, s50, 17
  s_add_u32 s49, s49, s28
  s_add_u32 s22, s49, 0
  buffer_load_dwordx4 a[0:3], v4, s[4:7], s22 offen offset:0 sc1
  buffer_load_dwordx4 a[16:19], v4, s[4:7], s22 offen offset:1024 sc1
  buffer_load_dwordx4 a[32:35], v4, s[4:7], s22 offen offset:2048 sc1
  buffer_load_dwordx4 a[48:51], v4, s[4:7], s22 offen offset:3072 sc1
  s_add_u32 s22, s49, 4096
  buffer_load_dwordx4 a[64:67], v4, s[4:7], s22 offen offset:0 sc1
  buffer_load_dwordx4 a[80:83], v4, s[4:7], s22 offen offset:1024 sc1
  buffer_load_dwordx4 a[96:99], v4, s[4:7], s22 offen offset:2048 sc1
  buffer_load_dwordx4 a[112:115], v4, s[4:7], s22 offen offset:3072 sc1
  s_add_u32 s22, s49, 32768
  buffer_load_dwordx4 a[4:7], v4, s[4:7], s22 offen offset:0 sc1
  buffer_load_dwordx4 a[20:23], v4, s[4:7], s22 offen offset:1024 sc1
  buffer_load_dwordx4 a[36:39], v4, s[4:7], s22 offen offset:2048 sc1
  buffer_load_dwordx4 a[52:55], v4, s[4:7], s22 offen offset:3072 sc1
  s_add_u32 s22, s49, 36864
  buffer_load_dwordx4 a[68:71], v4, s[4:7], s22 offen offset:0 sc1
  buffer_load_dwordx4 a[84:87], v4, s[4:7], s22 offen offset:1024 sc1
  buffer_load_dwordx4 a[100:103], v4, s[4:7], s22 offen offset:2048 sc1
  buffer_load_dwordx4 a[116:119], v4, s[4:7], s22 offen offset:3072 sc1
  s_add_u32 s22, s49, 65536
  buffer_load_dwordx4 a[8:11], v4, s[4:7], s22 offen offset:0 sc1
  buffer_load_dwordx4 a[24:27], v4, s[4:7], s22 offen offset:1024 sc1
  buffer_load_dwordx4 a[40:43], v4, s[4:7], s22 offen offset:2048 sc1
  buffer_load_dwordx4 a[56:59], v4, s[4:7], s22 offen offset:3072 sc1
  s_add_u32 s22, s49, 69632
  buffer_load_dwordx4 a[72:75], v4, s[4:7], s22 offen offset:0 sc1
  buffer_load_dwordx4 a[88:91], v4, s[4:7], s22 offen offset:1024 sc1
  buffer_load_dwordx4 a[104:107], v4, s[4:7], s22 offen offset:2048 sc1
  buffer_load_dwordx4 a[120:123], v4, s[4:7], s22 offen offset:3072 sc1
  s_add_u32 s22, s49, 98304
  buffer_load_dwordx4 a[12:15], v4, s[4:7], s22 offen offset:0 sc1
  buffer_load_dwordx4 a[28:31], v4, s[4:7], s22 offen offset:1024 sc1
  buffer_load_dwordx4 a[44:47], v4, s[4:7], s22 offen offset:2048 sc1
  buffer_load_dwordx4 a[60:63], v4, s[4:7], s22 offen offset:3072 sc1
  s_add_u32 s22, s49, 102400
  buffer_load_dwordx4 a[76:79], v4, s[4:7], s22 offen offset:0 sc1
  buffer_load_dwordx4 a[92:95], v4, s[4:7], s22 offen offset:1024 sc1
  buffer_load_dwordx4 a[108:111], v4, s[4:7], s22 offen offset:2048 sc1
  buffer_load_dwordx4 a[124:127], v4, s[4:7], s22 offen offset:3072 sc1
L_T_loop:
  s_mul_i32 s20, s50, 6554
  s_lshr_b32 s20, s20, 16
  s_mul_i32 s22, s20, 10
  s_sub_u32 s32, s50, s22
  s_lshl_b32 s24, s32, 1
  s_add_u32 s24, s24, s53
  s_lshl_b32 s22, s24, 7
  s_add_u32 s23, s22, 5120
  buffer_load_dwordx4 v[16:19], v13, s[4:7], s23 offen sc1
  buffer_load_dwordx4 v[20:23], v13, s[4:7], s23 offen offset:64 sc1
  s_add_u32 s23, s22, 10240
  buffer_load_dwordx4 v[24:27], v13, s[4:7], s23 offen sc1
  buffer_load_dwordx4 v[28:31], v13, s[4:7], s23 offen offset:64 sc1
  s_lshl_b32 s25, s20, 1
  s_add_u32 s25, s25, s54
  s_mul_i32 s47, s25, 20480
  s_lshl_b32 s22, s24, 6
  s_add_u32 s47, s47, s22
  buffer_load_dwordx2 v[32:33], v10, s[8:11], s47 offen
  buffer_load_dwordx2 v[34:35], v10, s[8:11], s47 offen offset:32
  s_mul_i32 s44, s25, 20
  s_add_u32 s44, s44, s24
  s_lshl_b32 s45, s44, 7
  s_add_u32 s45, s45, 262144
  s_lshl_b32 s44, s44, 10
  s_lshl_b32 s36, s50, 6
  s_add_u32 s36, s36, 196608
  s_mul_i32 s42, s20, 327680
  s_add_u32 s42, s42, s33
  s_lshl_b32 s22, s32, 13
  s_add_u32 s42, s42, s22
  s_lshl_b32 s40, s20, 16
  s_add_u32 s40, s40, s29
  s_lshl_b32 s43, s20, 14
  s_add_u32 s43, s43, s30
  s_add_u32 s50, s50, s51
  s_mul_i32 s31, s50, 6554
  s_lshr_b32 s31, s31, 16
  s_mul_i32 s22, s31, 10
  s_sub_u32 s48, s50, s22
  s_add_u32 s31, s31, 1
  s_min_u32 s31, s31, 64
  s_cmp_eq_u32 s46, 64
  s_cbranch_scc1 L_T_wu0_ok
  s_branch L_T_wu0_in
L_T_wu0:
  s_sleep 3
L_T_wu0_in:
  buffer_load_dword v15, v6, s[4:7], s34 offen sc1
  s_add_u32 s39, s39, 1
  s_cmp_gt_u32 s39, 200000
  s_cbranch_scc1 L_exit
  s_waitcnt vmcnt(0)
  v_cmp_gt_u32 vcc, s31, v15
  s_cbranch_vccnz L_T_wu0
  v_cmp_gt_u32 vcc, 64, v15
  s_cbranch_vccnz L_T_wu0_ok
  s_mov_b32 s46, 64
L_T_wu0_ok:
  s_add_u32 s31, s20, 1
  s_branch L_T_wp0_in
L_T_wp0:
  s_sleep 3
L_T_wp0_in:
  buffer_load_dword v15, v7, s[4:7], s35 offen sc1
  s_add_u32 s39, s39, 1
  s_cmp_gt_u32 s39, 200000
  s_cbranch_scc1 L_exit
  s_waitcnt vmcnt(0)
  v_cmp_gt_u32 vcc, s31, v15
  s_cbranch_vccnz L_T_wp0
  s_add_u32 s22, s40, 0
  buffer_load_dwordx4 v[72:75], v4, s[4:7], s22 offen offset:0 sc1
  s_add_u32 s23, s40, 32768
  buffer_load_dwordx4 v[76:79], v4, s[4:7], s23 offen offset:0 sc1
  buffer_load_dwordx4 v[80:83], v4, s[4:7], s22 offen offset:1024 sc1
  buffer_load_dwordx4 v[84:87], v4, s[4:7], s23 offen offset:1024 sc1
  buffer_load_dwordx4 v[88:91], v4, s[4:7], s22 offen offset:2048 sc1
  buffer_load_dwordx4 v[92:95], v4, s[4:7], s23 offen offset:2048 sc1
  buffer_load_dwordx4 v[96:99], v4, s[4:7], s22 offen offset:3072 sc1
  buffer_load_dwordx4 v[100:103], v4, s[4:7], s23 offen offset:3072 sc1
  s_add_u32 s22, s40, 4096
  buffer_load_dwordx4 v[104:107], v4, s[4:7], s22 offen offset:0 sc1
  s_add_u32 s23, s40, 36864
  buffer_load_dwordx4 v[108:111], v4, s[4:7], s23 offen offset:0 sc1
  buffer_load_dwordx4 v[112:115], v4, s[4:7], s22 offen offset:1024 sc1
  buffer_load_dwordx4 v[116:119], v4, s[4:7], s23 offen offset:1024 sc1
  buffer_load_dwordx4 v[120:123], v4, s[4:7], s22 offen offset:2048 sc1
  buffer_load_dwordx4 v[124:127], v4, s[4:7], s23 offen offset:2048 sc1
  buffer_load_dwordx4 v[128:131], v4, s[4:7], s22 offen offset:3072 sc1
  buffer_load_dwordx4 v[132:135], v4, s[4:7], s23 offen offset:3072 sc1
  s_add_u32 s22, s43, 0
  buffer_load_dwordx4 v[136:139], v4, s[4:7], s22 offen offset:0 sc1
  buffer_load_dwordx4 v[144:147], v4, s[4:7], s22 offen offset:1024 sc1
  s_add_u32 s22, s43, 8192
  buffer_load_dwordx4 v[140:143], v4, s[4:7], s22 offen offset:0 sc1
  buffer_load_dwordx4 v[148:151], v4, s[4:7], s22 offen offset:1024 sc1
  s_add_u32 s22, s42, 0
  buffer_load_dwordx4 v[152:155], v4, s[4:7], s22 offen offset:0 sc1
  buffer_load_dwordx4 v[168:171], v4, s[4:7], s22 offen offset:1024 sc1
  s_add_u32 s22, s42, 2048
  buffer_load_dwordx4 v[156:159], v4, s[4:7], s22 offen offset:0 sc1
  buffer_load_dwordx4 v[172:175], v4, s[4:7], s22 offen offset:1024 sc1
  s_add_u32 s22, s42, 4096
  buffer_load_dwordx4 v[160:163], v4, s[4:7], s22 offen offset:0 sc1
  buffer_load_dwordx4 v[176:179], v4, s[4:7], s22 offen offset:1024 sc1
  s_add_u32 s22, s42, 6144
  buffer_load_dwordx4 v[164:167], v4, s[4:7], s22 offen offset:0 sc1
  buffer_load_dwordx4 v[180:183], v4, s[4:7], s22 offen offset:1024 sc1
  s_lshl_b32 s49, s50, 17
  s_add_u32 s49, s49, s28
  s_cmp_ge_u32 s50, s52
  s_cselect_b32 s49, 0xf0000000, s49
  s_waitcnt vmcnt(27)
  v_mfma_f32_16x16x32_bf16 v[40:43], a[0:3], v[72:75], 0
  s_waitcnt vmcnt(26)
  v_mfma_f32_16x16x32_bf16 v[44:47], a[0:3], v[76:79], 0
  v_mfma_f32_16x16x32_bf16 v[48:51], a[4:7], v[72:75], 0
  v_mfma_f32_16x16x32_bf16 v[52:55], a[4:7], v[76:79], 0
  v_mfma_f32_16x16x32_bf16 v[56:59], a[8:11], v[72:75], 0
  v_mfma_f32_16x16x32_bf16 v[60:63], a[8:11], v[76:79], 0
  v_mfma_f32_16x16x32_bf16 v[64:67], a[12:15], v[72:75], 0
  v_mfma_f32_16x16x32_bf16 v[68:71], a[12:15], v[76:79], 0
  s_waitcnt vmcnt(25)
  v_mfma_f32_16x16x32_bf16 v[40:43], a[16:19], v[80:83], v[40:43]
  s_waitcnt vmcnt(24)
  v_mfma_f32_16x16x32_bf16 v[44:47], a[16:19], v[84:87], v[44:47]
  v_mfma_f32_16x16x32_bf16 v[48:51], a[20:23], v[80:83], v[48:51]
  v_mfma_f32_16x16x32_bf16 v[52:55], a[20:23], v[84:87], v[52:55]
  v_mfma_f32_16x16x32_bf16 v[56:59], a[24:27], v[80:83], v[56:59]
  v_mfma_f32_16x16x32_bf16 v[60:63], a[24:27], v[84:87], v[60:63]
  v_mfma_f32_16x16x32_bf16 v[64:67], a[28:31], v[80:83], v[64:67]
  v_mfma_f32_16x16x32_bf16 v[68:71], a[28:31], v[84:87], v[68:71]
  s_waitcnt vmcnt(23)
  v_mfma_f32_16x16x32_bf16 v[40:43], a[32:35], v[88:91], v[40:43]
  s_waitcnt vmcnt(22)
  v_mfma_f32_16x16x32_bf16 v[44:47], a[32:35], v[92:95], v[44:47]
  v_mfma_f32_16x16x32_bf16 v[48:51], a[36:39], v[88:91], v[48:51]
  v_mfma_f32_16x16x32_bf16 v[52:55], a[36:39], v[92:95], v[52:55]
  v_mfma_f32_16x16x32_bf16 v[56:59], a[40:43], v[88:91], v[56:59]
  v_mfma_f32_16x16x32_bf16 v[60:63], a[40:43], v[92:95], v[60:63]
  v_mfma_f32_16x16x32_bf16 v[64:67], a[44:47], v[88:91], v[64:67]
  v_mfma_f32_16x16x32_bf16 v[68:71], a[44:47], v[92:95], v[68:71]
  s_waitcnt vmcnt(21)
  v_mfma_f32_16x16x32_bf16 v[40:43], a[48:51], v[96:99], v[40:43]
  s_waitcnt vmcnt(20)
  v_mfma_f32_16x16x32_bf16 v[44:47], a[48:51], v[100:103], v[44:47]
  v_mfma_f32_16x16x32_bf16 v[48:51], a[52:55], v[96:99], v[48:51]
  v_mfma_f32_16x16x32_bf16 v[52:55], a[52:55], v[100:103], v[52:55]
  v_mfma_f32_16x16x32_bf16 v[56:59], a[56:59], v[96:99], v[56:59]
  v_mfma_f32_16x16x32_bf16 v[60:63], a[56:59], v[100:103], v[60:63]
  v_mfma_f32_16x16x32_bf16 v[64:67], a[60:63], v[96:99], v[64:67]
  v_mfma_f32_16x16x32_bf16 v[68:71], a[60:63], v[100:103], v[68:71]
  s_waitcnt vmcnt(19)
  v_mfma_f32_16x16x32_bf16 v[40:43], a[64:67], v[104:107], v[40:43]
  s_add_u32 s22, s49, 0
  buffer_load_dwordx4 a[128:131], v4, s[4:7], s22 offen offset:0 sc1
  s_waitcnt vmcnt(19)
  v_mfma_f32_16x16x32_bf16 v[44:47], a[64:67], v[108:111], v[44:47]
  buffer_load_dwordx4 a[144:147], v4, s[4:7], s22 offen offset:1024 sc1
  v_mfma_f32_16x16x32_bf16 v[48:51], a[68:71], v[104:107], v[48:51]
  buffer_load_dwordx4 a[160:163], v4, s[4:7], s22 offen offset:2048 sc1
  v_mfma_f32_16x16x32_bf16 v[52:55], a[68:71], v[108:111], v[52:55]
  buffer_load_dwordx4 a[176:179], v4, s[4:7], s22 offen offset:3072 sc1
  v_mfma_f32_16x16x32_bf16 v[56:59], a[72:75], v[104:107], v[56:59]
  s_add_u32 s22, s49, 4096
  buffer_load_dwordx4 a[192:195], v4, s[4:7], s22 offen offset:0 sc1
  v_mfma_f32_16x16x32_bf16 v[60:63], a[72:75], v[108:111], v[60:63]
  buffer_load_dwordx4 a[208:211], v4, s[4:7], s22 offen offset:1024 sc1
  v_mfma_f32_16x16x32_bf16 v[64:67], a[76:79], v[104:107], v[64:67]
  buffer_load_dwordx4 a[224:227], v4, s[4:7], s22 offen offset:2048 sc1
  v_mfma_f32_16x16x32_bf16 v[68:71], a[76:79], v[108:111], v[68:71]
  buffer_load_dwordx4 a[240:243], v4, s[4:7], s22 offen offset:3072 sc1
  s_waitcnt vmcnt(25)
  v_mfma_f32_16x16x32_bf16 v[40:43], a[80:83], v[112:115], v[40:43]
  s_add_u32 s22, s49, 32768
  buffer_load_dwordx4 a[132:135], v4, s[4:7], s22 offen offset:0 sc1
  s_waitcnt vmcnt(25)
  v_mfma_f32_16x16x32_bf16 v[44:47], a[80:83], v[116:119], v[44:47]
  buffer_load_dwordx4 a[148:151], v4, s[4:7], s22 offen offset:1024 sc1
  v_mfma_f32_16x16x32_bf16 v[48:51], a[84:87], v[112:115], v[48:51]
  buffer_load_dwordx4 a[164:167], v4, s[4:7], s22 offen offset:2048 sc1
  v_mfma_f32_16x16x32_bf16 v[52:55], a[84:87], v[116:119], v[52:55]
  buffer_load_dwordx4 a[180:183], v4, s[4:7], s22 offen offset:3072 sc1
  v_mfma_f32_16x16x32_bf16 v[56:59], a[88:91], v[112:115], v[56:59]
  s_add_u32 s22, s49, 36864
  buffer_load_dwordx4 a[196:199], v4, s[4:7], s22 offen offset:0 sc1
  v_mfma_f32_16x16x32_bf16 v[60:63], a[88:91], v[116:119], v[60:63]
  buffer_load_dwordx4 a[212:215], v4, s[4:7], s22 offen offset:1024 sc1
  v_mfma_f32_16x16x32_bf16 v[64:67], a[92:95], v[112:115], v[64:67]
  buffer_load_dwordx4 a[228:231], v4, s[4:7], s22 offen offset:2048 sc1
  v_mfma_f32_16x16x32_bf16 v[68:71], a[92:95], v[116:119], v[68:71]
  buffer_load_dwordx4 a[244:247], v4, s[4:7], s22 offen offset:3072 sc1
  s_waitcnt vmcnt(31)
  v_mfma_f32_16x16x32_bf16 v[40:43], a[96:99], v[120:123], v[40:43]
  s_add_u32 s22, s49, 65536
  buffer_load_dwordx4 a[136:139], v4, s[4:7], s22 offen offset:0 sc1
  s_waitcnt vmcnt(31)
  v_mfma_f32_16x16x32_bf16 v[44:47], a[96:99], v[124:127], v[44:47]
  buffer_load_dwordx4 a[152:155], v4, s[4:7], s22 offen offset:1024 sc1
  v_mfma_f32_16x16x32_bf16 v[48:51], a[100:103], v[120:123], v[48:51]
  buffer_load_dwordx4 a[168:171], v4, s[4:7], s22 offen offset:2048 sc1
  v_mfma_f32_16x16x32_bf16 v[52:55], a[100:103], v[124:127], v[52:55]
  buffer_load_dwordx4 a[184:187], v4, s[4:7], s22 offen offset:3072 sc1
  v_mfma_f32_16x16x32_bf16 v[56:59], a[104:107], v[120:123], v[56:59]
  s_add_u32 s22, s49, 69632
  buffer_load_dwordx4 a[200:203], v4, s[4:7], s22 offen offset:0 sc1
  v_mfma_f32_16x16x32_bf16 v[60:63], a[104:107], v[124:127], v[60:63]
  buffer_load_dwordx4 a[216:219], v4, s[4:7], s22 offen offset:1024 sc1
  v_mfma_f32_16x16x32_bf16 v[64:67], a[108:111], v[120:123], v[64:67]
  buffer_load_dwordx4 a[232:235], v4, s[4:7], s22 offen offset:2048 sc1
  v_mfma_f32_16x16x32_bf16 v[68:71], a[108:111], v[124:127], v[68:71]
  buffer_load_dwordx4 a[248:251], v4, s[4:7], s22 offen offset:3072 sc1
  s_waitcnt vmcnt(37)
  v_mfma_f32_16x16x32_bf16 v[40:43], a[112:115], v[128:131], v[40:43]
  s_add_u32 s22, s49, 98304
  buffer_load_dwordx4 a[140:143], v4, s[4:7], s22 offen offset:0 sc1
  s_waitcnt vmcnt(37)
  v_mfma_f32_16x16x32_bf16 v[44:47], a[112:115], v[132:135], v[44:47]
  buffer_load_dwordx4 a[156:159], v4, s[4:7], s22 offen offset:1024 sc1
  v_mfma_f32_16x16x32_bf16 v[48:51], a[116:119], v[128:131], v[48:51]
  buffer_load_dwordx4 a[172:175], v4, s[4:7], s22 offen offset:2048 sc1
  v_mfma_f32_16x16x32_bf16 v[52:55], a[116:119], v[132:135], v[52:55]
  buffer_load_dwordx4 a[188:191], v4, s[4:7], s22 offen offset:3072 sc1
  v_mfma_f32_16x16x32_bf16 v[56:59], a[120:123], v[128:131], v[56:59]
  s_add_u32 s22, s49, 102400
  buffer_load_dwordx4 a[204:207], v4, s[4:7], s22 offen offset:0 sc1
  v_mfma_f32_16x16x32_bf16 v[60:63], a[120:123], v[132:135], v[60:63]
  buffer_load_dwordx4 a[220:223], v4, s[4:7], s22 offen offset:1024 sc1
  v_mfma_f32_16x16x32_bf16 v[64:67], a[124:127], v[128:131], v[64:67]
  buffer_load_dwordx4 a[236:239], v4, s[4:7], s22 offen offset:2048 sc1
  v_mfma_f32_16x16x32_bf16 v[68:71], a[124:127], v[132:135], v[68:71]
  buffer_load_dwordx4 a[252:255], v4, s[4:7], s22 offen offset:3072 sc1
  s_waitcnt vmcnt(39)
  v_mfma_f32_16x16x32_bf16 v[40:43], v[152:155], v[136:139], v[40:43]
  v_mfma_f32_16x16x32_bf16 v[44:47], v[152:155], v[140:143], v[44:47]
  s_waitcnt vmcnt(37)
  v_mfma_f32_16x16x32_bf16 v[48:51], v[156:159], v[136:139], v[48:51]
  v_mfma_f32_16x16x32_bf16 v[52:55], v[156:159], v[140:143], v[52:55]
  s_waitcnt vmcnt(35)
  v_mfma_f32_16x16x32_bf16 v[56:59], v[160:163], v[136:139], v[56:59]
  v_mfma_f32_16x16x32_bf16 v[60:63], v[160:163], v[140:143], v[60:63]
  s_waitcnt vmcnt(33)
  v_mfma_f32_16x16x32_bf16 v[64:67], v[164:167], v[136:139], v[64:67]
  v_mfma_f32_16x16x32_bf16 v[68:71], v[164:167], v[140:143], v[68:71]
  v_mfma_f32_16x16x32_bf16 v[40:43], v[168:171], v[144:147], v[40:43]
  v_mfma_f32_16x16x32_bf16 v[44:47], v[168:171], v[148:151], v[44:47]
  v_mfma_f32_16x16x32_bf16 v[48:51], v[172:175], v[144:147], v[48:51]
  v_mfma_f32_16x16x32_bf16 v[52:55], v[172:175], v[148:151], v[52:55]
  v_mfma_f32_16x16x32_bf16 v[56:59], v[176:179], v[144:147], v[56:59]
  v_mfma_f32_16x16x32_bf16 v[60:63], v[176:179], v[148:151], v[60:63]
  s_waitcnt vmcnt(32)
  v_mfma_f32_16x16x32_bf16 v[64:67], v[180:183], v[144:147], v[64:67]
  v_mfma_f32_16x16x32_bf16 v[68:71], v[180:183], v[148:151], v[68:71]
  ds_write_b128 v8, v[40:43] offset:0
  ds_write_b128 v8, v[44:47] offset:1024
  ds_write_b128 v8, v[48:51] offset:2048
  ds_write_b128 v8, v[52:55] offset:3072
  ds_write_b128 v8, v[56:59] offset:4096
  ds_write_b128 v8, v[60:63] offset:5120
  ds_write_b128 v8, v[64:67] offset:6144
  s_nop 0
  ds_write_b128 v8, v[68:71] offset:7168
  s_waitcnt lgkmcnt(0)
  s_barrier
  ds_read_b128 v[72:75], v9 offset:0
  ds_read_b128 v[76:79], v9 offset:2048
  ds_read_b128 v[80:83], v9 offset:8192
  ds_read_b128 v[84:87], v9 offset:10240
  ds_read_b128 v[88:91], v9 offset:16384
  ds_read_b128 v[92:95], v9 offset:18432
  ds_read_b128 v[96:99], v9 offset:24576
  ds_read_b128 v[100:103], v9 offset:26624
  s_waitcnt lgkmcnt(5)
  v_pk_add_f32 v[72:73], v[72:73], v[80:81]
  v_pk_add_f32 v[74:75], v[74:75], v[82:83]
  s_waitcnt lgkmcnt(4)
  v_pk_add_f32 v[76:77], v[76:77], v[84:85]
  v_pk_add_f32 v[78:79], v[78:79], v[86:87]
  s_waitcnt lgkmcnt(1)
  v_pk_add_f32 v[88:89], v[88:89], v[96:97]
  v_pk_add_f32 v[90:91], v[90:91], v[98:99]
  s_waitcnt lgkmcnt(0)
  v_pk_add_f32 v[92:93], v[92:93], v[100:101]
  v_pk_add_f32 v[94:95], v[94:95], v[102:103]
  v_pk_add_f32 v[72:73], v[72:73], v[88:89]
  v_pk_add_f32 v[74:75], v[74:75], v[90:91]
  v_pk_add_f32 v[76:77], v[76:77], v[92:93]
  v_pk_add_f32 v[78:79], v[78:79], v[94:95]
  v_lshlrev_b32 v80, 16, v32
  v_and_b32 v81, 0xffff0000, v32
  v_lshlrev_b32 v82, 16, v33
  v_and_b32 v83, 0xffff0000, v33
  v_lshlrev_b32 v84, 16, v34
  v_and_b32 v85, 0xffff0000, v34
  v_lshlrev_b32 v86, 16, v35
  v_and_b32 v87, 0xffff0000, v35
  v_pk_fma_f32 v[80:81], v[72:73], v[16:17], v[80:81]
  v_pk_fma_f32 v[82:83], v[74:75], v[18:19], v[82:83]
  v_pk_fma_f32 v[84:85], v[76:77], v[20:21], v[84:85]
  v_pk_fma_f32 v[86:87], v[78:79], v[22:23], v[86:87]
  v_cvt_pk_bf16_f32 v88, v80, v81
  v_cvt_pk_bf16_f32 v89, v82, v83
  v_cvt_pk_bf16_f32 v90, v84, v85
  v_cvt_pk_bf16_f32 v91, v86, v87
  v_lshlrev_b32 v80, 16, v88
  v_and_b32 v81, 0xffff0000, v88
  v_lshlrev_b32 v82, 16, v89
  v_and_b32 v83, 0xffff0000, v89
  v_lshlrev_b32 v84, 16, v90
  v_and_b32 v85, 0xffff0000, v90
  v_lshlrev_b32 v86, 16, v91
  v_and_b32 v87, 0xffff0000, v91
  v_pk_mul_f32 v[72:73], v[80:81], v[24:25]
  v_pk_mul_f32 v[74:75], v[82:83], v[26:27]
  v_pk_mul_f32 v[76:77], v[84:85], v[28:29]
  v_pk_mul_f32 v[78:79], v[86:87], v[30:31]
  v_cvt_pk_bf16_f32 v92, v72, v73
  v_cvt_pk_bf16_f32 v93, v74, v75
  v_cvt_pk_bf16_f32 v94, v76, v77
  v_cvt_pk_bf16_f32 v95, v78, v79
  v_permlane16_swap_b32 v88, v90
  v_permlane16_swap_b32 v89, v91
  v_permlane16_swap_b32 v92, v94
  v_permlane16_swap_b32 v93, v95
  s_add_u32 s22, s44, 251658240
  buffer_store_dwordx4 v[92:95], v11, s[4:7], s22 offen sc1
  s_add_u32 s22, s44, 13631488
  buffer_store_dwordx4 v[88:91], v11, s[4:7], s22 offen sc1
  v_add_f32 v96, v80, v81
  v_mul_f32 v97, v80, v80
  v_add_f32 v96, v96, v82
  v_add_f32 v96, v96, v83
  v_add_f32 v96, v96, v84
  v_add_f32 v96, v96, v85
  v_add_f32 v96, v96, v86
  v_add_f32 v96, v96, v87
  v_fmac_f32 v97, v81, v81
  v_fmac_f32 v97, v82, v82
  v_fmac_f32 v97, v83, v83
  v_fmac_f32 v97, v84, v84
  v_fmac_f32 v97, v85, v85
  v_fmac_f32 v97, v86, v86
  v_fmac_f32 v97, v87, v87
  v_mov_b32 v98, v96
  s_nop 1
  v_permlane16_swap_b32 v98, v96
  v_add_f32 v96, v96, v98
  v_mov_b32 v98, v96
  s_nop 1
  v_permlane32_swap_b32 v98, v96
  v_add_f32 v96, v96, v98
  v_mov_b32 v99, v97
  s_nop 1
  v_permlane16_swap_b32 v99, v97
  v_add_f32 v97, v97, v99
  v_mov_b32 v99, v97
  s_nop 1
  v_permlane32_swap_b32 v99, v97
  v_add_f32 v97, v97, v99
  s_mov_b64 exec, 0xffff
  buffer_store_dwordx2 v[96:97], v12, s[4:7], s45 offen sc1
  s_mov_b64 exec, -1
  v_xor_b32 v8, 32768, v8
  v_xor_b32 v9, 32768, v9
  v_mov_b32 v15, s31
  s_cmp_lg_u32 s17, 0
  s_waitcnt vmcnt(0)
  s_barrier
  s_cbranch_scc1 L_T_pf0
  s_mov_b64 exec, 1
  buffer_store_dword v15, v5, s[4:7], s36 offen sc1
  s_mov_b64 exec, -1
L_T_pf0:
  s_cmp_ge_u32 s50, s52
  s_cbranch_scc1 L_exit
  s_mul_i32 s20, s50, 6554
  s_lshr_b32 s20, s20, 16
  s_mul_i32 s22, s20, 10
  s_sub_u32 s32, s50, s22
  s_lshl_b32 s24, s32, 1
  s_add_u32 s24, s24, s53
  s_lshl_b32 s22, s24, 7
  s_add_u32 s23, s22, 5120
  buffer_load_dwordx4 v[16:19], v13, s[4:7], s23 offen sc1
  buffer_load_dwordx4 v[20:23], v13, s[4:7], s23 offen offset:64 sc1
  s_add_u32 s23, s22, 10240
  buffer_load_dwordx4 v[24:27], v13, s[4:7], s23 offen sc1
  buffer_load_dwordx4 v[28:31], v13, s[4:7], s23 offen offset:64 sc1
  s_lshl_b32 s25, s20, 1
  s_add_u32 s25, s25, s54
  s_mul_i32 s47, s25, 20480
  s_lshl_b32 s22, s24, 6
  s_add_u32 s47, s47, s22
  buffer_load_dwordx2 v[32:33], v10, s[8:11], s47 offen
  buffer_load_dwordx2 v[34:35], v10, s[8:11], s47 offen offset:32
  s_mul_i32 s44, s25, 20
  s_add_u32 s44, s44, s24
  s_lshl_b32 s45, s44, 7
  s_add_u32 s45, s45, 262144
  s_lshl_b32 s44, s44, 10
  s_lshl_b32 s36, s50, 6
  s_add_u32 s36, s36, 196608
  s_mul_i32 s42, s20, 327680
  s_add_u32 s42, s42, s33
  s_lshl_b32 s22, s32, 13
  s_add_u32 s42, s42, s22
  s_lshl_b32 s40, s20, 16
  s_add_u32 s40, s40, s29
  s_lshl_b32 s43, s20, 14
  s_add_u32 s43, s43, s30
  s_add_u32 s50, s50, s51
  s_mul_i32 s31, s50, 6554
  s_lshr_b32 s31, s31, 16
  s_mul_i32 s22, s31, 10
  s_sub_u32 s48, s50, s22
  s_add_u32 s31, s31, 1
  s_min_u32 s31, s31, 64
  s_cmp_eq_u32 s46, 64
  s_cbranch_scc1 L_T_wu1_ok
  s_branch L_T_wu1_in
L_T_wu1:
  s_sleep 3
L_T_wu1_in:
  buffer_load_dword v15, v6, s[4:7], s34 offen sc1
  s_add_u32 s39, s39, 1
  s_cmp_gt_u32 s39, 200000
  s_cbranch_scc1 L_exit
  s_waitcnt vmcnt(0)
  v_cmp_gt_u32 vcc, s31, v15
  s_cbranch_vccnz L_T_wu1
  v_cmp_gt_u32 vcc, 64, v15
  s_cbranch_vccnz L_T_wu1_ok
  s_mov_b32 s46, 64
L_T_wu1_ok:
  s_add_u32 s31, s20, 1
  s_branch L_T_wp1_in
L_T_wp1:
  s_sleep 3
L_T_wp1_in:
  buffer_load_dword v15, v7, s[4:7], s35 offen sc1
  s_add_u32 s39, s39, 1
  s_cmp_gt_u32 s39, 200000
  s_cbranch_scc1 L_exit
  s_waitcnt vmcnt(0)
  v_cmp_gt_u32 vcc, s31, v15
  s_cbranch_vccnz L_T_wp1
  s_add_u32 s22, s40, 0
  buffer_load_dwordx4 v[72:75], v4, s[4:7], s22 offen offset:0 sc1
  s_add_u32 s23, s40, 32768
  buffer_load_dwordx4 v[76:79], v4, s[4:7], s23 offen offset:0 sc1
  buffer_load_dwordx4 v[80:83], v4, s[4:7], s22 offen offset:1024 sc1
  buffer_load_dwordx4 v[84:87], v4, s[4:7], s23 offen offset:1024 sc1
  buffer_load_dwordx4 v[88:91], v4, s[4:7], s22 offen offset:2048 sc1
  buffer_load_dwordx4 v[92:95], v4, s[4:7], s23 offen offset:2048 sc1
  buffer_load_dwordx4 v[96:99], v4, s[4:7], s22 offen offset:3072 sc1
  buffer_load_dwordx4 v[100:103], v4, s[4:7], s23 offen offset:3072 sc1
  s_add_u32 s22, s40, 4096
  buffer_load_dwordx4 v[104:107], v4, s[4:7], s22 offen offset:0 sc1
  s_add_u32 s23, s40, 36864
  buffer_load_dwordx4 v[108:111], v4, s[4:7], s23 offen offset:0 sc1
  buffer_load_dwordx4 v[112:115], v4, s[4:7], s22 offen offset:1024 sc1
  buffer_load_dwordx4 v[116:119], v4, s[4:7], s23 offen offset:1024 sc1
  buffer_load_dwordx4 v[120:123], v4, s[4:7], s22 offen offset:2048 sc1
  buffer_load_dwordx4 v[124:127], v4, s[4:7], s23 offen offset:2048 sc1
  buffer_load_dwordx4 v[128:131], v4, s[4:7], s22 offen offset:3072 sc1
  buffer_load_dwordx4 v[132:135], v4, s[4:7], s23 offen offset:3072 sc1
  s_add_u32 s22, s43, 0
  buffer_load_dwordx4 v[136:139], v4, s[4:7], s22 offen offset:0 sc1
  buffer_load_dwordx4 v[144:147], v4, s[4:7], s22 offen offset:1024 sc1
  s_add_u32 s22, s43, 8192
  buffer_load_dwordx4 v[140:143], v4, s[4:7], s22 offen offset:0 sc1
  buffer_load_dwordx4 v[148:151], v4, s[4:7], s22 offen offset:1024 sc1
  s_add_u32 s22, s42, 0
  buffer_load_dwordx4 v[152:155], v4, s[4:7], s22 offen offset:0 sc1
  buffer_load_dwordx4 v[168:171], v4, s[4:7], s22 offen offset:1024 sc1
  s_add_u32 s22, s42, 2048
  buffer_load_dwordx4 v[156:159], v4, s[4:7], s22 offen offset:0 sc1
  buffer_load_dwordx4 v[172:175], v4, s[4:7], s22 offen offset:1024 sc1
  s_add_u32 s22, s42, 4096
  buffer_load_dwordx4 v[160:163], v4, s[4:7], s22 offen offset:0 sc1
  buffer_load_dwordx4 v[176:179], v4, s[4:7], s22 offen offset:1024 sc1
  s_add_u32 s22, s42, 6144
  buffer_load_dwordx4 v[164:167], v4, s[4:7], s22 offen offset:0 sc1
  buffer_load_dwordx4 v[180:183], v4, s[4:7], s22 offen offset:1024 sc1
  s_lshl_b32 s49, s50, 17
  s_add_u32 s49, s49, s28
  s_cmp_ge_u32 s50, s52
  s_cselect_b32 s49, 0xf0000000, s49
  s_waitcnt vmcnt(27)
  v_mfma_f32_16x16x32_bf16 v[40:43], a[128:131], v[72:75], 0
  s_waitcnt vmcnt(26)
  v_mfma_f32_16x16x32_bf16 v[44:47], a[128:131], v[76:79], 0
  v_mfma_f32_16x16x32_bf16 v[48:51], a[132:135], v[72:75], 0
  v_mfma_f32_16x16x32_bf16 v[52:55], a[132:135], v[76:79], 0
  v_mfma_f32_16x16x32_bf16 v[56:59], a[136:139], v[72:75], 0
  v_mfma_f32_16x16x32_bf16 v[60:63], a[136:139], v[76:79], 0
  v_mfma_f32_16x16x32_bf16 v[64:67], a[140:143], v[72:75], 0
  v_mfma_f32_16x16x32_bf16 v[68:71], a[140:143], v[76:79], 0
  s_waitcnt vmcnt(25)
  v_mfma_f32_16x16x32_bf16 v[40:43], a[144:147], v[80:83], v[40:43]
  s_waitcnt vmcnt(24)
  v_mfma_f32_16x16x32_bf16 v[44:47], a[144:147], v[84:87], v[44:47]
  v_mfma_f32_16x16x32_bf16 v[48:51], a[148:151], v[80:83], v[48:51]
  v_mfma_f32_16x16x32_bf16 v[52:55], a[148:151], v[84:87], v[52:55]
  v_mfma_f32_16x16x32_bf16 v[56:59], a[152:155], v[80:83], v[56:59]
  v_mfma_f32_16x16x32_bf16 v[60:63], a[152:155], v[84:87], v[60:63]
  v_mfma_f32_16x16x32_bf16 v[64:67], a[156:159], v[80:83], v[64:67]
  v_mfma_f32_16x16x32_bf16 v[68:71], a[156:159], v[84:87], v[68:71]
  s_waitcnt vmcnt(23)
  v_mfma_f32_16x16x32_bf16 v[40:43], a[160:163], v[88:91], v[40:43]
  s_waitcnt vmcnt(22)
  v_mfma_f32_16x16x32_bf16 v[44:47], a[160:163], v[92:95], v[44:47]
  v_mfma_f32_16x16x32_bf16 v[48:51], a[164:167], v[88:91], v[48:51]
  v_mfma_f32_16x16x32_bf16 v[52:55], a[164:167], v[92:95], v[52:55]
  v_mfma_f32_16x16x32_bf16 v[56:59], a[168:171], v[88:91], v[56:59]
  v_mfma_f32_16x16x32_bf16 v[60:63], a[168:171], v[92:95], v[60:63]
  v_mfma_f32_16x16x32_bf16 v[64:67], a[172:175], v[88:91], v[64:67]
  v_mfma_f32_16x16x32_bf16 v[68:71], a[172:175], v[92:95], v[68:71]
  s_waitcnt vmcnt(21)
  v_mfma_f32_16x16x32_bf16 v[40:43], a[176:179], v[96:99], v[40:43]
  s_waitcnt vmcnt(20)
  v_mfma_f32_16x16x32_bf16 v[44:47], a[176:179], v[100:103], v[44:47]
  v_mfma_f32_16x16x32_bf16 v[48:51], a[180:183], v[96:99], v[48:51]
  v_mfma_f32_16x16x32_bf16 v[52:55], a[180:183], v[100:103], v[52:55]
  v_mfma_f32_16x16x32_bf16 v[56:59], a[184:187], v[96:99], v[56:59]
  v_mfma_f32_16x16x32_bf16 v[60:63], a[184:187], v[100:103], v[60:63]
  v_mfma_f32_16x16x32_bf16 v[64:67], a[188:191], v[96:99], v[64:67]
  v_mfma_f32_16x16x32_bf16 v[68:71], a[188:191], v[100:103], v[68:71]
  s_waitcnt vmcnt(19)
  v_mfma_f32_16x16x32_bf16 v[40:43], a[192:195], v[104:107], v[40:43]
  s_add_u32 s22, s49, 0
  buffer_load_dwordx4 a[0:3], v4, s[4:7], s22 offen offset:0 sc1
  s_waitcnt vmcnt(19)
  v_mfma_f32_16x16x32_bf16 v[44:47], a[192:195], v[108:111], v[44:47]
  buffer_load_dwordx4 a[16:19], v4, s[4:7], s22 offen offset:1024 sc1
  v_mfma_f32_16x16x32_bf16 v[48:51], a[196:199], v[104:107], v[48:51]
  buffer_load_dwordx4 a[32:35], v4, s[4:7], s22 offen offset:2048 sc1
  v_mfma_f32_16x16x32_bf16 v[52:55], a[196:199], v[108:111], v[52:55]
  buffer_load_dwordx4 a[48:51], v4, s[4:7], s22 offen offset:3072 sc1
  v_mfma_f32_16x16x32_bf16 v[56:59], a[200:203], v[104:107], v[56:59]
  s_add_u32 s22, s49, 4096
  buffer_load_dwordx4 a[64:67], v4, s[4:7], s22 offen offset:0 sc1
  v_mfma_f32_16x16x32_bf16 v[60:63], a[200:203], v[108:111], v[60:63]
  buffer_load_dwordx4 a[80:83], v4, s[4:7], s22 offen offset:1024 sc1
  v_mfma_f32_16x16x32_bf16 v[64:67], a[204:207], v[104:107], v[64:67]
  buffer_load_dwordx4 a[96:99], v4, s[4:7], s22 offen offset:2048 sc1
  v_mfma_f32_16x16x32_bf16 v[68:71], a[204:207], v[108:111], v[68:71]
  buffer_load_dwordx4 a[112:115], v4, s[4:7], s22 offen offset:3072 sc1
  s_waitcnt vmcnt(25)
  v_mfma_f32_16x16x32_bf16 v[40:43], a[208:211], v[112:115], v[40:43]
  s_add_u32 s22, s49, 32768
  buffer_load_dwordx4 a[4:7], v4, s[4:7], s22 offen offset:0 sc1
  s_waitcnt vmcnt(25)
  v_mfma_f32_16x16x32_bf16 v[44:47], a[208:211], v[116:119], v[44:47]
  buffer_load_dwordx4 a[20:23], v4, s[4:7], s22 offen offset:1024 sc1
  v_mfma_f32_16x16x32_bf16 v[48:51], a[212:215], v[112:115], v[48:51]
  buffer_load_dwordx4 a[36:39], v4, s[4:7], s22 offen offset:2048 sc1
  v_mfma_f32_16x16x32_bf16 v[52:55], a[212:215], v[116:119], v[52:55]
  buffer_load_dwordx4 a[52:55], v4, s[4:7], s22 offen offset:3072 sc1
  v_mfma_f32_16x16x32_bf16 v[56:59], a[216:219], v[112:115], v[56:59]
  s_add_u32 s22, s49, 36864
  buffer_load_dwordx4 a[68:71], v4, s[4:7], s22 offen offset:0 sc1
  v_mfma_f32_16x16x32_bf16 v[60:63], a[216:219], v[116:119], v[60:63]
  buffer_load_dwordx4 a[84:87], v4, s[4:7], s22 offen offset:1024 sc1
  v_mfma_f32_16x16x32_bf16 v[64:67], a[220:223], v[112:115], v[64:67]
  buffer_load_dwordx4 a[100:103], v4, s[4:7], s22 offen offset:2048 sc1
  v_mfma_f32_16x16x32_bf16 v[68:71], a[220:223], v[116:119], v[68:71]
  buffer_load_dwordx4 a[116:119], v4, s[4:7], s22 offen offset:3072 sc1
  s_waitcnt vmcnt(31)
  v_mfma_f32_16x16x32_bf16 v[40:43], a[224:227], v[120:123], v[40:43]
  s_add_u32 s22, s49, 65536
  buffer_load_dwordx4 a[8:11], v4, s[4:7], s22 offen offset:0 sc1
  s_waitcnt vmcnt(31)
  v_mfma_f32_16x16x32_bf16 v[44:47], a[224:227], v[124:127], v[44:47]
  buffer_load_dwordx4 a[24:27], v4, s[4:7], s22 offen offset:1024 sc1
  v_mfma_f32_16x16x32_bf16 v[48:51], a[228:231], v[120:123], v[48:51]
  buffer_load_dwordx4 a[40:43], v4, s[4:7], s22 offen offset:2048 sc1
  v_mfma_f32_16x16x32_bf16 v[52:55], a[228:231], v[124:127], v[52:55]
  buffer_load_dwordx4 a[56:59], v4, s[4:7], s22 offen offset:3072 sc1
  v_mfma_f32_16x16x32_bf16 v[56:59], a[232:235], v[120:123], v[56:59]
  s_add_u32 s22, s49, 69632
  buffer_load_dwordx4 a[72:75], v4, s[4:7], s22 offen offset:0 sc1
  v_mfma_f32_16x16x32_bf16 v[60:63], a[232:235], v[124:127], v[60:63]
  buffer_load_dwordx4 a[88:91], v4, s[4:7], s22 offen offset:1024 sc1
  v_mfma_f32_16x16x32_bf16 v[64:67], a[236:239], v[120:123], v[64:67]
  buffer_load_dwordx4 a[104:107], v4, s[4:7], s22 offen offset:2048 sc1
  v_mfma_f32_16x16x32_bf16 v[68:71], a[236:239], v[124:127], v[68:71]
  buffer_load_dwordx4 a[120:123], v4, s[4:7], s22 offen offset:3072 sc1
  s_waitcnt vmcnt(37)
  v_mfma_f32_16x16x32_bf16 v[40:43], a[240:243], v[128:131], v[40:43]
  s_add_u32 s22, s49, 98304
  buffer_load_dwordx4 a[12:15], v4, s[4:7], s22 offen offset:0 sc1
  s_waitcnt vmcnt(37)
  v_mfma_f32_16x16x32_bf16 v[44:47], a[240:243], v[132:135], v[44:47]
  buffer_load_dwordx4 a[28:31], v4, s[4:7], s22 offen offset:1024 sc1
  v_mfma_f32_16x16x32_bf16 v[48:51], a[244:247], v[128:131], v[48:51]
  buffer_load_dwordx4 a[44:47], v4, s[4:7], s22 offen offset:2048 sc1
  v_mfma_f32_16x16x32_bf16 v[52:55], a[244:247], v[132:135], v[52:55]
  buffer_load_dwordx4 a[60:63], v4, s[4:7], s22 offen offset:3072 sc1
  v_mfma_f32_16x16x32_bf16 v[56:59], a[248:251], v[128:131], v[56:59]
  s_add_u32 s22, s49, 102400
  buffer_load_dwordx4 a[76:79], v4, s[4:7], s22 offen offset:0 sc1
  v_mfma_f32_16x16x32_bf16 v[60:63], a[248:251], v[132:135], v[60:63]
  buffer_load_dwordx4 a[92:95], v4, s[4:7], s22 offen offset:1024 sc1
  v_mfma_f32_16x16x32_bf16 v[64:67], a[252:255], v[128:131], v[64:67]
  buffer_load_dwordx4 a[108:111], v4, s[4:7], s22 offen offset:2048 sc1
  v_mfma_f32_16x16x32_bf16 v[68:71], a[252:255], v[132:135], v[68:71]
  buffer_load_dwordx4 a[124:127], v4, s[4:7], s22 offen offset:3072 sc1
  s_waitcnt vmcnt(39)
  v_mfma_f32_16x16x32_bf16 v[40:43], v[152:155], v[136:139], v[40:43]
  v_mfma_f32_16x16x32_bf16 v[44:47], v[152:155], v[140:143], v[44:47]
  s_waitcnt vmcnt(37)
  v_mfma_f32_16x16x32_bf16 v[48:51], v[156:159], v[136:139], v[48:51]
  v_mfma_f32_16x16x32_bf16 v[52:55], v[156:159], v[140:143], v[52:55]
  s_waitcnt vmcnt(35)
  v_mfma_f32_16x16x32_bf16 v[56:59], v[160:163], v[136:139], v[56:59]
  v_mfma_f32_16x16x32_bf16 v[60:63], v[160:163], v[140:143], v[60:63]
  s_waitcnt vmcnt(33)
  v_mfma_f32_16x16x32_bf16 v[64:67], v[164:167], v[136:139], v[64:67]
  v_mfma_f32_16x16x32_bf16 v[68:71], v[164:167], v[140:143], v[68:71]
  v_mfma_f32_16x16x32_bf16 v[40:43], v[168:171], v[144:147], v[40:43]
  v_mfma_f32_16x16x32_bf16 v[44:47], v[168:171], v[148:151], v[44:47]
  v_mfma_f32_16x16x32_bf16 v[48:51], v[172:175], v[144:147], v[48:51]
  v_mfma_f32_16x16x32_bf16 v[52:55], v[172:175], v[148:151], v[52:55]
  v_mfma_f32_16x16x32_bf16 v[56:59], v[176:179], v[144:147], v[56:59]
  v_mfma_f32_16x16x32_bf16 v[60:63], v[176:179], v[148:151], v[60:63]
  s_waitcnt vmcnt(32)
  v_mfma_f32_16x16x32_bf16 v[64:67], v[180:183], v[144:147], v[64:67]
  v_mfma_f32_16x16x32_bf16 v[68:71], v[180:183], v[148:151], v[68:71]
  ds_write_b128 v8, v[40:43] offset:0
  ds_write_b128 v8, v[44:47] offset:1024
  ds_write_b128 v8, v[48:51] offset:2048
  ds_write_b128 v8, v[52:55] offset:3072
  ds_write_b128 v8, v[56:59] offset:4096
  ds_write_b128 v8, v[60:63] offset:5120
  ds_write_b128 v8, v[64:67] offset:6144
  s_nop 0
  ds_write_b128 v8, v[68:71] offset:7168
  s_waitcnt lgkmcnt(0)
  s_barrier
  ds_read_b128 v[72:75], v9 offset:0
  ds_read_b128 v[76:79], v9 offset:2048
  ds_read_b128 v[80:83], v9 offset:8192
  ds_read_b128 v[84:87], v9 offset:10240
  ds_read_b128 v[88:91], v9 offset:16384
  ds_read_b128 v[92:95], v9 offset:18432
  ds_read_b128 v[96:99], v9 offset:24576
  ds_read_b128 v[100:103], v9 offset:26624
  s_waitcnt lgkmcnt(5)
  v_pk_add_f32 v[72:73], v[72:73], v[80:81]
  v_pk_add_f32 v[74:75], v[74:75], v[82:83]
  s_waitcnt lgkmcnt(4)
  v_pk_add_f32 v[76:77], v[76:77], v[84:85]
  v_pk_add_f32 v[78:79], v[78:79], v[86:87]
  s_waitcnt lgkmcnt(1)
  v_pk_add_f32 v[88:89], v[88:89], v[96:97]
  v_pk_add_f32 v[90:91], v[90:91], v[98:99]
  s_waitcnt lgkmcnt(0)
  v_pk_add_f32 v[92:93], v[92:93], v[100:101]
  v_pk_add_f32 v[94:95], v[94:95], v[102:103]
  v_pk_add_f32 v[72:73], v[72:73], v[88:89]
  v_pk_add_f32 v[74:75], v[74:75], v[90:91]
  v_pk_add_f32 v[76:77], v[76:77], v[92:93]
  v_pk_add_f32 v[78:79], v[78:79], v[94:95]
  v_lshlrev_b32 v80, 16, v32
  v_and_b32 v81, 0xffff0000, v32
  v_lshlrev_b32 v82, 16, v33
  v_and_b32 v83, 0xffff0000, v33
  v_lshlrev_b32 v84, 16, v34
  v_and_b32 v85, 0xffff0000, v34
  v_lshlrev_b32 v86, 16, v35
  v_and_b32 v87, 0xffff0000, v35
  v_pk_fma_f32 v[80:81], v[72:73], v[16:17], v[80:81]
  v_pk_fma_f32 v[82:83], v[74:75], v[18:19], v[82:83]
  v_pk_fma_f32 v[84:85], v[76:77], v[20:21], v[84:85]
  v_pk_fma_f32 v[86:87], v[78:79], v[22:23], v[86:87]
  v_cvt_pk_bf16_f32 v88, v80, v81
  v_cvt_pk_bf16_f32 v89, v82, v83
  v_cvt_pk_bf16_f32 v90, v84, v85
  v_cvt_pk_bf16_f32 v91, v86, v87
  v_lshlrev_b32 v80, 16, v88
  v_and_b32 v81, 0xffff0000, v88
  v_lshlrev_b32 v82, 16, v89
  v_and_b32 v83, 0xffff0000, v89
  v_lshlrev_b32 v84, 16, v90
  v_and_b32 v85, 0xffff0000, v90
  v_lshlrev_b32 v86, 16, v91
  v_and_b32 v87, 0xffff0000, v91
  v_pk_mul_f32 v[72:73], v[80:81], v[24:25]
  v_pk_mul_f32 v[74:75], v[82:83], v[26:27]
  v_pk_mul_f32 v[76:77], v[84:85], v[28:29]
  v_pk_mul_f32 v[78:79], v[86:87], v[30:31]
  v_cvt_pk_bf16_f32 v92, v72, v73
  v_cvt_pk_bf16_f32 v93, v74, v75
  v_cvt_pk_bf16_f32 v94, v76, v77
  v_cvt_pk_bf16_f32 v95, v78, v79
  v_permlane16_swap_b32 v88, v90
  v_permlane16_swap_b32 v89, v91
  v_permlane16_swap_b32 v92, v94
  v_permlane16_swap_b32 v93, v95
  s_add_u32 s22, s44, 251658240
  buffer_store_dwordx4 v[92:95], v11, s[4:7], s22 offen sc1
  s_add_u32 s22, s44, 13631488
  buffer_store_dwordx4 v[88:91], v11, s[4:7], s22 offen sc1
  v_add_f32 v96, v80, v81
  v_mul_f32 v97, v80, v80
  v_add_f32 v96, v96, v82
  v_add_f32 v96, v96, v83
  v_add_f32 v96, v96, v84
  v_add_f32 v96, v96, v85
  v_add_f32 v96, v96, v86
  v_add_f32 v96, v96, v87
  v_fmac_f32 v97, v81, v81
  v_fmac_f32 v97, v82, v82
  v_fmac_f32 v97, v83, v83
  v_fmac_f32 v97, v84, v84
  v_fmac_f32 v97, v85, v85
  v_fmac_f32 v97, v86, v86
  v_fmac_f32 v97, v87, v87
  v_mov_b32 v98, v96
  s_nop 1
  v_permlane16_swap_b32 v98, v96
  v_add_f32 v96, v96, v98
  v_mov_b32 v98, v96
  s_nop 1
  v_permlane32_swap_b32 v98, v96
  v_add_f32 v96, v96, v98
  v_mov_b32 v99, v97
  s_nop 1
  v_permlane16_swap_b32 v99, v97
  v_add_f32 v97, v97, v99
  v_mov_b32 v99, v97
  s_nop 1
  v_permlane32_swap_b32 v99, v97
  v_add_f32 v97, v97, v99
  s_mov_b64 exec, 0xffff
  buffer_store_dwordx2 v[96:97], v12, s[4:7], s45 offen sc1
  s_mov_b64 exec, -1
  v_xor_b32 v8, 32768, v8
  v_xor_b32 v9, 32768, v9
  v_mov_b32 v15, s31
  s_cmp_lg_u32 s17, 0
  s_waitcnt vmcnt(0)
  s_barrier
  s_cbranch_scc1 L_T_pf1
  s_mov_b64 exec, 1
  buffer_store_dword v15, v5, s[4:7], s36 offen sc1
  s_mov_b64 exec, -1
L_T_pf1:
  s_cmp_ge_u32 s50, s52
  s_cbranch_scc1 L_exit
  s_branch L_T_loop
L_proj:
  s_mul_i32 s32, s18, 384
  v_lshrrev_b32 v16, 3, v1
  v_and_b32 v17, 7, v1
  v_lshrrev_b32 v19, 1, v17
  v_lshrrev_b32 v20, 1, v16
  v_xor_b32 v19, v19, v20
  v_lshlrev_b32 v18, 5, v19
  v_and_b32 v19, 1, v17
  v_lshl_add_u32 v18, v19, 4, v18
  v_lshrrev_b32 v19, 2, v16
  v_and_b32 v20, 3, v16
  v_lshl_add_u32 v21, v19, 3, v20
  s_lshr_b32 s22, s17, 1
  s_lshl_b32 s22, s22, 5
  s_and_b32 s23, s17, 1
  s_lshl_b32 s23, s23, 2
  s_add_u32 s22, s22, s23
  v_add_u32 v21, s22, v21
  s_mov_b32 s22, 12288
  v_mul_lo_u32 v21, v21, s22
  v_add_u32 v21, v21, v18
  s_mul_i32 s24, s17, 6144
  s_and_b32 s25, s17, 1
  s_mul_i32 s25, s25, 10240
  s_lshr_b32 s22, s17, 1
  s_mul_i32 s22, s22, 5120
  s_add_u32 s25, s25, s22
  v_bfe_u32 v16, v1, 2, 3
  v_and_b32 v17, 3, v1
  v_lshlrev_b32 v17, 3, v17
  v_lshl_add_u32 v17, v16, 7, v17
  v_lshrrev_b32 v16, 1, v16
  v_lshrrev_b32 v20, 5, v1
  s_mul_i32 s22, s17, 3
  s_add_u32 s22, s22, 0
  s_and_b32 s23, s22, 3
  s_lshr_b32 s22, s22, 2
  s_lshl_b32 s22, s22, 10
  v_xor_b32 v19, s23, v16
  v_lshl_add_u32 v22, v19, 5, v17
  v_add_u32 v22, s22, v22
  v_mul_u32_u24 v19, 3072, v20
  v_add_u32 v22, v22, v19
  s_mul_i32 s22, s17, 3
  s_add_u32 s22, s22, 1
  s_and_b32 s23, s22, 3
  s_lshr_b32 s22, s22, 2
  s_lshl_b32 s22, s22, 10
  v_xor_b32 v19, s23, v16
  v_lshl_add_u32 v23, v19, 5, v17
  v_add_u32 v23, s22, v23
  v_mul_u32_u24 v19, 3072, v20
  v_add_u32 v23, v23, v19
  s_mul_i32 s22, s17, 3
  s_add_u32 s22, s22, 2
  s_and_b32 s23, s22, 3
  s_lshr_b32 s22, s22, 2
  s_lshl_b32 s22, s22, 10
  v_xor_b32 v19, s23, v16
  v_lshl_add_u32 v24, v19, 5, v17
  v_add_u32 v24, s22, v24
  v_mul_u32_u24 v19, 3072, v20
  v_add_u32 v24, v24, v19
  s_add_u32 m0, s24, 0
  s_add_u32 s26, s32, 0
  buffer_load_dwordx4 v21, s[8:11], s26 offen  lds
  s_add_u32 m0, s24, 1024
  s_add_u32 s26, s32, 128
  buffer_load_dwordx4 v21, s[8:11], s26 offen  lds
  s_add_u32 m0, s24, 2048
  s_add_u32 s26, s32, 256
  buffer_load_dwordx4 v21, s[8:11], s26 offen  lds
  s_add_u32 m0, s24, 3072
  s_add_u32 s26, s32, 196608
  buffer_load_dwordx4 v21, s[8:11], s26 offen  lds
  s_add_u32 m0, s24, 4096
  s_add_u32 s26, s32, 196736
  buffer_load_dwordx4 v21, s[8:11], s26 offen  lds
  s_add_u32 m0, s24, 5120
  s_add_u32 s26, s32, 196864
  buffer_load_dwordx4 v21, s[8:11], s26 offen  lds
  s_waitcnt vmcnt(0)
  s_barrier
  s_add_u32 m0, s24, 24576
  s_add_u32 s26, s32, 786432
  buffer_load_dwordx4 v21, s[8:11], s26 offen  lds
  s_add_u32 m0, s24, 25600
  s_add_u32 s26, s32, 786560
  buffer_load_dwordx4 v21, s[8:11], s26 offen  lds
  s_add_u32 m0, s24, 26624
  s_add_u32 s26, s32, 786688
  buffer_load_dwordx4 v21, s[8:11], s26 offen  lds
  s_add_u32 m0, s24, 27648
  s_add_u32 s26, s32, 983040
  buffer_load_dwordx4 v21, s[8:11], s26 offen  lds
  s_add_u32 m0, s24, 28672
  s_add_u32 s26, s32, 983168
  buffer_load_dwordx4 v21, s[8:11], s26 offen  lds
  s_add_u32 m0, s24, 29696
  s_add_u32 s26, s32, 983296
  buffer_load_dwordx4 v21, s[8:11], s26 offen  lds
  s_add_u32 m0, s24, 49152
  s_add_u32 s26, s32, 1572864
  buffer_load_dwordx4 v21, s[8:11], s26 offen  lds
  s_add_u32 m0, s24, 50176
  s_add_u32 s26, s32, 1572992
  buffer_load_dwordx4 v21, s[8:11], s26 offen  lds
  s_add_u32 m0, s24, 51200
  s_add_u32 s26, s32, 1573120
  buffer_load_dwordx4 v21, s[8:11], s26 offen  lds
  s_add_u32 m0, s24, 52224
  s_add_u32 s26, s32, 1769472
  buffer_load_dwordx4 v21, s[8:11], s26 offen  lds
  s_add_u32 m0, s24, 53248
  s_add_u32 s26, s32, 1769600
  buffer_load_dwordx4 v21, s[8:11], s26 offen  lds
  s_add_u32 m0, s24, 54272
  s_add_u32 s26, s32, 1769728
  buffer_load_dwordx4 v21, s[8:11], s26 offen  lds
  s_add_u32 m0, s24, 73728
  s_add_u32 s26, s32, 2359296
  buffer_load_dwordx4 v21, s[8:11], s26 offen  lds
  s_add_u32 m0, s24, 74752
  s_add_u32 s26, s32, 2359424
  buffer_load_dwordx4 v21, s[8:11], s26 offen  lds
  s_add_u32 m0, s24, 75776
  s_add_u32 s26, s32, 2359552
  buffer_load_dwordx4 v21, s[8:11], s26 offen  lds
  s_add_u32 m0, s24, 76800
  s_add_u32 s26, s32, 2555904
  buffer_load_dwordx4 v21, s[8:11], s26 offen  lds
  s_add_u32 m0, s24, 77824
  s_add_u32 s26, s32, 2556032
  buffer_load_dwordx4 v21, s[8:11], s26 offen  lds
  s_add_u32 m0, s24, 78848
  s_add_u32 s26, s32, 2556160
  buffer_load_dwordx4 v21, s[8:11], s26 offen  lds
  s_add_u32 m0, s24, 98304
  s_add_u32 s26, s32, 3145728
  buffer_load_dwordx4 v21, s[8:11], s26 offen  lds
  s_add_u32 m0, s24, 99328
  s_add_u32 s26, s32, 3145856
  buffer_load_dwordx4 v21, s[8:11], s26 offen  lds
  s_add_u32 m0, s24, 100352
  s_add_u32 s26, s32, 3145984
  buffer_load_dwordx4 v21, s[8:11], s26 offen  lds
  s_add_u32 m0, s24, 101376
  s_add_u32 s26, s32, 3342336
  buffer_load_dwordx4 v21, s[8:11], s26 offen  lds
  s_add_u32 m0, s24, 102400
  s_add_u32 s26, s32, 3342464
  buffer_load_dwordx4 v21, s[8:11], s26 offen  lds
  s_add_u32 m0, s24, 103424
  s_add_u32 s26, s32, 3342592
  buffer_load_dwordx4 v21, s[8:11], s26 offen  lds
  s_add_u32 m0, s24, 122880
  s_add_u32 s26, s32, 3932160
  buffer_load_dwordx4 v21, s[8:11], s26 offen  lds
  s_add_u32 m0, s24, 123904
  s_add_u32 s26, s32, 3932288
  buffer_load_dwordx4 v21, s[8:11], s26 offen  lds
  s_add_u32 m0, s24, 124928
  s_add_u32 s26, s32, 3932416
  buffer_load_dwordx4 v21, s[8:11], s26 offen  lds
  s_add_u32 m0, s24, 125952
  s_add_u32 s26, s32, 4128768
  buffer_load_dwordx4 v21, s[8:11], s26 offen  lds
  s_add_u32 m0, s24, 126976
  s_add_u32 s26, s32, 4128896
  buffer_load_dwordx4 v21, s[8:11], s26 offen  lds
  s_add_u32 m0, s24, 128000
  s_add_u32 s26, s32, 4129024
  buffer_load_dwordx4 v21, s[8:11], s26 offen  lds
  v_add_u32 v25, 0, v22
  v_add_u32 v26, 0, v23
  v_add_u32 v27, 0, v24
  ds_read_b64_tr_b16 a[0:1], v25 offset:0
  ds_read_b64_tr_b16 a[2:3], v25 offset:6144
  ds_read_b64_tr_b16 a[12:13], v25 offset:12288
  ds_read_b64_tr_b16 a[14:15], v25 offset:18432
  ds_read_b64_tr_b16 a[4:5], v26 offset:0
  ds_read_b64_tr_b16 a[6:7], v26 offset:6144
  ds_read_b64_tr_b16 a[16:17], v26 offset:12288
  ds_read_b64_tr_b16 a[18:19], v26 offset:18432
  ds_read_b64_tr_b16 a[8:9], v27 offset:0
  ds_read_b64_tr_b16 a[10:11], v27 offset:6144
  ds_read_b64_tr_b16 a[20:21], v27 offset:12288
  ds_read_b64_tr_b16 a[22:23], v27 offset:18432
  s_waitcnt lgkmcnt(0)
  s_waitcnt vmcnt(24)
  s_barrier
  s_add_u32 m0, s24, 0
  s_add_u32 s26, s32, 4718592
  buffer_load_dwordx4 v21, s[8:11], s26 offen  lds
  s_add_u32 m0, s24, 1024
  s_add_u32 s26, s32, 4718720
  buffer_load_dwordx4 v21, s[8:11], s26 offen  lds
  s_add_u32 m0, s24, 2048
  s_add_u32 s26, s32, 4718848
  buffer_load_dwordx4 v21, s[8:11], s26 offen  lds
  s_add_u32 m0, s24, 3072
  s_add_u32 s26, s32, 4915200
  buffer_load_dwordx4 v21, s[8:11], s26 offen  lds
  s_add_u32 m0, s24, 4096
  s_add_u32 s26, s32, 4915328
  buffer_load_dwordx4 v21, s[8:11], s26 offen  lds
  s_add_u32 m0, s24, 5120
  s_add_u32 s26, s32, 4915456
  buffer_load_dwordx4 v21, s[8:11], s26 offen  lds
  v_add_u32 v25, 24576, v22
  v_add_u32 v26, 24576, v23
  v_add_u32 v27, 24576, v24
  ds_read_b64_tr_b16 a[24:25], v25 offset:0
  ds_read_b64_tr_b16 a[26:27], v25 offset:6144
  ds_read_b64_tr_b16 a[36:37], v25 offset:12288
  ds_read_b64_tr_b16 a[38:39], v25 offset:18432
  ds_read_b64_tr_b16 a[28:29], v26 offset:0
  ds_read_b64_tr_b16 a[30:31], v26 offset:6144
  ds_read_b64_tr_b16 a[40:41], v26 offset:12288
  ds_read_b64_tr_b16 a[42:43], v26 offset:18432
  ds_read_b64_tr_b16 a[32:33], v27 offset:0
  ds_read_b64_tr_b16 a[34:35], v27 offset:6144
  ds_read_b64_tr_b16 a[44:45], v27 offset:12288
  ds_read_b64_tr_b16 a[46:47], v27 offset:18432
  s_waitcnt lgkmcnt(0)
  s_waitcnt vmcnt(24)
  s_barrier
  s_add_u32 m0, s24, 24576
  s_add_u32 s26, s32, 5505024
  buffer_load_dwordx4 v21, s[8:11], s26 offen  lds
  s_add_u32 m0, s24, 25600
  s_add_u32 s26, s32, 5505152
  buffer_load_dwordx4 v21, s[8:11], s26 offen  lds
  s_add_u32 m0, s24, 26624
  s_add_u32 s26, s32, 5505280
  buffer_load_dwordx4 v21, s[8:11], s26 offen  lds
  s_add_u32 m0, s24, 27648
  s_add_u32 s26, s32, 5701632
  buffer_load_dwordx4 v21, s[8:11], s26 offen  lds
  s_add_u32 m0, s24, 28672
  s_add_u32 s26, s32, 5701760
  buffer_load_dwordx4 v21, s[8:11], s26 offen  lds
  s_add_u32 m0, s24, 29696
  s_add_u32 s26, s32, 5701888
  buffer_load_dwordx4 v21, s[8:11], s26 offen  lds
  v_add_u32 v25, 49152, v22
  v_add_u32 v26, 49152, v23
  v_add_u32 v27, 49152, v24
  ds_read_b64_tr_b16 a[48:49], v25 offset:0
  ds_read_b64_tr_b16 a[50:51], v25 offset:6144
  ds_read_b64_tr_b16 a[60:61], v25 offset:12288
  ds_read_b64_tr_b16 a[62:63], v25 offset:18432
  ds_read_b64_tr_b16 a[52:53], v26 offset:0
  ds_read_b64_tr_b16 a[54:55], v26 offset:6144
  ds_read_b64_tr_b16 a[64:65], v26 offset:12288
  ds_read_b64_tr_b16 a[66:67], v26 offset:18432
  ds_read_b64_tr_b16 a[56:57], v27 offset:0
  ds_read_b64_tr_b16 a[58:59], v27 offset:6144
  ds_read_b64_tr_b16 a[68:69], v27 offset:12288
  ds_read_b64_tr_b16 a[70:71], v27 offset:18432
  s_waitcnt lgkmcnt(0)
  s_waitcnt vmcnt(24)
  s_barrier
  s_add_u32 m0, s24, 49152
  s_add_u32 s26, s32, 6291456
  buffer_load_dwordx4 v21, s[8:11], s26 offen  lds
  s_add_u32 m0, s24, 50176
  s_add_u32 s26, s32, 6291584
  buffer_load_dwordx4 v21, s[8:11], s26 offen  lds
  s_add_u32 m0, s24, 51200
  s_add_u32 s26, s32, 6291712
  buffer_load_dwordx4 v21, s[8:11], s26 offen  lds
  s_add_u32 m0, s24, 52224
  s_add_u32 s26, s32, 6488064
  buffer_load_dwordx4 v21, s[8:11], s26 offen  lds
  s_add_u32 m0, s24, 53248
  s_add_u32 s26, s32, 6488192
  buffer_load_dwordx4 v21, s[8:11], s26 offen  lds
  s_add_u32 m0, s24, 54272
  s_add_u32 s26, s32, 6488320
  buffer_load_dwordx4 v21, s[8:11], s26 offen  lds
  v_add_u32 v25, 73728, v22
  v_add_u32 v26, 73728, v23
  v_add_u32 v27, 73728, v24
  ds_read_b64_tr_b16 a[72:73], v25 offset:0
  ds_read_b64_tr_b16 a[74:75], v25 offset:6144
  ds_read_b64_tr_b16 a[84:85], v25 offset:12288
  ds_read_b64_tr_b16 a[86:87], v25 offset:18432
  ds_read_b64_tr_b16 a[76:77], v26 offset:0
  ds_read_b64_tr_b16 a[78:79], v26 offset:6144
  ds_read_b64_tr_b16 a[88:89], v26 offset:12288
  ds_read_b64_tr_b16 a[90:91], v26 offset:18432
  ds_read_b64_tr_b16 a[80:81], v27 offset:0
  ds_read_b64_tr_b16 a[82:83], v27 offset:6144
  ds_read_b64_tr_b16 a[92:93], v27 offset:12288
  ds_read_b64_tr_b16 a[94:95], v27 offset:18432
  s_waitcnt lgkmcnt(0)
  s_waitcnt vmcnt(24)
  s_barrier
  s_add_u32 m0, s24, 73728
  s_add_u32 s26, s32, 7077888
  buffer_load_dwordx4 v21, s[8:11], s26 offen  lds
  s_add_u32 m0, s24, 74752
  s_add_u32 s26, s32, 7078016
  buffer_load_dwordx4 v21, s[8:11], s26 offen  lds
  s_add_u32 m0, s24, 75776
  s_add_u32 s26, s32, 7078144
  buffer_load_dwordx4 v21, s[8:11], s26 offen  lds
  s_add_u32 m0, s24, 76800
  s_add_u32 s26, s32, 7274496
  buffer_load_dwordx4 v21, s[8:11], s26 offen  lds
  s_add_u32 m0, s24, 77824
  s_add_u32 s26, s32, 7274624
  buffer_load_dwordx4 v21, s[8:11], s26 offen  lds
  s_add_u32 m0, s24, 78848
  s_add_u32 s26, s32, 7274752
  buffer_load_dwordx4 v21, s[8:11], s26 offen  lds
  v_add_u32 v25, 98304, v22
  v_add_u32 v26, 98304, v23
  v_add_u32 v27, 98304, v24
  ds_read_b64_tr_b16 a[96:97], v25 offset:0
  ds_read_b64_tr_b16 a[98:99], v25 offset:6144
  ds_read_b64_tr_b16 a[108:109], v25 offset:12288
  ds_read_b64_tr_b16 a[110:111], v25 offset:18432
  ds_read_b64_tr_b16 a[100:101], v26 offset:0
  ds_read_b64_tr_b16 a[102:103], v26 offset:6144
  ds_read_b64_tr_b16 a[112:113], v26 offset:12288
  ds_read_b64_tr_b16 a[114:115], v26 offset:18432
  ds_read_b64_tr_b16 a[104:105], v27 offset:0
  ds_read_b64_tr_b16 a[106:107], v27 offset:6144
  ds_read_b64_tr_b16 a[116:117], v27 offset:12288
  ds_read_b64_tr_b16 a[118:119], v27 offset:18432
  s_waitcnt lgkmcnt(0)
  s_waitcnt vmcnt(24)
  s_barrier
  v_add_u32 v25, 122880, v22
  v_add_u32 v26, 122880, v23
  v_add_u32 v27, 122880, v24
  ds_read_b64_tr_b16 a[120:121], v25 offset:0
  ds_read_b64_tr_b16 a[122:123], v25 offset:6144
  ds_read_b64_tr_b16 a[132:133], v25 offset:12288
  ds_read_b64_tr_b16 a[134:135], v25 offset:18432
  ds_read_b64_tr_b16 a[124:125], v26 offset:0
  ds_read_b64_tr_b16 a[126:127], v26 offset:6144
  ds_read_b64_tr_b16 a[136:137], v26 offset:12288
  ds_read_b64_tr_b16 a[138:139], v26 offset:18432
  ds_read_b64_tr_b16 a[128:129], v27 offset:0
  ds_read_b64_tr_b16 a[130:131], v27 offset:6144
  ds_read_b64_tr_b16 a[140:141], v27 offset:12288
  ds_read_b64_tr_b16 a[142:143], v27 offset:18432
  s_waitcnt lgkmcnt(0)
  s_waitcnt vmcnt(18)
  s_barrier
  v_add_u32 v25, 0, v22
  v_add_u32 v26, 0, v23
  v_add_u32 v27, 0, v24
  ds_read_b64_tr_b16 a[144:145], v25 offset:0
  ds_read_b64_tr_b16 a[146:147], v25 offset:6144
  ds_read_b64_tr_b16 a[156:157], v25 offset:12288
  ds_read_b64_tr_b16 a[158:159], v25 offset:18432
  ds_read_b64_tr_b16 a[148:149], v26 offset:0
  ds_read_b64_tr_b16 a[150:151], v26 offset:6144
  ds_read_b64_tr_b16 a[160:161], v26 offset:12288
  ds_read_b64_tr_b16 a[162:163], v26 offset:18432
  ds_read_b64_tr_b16 a[152:153], v27 offset:0
  ds_read_b64_tr_b16 a[154:155], v27 offset:6144
  ds_read_b64_tr_b16 a[164:165], v27 offset:12288
  ds_read_b64_tr_b16 a[166:167], v27 offset:18432
  s_waitcnt lgkmcnt(0)
  s_waitcnt vmcnt(12)
  s_barrier
  v_add_u32 v25, 24576, v22
  v_add_u32 v26, 24576, v23
  v_add_u32 v27, 24576, v24
  ds_read_b64_tr_b16 a[168:169], v25 offset:0
  ds_read_b64_tr_b16 a[170:171], v25 offset:6144
  ds_read_b64_tr_b16 a[180:181], v25 offset:12288
  ds_read_b64_tr_b16 a[182:183], v25 offset:18432
  ds_read_b64_tr_b16 a[172:173], v26 offset:0
  ds_read_b64_tr_b16 a[174:175], v26 offset:6144
  ds_read_b64_tr_b16 a[184:185], v26 offset:12288
  ds_read_b64_tr_b16 a[186:187], v26 offset:18432
  ds_read_b64_tr_b16 a[176:177], v27 offset:0
  ds_read_b64_tr_b16 a[178:179], v27 offset:6144
  ds_read_b64_tr_b16 a[188:189], v27 offset:12288
  ds_read_b64_tr_b16 a[190:191], v27 offset:18432
  s_waitcnt lgkmcnt(0)
  s_waitcnt vmcnt(6)
  s_barrier
  buffer_load_dword v48, off, s[96:99], 0 offset:128 sc1
  buffer_load_dword v49, off, s[96:99], s94 sc1
  v_add_u32 v25, 49152, v22
  v_add_u32 v26, 49152, v23
  v_add_u32 v27, 49152, v24
  ds_read_b64_tr_b16 a[192:193], v25 offset:0
  ds_read_b64_tr_b16 a[194:195], v25 offset:6144
  ds_read_b64_tr_b16 a[204:205], v25 offset:12288
  ds_read_b64_tr_b16 a[206:207], v25 offset:18432
  ds_read_b64_tr_b16 a[196:197], v26 offset:0
  ds_read_b64_tr_b16 a[198:199], v26 offset:6144
  ds_read_b64_tr_b16 a[208:209], v26 offset:12288
  ds_read_b64_tr_b16 a[210:211], v26 offset:18432
  ds_read_b64_tr_b16 a[200:201], v27 offset:0
  ds_read_b64_tr_b16 a[202:203], v27 offset:6144
  ds_read_b64_tr_b16 a[212:213], v27 offset:12288
  ds_read_b64_tr_b16 a[214:215], v27 offset:18432
  s_waitcnt lgkmcnt(0)
  s_waitcnt vmcnt(2)
  s_barrier
  v_add_u32 v25, 73728, v22
  v_add_u32 v26, 73728, v23
  v_add_u32 v27, 73728, v24
  ds_read_b64_tr_b16 a[216:217], v25 offset:0
  ds_read_b64_tr_b16 a[218:219], v25 offset:6144
  ds_read_b64_tr_b16 a[228:229], v25 offset:12288
  ds_read_b64_tr_b16 a[230:231], v25 offset:18432
  ds_read_b64_tr_b16 a[220:221], v26 offset:0
  ds_read_b64_tr_b16 a[222:223], v26 offset:6144
  ds_read_b64_tr_b16 a[232:233], v26 offset:12288
  ds_read_b64_tr_b16 a[234:235], v26 offset:18432
  ds_read_b64_tr_b16 a[224:225], v27 offset:0
  ds_read_b64_tr_b16 a[226:227], v27 offset:6144
  ds_read_b64_tr_b16 a[236:237], v27 offset:12288
  ds_read_b64_tr_b16 a[238:239], v27 offset:18432
  s_waitcnt lgkmcnt(0)
  s_waitcnt vmcnt(0)
  s_barrier
  v_mov_b32 v50, 163824
  s_cmp_lg_u32 s17, 0
  s_cbranch_scc1 L_wh1_b
  s_branch L_wh1_t
L_wh1:
  s_sleep 3
L_wh1_in:
  buffer_load_dword v48, off, s[96:99], 0 offset:128 sc1
  buffer_load_dword v49, off, s[96:99], s94 sc1
  s_add_u32 s39, s39, 1
  s_cmp_gt_u32 s39, 200000
  s_cbranch_scc1 L_exit
  s_waitcnt vmcnt(0)
L_wh1_t:
  v_readfirstlane_b32 s19, v48
  v_readfirstlane_b32 s74, v49
  s_nop 0
  s_and_b32 s22, s19, 255
  s_cmp_lt_u32 s22, 64
  s_cbranch_scc1 L_wh1
  s_and_b32 s22, s74, 255
  s_cmp_lt_u32 s22, 26
  s_cbranch_scc1 L_wh1
  ds_write_b64 v50, v[48:49]
  s_waitcnt lgkmcnt(0)
L_wh1_b:
  s_barrier
  ds_read_b64 v[48:49], v50
  s_waitcnt lgkmcnt(0)
  v_readfirstlane_b32 s19, v48
  v_readfirstlane_b32 s74, v49
  s_nop 0
  s_and_b32 s19, s19, 512
  s_lshl_b32 s19, s19, 4
  s_mul_i32 s22, s95, 26
  s_sub_u32 s74, s74, s22
  s_mov_b32 s33, 25165824
  s_cmp_eq_u32 s27, 1
  s_cselect_b32 s33, 75497472, s33
  s_cmp_eq_u32 s27, 3
  s_cselect_b32 s33, 50331648, s33
  s_mul_i32 s22, s18, 12288
  s_add_u32 s33, s33, s22
  s_mul_i32 s22, s17, 3072
  s_add_u32 s33, s33, s22
  s_lshl_b32 s34, s27, 14
  s_add_u32 s34, s34, s19
  s_cmp_eq_u32 s27, 1
  s_cselect_b32 s22, 8192, 0
  s_xor_b32 s34, s34, s22
  s_lshl_b32 s22, s18, 8
  s_add_u32 s34, s34, s22
  s_lshl_b32 s22, s17, 6
  s_add_u32 s34, s34, s22
  s_add_u32 s34, s34, 7405568
  s_mov_b32 s20, 0
  s_mov_b32 s21, 64
  v_lshlrev_b32 v4, 4, v1
  s_mul_i32 s42, s17, 10240
  v_add_u32 v5, s42, v4
  v_mov_b32 v6, 0
  s_mov_b32 s31, 0
  s_mov_b32 s30, 0
  s_min_u32 s23, s31, 63
  s_mul_i32 s23, s23, 40960
  s_add_u32 s23, s23, 1048576
  s_add_u32 s22, s42, s30
  s_add_u32 m0, s22, 0
  s_add_u32 s26, s23, 0
  buffer_load_dwordx4 v5, s[4:7], s26 offen offset:0 sc1 lds
  buffer_load_dwordx4 v5, s[4:7], s26 offen offset:1024 sc1 lds
  buffer_load_dwordx4 v5, s[4:7], s26 offen offset:2048 sc1 lds
  buffer_load_dwordx4 v5, s[4:7], s26 offen offset:3072 sc1 lds
  s_add_u32 m0, s22, 4096
  s_add_u32 s26, s23, 4096
  buffer_load_dwordx4 v5, s[4:7], s26 offen offset:0 sc1 lds
  buffer_load_dwordx4 v5, s[4:7], s26 offen offset:1024 sc1 lds
  buffer_load_dwordx4 v5, s[4:7], s26 offen offset:2048 sc1 lds
  buffer_load_dwordx4 v5, s[4:7], s26 offen offset:3072 sc1 lds
  s_add_u32 m0, s22, 8192
  s_add_u32 s26, s23, 8192
  buffer_load_dwordx4 v5, s[4:7], s26 offen offset:0 sc1 lds
  buffer_load_dwordx4 v5, s[4:7], s26 offen offset:1024 sc1 lds
  s_waitcnt vmcnt(6)
  s_mov_b32 s31, 1
  s_mov_b32 s30, 40960
  s_min_u32 s23, s31, 63
  s_mul_i32 s23, s23, 40960
  s_add_u32 s23, s23, 1048576
  s_add_u32 s22, s42, s30
  s_add_u32 m0, s22, 0
  s_add_u32 s26, s23, 0
  buffer_load_dwordx4 v5, s[4:7], s26 offen offset:0 sc1 lds
  buffer_load_dwordx4 v5, s[4:7], s26 offen offset:1024 sc1 lds
  buffer_load_dwordx4 v5, s[4:7], s26 offen offset:2048 sc1 lds
  buffer_load_dwordx4 v5, s[4:7], s26 offen offset:3072 sc1 lds
  s_add_u32 m0, s22, 4096
  s_add_u32 s26, s23, 4096
  buffer_load_dwordx4 v5, s[4:7], s26 offen offset:0 sc1 lds
  buffer_load_dwordx4 v5, s[4:7], s26 offen offset:1024 sc1 lds
  buffer_load_dwordx4 v5, s[4:7], s26 offen offset:2048 sc1 lds
  buffer_load_dwordx4 v5, s[4:7], s26 offen offset:3072 sc1 lds
  s_add_u32 m0, s22, 8192
  s_add_u32 s26, s23, 8192
  buffer_load_dwordx4 v5, s[4:7], s26 offen offset:0 sc1 lds
  buffer_load_dwordx4 v5, s[4:7], s26 offen offset:1024 sc1 lds
  s_mov_b32 s31, 2
  s_mov_b32 s30, 81920
  s_min_u32 s23, s31, 63
  s_mul_i32 s23, s23, 40960
  s_add_u32 s23, s23, 1048576
  s_add_u32 s22, s42, s30
  s_add_u32 m0, s22, 0
  s_add_u32 s26, s23, 0
  buffer_load_dwordx4 v5, s[4:7], s26 offen offset:0 sc1 lds
  buffer_load_dwordx4 v5, s[4:7], s26 offen offset:1024 sc1 lds
  buffer_load_dwordx4 v5, s[4:7], s26 offen offset:2048 sc1 lds
  buffer_load_dwordx4 v5, s[4:7], s26 offen offset:3072 sc1 lds
  s_add_u32 m0, s22, 4096
  s_add_u32 s26, s23, 4096
  buffer_load_dwordx4 v5, s[4:7], s26 offen offset:0 sc1 lds
  buffer_load_dwordx4 v5, s[4:7], s26 offen offset:1024 sc1 lds
  buffer_load_dwordx4 v5, s[4:7], s26 offen offset:2048 sc1 lds
  buffer_load_dwordx4 v5, s[4:7], s26 offen offset:3072 sc1 lds
  s_add_u32 m0, s22, 8192
  s_add_u32 s26, s23, 8192
  buffer_load_dwordx4 v5, s[4:7], s26 offen offset:0 sc1 lds
  buffer_load_dwordx4 v5, s[4:7], s26 offen offset:1024 sc1 lds
  s_mov_b32 s28, 0
  s_mov_b32 s43, s33
  v_mov_b32 v7, v4
  s_waitcnt vmcnt(20)
  s_barrier
  ds_read_b128 v[16:19], v7 offset:0
  ds_read_b128 v[20:23], v7 offset:20480
  ds_read_b128 v[24:27], v7 offset:1024
  ds_read_b128 v[28:31], v7 offset:21504
  s_waitcnt lgkmcnt(0)
  v_mfma_f32_16x16x32_bf16 v[48:51], a[0:3], v[16:19], 0
  ds_read_b128 v[32:35], v7 offset:2048
  v_mfma_f32_16x16x32_bf16 v[56:59], a[4:7], v[16:19], 0
  ds_read_b128 v[36:39], v7 offset:22528
  v_mfma_f32_16x16x32_bf16 v[64:67], a[8:11], v[16:19], 0
  v_mfma_f32_16x16x32_bf16 v[52:55], a[0:3], v[20:23], 0
  v_mfma_f32_16x16x32_bf16 v[60:63], a[4:7], v[20:23], 0
  v_mfma_f32_16x16x32_bf16 v[68:71], a[8:11], v[20:23], 0
  v_mfma_f32_16x16x32_bf16 v[48:51], a[12:15], v[24:27], v[48:51]
  ds_read_b128 v[40:43], v7 offset:3072
  v_mfma_f32_16x16x32_bf16 v[56:59], a[16:19], v[24:27], v[56:59]
  ds_read_b128 v[44:47], v7 offset:23552
  v_mfma_f32_16x16x32_bf16 v[64:67], a[20:23], v[24:27], v[64:67]
  v_mfma_f32_16x16x32_bf16 v[52:55], a[12:15], v[28:31], v[52:55]
  v_mfma_f32_16x16x32_bf16 v[60:63], a[16:19], v[28:31], v[60:63]
  v_mfma_f32_16x16x32_bf16 v[68:71], a[20:23], v[28:31], v[68:71]
  s_waitcnt lgkmcnt(3)
  v_mfma_f32_16x16x32_bf16 v[48:51], a[24:27], v[32:35], v[48:51]
  ds_read_b128 v[16:19], v7 offset:4096
  v_mfma_f32_16x16x32_bf16 v[56:59], a[28:31], v[32:35], v[56:59]
  ds_read_b128 v[20:23], v7 offset:24576
  v_mfma_f32_16x16x32_bf16 v[64:67], a[32:35], v[32:35], v[64:67]
  s_waitcnt lgkmcnt(4)
  v_mfma_f32_16x16x32_bf16 v[52:55], a[24:27], v[36:39], v[52:55]
  v_mfma_f32_16x16x32_bf16 v[60:63], a[28:31], v[36:39], v[60:63]
  v_mfma_f32_16x16x32_bf16 v[68:71], a[32:35], v[36:39], v[68:71]
  s_waitcnt lgkmcnt(3)
  v_mfma_f32_16x16x32_bf16 v[48:51], a[36:39], v[40:43], v[48:51]
  ds_read_b128 v[24:27], v7 offset:5120
  v_mfma_f32_16x16x32_bf16 v[56:59], a[40:43], v[40:43], v[56:59]
  ds_read_b128 v[28:31], v7 offset:25600
  v_mfma_f32_16x16x32_bf16 v[64:67], a[44:47], v[40:43], v[64:67]
  s_waitcnt lgkmcnt(4)
  v_mfma_f32_16x16x32_bf16 v[52:55], a[36:39], v[44:47], v[52:55]
  v_mfma_f32_16x16x32_bf16 v[60:63], a[40:43], v[44:47], v[60:63]
  v_mfma_f32_16x16x32_bf16 v[68:71], a[44:47], v[44:47], v[68:71]
  s_waitcnt lgkmcnt(3)
  v_mfma_f32_16x16x32_bf16 v[48:51], a[48:51], v[16:19], v[48:51]
  ds_read_b128 v[32:35], v7 offset:6144
  v_mfma_f32_16x16x32_bf16 v[56:59], a[52:55], v[16:19], v[56:59]
  ds_read_b128 v[36:39], v7 offset:26624
  v_mfma_f32_16x16x32_bf16 v[64:67], a[56:59], v[16:19], v[64:67]
  s_waitcnt lgkmcnt(4)
  v_mfma_f32_16x16x32_bf16 v[52:55], a[48:51], v[20:23], v[52:55]
  v_mfma_f32_16x16x32_bf16 v[60:63], a[52:55], v[20:23], v[60:63]
  v_mfma_f32_16x16x32_bf16 v[68:71], a[56:59], v[20:23], v[68:71]
  s_waitcnt lgkmcnt(3)
  v_mfma_f32_16x16x32_bf16 v[48:51], a[60:63], v[24:27], v[48:51]
  ds_read_b128 v[40:43], v7 offset:7168
  v_mfma_f32_16x16x32_bf16 v[56:59], a[64:67], v[24:27], v[56:59]
  ds_read_b128 v[44:47], v7 offset:27648
  v_mfma_f32_16x16x32_bf16 v[64:67], a[68:71], v[24:27], v[64:67]
  s_waitcnt lgkmcnt(4)
  v_mfma_f32_16x16x32_bf16 v[52:55], a[60:63], v[28:31], v[52:55]
  s_add_u32 s29, s28, 40960
  s_cmp_eq_u32 s29, 163840
  s_cselect_b32 s29, 0, s29
  v_mfma_f32_16x16x32_bf16 v[60:63], a[64:67], v[28:31], v[60:63]
  v_add_u32 v8, s29, v4
  v_mov_b32 v9, s20
  v_mfma_f32_16x16x32_bf16 v[68:71], a[68:71], v[28:31], v[68:71]
  s_waitcnt vmcnt(10)
  s_barrier
  s_waitcnt lgkmcnt(3)
  v_mfma_f32_16x16x32_bf16 v[48:51], a[72:75], v[32:35], v[48:51]
  ds_read_b128 v[16:19], v7 offset:8192
  v_mfma_f32_16x16x32_bf16 v[56:59], a[76:79], v[32:35], v[56:59]
  ds_read_b128 v[20:23], v7 offset:28672
  v_mfma_f32_16x16x32_bf16 v[64:67], a[80:83], v[32:35], v[64:67]
  s_add_u32 s30, s28, 122880
  s_sub_u32 s31, s30, 163840
  s_cmp_ge_u32 s30, 163840
  s_waitcnt lgkmcnt(4)
  v_mfma_f32_16x16x32_bf16 v[52:55], a[72:75], v[36:39], v[52:55]
  s_cselect_b32 s30, s31, s30
  s_add_u32 s31, s20, 3
  v_mfma_f32_16x16x32_bf16 v[60:63], a[76:79], v[36:39], v[60:63]
  s_min_u32 s23, s31, 63
  s_mul_i32 s23, s23, 40960
  v_mfma_f32_16x16x32_bf16 v[68:71], a[80:83], v[36:39], v[68:71]
  s_add_u32 s23, s23, 1048576
  s_add_u32 s22, s42, s30
  s_waitcnt lgkmcnt(3)
  v_mfma_f32_16x16x32_bf16 v[48:51], a[84:87], v[40:43], v[48:51]
  ds_read_b128 v[24:27], v7 offset:9216
  v_mfma_f32_16x16x32_bf16 v[56:59], a[88:91], v[40:43], v[56:59]
  ds_read_b128 v[28:31], v7 offset:29696
  v_mfma_f32_16x16x32_bf16 v[64:67], a[92:95], v[40:43], v[64:67]
  s_add_u32 m0, s22, 0
  s_add_u32 s26, s23, 0
  buffer_load_dwordx4 v5, s[4:7], s26 offen offset:0 sc1 lds
  s_waitcnt lgkmcnt(4)
  v_mfma_f32_16x16x32_bf16 v[52:55], a[84:87], v[44:47], v[52:55]
  v_mfma_f32_16x16x32_bf16 v[60:63], a[88:91], v[44:47], v[60:63]
  v_mfma_f32_16x16x32_bf16 v[68:71], a[92:95], v[44:47], v[68:71]
  buffer_load_dwordx4 v5, s[4:7], s26 offen offset:1024 sc1 lds
  s_waitcnt lgkmcnt(3)
  v_mfma_f32_16x16x32_bf16 v[48:51], a[96:99], v[16:19], v[48:51]
  ds_read_b128 v[32:35], v7 offset:10240
  v_mfma_f32_16x16x32_bf16 v[56:59], a[100:103], v[16:19], v[56:59]
  ds_read_b128 v[36:39], v7 offset:30720
  v_mfma_f32_16x16x32_bf16 v[64:67], a[104:107], v[16:19], v[64:67]
  s_waitcnt lgkmcnt(4)
  v_mfma_f32_16x16x32_bf16 v[52:55], a[96:99], v[20:23], v[52:55]
  buffer_load_dwordx4 v5, s[4:7], s26 offen offset:2048 sc1 lds
  v_mfma_f32_16x16x32_bf16 v[60:63], a[100:103], v[20:23], v[60:63]
  v_mfma_f32_16x16x32_bf16 v[68:71], a[104:107], v[20:23], v[68:71]
  s_waitcnt lgkmcnt(3)
  v_mfma_f32_16x16x32_bf16 v[48:51], a[108:111], v[24:27], v[48:51]
  ds_read_b128 v[40:43], v7 offset:11264
  v_mfma_f32_16x16x32_bf16 v[56:59], a[112:115], v[24:27], v[56:59]
  ds_read_b128 v[44:47], v7 offset:31744
  v_mfma_f32_16x16x32_bf16 v[64:67], a[116:119], v[24:27], v[64:67]
  buffer_load_dwordx4 v5, s[4:7], s26 offen offset:3072 sc1 lds
  s_waitcnt lgkmcnt(4)
  v_mfma_f32_16x16x32_bf16 v[52:55], a[108:111], v[28:31], v[52:55]
  v_mfma_f32_16x16x32_bf16 v[60:63], a[112:115], v[28:31], v[60:63]
  v_mfma_f32_16x16x32_bf16 v[68:71], a[116:119], v[28:31], v[68:71]
  s_add_u32 m0, s22, 4096
  s_add_u32 s26, s23, 4096
  buffer_load_dwordx4 v5, s[4:7], s26 offen offset:0 sc1 lds
  s_waitcnt lgkmcnt(3)
  v_mfma_f32_16x16x32_bf16 v[48:51], a[120:123], v[32:35], v[48:51]
  ds_read_b128 v[16:19], v7 offset:12288
  v_mfma_f32_16x16x32_bf16 v[56:59], a[124:127], v[32:35], v[56:59]
  ds_read_b128 v[20:23], v7 offset:32768
  v_mfma_f32_16x16x32_bf16 v[64:67], a[128:131], v[32:35], v[64:67]
  s_waitcnt lgkmcnt(4)
  v_mfma_f32_16x16x32_bf16 v[52:55], a[120:123], v[36:39], v[52:55]
  buffer_load_dwordx4 v5, s[4:7], s26 offen offset:1024 sc1 lds
  v_mfma_f32_16x16x32_bf16 v[60:63], a[124:127], v[36:39], v[60:63]
  v_mfma_f32_16x16x32_bf16 v[68:71], a[128:131], v[36:39], v[68:71]
  s_waitcnt lgkmcnt(3)
  v_mfma_f32_16x16x32_bf16 v[48:51], a[132:135], v[40:43], v[48:51]
  ds_read_b128 v[24:27], v7 offset:13312
  v_mfma_f32_16x16x32_bf16 v[56:59], a[136:139], v[40:43], v[56:59]
  ds_read_b128 v[28:31], v7 offset:33792
  v_mfma_f32_16x16x32_bf16 v[64:67], a[140:143], v[40:43], v[64:67]
  buffer_load_dwordx4 v5, s[4:7], s26 offen offset:2048 sc1 lds
  s_waitcnt lgkmcnt(4)
  v_mfma_f32_16x16x32_bf16 v[52:55], a[132:135], v[44:47], v[52:55]
  v_mfma_f32_16x16x32_bf16 v[60:63], a[136:139], v[44:47], v[60:63]
  v_mfma_f32_16x16x32_bf16 v[68:71], a[140:143], v[44:47], v[68:71]
  buffer_load_dwordx4 v5, s[4:7], s26 offen offset:3072 sc1 lds
  s_waitcnt lgkmcnt(3)
  v_mfma_f32_16x16x32_bf16 v[48:51], a[144:147], v[16:19], v[48:51]
  ds_read_b128 v[32:35], v7 offset:14336
  v_mfma_f32_16x16x32_bf16 v[56:59], a[148:151], v[16:19], v[56:59]
  ds_read_b128 v[36:39], v7 offset:34816
  v_mfma_f32_16x16x32_bf16 v[64:67], a[152:155], v[16:19], v[64:67]
  s_waitcnt lgkmcnt(4)
  v_mfma_f32_16x16x32_bf16 v[52:55], a[144:147], v[20:23], v[52:55]
  s_add_u32 m0, s22, 8192
  s_add_u32 s26, s23, 8192
  buffer_load_dwordx4 v5, s[4:7], s26 offen offset:0 sc1 lds
  v_mfma_f32_16x16x32_bf16 v[60:63], a[148:151], v[20:23], v[60:63]
  v_mfma_f32_16x16x32_bf16 v[68:71], a[152:155], v[20:23], v[68:71]
  s_waitcnt lgkmcnt(3)
  v_mfma_f32_16x16x32_bf16 v[48:51], a[156:159], v[24:27], v[48:51]
  ds_read_b128 v[40:43], v7 offset:15360
  v_mfma_f32_16x16x32_bf16 v[56:59], a[160:163], v[24:27], v[56:59]
  ds_read_b128 v[44:47], v7 offset:35840
  v_mfma_f32_16x16x32_bf16 v[64:67], a[164:167], v[24:27], v[64:67]
  buffer_load_dwordx4 v5, s[4:7], s26 offen offset:1024 sc1 lds
  s_waitcnt lgkmcnt(4)
  v_mfma_f32_16x16x32_bf16 v[52:55], a[156:159], v[28:31], v[52:55]
  v_mfma_f32_16x16x32_bf16 v[60:63], a[160:163], v[28:31], v[60:63]
  v_mfma_f32_16x16x32_bf16 v[68:71], a[164:167], v[28:31], v[68:71]
  s_waitcnt lgkmcnt(3)
  v_mfma_f32_16x16x32_bf16 v[48:51], a[168:171], v[32:35], v[48:51]
  ds_read_b128 v[16:19], v7 offset:16384
  v_mfma_f32_16x16x32_bf16 v[56:59], a[172:175], v[32:35], v[56:59]
  ds_read_b128 v[20:23], v7 offset:36864
  v_mfma_f32_16x16x32_bf16 v[64:67], a[176:179], v[32:35], v[64:67]
  s_waitcnt lgkmcnt(4)
  v_mfma_f32_16x16x32_bf16 v[52:55], a[168:171], v[36:39], v[52:55]
  v_mfma_f32_16x16x32_bf16 v[60:63], a[172:175], v[36:39], v[60:63]
  v_mfma_f32_16x16x32_bf16 v[68:71], a[176:179], v[36:39], v[68:71]
  s_waitcnt lgkmcnt(3)
  v_mfma_f32_16x16x32_bf16 v[48:51], a[180:183], v[40:43], v[48:51]
  ds_read_b128 v[24:27], v7 offset:17408
  v_mfma_f32_16x16x32_bf16 v[56:59], a[184:187], v[40:43], v[56:59]
  ds_read_b128 v[28:31], v7 offset:37888
  v_mfma_f32_16x16x32_bf16 v[64:67], a[188:191], v[40:43], v[64:67]
  s_waitcnt lgkmcnt(4)
  v_mfma_f32_16x16x32_bf16 v[52:55], a[180:183], v[44:47], v[52:55]
  v_mfma_f32_16x16x32_bf16 v[60:63], a[184:187], v[44:47], v[60:63]
  v_mfma_f32_16x16x32_bf16 v[68:71], a[188:191], v[44:47], v[68:71]
  s_waitcnt lgkmcnt(3)
  v_mfma_f32_16x16x32_bf16 v[48:51], a[192:195], v[16:19], v[48:51]
  ds_read_b128 v[32:35], v7 offset:18432
  v_mfma_f32_16x16x32_bf16 v[56:59], a[196:199], v[16:19], v[56:59]
  ds_read_b128 v[36:39], v7 offset:38912
  v_mfma_f32_16x16x32_bf16 v[64:67], a[200:203], v[16:19], v[64:67]
  s_waitcnt lgkmcnt(4)
  v_mfma_f32_16x16x32_bf16 v[52:55], a[192:195], v[20:23], v[52:55]
  v_mfma_f32_16x16x32_bf16 v[60:63], a[196:199], v[20:23], v[60:63]
  v_mfma_f32_16x16x32_bf16 v[68:71], a[200:203], v[20:23], v[68:71]
  s_waitcnt lgkmcnt(3)
  v_mfma_f32_16x16x32_bf16 v[48:51], a[204:207], v[24:27], v[48:51]
  ds_read_b128 v[40:43], v7 offset:19456
  v_mfma_f32_16x16x32_bf16 v[56:59], a[208:211], v[24:27], v[56:59]
  ds_read_b128 v[44:47], v7 offset:39936
  v_mfma_f32_16x16x32_bf16 v[64:67], a[212:215], v[24:27], v[64:67]
  s_waitcnt lgkmcnt(4)
  v_mfma_f32_16x16x32_bf16 v[52:55], a[204:207], v[28:31], v[52:55]
  v_mfma_f32_16x16x32_bf16 v[60:63], a[208:211], v[28:31], v[60:63]
  v_mfma_f32_16x16x32_bf16 v[68:71], a[212:215], v[28:31], v[68:71]
  s_waitcnt lgkmcnt(3)
  v_mfma_f32_16x16x32_bf16 v[48:51], a[216:219], v[32:35], v[48:51]
  ds_read_b128 v[16:19], v8 offset:0
  v_mfma_f32_16x16x32_bf16 v[56:59], a[220:223], v[32:35], v[56:59]
  ds_read_b128 v[20:23], v8 offset:20480
  v_mfma_f32_16x16x32_bf16 v[64:67], a[224:227], v[32:35], v[64:67]
  s_waitcnt lgkmcnt(4)
  v_mfma_f32_16x16x32_bf16 v[52:55], a[216:219], v[36:39], v[52:55]
  v_mfma_f32_16x16x32_bf16 v[60:63], a[220:223], v[36:39], v[60:63]
  v_mfma_f32_16x16x32_bf16 v[68:71], a[224:227], v[36:39], v[68:71]
  s_waitcnt lgkmcnt(3)
  v_mfma_f32_16x16x32_bf16 v[48:51], a[228:231], v[40:43], v[48:51]
  ds_read_b128 v[24:27], v8 offset:1024
  v_mfma_f32_16x16x32_bf16 v[56:59], a[232:235], v[40:43], v[56:59]
  ds_read_b128 v[28:31], v8 offset:21504
  v_mfma_f32_16x16x32_bf16 v[64:67], a[236:239], v[40:43], v[64:67]
  s_waitcnt lgkmcnt(4)
  v_mfma_f32_16x16x32_bf16 v[52:55], a[228:231], v[44:47], v[52:55]
  v_mfma_f32_16x16x32_bf16 v[60:63], a[232:235], v[44:47], v[60:63]
  v_mfma_f32_16x16x32_bf16 v[68:71], a[236:239], v[44:47], v[68:71]
  s_mov_b32 s28, s29
  s_add_u32 s20, s20, 1
  v_cvt_pk_bf16_f32 v96, v48, v49
  v_cvt_pk_bf16_f32 v97, v50, v51
  v_cvt_pk_bf16_f32 v98, v52, v53
  v_cvt_pk_bf16_f32 v99, v54, v55
  buffer_store_dwordx4 v[96:99], v4, s[4:7], s43 offen offset:0 sc1
  v_cvt_pk_bf16_f32 v100, v56, v57
  v_cvt_pk_bf16_f32 v101, v58, v59
  v_cvt_pk_bf16_f32 v102, v60, v61
  v_cvt_pk_bf16_f32 v103, v62, v63
  buffer_store_dwordx4 v[100:103], v4, s[4:7], s43 offen offset:1024 sc1
  v_cvt_pk_bf16_f32 v104, v64, v65
  v_cvt_pk_bf16_f32 v105, v66, v67
  v_cvt_pk_bf16_f32 v106, v68, v69
  v_cvt_pk_bf16_f32 v107, v70, v71
  buffer_store_dwordx4 v[104:107], v4, s[4:7], s43 offen offset:2048 sc1
  v_mov_b32 v9, s20
  s_add_u32 s43, s43, 393216
  s_waitcnt vmcnt(0)
  s_mov_b64 exec, 1
  buffer_store_dword v9, v6, s[4:7], s34 offen sc1
  s_mov_b64 exec, -1
  s_waitcnt lgkmcnt(3)
  v_mfma_f32_16x16x32_bf16 v[72:75], a[0:3], v[16:19], 0
  ds_read_b128 v[32:35], v8 offset:2048
  v_mfma_f32_16x16x32_bf16 v[80:83], a[4:7], v[16:19], 0
  ds_read_b128 v[36:39], v8 offset:22528
  v_mfma_f32_16x16x32_bf16 v[88:91], a[8:11], v[16:19], 0
  s_waitcnt lgkmcnt(4)
  v_mfma_f32_16x16x32_bf16 v[76:79], a[0:3], v[20:23], 0
  v_mfma_f32_16x16x32_bf16 v[84:87], a[4:7], v[20:23], 0
  v_mfma_f32_16x16x32_bf16 v[92:95], a[8:11], v[20:23], 0
  s_waitcnt lgkmcnt(3)
  v_mfma_f32_16x16x32_bf16 v[72:75], a[12:15], v[24:27], v[72:75]
  ds_read_b128 v[40:43], v8 offset:3072
  v_mfma_f32_16x16x32_bf16 v[80:83], a[16:19], v[24:27], v[80:83]
  ds_read_b128 v[44:47], v8 offset:23552
  v_mfma_f32_16x16x32_bf16 v[88:91], a[20:23], v[24:27], v[88:91]
  s_waitcnt lgkmcnt(4)
  v_mfma_f32_16x16x32_bf16 v[76:79], a[12:15], v[28:31], v[76:79]
  v_mfma_f32_16x16x32_bf16 v[84:87], a[16:19], v[28:31], v[84:87]
  v_mfma_f32_16x16x32_bf16 v[92:95], a[20:23], v[28:31], v[92:95]
  s_waitcnt lgkmcnt(3)
  v_mfma_f32_16x16x32_bf16 v[72:75], a[24:27], v[32:35], v[72:75]
  ds_read_b128 v[16:19], v8 offset:4096
  v_mfma_f32_16x16x32_bf16 v[80:83], a[28:31], v[32:35], v[80:83]
  ds_read_b128 v[20:23], v8 offset:24576
  v_mfma_f32_16x16x32_bf16 v[88:91], a[32:35], v[32:35], v[88:91]
  s_waitcnt lgkmcnt(4)
  v_mfma_f32_16x16x32_bf16 v[76:79], a[24:27], v[36:39], v[76:79]
  v_mfma_f32_16x16x32_bf16 v[84:87], a[28:31], v[36:39], v[84:87]
  v_mfma_f32_16x16x32_bf16 v[92:95], a[32:35], v[36:39], v[92:95]
  s_waitcnt lgkmcnt(3)
  v_mfma_f32_16x16x32_bf16 v[72:75], a[36:39], v[40:43], v[72:75]
  ds_read_b128 v[24:27], v8 offset:5120
  v_mfma_f32_16x16x32_bf16 v[80:83], a[40:43], v[40:43], v[80:83]
  ds_read_b128 v[28:31], v8 offset:25600
  v_mfma_f32_16x16x32_bf16 v[88:91], a[44:47], v[40:43], v[88:91]
  s_waitcnt lgkmcnt(4)
  v_mfma_f32_16x16x32_bf16 v[76:79], a[36:39], v[44:47], v[76:79]
  v_mfma_f32_16x16x32_bf16 v[84:87], a[40:43], v[44:47], v[84:87]
  v_mfma_f32_16x16x32_bf16 v[92:95], a[44:47], v[44:47], v[92:95]
  s_waitcnt lgkmcnt(3)
  v_mfma_f32_16x16x32_bf16 v[72:75], a[48:51], v[16:19], v[72:75]
  ds_read_b128 v[32:35], v8 offset:6144
  v_mfma_f32_16x16x32_bf16 v[80:83], a[52:55], v[16:19], v[80:83]
  ds_read_b128 v[36:39], v8 offset:26624
  v_mfma_f32_16x16x32_bf16 v[88:91], a[56:59], v[16:19], v[88:91]
  s_waitcnt lgkmcnt(4)
  v_mfma_f32_16x16x32_bf16 v[76:79], a[48:51], v[20:23], v[76:79]
  v_mfma_f32_16x16x32_bf16 v[84:87], a[52:55], v[20:23], v[84:87]
  v_mfma_f32_16x16x32_bf16 v[92:95], a[56:59], v[20:23], v[92:95]
  s_waitcnt lgkmcnt(3)
  v_mfma_f32_16x16x32_bf16 v[72:75], a[60:63], v[24:27], v[72:75]
  ds_read_b128 v[40:43], v8 offset:7168
  v_mfma_f32_16x16x32_bf16 v[80:83], a[64:67], v[24:27], v[80:83]
  ds_read_b128 v[44:47], v8 offset:27648
  v_mfma_f32_16x16x32_bf16 v[88:91], a[68:71], v[24:27], v[88:91]
  s_waitcnt lgkmcnt(4)
  v_mfma_f32_16x16x32_bf16 v[76:79], a[60:63], v[28:31], v[76:79]
  s_add_u32 s29, s28, 40960
  s_cmp_eq_u32 s29, 163840
  s_cselect_b32 s29, 0, s29
  v_mfma_f32_16x16x32_bf16 v[84:87], a[64:67], v[28:31], v[84:87]
  v_add_u32 v7, s29, v4
  v_mov_b32 v9, s20
  v_mfma_f32_16x16x32_bf16 v[92:95], a[68:71], v[28:31], v[92:95]
  s_waitcnt vmcnt(10)
  s_barrier
  s_waitcnt lgkmcnt(3)
  v_mfma_f32_16x16x32_bf16 v[72:75], a[72:75], v[32:35], v[72:75]
  ds_read_b128 v[16:19], v8 offset:8192
  v_mfma_f32_16x16x32_bf16 v[80:83], a[76:79], v[32:35], v[80:83]
  ds_read_b128 v[20:23], v8 offset:28672
  v_mfma_f32_16x16x32_bf16 v[88:91], a[80:83], v[32:35], v[88:91]
  s_add_u32 s30, s28, 122880
  s_sub_u32 s31, s30, 163840
  s_cmp_ge_u32 s30, 163840
  s_waitcnt lgkmcnt(4)
  v_mfma_f32_16x16x32_bf16 v[76:79], a[72:75], v[36:39], v[76:79]
  s_cselect_b32 s30, s31, s30
  s_add_u32 s31, s20, 3
  v_mfma_f32_16x16x32_bf16 v[84:87], a[76:79], v[36:39], v[84:87]
  s_min_u32 s23, s31, 63
  s_mul_i32 s23, s23, 40960
  v_mfma_f32_16x16x32_bf16 v[92:95], a[80:83], v[36:39], v[92:95]
  s_add_u32 s23, s23, 1048576
  s_add_u32 s22, s42, s30
  s_waitcnt lgkmcnt(3)
  v_mfma_f32_16x16x32_bf16 v[72:75], a[84:87], v[40:43], v[72:75]
  ds_read_b128 v[24:27], v8 offset:9216
  v_mfma_f32_16x16x32_bf16 v[80:83], a[88:91], v[40:43], v[80:83]
  ds_read_b128 v[28:31], v8 offset:29696
  v_mfma_f32_16x16x32_bf16 v[88:91], a[92:95], v[40:43], v[88:91]
  s_add_u32 m0, s22, 0
  s_add_u32 s26, s23, 0
  buffer_load_dwordx4 v5, s[4:7], s26 offen offset:0 sc1 lds
  s_waitcnt lgkmcnt(4)
  v_mfma_f32_16x16x32_bf16 v[76:79], a[84:87], v[44:47], v[76:79]
  v_mfma_f32_16x16x32_bf16 v[84:87], a[88:91], v[44:47], v[84:87]
  v_mfma_f32_16x16x32_bf16 v[92:95], a[92:95], v[44:47], v[92:95]
  buffer_load_dwordx4 v5, s[4:7], s26 offen offset:1024 sc1 lds
  s_waitcnt lgkmcnt(3)
  v_mfma_f32_16x16x32_bf16 v[72:75], a[96:99], v[16:19], v[72:75]
  ds_read_b128 v[32:35], v8 offset:10240
  v_mfma_f32_16x16x32_bf16 v[80:83], a[100:103], v[16:19], v[80:83]
  ds_read_b128 v[36:39], v8 offset:30720
  v_mfma_f32_16x16x32_bf16 v[88:91], a[104:107], v[16:19], v[88:91]
  s_waitcnt lgkmcnt(4)
  v_mfma_f32_16x16x32_bf16 v[76:79], a[96:99], v[20:23], v[76:79]
  buffer_load_dwordx4 v5, s[4:7], s26 offen offset:2048 sc1 lds
  v_mfma_f32_16x16x32_bf16 v[84:87], a[100:103], v[20:23], v[84:87]
  v_mfma_f32_16x16x32_bf16 v[92:95], a[104:107], v[20:23], v[92:95]
  s_waitcnt lgkmcnt(3)
  v_mfma_f32_16x16x32_bf16 v[72:75], a[108:111], v[24:27], v[72:75]
  ds_read_b128 v[40:43], v8 offset:11264
  v_mfma_f32_16x16x32_bf16 v[80:83], a[112:115], v[24:27], v[80:83]
  ds_read_b128 v[44:47], v8 offset:31744
  v_mfma_f32_16x16x32_bf16 v[88:91], a[116:119], v[24:27], v[88:91]
  buffer_load_dwordx4 v5, s[4:7], s26 offen offset:3072 sc1 lds
  s_waitcnt lgkmcnt(4)
  v_mfma_f32_16x16x32_bf16 v[76:79], a[108:111], v[28:31], v[76:79]
  v_mfma_f32_16x16x32_bf16 v[84:87], a[112:115], v[28:31], v[84:87]
  v_mfma_f32_16x16x32_bf16 v[92:95], a[116:119], v[28:31], v[92:95]
  s_add_u32 m0, s22, 4096
  s_add_u32 s26, s23, 4096
  buffer_load_dwordx4 v5, s[4:7], s26 offen offset:0 sc1 lds
  s_waitcnt lgkmcnt(3)
  v_mfma_f32_16x16x32_bf16 v[72:75], a[120:123], v[32:35], v[72:75]
  ds_read_b128 v[16:19], v8 offset:12288
  v_mfma_f32_16x16x32_bf16 v[80:83], a[124:127], v[32:35], v[80:83]
  ds_read_b128 v[20:23], v8 offset:32768
  v_mfma_f32_16x16x32_bf16 v[88:91], a[128:131], v[32:35], v[88:91]
  s_waitcnt lgkmcnt(4)
  v_mfma_f32_16x16x32_bf16 v[76:79], a[120:123], v[36:39], v[76:79]
  buffer_load_dwordx4 v5, s[4:7], s26 offen offset:1024 sc1 lds
  v_mfma_f32_16x16x32_bf16 v[84:87], a[124:127], v[36:39], v[84:87]
  v_mfma_f32_16x16x32_bf16 v[92:95], a[128:131], v[36:39], v[92:95]
  s_waitcnt lgkmcnt(3)
  v_mfma_f32_16x16x32_bf16 v[72:75], a[132:135], v[40:43], v[72:75]
  ds_read_b128 v[24:27], v8 offset:13312
  v_mfma_f32_16x16x32_bf16 v[80:83], a[136:139], v[40:43], v[80:83]
  ds_read_b128 v[28:31], v8 offset:33792
  v_mfma_f32_16x16x32_bf16 v[88:91], a[140:143], v[40:43], v[88:91]
  buffer_load_dwordx4 v5, s[4:7], s26 offen offset:2048 sc1 lds
  s_waitcnt lgkmcnt(4)
  v_mfma_f32_16x16x32_bf16 v[76:79], a[132:135], v[44:47], v[76:79]
  v_mfma_f32_16x16x32_bf16 v[84:87], a[136:139], v[44:47], v[84:87]
  v_mfma_f32_16x16x32_bf16 v[92:95], a[140:143], v[44:47], v[92:95]
  buffer_load_dwordx4 v5, s[4:7], s26 offen offset:3072 sc1 lds
  s_waitcnt lgkmcnt(3)
  v_mfma_f32_16x16x32_bf16 v[72:75], a[144:147], v[16:19], v[72:75]
  ds_read_b128 v[32:35], v8 offset:14336
  v_mfma_f32_16x16x32_bf16 v[80:83], a[148:151], v[16:19], v[80:83]
  ds_read_b128 v[36:39], v8 offset:34816
  v_mfma_f32_16x16x32_bf16 v[88:91], a[152:155], v[16:19], v[88:91]
  s_waitcnt lgkmcnt(4)
  v_mfma_f32_16x16x32_bf16 v[76:79], a[144:147], v[20:23], v[76:79]
  s_add_u32 m0, s22, 8192
  s_add_u32 s26, s23, 8192
  buffer_load_dwordx4 v5, s[4:7], s26 offen offset:0 sc1 lds
  v_mfma_f32_16x16x32_bf16 v[84:87], a[148:151], v[20:23], v[84:87]
  v_mfma_f32_16x16x32_bf16 v[92:95], a[152:155], v[20:23], v[92:95]
  s_waitcnt lgkmcnt(3)
  v_mfma_f32_16x16x32_bf16 v[72:75], a[156:159], v[24:27], v[72:75]
  ds_read_b128 v[40:43], v8 offset:15360
  v_mfma_f32_16x16x32_bf16 v[80:83], a[160:163], v[24:27], v[80:83]
  ds_read_b128 v[44:47], v8 offset:35840
  v_mfma_f32_16x16x32_bf16 v[88:91], a[164:167], v[24:27], v[88:91]
  buffer_load_dwordx4 v5, s[4:7], s26 offen offset:1024 sc1 lds
  s_waitcnt lgkmcnt(4)
  v_mfma_f32_16x16x32_bf16 v[76:79], a[156:159], v[28:31], v[76:79]
  v_mfma_f32_16x16x32_bf16 v[84:87], a[160:163], v[28:31], v[84:87]
  v_mfma_f32_16x16x32_bf16 v[92:95], a[164:167], v[28:31], v[92:95]
  s_waitcnt lgkmcnt(3)
  v_mfma_f32_16x16x32_bf16 v[72:75], a[168:171], v[32:35], v[72:75]
  ds_read_b128 v[16:19], v8 offset:16384
  v_mfma_f32_16x16x32_bf16 v[80:83], a[172:175], v[32:35], v[80:83]
  ds_read_b128 v[20:23], v8 offset:36864
  v_mfma_f32_16x16x32_bf16 v[88:91], a[176:179], v[32:35], v[88:91]
  s_waitcnt lgkmcnt(4)
  v_mfma_f32_16x16x32_bf16 v[76:79], a[168:171], v[36:39], v[76:79]
  v_mfma_f32_16x16x32_bf16 v[84:87], a[172:175], v[36:39], v[84:87]
  v_mfma_f32_16x16x32_bf16 v[92:95], a[176:179], v[36:39], v[92:95]
  s_waitcnt lgkmcnt(3)
  v_mfma_f32_16x16x32_bf16 v[72:75], a[180:183], v[40:43], v[72:75]
  ds_read_b128 v[24:27], v8 offset:17408
  v_mfma_f32_16x16x32_bf16 v[80:83], a[184:187], v[40:43], v[80:83]
  ds_read_b128 v[28:31], v8 offset:37888
  v_mfma_f32_16x16x32_bf16 v[88:91], a[188:191], v[40:43], v[88:91]
  s_waitcnt lgkmcnt(4)
  v_mfma_f32_16x16x32_bf16 v[76:79], a[180:183], v[44:47], v[76:79]
  v_mfma_f32_16x16x32_bf16 v[84:87], a[184:187], v[44:47], v[84:87]
  v_mfma_f32_16x16x32_bf16 v[92:95], a[188:191], v[44:47], v[92:95]
  s_waitcnt lgkmcnt(3)
  v_mfma_f32_16x16x32_bf16 v[72:75], a[192:195], v[16:19], v[72:75]
  ds_read_b128 v[32:35], v8 offset:18432
  v_mfma_f32_16x16x32_bf16 v[80:83], a[196:199], v[16:19], v[80:83]
  ds_read_b128 v[36:39], v8 offset:38912
  v_mfma_f32_16x16x32_bf16 v[88:91], a[200:203], v[16:19], v[88:91]
  s_waitcnt lgkmcnt(4)
  v_mfma_f32_16x16x32_bf16 v[76:79], a[192:195], v[20:23], v[76:79]
  v_mfma_f32_16x16x32_bf16 v[84:87], a[196:199], v[20:23], v[84:87]
  v_mfma_f32_16x16x32_bf16 v[92:95], a[200:203], v[20:23], v[92:95]
  s_waitcnt lgkmcnt(3)
  v_mfma_f32_16x16x32_bf16 v[72:75], a[204:207], v[24:27], v[72:75]
  ds_read_b128 v[40:43], v8 offset:19456
  v_mfma_f32_16x16x32_bf16 v[80:83], a[208:211], v[24:27], v[80:83]
  ds_read_b128 v[44:47], v8 offset:39936
  v_mfma_f32_16x16x32_bf16 v[88:91], a[212:215], v[24:27], v[88:91]
  s_waitcnt lgkmcnt(4)
  v_mfma_f32_16x16x32_bf16 v[76:79], a[204:207], v[28:31], v[76:79]
  v_mfma_f32_16x16x32_bf16 v[84:87], a[208:211], v[28:31], v[84:87]
  v_mfma_f32_16x16x32_bf16 v[92:95], a[212:215], v[28:31], v[92:95]
  s_waitcnt lgkmcnt(3)
  v_mfma_f32_16x16x32_bf16 v[72:75], a[216:219], v[32:35], v[72:75]
  ds_read_b128 v[16:19], v7 offset:0
  v_mfma_f32_16x16x32_bf16 v[80:83], a[220:223], v[32:35], v[80:83]
  ds_read_b128 v[20:23], v7 offset:20480
  v_mfma_f32_16x16x32_bf16 v[88:91], a[224:227], v[32:35], v[88:91]
  s_waitcnt lgkmcnt(4)
  v_mfma_f32_16x16x32_bf16 v[76:79], a[216:219], v[36:39], v[76:79]
  v_mfma_f32_16x16x32_bf16 v[84:87], a[220:223], v[36:39], v[84:87]
  v_mfma_f32_16x16x32_bf16 v[92:95], a[224:227], v[36:39], v[92:95]
  s_waitcnt lgkmcnt(3)
  v_mfma_f32_16x16x32_bf16 v[72:75], a[228:231], v[40:43], v[72:75]
  ds_read_b128 v[24:27], v7 offset:1024
  v_mfma_f32_16x16x32_bf16 v[80:83], a[232:235], v[40:43], v[80:83]
  ds_read_b128 v[28:31], v7 offset:21504
  v_mfma_f32_16x16x32_bf16 v[88:91], a[236:239], v[40:43], v[88:91]
  s_waitcnt lgkmcnt(4)
  v_mfma_f32_16x16x32_bf16 v[76:79], a[228:231], v[44:47], v[76:79]
  v_mfma_f32_16x16x32_bf16 v[84:87], a[232:235], v[44:47], v[84:87]
  v_mfma_f32_16x16x32_bf16 v[92:95], a[236:239], v[44:47], v[92:95]
  s_mov_b32 s28, s29
  s_add_u32 s20, s20, 1
  v_cvt_pk_bf16_f32 v96, v72, v73
  v_cvt_pk_bf16_f32 v97, v74, v75
  v_cvt_pk_bf16_f32 v98, v76, v77
  v_cvt_pk_bf16_f32 v99, v78, v79
  buffer_store_dwordx4 v[96:99], v4, s[4:7], s43 offen offset:0 sc1
  v_cvt_pk_bf16_f32 v100, v80, v81
  v_cvt_pk_bf16_f32 v101, v82, v83
  v_cvt_pk_bf16_f32 v102, v84, v85
  v_cvt_pk_bf16_f32 v103, v86, v87
  buffer_store_dwordx4 v[100:103], v4, s[4:7], s43 offen offset:1024 sc1
  v_cvt_pk_bf16_f32 v104, v88, v89
  v_cvt_pk_bf16_f32 v105, v90, v91
  v_cvt_pk_bf16_f32 v106, v92, v93
  v_cvt_pk_bf16_f32 v107, v94, v95
  buffer_store_dwordx4 v[104:107], v4, s[4:7], s43 offen offset:2048 sc1
  v_mov_b32 v9, s20
  s_add_u32 s43, s43, 393216
  s_waitcnt vmcnt(0)
  s_mov_b64 exec, 1
  buffer_store_dword v9, v6, s[4:7], s34 offen sc1
  s_mov_b64 exec, -1
  s_waitcnt lgkmcnt(3)
  v_mfma_f32_16x16x32_bf16 v[48:51], a[0:3], v[16:19], 0
  ds_read_b128 v[32:35], v7 offset:2048
  v_mfma_f32_16x16x32_bf16 v[56:59], a[4:7], v[16:19], 0
  ds_read_b128 v[36:39], v7 offset:22528
  v_mfma_f32_16x16x32_bf16 v[64:67], a[8:11], v[16:19], 0
  s_waitcnt lgkmcnt(4)
  v_mfma_f32_16x16x32_bf16 v[52:55], a[0:3], v[20:23], 0
  v_mfma_f32_16x16x32_bf16 v[60:63], a[4:7], v[20:23], 0
  v_mfma_f32_16x16x32_bf16 v[68:71], a[8:11], v[20:23], 0
  s_waitcnt lgkmcnt(3)
  v_mfma_f32_16x16x32_bf16 v[48:51], a[12:15], v[24:27], v[48:51]
  ds_read_b128 v[40:43], v7 offset:3072
  v_mfma_f32_16x16x32_bf16 v[56:59], a[16:19], v[24:27], v[56:59]
  ds_read_b128 v[44:47], v7 offset:23552
  v_mfma_f32_16x16x32_bf16 v[64:67], a[20:23], v[24:27], v[64:67]
  s_waitcnt lgkmcnt(4)
  v_mfma_f32_16x16x32_bf16 v[52:55], a[12:15], v[28:31], v[52:55]
  v_mfma_f32_16x16x32_bf16 v[60:63], a[16:19], v[28:31], v[60:63]
  v_mfma_f32_16x16x32_bf16 v[68:71], a[20:23], v[28:31], v[68:71]
  s_waitcnt lgkmcnt(3)
  v_mfma_f32_16x16x32_bf16 v[48:51], a[24:27], v[32:35], v[48:51]
  ds_read_b128 v[16:19], v7 offset:4096
  v_mfma_f32_16x16x32_bf16 v[56:59], a[28:31], v[32:35], v[56:59]
  ds_read_b128 v[20:23], v7 offset:24576
  v_mfma_f32_16x16x32_bf16 v[64:67], a[32:35], v[32:35], v[64:67]
  s_waitcnt lgkmcnt(4)
  v_mfma_f32_16x16x32_bf16 v[52:55], a[24:27], v[36:39], v[52:55]
  v_mfma_f32_16x16x32_bf16 v[60:63], a[28:31], v[36:39], v[60:63]
  v_mfma_f32_16x16x32_bf16 v[68:71], a[32:35], v[36:39], v[68:71]
  s_waitcnt lgkmcnt(3)
  v_mfma_f32_16x16x32_bf16 v[48:51], a[36:39], v[40:43], v[48:51]
  ds_read_b128 v[24:27], v7 offset:5120
  v_mfma_f32_16x16x32_bf16 v[56:59], a[40:43], v[40:43], v[56:59]
  ds_read_b128 v[28:31], v7 offset:25600
  v_mfma_f32_16x16x32_bf16 v[64:67], a[44:47], v[40:43], v[64:67]
  s_waitcnt lgkmcnt(4)
  v_mfma_f32_16x16x32_bf16 v[52:55], a[36:39], v[44:47], v[52:55]
  v_mfma_f32_16x16x32_bf16 v[60:63], a[40:43], v[44:47], v[60:63]
  v_mfma_f32_16x16x32_bf16 v[68:71], a[44:47], v[44:47], v[68:71]
  s_waitcnt lgkmcnt(3)
  v_mfma_f32_16x16x32_bf16 v[48:51], a[48:51], v[16:19], v[48:51]
  ds_read_b128 v[32:35], v7 offset:6144
  v_mfma_f32_16x16x32_bf16 v[56:59], a[52:55], v[16:19], v[56:59]
  ds_read_b128 v[36:39], v7 offset:26624
  v_mfma_f32_16x16x32_bf16 v[64:67], a[56:59], v[16:19], v[64:67]
  s_waitcnt lgkmcnt(4)
  v_mfma_f32_16x16x32_bf16 v[52:55], a[48:51], v[20:23], v[52:55]
  v_mfma_f32_16x16x32_bf16 v[60:63], a[52:55], v[20:23], v[60:63]
  v_mfma_f32_16x16x32_bf16 v[68:71], a[56:59], v[20:23], v[68:71]
  s_waitcnt lgkmcnt(3)
  v_mfma_f32_16x16x32_bf16 v[48:51], a[60:63], v[24:27], v[48:51]
  ds_read_b128 v[40:43], v7 offset:7168
  v_mfma_f32_16x16x32_bf16 v[56:59], a[64:67], v[24:27], v[56:59]
  ds_read_b128 v[44:47], v7 offset:27648
  v_mfma_f32_16x16x32_bf16 v[64:67], a[68:71], v[24:27], v[64:67]
  s_waitcnt lgkmcnt(4)
  v_mfma_f32_16x16x32_bf16 v[52:55], a[60:63], v[28:31], v[52:55]
  s_add_u32 s29, s28, 40960
  s_cmp_eq_u32 s29, 163840
  s_cselect_b32 s29, 0, s29
  v_mfma_f32_16x16x32_bf16 v[60:63], a[64:67], v[28:31], v[60:63]
  v_add_u32 v8, s29, v4
  v_mov_b32 v9, s20
  v_mfma_f32_16x16x32_bf16 v[68:71], a[68:71], v[28:31], v[68:71]
  s_waitcnt vmcnt(10)
  s_barrier
  s_waitcnt lgkmcnt(3)
  v_mfma_f32_16x16x32_bf16 v[48:51], a[72:75], v[32:35], v[48:51]
  ds_read_b128 v[16:19], v7 offset:8192
  v_mfma_f32_16x16x32_bf16 v[56:59], a[76:79], v[32:35], v[56:59]
  ds_read_b128 v[20:23], v7 offset:28672
  v_mfma_f32_16x16x32_bf16 v[64:67], a[80:83], v[32:35], v[64:67]
  s_add_u32 s30, s28, 122880
  s_sub_u32 s31, s30, 163840
  s_cmp_ge_u32 s30, 163840
  s_waitcnt lgkmcnt(4)
  v_mfma_f32_16x16x32_bf16 v[52:55], a[72:75], v[36:39], v[52:55]
  s_cselect_b32 s30, s31, s30
  s_add_u32 s31, s20, 3
  v_mfma_f32_16x16x32_bf16 v[60:63], a[76:79], v[36:39], v[60:63]
  s_min_u32 s23, s31, 63
  s_mul_i32 s23, s23, 40960
  v_mfma_f32_16x16x32_bf16 v[68:71], a[80:83], v[36:39], v[68:71]
  s_add_u32 s23, s23, 1048576
  s_add_u32 s22, s42, s30
  s_waitcnt lgkmcnt(3)
  v_mfma_f32_16x16x32_bf16 v[48:51], a[84:87], v[40:43], v[48:51]
  ds_read_b128 v[24:27], v7 offset:9216
  v_mfma_f32_16x16x32_bf16 v[56:59], a[88:91], v[40:43], v[56:59]
  ds_read_b128 v[28:31], v7 offset:29696
  v_mfma_f32_16x16x32_bf16 v[64:67], a[92:95], v[40:43], v[64:67]
  s_add_u32 m0, s22, 0
  s_add_u32 s26, s23, 0
  buffer_load_dwordx4 v5, s[4:7], s26 offen offset:0 sc1 lds
  s_waitcnt lgkmcnt(4)
  v_mfma_f32_16x16x32_bf16 v[52:55], a[84:87], v[44:47], v[52:55]
  v_mfma_f32_16x16x32_bf16 v[60:63], a[88:91], v[44:47], v[60:63]
  v_mfma_f32_16x16x32_bf16 v[68:71], a[92:95], v[44:47], v[68:71]
  buffer_load_dwordx4 v5, s[4:7], s26 offen offset:1024 sc1 lds
  s_waitcnt lgkmcnt(3)
  v_mfma_f32_16x16x32_bf16 v[48:51], a[96:99], v[16:19], v[48:51]
  ds_read_b128 v[32:35], v7 offset:10240
  v_mfma_f32_16x16x32_bf16 v[56:59], a[100:103], v[16:19], v[56:59]
  ds_read_b128 v[36:39], v7 offset:30720
  v_mfma_f32_16x16x32_bf16 v[64:67], a[104:107], v[16:19], v[64:67]
  s_waitcnt lgkmcnt(4)
  v_mfma_f32_16x16x32_bf16 v[52:55], a[96:99], v[20:23], v[52:55]
  buffer_load_dwordx4 v5, s[4:7], s26 offen offset:2048 sc1 lds
  v_mfma_f32_16x16x32_bf16 v[60:63], a[100:103], v[20:23], v[60:63]
  v_mfma_f32_16x16x32_bf16 v[68:71], a[104:107], v[20:23], v[68:71]
  s_waitcnt lgkmcnt(3)
  v_mfma_f32_16x16x32_bf16 v[48:51], a[108:111], v[24:27], v[48:51]
  ds_read_b128 v[40:43], v7 offset:11264
  v_mfma_f32_16x16x32_bf16 v[56:59], a[112:115], v[24:27], v[56:59]
  ds_read_b128 v[44:47], v7 offset:31744
  v_mfma_f32_16x16x32_bf16 v[64:67], a[116:119], v[24:27], v[64:67]
  buffer_load_dwordx4 v5, s[4:7], s26 offen offset:3072 sc1 lds
  s_waitcnt lgkmcnt(4)
  v_mfma_f32_16x16x32_bf16 v[52:55], a[108:111], v[28:31], v[52:55]
  v_mfma_f32_16x16x32_bf16 v[60:63], a[112:115], v[28:31], v[60:63]
  v_mfma_f32_16x16x32_bf16 v[68:71], a[116:119], v[28:31], v[68:71]
  s_add_u32 m0, s22, 4096
  s_add_u32 s26, s23, 4096
  buffer_load_dwordx4 v5, s[4:7], s26 offen offset:0 sc1 lds
  s_waitcnt lgkmcnt(3)
  v_mfma_f32_16x16x32_bf16 v[48:51], a[120:123], v[32:35], v[48:51]
  ds_read_b128 v[16:19], v7 offset:12288
  v_mfma_f32_16x16x32_bf16 v[56:59], a[124:127], v[32:35], v[56:59]
  ds_read_b128 v[20:23], v7 offset:32768
  v_mfma_f32_16x16x32_bf16 v[64:67], a[128:131], v[32:35], v[64:67]
  s_waitcnt lgkmcnt(4)
  v_mfma_f32_16x16x32_bf16 v[52:55], a[120:123], v[36:39], v[52:55]
  buffer_load_dwordx4 v5, s[4:7], s26 offen offset:1024 sc1 lds
  v_mfma_f32_16x16x32_bf16 v[60:63], a[124:127], v[36:39], v[60:63]
  v_mfma_f32_16x16x32_bf16 v[68:71], a[128:131], v[36:39], v[68:71]
  s_waitcnt lgkmcnt(3)
  v_mfma_f32_16x16x32_bf16 v[48:51], a[132:135], v[40:43], v[48:51]
  ds_read_b128 v[24:27], v7 offset:13312
  v_mfma_f32_16x16x32_bf16 v[56:59], a[136:139], v[40:43], v[56:59]
  ds_read_b128 v[28:31], v7 offset:33792
  v_mfma_f32_16x16x32_bf16 v[64:67], a[140:143], v[40:43], v[64:67]
  buffer_load_dwordx4 v5, s[4:7], s26 offen offset:2048 sc1 lds
  s_waitcnt lgkmcnt(4)
  v_mfma_f32_16x16x32_bf16 v[52:55], a[132:135], v[44:47], v[52:55]
  v_mfma_f32_16x16x32_bf16 v[60:63], a[136:139], v[44:47], v[60:63]
  v_mfma_f32_16x16x32_bf16 v[68:71], a[140:143], v[44:47], v[68:71]
  buffer_load_dwordx4 v5, s[4:7], s26 offen offset:3072 sc1 lds
  s_waitcnt lgkmcnt(3)
  v_mfma_f32_16x16x32_bf16 v[48:51], a[144:147], v[16:19], v[48:51]
  ds_read_b128 v[32:35], v7 offset:14336
  v_mfma_f32_16x16x32_bf16 v[56:59], a[148:151], v[16:19], v[56:59]
  ds_read_b128 v[36:39], v7 offset:34816
  v_mfma_f32_16x16x32_bf16 v[64:67], a[152:155], v[16:19], v[64:67]
  s_waitcnt lgkmcnt(4)
  v_mfma_f32_16x16x32_bf16 v[52:55], a[144:147], v[20:23], v[52:55]
  s_add_u32 m0, s22, 8192
  s_add_u32 s26, s23, 8192
  buffer_load_dwordx4 v5, s[4:7], s26 offen offset:0 sc1 lds
  v_mfma_f32_16x16x32_bf16 v[60:63], a[148:151], v[20:23], v[60:63]
  v_mfma_f32_16x16x32_bf16 v[68:71], a[152:155], v[20:23], v[68:71]
  s_waitcnt lgkmcnt(3)
  v_mfma_f32_16x16x32_bf16 v[48:51], a[156:159], v[24:27], v[48:51]
  ds_read_b128 v[40:43], v7 offset:15360
  v_mfma_f32_16x16x32_bf16 v[56:59], a[160:163], v[24:27], v[56:59]
  ds_read_b128 v[44:47], v7 offset:35840
  v_mfma_f32_16x16x32_bf16 v[64:67], a[164:167], v[24:27], v[64:67]
  buffer_load_dwordx4 v5, s[4:7], s26 offen offset:1024 sc1 lds
  s_waitcnt lgkmcnt(4)
  v_mfma_f32_16x16x32_bf16 v[52:55], a[156:159], v[28:31], v[52:55]
  v_mfma_f32_16x16x32_bf16 v[60:63], a[160:163], v[28:31], v[60:63]
  v_mfma_f32_16x16x32_bf16 v[68:71], a[164:167], v[28:31], v[68:71]
  s_waitcnt lgkmcnt(3)
  v_mfma_f32_16x16x32_bf16 v[48:51], a[168:171], v[32:35], v[48:51]
  ds_read_b128 v[16:19], v7 offset:16384
  v_mfma_f32_16x16x32_bf16 v[56:59], a[172:175], v[32:35], v[56:59]
  ds_read_b128 v[20:23], v7 offset:36864
  v_mfma_f32_16x16x32_bf16 v[64:67], a[176:179], v[32:35], v[64:67]
  s_waitcnt lgkmcnt(4)
  v_mfma_f32_16x16x32_bf16 v[52:55], a[168:171], v[36:39], v[52:55]
  v_mfma_f32_16x16x32_bf16 v[60:63], a[172:175], v[36:39], v[60:63]
  v_mfma_f32_16x16x32_bf16 v[68:71], a[176:179], v[36:39], v[68:71]
  s_waitcnt lgkmcnt(3)
  v_mfma_f32_16x16x32_bf16 v[48:51], a[180:183], v[40:43], v[48:51]
  ds_read_b128 v[24:27], v7 offset:17408
  v_mfma_f32_16x16x32_bf16 v[56:59], a[184:187], v[40:43], v[56:59]
  ds_read_b128 v[28:31], v7 offset:37888
  v_mfma_f32_16x16x32_bf16 v[64:67], a[188:191], v[40:43], v[64:67]
  s_waitcnt lgkmcnt(4)
  v_mfma_f32_16x16x32_bf16 v[52:55], a[180:183], v[44:47], v[52:55]
  v_mfma_f32_16x16x32_bf16 v[60:63], a[184:187], v[44:47], v[60:63]
  v_mfma_f32_16x16x32_bf16 v[68:71], a[188:191], v[44:47], v[68:71]
  s_waitcnt lgkmcnt(3)
  v_mfma_f32_16x16x32_bf16 v[48:51], a[192:195], v[16:19], v[48:51]
  ds_read_b128 v[32:35], v7 offset:18432
  v_mfma_f32_16x16x32_bf16 v[56:59], a[196:199], v[16:19], v[56:59]
  ds_read_b128 v[36:39], v7 offset:38912
  v_mfma_f32_16x16x32_bf16 v[64:67], a[200:203], v[16:19], v[64:67]
  s_waitcnt lgkmcnt(4)
  v_mfma_f32_16x16x32_bf16 v[52:55], a[192:195], v[20:23], v[52:55]
  v_mfma_f32_16x16x32_bf16 v[60:63], a[196:199], v[20:23], v[60:63]
  v_mfma_f32_16x16x32_bf16 v[68:71], a[200:203], v[20:23], v[68:71]
  s_waitcnt lgkmcnt(3)
  v_mfma_f32_16x16x32_bf16 v[48:51], a[204:207], v[24:27], v[48:51]
  ds_read_b128 v[40:43], v7 offset:19456
  v_mfma_f32_16x16x32_bf16 v[56:59], a[208:211], v[24:27], v[56:59]
  ds_read_b128 v[44:47], v7 offset:39936
  v_mfma_f32_16x16x32_bf16 v[64:67], a[212:215], v[24:27], v[64:67]
  s_waitcnt lgkmcnt(4)
  v_mfma_f32_16x16x32_bf16 v[52:55], a[204:207], v[28:31], v[52:55]
  v_mfma_f32_16x16x32_bf16 v[60:63], a[208:211], v[28:31], v[60:63]
  v_mfma_f32_16x16x32_bf16 v[68:71], a[212:215], v[28:31], v[68:71]
  s_waitcnt lgkmcnt(3)
  v_mfma_f32_16x16x32_bf16 v[48:51], a[216:219], v[32:35], v[48:51]
  ds_read_b128 v[16:19], v8 offset:0
  v_mfma_f32_16x16x32_bf16 v[56:59], a[220:223], v[32:35], v[56:59]
  ds_read_b128 v[20:23], v8 offset:20480
  v_mfma_f32_16x16x32_bf16 v[64:67], a[224:227], v[32:35], v[64:67]
  s_waitcnt lgkmcnt(4)
  v_mfma_f32_16x16x32_bf16 v[52:55], a[216:219], v[36:39], v[52:55]
  v_mfma_f32_16x16x32_bf16 v[60:63], a[220:223], v[36:39], v[60:63]
  v_mfma_f32_16x16x32_bf16 v[68:71], a[224:227], v[36:39], v[68:71]
  s_waitcnt lgkmcnt(3)
  v_mfma_f32_16x16x32_bf16 v[48:51], a[228:231], v[40:43], v[48:51]
  ds_read_b128 v[24:27], v8 offset:1024
  v_mfma_f32_16x16x32_bf16 v[56:59], a[232:235], v[40:43], v[56:59]
  ds_read_b128 v[28:31], v8 offset:21504
  v_mfma_f32_16x16x32_bf16 v[64:67], a[236:239], v[40:43], v[64:67]
  s_waitcnt lgkmcnt(4)
  v_mfma_f32_16x16x32_bf16 v[52:55], a[228:231], v[44:47], v[52:55]
  v_mfma_f32_16x16x32_bf16 v[60:63], a[232:235], v[44:47], v[60:63]
  v_mfma_f32_16x16x32_bf16 v[68:71], a[236:239], v[44:47], v[68:71]
  s_mov_b32 s28, s29
  s_add_u32 s20, s20, 1
  s_waitcnt lgkmcnt(0)
L_proj_loop:
  v_mfma_f32_16x16x32_bf16 v[72:75], a[0:3], v[16:19], 0
  ds_read_b128 v[32:35], v8 offset:2048
  v_mfma_f32_16x16x32_bf16 v[80:83], a[4:7], v[16:19], 0
  ds_read_b128 v[36:39], v8 offset:22528
  v_mfma_f32_16x16x32_bf16 v[88:91], a[8:11], v[16:19], 0
  v_mfma_f32_16x16x32_bf16 v[76:79], a[0:3], v[20:23], 0
  v_cvt_pk_bf16_f32 v96, v48, v49
  v_mfma_f32_16x16x32_bf16 v[84:87], a[4:7], v[20:23], 0
  v_mfma_f32_16x16x32_bf16 v[92:95], a[8:11], v[20:23], 0
  v_cvt_pk_bf16_f32 v97, v50, v51
  v_mfma_f32_16x16x32_bf16 v[72:75], a[12:15], v[24:27], v[72:75]
  ds_read_b128 v[40:43], v8 offset:3072
  v_mfma_f32_16x16x32_bf16 v[80:83], a[16:19], v[24:27], v[80:83]
  ds_read_b128 v[44:47], v8 offset:23552
  v_cvt_pk_bf16_f32 v98, v52, v53
  v_mfma_f32_16x16x32_bf16 v[88:91], a[20:23], v[24:27], v[88:91]
  v_mfma_f32_16x16x32_bf16 v[76:79], a[12:15], v[28:31], v[76:79]
  v_cvt_pk_bf16_f32 v99, v54, v55
  v_mfma_f32_16x16x32_bf16 v[84:87], a[16:19], v[28:31], v[84:87]
  v_mfma_f32_16x16x32_bf16 v[92:95], a[20:23], v[28:31], v[92:95]
  buffer_store_dwordx4 v[96:99], v4, s[4:7], s43 offen offset:0 sc1
  s_waitcnt lgkmcnt(3)
  v_mfma_f32_16x16x32_bf16 v[72:75], a[24:27], v[32:35], v[72:75]
  ds_read_b128 v[16:19], v8 offset:4096
  v_mfma_f32_16x16x32_bf16 v[80:83], a[28:31], v[32:35], v[80:83]
  ds_read_b128 v[20:23], v8 offset:24576
  v_cvt_pk_bf16_f32 v100, v56, v57
  v_mfma_f32_16x16x32_bf16 v[88:91], a[32:35], v[32:35], v[88:91]
  s_waitcnt lgkmcnt(4)
  v_mfma_f32_16x16x32_bf16 v[76:79], a[24:27], v[36:39], v[76:79]
  v_cvt_pk_bf16_f32 v101, v58, v59
  v_mfma_f32_16x16x32_bf16 v[84:87], a[28:31], v[36:39], v[84:87]
  v_mfma_f32_16x16x32_bf16 v[92:95], a[32:35], v[36:39], v[92:95]
  v_cvt_pk_bf16_f32 v102, v60, v61
  s_waitcnt lgkmcnt(3)
  v_mfma_f32_16x16x32_bf16 v[72:75], a[36:39], v[40:43], v[72:75]
  ds_read_b128 v[24:27], v8 offset:5120
  v_mfma_f32_16x16x32_bf16 v[80:83], a[40:43], v[40:43], v[80:83]
  ds_read_b128 v[28:31], v8 offset:25600
  v_cvt_pk_bf16_f32 v103, v62, v63
  v_mfma_f32_16x16x32_bf16 v[88:91], a[44:47], v[40:43], v[88:91]
  s_waitcnt lgkmcnt(4)
  v_mfma_f32_16x16x32_bf16 v[76:79], a[36:39], v[44:47], v[76:79]
  buffer_store_dwordx4 v[100:103], v4, s[4:7], s43 offen offset:1024 sc1
  v_mfma_f32_16x16x32_bf16 v[84:87], a[40:43], v[44:47], v[84:87]
  v_mfma_f32_16x16x32_bf16 v[92:95], a[44:47], v[44:47], v[92:95]
  v_cvt_pk_bf16_f32 v104, v64, v65
  s_waitcnt lgkmcnt(3)
  v_mfma_f32_16x16x32_bf16 v[72:75], a[48:51], v[16:19], v[72:75]
  ds_read_b128 v[32:35], v8 offset:6144
  v_mfma_f32_16x16x32_bf16 v[80:83], a[52:55], v[16:19], v[80:83]
  ds_read_b128 v[36:39], v8 offset:26624
  v_cvt_pk_bf16_f32 v105, v66, v67
  v_mfma_f32_16x16x32_bf16 v[88:91], a[56:59], v[16:19], v[88:91]
  s_waitcnt lgkmcnt(4)
  v_mfma_f32_16x16x32_bf16 v[76:79], a[48:51], v[20:23], v[76:79]
  v_cvt_pk_bf16_f32 v106, v68, v69
  v_mfma_f32_16x16x32_bf16 v[84:87], a[52:55], v[20:23], v[84:87]
  v_mfma_f32_16x16x32_bf16 v[92:95], a[56:59], v[20:23], v[92:95]
  v_cvt_pk_bf16_f32 v107, v70, v71
  s_waitcnt lgkmcnt(3)
  v_mfma_f32_16x16x32_bf16 v[72:75], a[60:63], v[24:27], v[72:75]
  ds_read_b128 v[40:43], v8 offset:7168
  v_mfma_f32_16x16x32_bf16 v[80:83], a[64:67], v[24:27], v[80:83]
  ds_read_b128 v[44:47], v8 offset:27648
  buffer_store_dwordx4 v[104:107], v4, s[4:7], s43 offen offset:2048 sc1
  v_mfma_f32_16x16x32_bf16 v[88:91], a[68:71], v[24:27], v[88:91]
  s_add_u32 s43, s43, 393216
  s_waitcnt lgkmcnt(4)
  v_mfma_f32_16x16x32_bf16 v[76:79], a[60:63], v[28:31], v[76:79]
  s_add_u32 s29, s28, 40960
  s_cmp_eq_u32 s29, 163840
  s_cselect_b32 s29, 0, s29
  v_mfma_f32_16x16x32_bf16 v[84:87], a[64:67], v[28:31], v[84:87]
  v_add_u32 v7, s29, v4
  v_mov_b32 v9, s20
  v_mfma_f32_16x16x32_bf16 v[92:95], a[68:71], v[28:31], v[92:95]
  s_waitcnt vmcnt(13)
  s_barrier
  s_waitcnt lgkmcnt(3)
  v_mfma_f32_16x16x32_bf16 v[72:75], a[72:75], v[32:35], v[72:75]
  ds_read_b128 v[16:19], v8 offset:8192
  v_mfma_f32_16x16x32_bf16 v[80:83], a[76:79], v[32:35], v[80:83]
  ds_read_b128 v[20:23], v8 offset:28672
  v_mfma_f32_16x16x32_bf16 v[88:91], a[80:83], v[32:35], v[88:91]
  s_add_u32 s30, s28, 122880
  s_sub_u32 s31, s30, 163840
  s_cmp_ge_u32 s30, 163840
  s_waitcnt lgkmcnt(4)
  v_mfma_f32_16x16x32_bf16 v[76:79], a[72:75], v[36:39], v[76:79]
  s_cselect_b32 s30, s31, s30
  s_add_u32 s31, s20, 3
  v_mfma_f32_16x16x32_bf16 v[84:87], a[76:79], v[36:39], v[84:87]
  s_min_u32 s23, s31, 63
  s_mul_i32 s23, s23, 40960
  v_mfma_f32_16x16x32_bf16 v[92:95], a[80:83], v[36:39], v[92:95]
  s_add_u32 s23, s23, 1048576
  s_add_u32 s22, s42, s30
  s_waitcnt lgkmcnt(3)
  v_mfma_f32_16x16x32_bf16 v[72:75], a[84:87], v[40:43], v[72:75]
  ds_read_b128 v[24:27], v8 offset:9216
  v_mfma_f32_16x16x32_bf16 v[80:83], a[88:91], v[40:43], v[80:83]
  ds_read_b128 v[28:31], v8 offset:29696
  v_mfma_f32_16x16x32_bf16 v[88:91], a[92:95], v[40:43], v[88:91]
  s_add_u32 m0, s22, 0
  s_add_u32 s26, s23, 0
  buffer_load_dwordx4 v5, s[4:7], s26 offen offset:0 sc1 lds
  s_waitcnt lgkmcnt(4)
  v_mfma_f32_16x16x32_bf16 v[76:79], a[84:87], v[44:47], v[76:79]
  v_mfma_f32_16x16x32_bf16 v[84:87], a[88:91], v[44:47], v[84:87]
  v_mfma_f32_16x16x32_bf16 v[92:95], a[92:95], v[44:47], v[92:95]
  buffer_load_dwordx4 v5, s[4:7], s26 offen offset:1024 sc1 lds
  s_waitcnt lgkmcnt(3)
  v_mfma_f32_16x16x32_bf16 v[72:75], a[96:99], v[16:19], v[72:75]
  ds_read_b128 v[32:35], v8 offset:10240
  v_mfma_f32_16x16x32_bf16 v[80:83], a[100:103], v[16:19], v[80:83]
  ds_read_b128 v[36:39], v8 offset:30720
  v_mfma_f32_16x16x32_bf16 v[88:91], a[104:107], v[16:19], v[88:91]
  s_waitcnt lgkmcnt(4)
  v_mfma_f32_16x16x32_bf16 v[76:79], a[96:99], v[20:23], v[76:79]
  buffer_load_dwordx4 v5, s[4:7], s26 offen offset:2048 sc1 lds
  v_mfma_f32_16x16x32_bf16 v[84:87], a[100:103], v[20:23], v[84:87]
  v_mfma_f32_16x16x32_bf16 v[92:95], a[104:107], v[20:23], v[92:95]
  s_waitcnt lgkmcnt(3)
  v_mfma_f32_16x16x32_bf16 v[72:75], a[108:111], v[24:27], v[72:75]
  ds_read_b128 v[40:43], v8 offset:11264
  v_mfma_f32_16x16x32_bf16 v[80:83], a[112:115], v[24:27], v[80:83]
  ds_read_b128 v[44:47], v8 offset:31744
  v_mfma_f32_16x16x32_bf16 v[88:91], a[116:119], v[24:27], v[88:91]
  buffer_load_dwordx4 v5, s[4:7], s26 offen offset:3072 sc1 lds
  s_waitcnt lgkmcnt(4)
  v_mfma_f32_16x16x32_bf16 v[76:79], a[108:111], v[28:31], v[76:79]
  v_mfma_f32_16x16x32_bf16 v[84:87], a[112:115], v[28:31], v[84:87]
  v_mfma_f32_16x16x32_bf16 v[92:95], a[116:119], v[28:31], v[92:95]
  s_add_u32 m0, s22, 4096
  s_add_u32 s26, s23, 4096
  buffer_load_dwordx4 v5, s[4:7], s26 offen offset:0 sc1 lds
  s_waitcnt lgkmcnt(3)
  v_mfma_f32_16x16x32_bf16 v[72:75], a[120:123], v[32:35], v[72:75]
  ds_read_b128 v[16:19], v8 offset:12288
  v_mfma_f32_16x16x32_bf16 v[80:83], a[124:127], v[32:35], v[80:83]
  ds_read_b128 v[20:23], v8 offset:32768
  v_mfma_f32_16x16x32_bf16 v[88:91], a[128:131], v[32:35], v[88:91]
  s_waitcnt lgkmcnt(4)
  v_mfma_f32_16x16x32_bf16 v[76:79], a[120:123], v[36:39], v[76:79]
  buffer_load_dwordx4 v5, s[4:7], s26 offen offset:1024 sc1 lds
  v_mfma_f32_16x16x32_bf16 v[84:87], a[124:127], v[36:39], v[84:87]
  v_mfma_f32_16x16x32_bf16 v[92:95], a[128:131], v[36:39], v[92:95]
  s_waitcnt lgkmcnt(3)
  v_mfma_f32_16x16x32_bf16 v[72:75], a[132:135], v[40:43], v[72:75]
  ds_read_b128 v[24:27], v8 offset:13312
  v_mfma_f32_16x16x32_bf16 v[80:83], a[136:139], v[40:43], v[80:83]
  ds_read_b128 v[28:31], v8 offset:33792
  v_mfma_f32_16x16x32_bf16 v[88:91], a[140:143], v[40:43], v[88:91]
  buffer_load_dwordx4 v5, s[4:7], s26 offen offset:2048 sc1 lds
  s_waitcnt lgkmcnt(4)
  v_mfma_f32_16x16x32_bf16 v[76:79], a[132:135], v[44:47], v[76:79]
  v_mfma_f32_16x16x32_bf16 v[84:87], a[136:139], v[44:47], v[84:87]
  v_mfma_f32_16x16x32_bf16 v[92:95], a[140:143], v[44:47], v[92:95]
  buffer_load_dwordx4 v5, s[4:7], s26 offen offset:3072 sc1 lds
  s_waitcnt lgkmcnt(3)
  v_mfma_f32_16x16x32_bf16 v[72:75], a[144:147], v[16:19], v[72:75]
  ds_read_b128 v[32:35], v8 offset:14336
  v_mfma_f32_16x16x32_bf16 v[80:83], a[148:151], v[16:19], v[80:83]
  ds_read_b128 v[36:39], v8 offset:34816
  v_mfma_f32_16x16x32_bf16 v[88:91], a[152:155], v[16:19], v[88:91]
  s_waitcnt lgkmcnt(4)
  v_mfma_f32_16x16x32_bf16 v[76:79], a[144:147], v[20:23], v[76:79]
  s_add_u32 m0, s22, 8192
  s_add_u32 s26, s23, 8192
  buffer_load_dwordx4 v5, s[4:7], s26 offen offset:0 sc1 lds
  v_mfma_f32_16x16x32_bf16 v[84:87], a[148:151], v[20:23], v[84:87]
  v_mfma_f32_16x16x32_bf16 v[92:95], a[152:155], v[20:23], v[92:95]
  s_waitcnt lgkmcnt(3)
  v_mfma_f32_16x16x32_bf16 v[72:75], a[156:159], v[24:27], v[72:75]
  ds_read_b128 v[40:43], v8 offset:15360
  v_mfma_f32_16x16x32_bf16 v[80:83], a[160:163], v[24:27], v[80:83]
  ds_read_b128 v[44:47], v8 offset:35840
  v_mfma_f32_16x16x32_bf16 v[88:91], a[164:167], v[24:27], v[88:91]
  buffer_load_dwordx4 v5, s[4:7], s26 offen offset:1024 sc1 lds
  s_waitcnt lgkmcnt(4)
  v_mfma_f32_16x16x32_bf16 v[76:79], a[156:159], v[28:31], v[76:79]
  v_mfma_f32_16x16x32_bf16 v[84:87], a[160:163], v[28:31], v[84:87]
  v_mfma_f32_16x16x32_bf16 v[92:95], a[164:167], v[28:31], v[92:95]
  s_waitcnt lgkmcnt(3)
  v_mfma_f32_16x16x32_bf16 v[72:75], a[168:171], v[32:35], v[72:75]
  ds_read_b128 v[16:19], v8 offset:16384
  v_mfma_f32_16x16x32_bf16 v[80:83], a[172:175], v[32:35], v[80:83]
  ds_read_b128 v[20:23], v8 offset:36864
  v_mfma_f32_16x16x32_bf16 v[88:91], a[176:179], v[32:35], v[88:91]
  s_waitcnt lgkmcnt(4)
  v_mfma_f32_16x16x32_bf16 v[76:79], a[168:171], v[36:39], v[76:79]
  v_mfma_f32_16x16x32_bf16 v[84:87], a[172:175], v[36:39], v[84:87]
  v_mfma_f32_16x16x32_bf16 v[92:95], a[176:179], v[36:39], v[92:95]
  s_waitcnt lgkmcnt(3)
  v_mfma_f32_16x16x32_bf16 v[72:75], a[180:183], v[40:43], v[72:75]
  ds_read_b128 v[24:27], v8 offset:17408
  v_mfma_f32_16x16x32_bf16 v[80:83], a[184:187], v[40:43], v[80:83]
  ds_read_b128 v[28:31], v8 offset:37888
  v_mfma_f32_16x16x32_bf16 v[88:91], a[188:191], v[40:43], v[88:91]
  s_waitcnt lgkmcnt(4)
  v_mfma_f32_16x16x32_bf16 v[76:79], a[180:183], v[44:47], v[76:79]
  s_waitcnt vmcnt(10)
  s_mov_b64 exec, 1
  buffer_store_dword v9, v6, s[4:7], s34 offen sc1
  s_mov_b64 exec, -1
  v_mfma_f32_16x16x32_bf16 v[84:87], a[184:187], v[44:47], v[84:87]
  v_mfma_f32_16x16x32_bf16 v[92:95], a[188:191], v[44:47], v[92:95]
  s_waitcnt lgkmcnt(3)
  v_mfma_f32_16x16x32_bf16 v[72:75], a[192:195], v[16:19], v[72:75]
  ds_read_b128 v[32:35], v8 offset:18432
  v_mfma_f32_16x16x32_bf16 v[80:83], a[196:199], v[16:19], v[80:83]
  ds_read_b128 v[36:39], v8 offset:38912
  v_mfma_f32_16x16x32_bf16 v[88:91], a[200:203], v[16:19], v[88:91]
  s_waitcnt lgkmcnt(4)
  v_mfma_f32_16x16x32_bf16 v[76:79], a[192:195], v[20:23], v[76:79]
  v_mfma_f32_16x16x32_bf16 v[84:87], a[196:199], v[20:23], v[84:87]
  v_mfma_f32_16x16x32_bf16 v[92:95], a[200:203], v[20:23], v[92:95]
  s_waitcnt lgkmcnt(3)
  v_mfma_f32_16x16x32_bf16 v[72:75], a[204:207], v[24:27], v[72:75]
  ds_read_b128 v[40:43], v8 offset:19456
  v_mfma_f32_16x16x32_bf16 v[80:83], a[208:211], v[24:27], v[80:83]
  ds_read_b128 v[44:47], v8 offset:39936
  v_mfma_f32_16x16x32_bf16 v[88:91], a[212:215], v[24:27], v[88:91]
  s_waitcnt lgkmcnt(4)
  v_mfma_f32_16x16x32_bf16 v[76:79], a[204:207], v[28:31], v[76:79]
  v_mfma_f32_16x16x32_bf16 v[84:87], a[208:211], v[28:31], v[84:87]
  v_mfma_f32_16x16x32_bf16 v[92:95], a[212:215], v[28:31], v[92:95]
  s_waitcnt lgkmcnt(3)
  v_mfma_f32_16x16x32_bf16 v[72:75], a[216:219], v[32:35], v[72:75]
  ds_read_b128 v[16:19], v7 offset:0
  v_mfma_f32_16x16x32_bf16 v[80:83], a[220:223], v[32:35], v[80:83]
  ds_read_b128 v[20:23], v7 offset:20480
  v_mfma_f32_16x16x32_bf16 v[88:91], a[224:227], v[32:35], v[88:91]
  s_waitcnt lgkmcnt(4)
  v_mfma_f32_16x16x32_bf16 v[76:79], a[216:219], v[36:39], v[76:79]
  v_mfma_f32_16x16x32_bf16 v[84:87], a[220:223], v[36:39], v[84:87]
  v_mfma_f32_16x16x32_bf16 v[92:95], a[224:227], v[36:39], v[92:95]
  s_waitcnt lgkmcnt(3)
  v_mfma_f32_16x16x32_bf16 v[72:75], a[228:231], v[40:43], v[72:75]
  ds_read_b128 v[24:27], v7 offset:1024
  v_mfma_f32_16x16x32_bf16 v[80:83], a[232:235], v[40:43], v[80:83]
  ds_read_b128 v[28:31], v7 offset:21504
  v_mfma_f32_16x16x32_bf16 v[88:91], a[236:239], v[40:43], v[88:91]
  s_waitcnt lgkmcnt(4)
  v_mfma_f32_16x16x32_bf16 v[76:79], a[228:231], v[44:47], v[76:79]
  v_mfma_f32_16x16x32_bf16 v[84:87], a[232:235], v[44:47], v[84:87]
  v_mfma_f32_16x16x32_bf16 v[92:95], a[236:239], v[44:47], v[92:95]
  s_mov_b32 s28, s29
  s_add_u32 s20, s20, 1
  s_cmp_eq_u32 s20, 64
  s_cbranch_scc1 L_proj_fin
  s_waitcnt lgkmcnt(3)
  v_mfma_f32_16x16x32_bf16 v[48:51], a[0:3], v[16:19], 0
  ds_read_b128 v[32:35], v7 offset:2048
  v_mfma_f32_16x16x32_bf16 v[56:59], a[4:7], v[16:19], 0
  ds_read_b128 v[36:39], v7 offset:22528
  v_mfma_f32_16x16x32_bf16 v[64:67], a[8:11], v[16:19], 0
  s_waitcnt lgkmcnt(4)
  v_mfma_f32_16x16x32_bf16 v[52:55], a[0:3], v[20:23], 0
  v_cvt_pk_bf16_f32 v96, v72, v73
  v_mfma_f32_16x16x32_bf16 v[60:63], a[4:7], v[20:23], 0
  v_mfma_f32_16x16x32_bf16 v[68:71], a[8:11], v[20:23], 0
  v_cvt_pk_bf16_f32 v97, v74, v75
  s_waitcnt lgkmcnt(3)
  v_mfma_f32_16x16x32_bf16 v[48:51], a[12:15], v[24:27], v[48:51]
  ds_read_b128 v[40:43], v7 offset:3072
  v_mfma_f32_16x16x32_bf16 v[56:59], a[16:19], v[24:27], v[56:59]
  ds_read_b128 v[44:47], v7 offset:23552
  v_cvt_pk_bf16_f32 v98, v76, v77
  v_mfma_f32_16x16x32_bf16 v[64:67], a[20:23], v[24:27], v[64:67]
  s_waitcnt lgkmcnt(4)
  v_mfma_f32_16x16x32_bf16 v[52:55], a[12:15], v[28:31], v[52:55]
  v_cvt_pk_bf16_f32 v99, v78, v79
  v_mfma_f32_16x16x32_bf16 v[60:63], a[16:19], v[28:31], v[60:63]
  v_mfma_f32_16x16x32_bf16 v[68:71], a[20:23], v[28:31], v[68:71]
  buffer_store_dwordx4 v[96:99], v4, s[4:7], s43 offen offset:0 sc1
  s_waitcnt lgkmcnt(3)
  v_mfma_f32_16x16x32_bf16 v[48:51], a[24:27], v[32:35], v[48:51]
  ds_read_b128 v[16:19], v7 offset:4096
  v_mfma_f32_16x16x32_bf16 v[56:59], a[28:31], v[32:35], v[56:59]
  ds_read_b128 v[20:23], v7 offset:24576
  v_cvt_pk_bf16_f32 v100, v80, v81
  v_mfma_f32_16x16x32_bf16 v[64:67], a[32:35], v[32:35], v[64:67]
  s_waitcnt lgkmcnt(4)
  v_mfma_f32_16x16x32_bf16 v[52:55], a[24:27], v[36:39], v[52:55]
  v_cvt_pk_bf16_f32 v101, v82, v83
  v_mfma_f32_16x16x32_bf16 v[60:63], a[28:31], v[36:39], v[60:63]
  v_mfma_f32_16x16x32_bf16 v[68:71], a[32:35], v[36:39], v[68:71]
  v_cvt_pk_bf16_f32 v102, v84, v85
  s_waitcnt lgkmcnt(3)
  v_mfma_f32_16x16x32_bf16 v[48:51], a[36:39], v[40:43], v[48:51]
  ds_read_b128 v[24:27], v7 offset:5120
  v_mfma_f32_16x16x32_bf16 v[56:59], a[40:43], v[40:43], v[56:59]
  ds_read_b128 v[28:31], v7 offset:25600
  v_cvt_pk_bf16_f32 v103, v86, v87
  v_mfma_f32_16x16x32_bf16 v[64:67], a[44:47], v[40:43], v[64:67]
  s_waitcnt lgkmcnt(4)
  v_mfma_f32_16x16x32_bf16 v[52:55], a[36:39], v[44:47], v[52:55]
  buffer_store_dwordx4 v[100:103], v4, s[4:7], s43 offen offset:1024 sc1
  v_mfma_f32_16x16x32_bf16 v[60:63], a[40:43], v[44:47], v[60:63]
  v_mfma_f32_16x16x32_bf16 v[68:71], a[44:47], v[44:47], v[68:71]
  v_cvt_pk_bf16_f32 v104, v88, v89
  s_waitcnt lgkmcnt(3)
  v_mfma_f32_16x16x32_bf16 v[48:51], a[48:51], v[16:19], v[48:51]
  ds_read_b128 v[32:35], v7 offset:6144
  v_mfma_f32_16x16x32_bf16 v[56:59], a[52:55], v[16:19], v[56:59]
  ds_read_b128 v[36:39], v7 offset:26624
  v_cvt_pk_bf16_f32 v105, v90, v91
  v_mfma_f32_16x16x32_bf16 v[64:67], a[56:59], v[16:19], v[64:67]
  s_waitcnt lgkmcnt(4)
  v_mfma_f32_16x16x32_bf16 v[52:55], a[48:51], v[20:23], v[52:55]
  v_cvt_pk_bf16_f32 v106, v92, v93
  v_mfma_f32_16x16x32_bf16 v[60:63], a[52:55], v[20:23], v[60:63]
  v_mfma_f32_16x16x32_bf16 v[68:71], a[56:59], v[20:23], v[68:71]
  v_cvt_pk_bf16_f32 v107, v94, v95
  s_waitcnt lgkmcnt(3)
  v_mfma_f32_16x16x32_bf16 v[48:51], a[60:63], v[24:27], v[48:51]
  ds_read_b128 v[40:43], v7 offset:7168
  v_mfma_f32_16x16x32_bf16 v[56:59], a[64:67], v[24:27], v[56:59]
  ds_read_b128 v[44:47], v7 offset:27648
  buffer_store_dwordx4 v[104:107], v4, s[4:7], s43 offen offset:2048 sc1
  v_mfma_f32_16x16x32_bf16 v[64:67], a[68:71], v[24:27], v[64:67]
  s_add_u32 s43, s43, 393216
  s_waitcnt lgkmcnt(4)
  v_mfma_f32_16x16x32_bf16 v[52:55], a[60:63], v[28:31], v[52:55]
  s_add_u32 s29, s28, 40960
  s_cmp_eq_u32 s29, 163840
  s_cselect_b32 s29, 0, s29
  v_mfma_f32_16x16x32_bf16 v[60:63], a[64:67], v[28:31], v[60:63]
  v_add_u32 v8, s29, v4
  v_mov_b32 v9, s20
  v_mfma_f32_16x16x32_bf16 v[68:71], a[68:71], v[28:31], v[68:71]
  s_waitcnt vmcnt(13)
  s_barrier
  s_waitcnt lgkmcnt(3)
  v_mfma_f32_16x16x32_bf16 v[48:51], a[72:75], v[32:35], v[48:51]
  ds_read_b128 v[16:19], v7 offset:8192
  v_mfma_f32_16x16x32_bf16 v[56:59], a[76:79], v[32:35], v[56:59]
  ds_read_b128 v[20:23], v7 offset:28672
  v_mfma_f32_16x16x32_bf16 v[64:67], a[80:83], v[32:35], v[64:67]
  s_add_u32 s30, s28, 122880
  s_sub_u32 s31, s30, 163840
  s_cmp_ge_u32 s30, 163840
  s_waitcnt lgkmcnt(4)
  v_mfma_f32_16x16x32_bf16 v[52:55], a[72:75], v[36:39], v[52:55]
  s_cselect_b32 s30, s31, s30
  s_add_u32 s31, s20, 3
  v_mfma_f32_16x16x32_bf16 v[60:63], a[76:79], v[36:39], v[60:63]
  s_min_u32 s23, s31, 63
  s_mul_i32 s23, s23, 40960
  v_mfma_f32_16x16x32_bf16 v[68:71], a[80:83], v[36:39], v[68:71]
  s_add_u32 s23, s23, 1048576
  s_add_u32 s22, s42, s30
  s_waitcnt lgkmcnt(3)
  v_mfma_f32_16x16x32_bf16 v[48:51], a[84:87], v[40:43], v[48:51]
  ds_read_b128 v[24:27], v7 offset:9216
  v_mfma_f32_16x16x32_bf16 v[56:59], a[88:91], v[40:43], v[56:59]
  ds_read_b128 v[28:31], v7 offset:29696
  v_mfma_f32_16x16x32_bf16 v[64:67], a[92:95], v[40:43], v[64:67]
  s_add_u32 m0, s22, 0
  s_add_u32 s26, s23, 0
  buffer_load_dwordx4 v5, s[4:7], s26 offen offset:0 sc1 lds
  s_waitcnt lgkmcnt(4)
  v_mfma_f32_16x16x32_bf16 v[52:55], a[84:87], v[44:47], v[52:55]
  v_mfma_f32_16x16x32_bf16 v[60:63], a[88:91], v[44:47], v[60:63]
  v_mfma_f32_16x16x32_bf16 v[68:71], a[92:95], v[44:47], v[68:71]
  buffer_load_dwordx4 v5, s[4:7], s26 offen offset:1024 sc1 lds
  s_waitcnt lgkmcnt(3)
  v_mfma_f32_16x16x32_bf16 v[48:51], a[96:99], v[16:19], v[48:51]
  ds_read_b128 v[32:35], v7 offset:10240
  v_mfma_f32_16x16x32_bf16 v[56:59], a[100:103], v[16:19], v[56:59]
  ds_read_b128 v[36:39], v7 offset:30720
  v_mfma_f32_16x16x32_bf16 v[64:67], a[104:107], v[16:19], v[64:67]
  s_waitcnt lgkmcnt(4)
  v_mfma_f32_16x16x32_bf16 v[52:55], a[96:99], v[20:23], v[52:55]
  buffer_load_dwordx4 v5, s[4:7], s26 offen offset:2048 sc1 lds
  v_mfma_f32_16x16x32_bf16 v[60:63], a[100:103], v[20:23], v[60:63]
  v_mfma_f32_16x16x32_bf16 v[68:71], a[104:107], v[20:23], v[68:71]
  s_waitcnt lgkmcnt(3)
  v_mfma_f32_16x16x32_bf16 v[48:51], a[108:111], v[24:27], v[48:51]
  ds_read_b128 v[40:43], v7 offset:11264
  v_mfma_f32_16x16x32_bf16 v[56:59], a[112:115], v[24:27], v[56:59]
  ds_read_b128 v[44:47], v7 offset:31744
  v_mfma_f32_16x16x32_bf16 v[64:67], a[116:119], v[24:27], v[64:67]
  buffer_load_dwordx4 v5, s[4:7], s26 offen offset:3072 sc1 lds
  s_waitcnt lgkmcnt(4)
  v_mfma_f32_16x16x32_bf16 v[52:55], a[108:111], v[28:31], v[52:55]
  v_mfma_f32_16x16x32_bf16 v[60:63], a[112:115], v[28:31], v[60:63]
  v_mfma_f32_16x16x32_bf16 v[68:71], a[116:119], v[28:31], v[68:71]
  s_add_u32 m0, s22, 4096
  s_add_u32 s26, s23, 4096
  buffer_load_dwordx4 v5, s[4:7], s26 offen offset:0 sc1 lds
  s_waitcnt lgkmcnt(3)
  v_mfma_f32_16x16x32_bf16 v[48:51], a[120:123], v[32:35], v[48:51]
  ds_read_b128 v[16:19], v7 offset:12288
  v_mfma_f32_16x16x32_bf16 v[56:59], a[124:127], v[32:35], v[56:59]
  ds_read_b128 v[20:23], v7 offset:32768
  v_mfma_f32_16x16x32_bf16 v[64:67], a[128:131], v[32:35], v[64:67]
  s_waitcnt lgkmcnt(4)
  v_mfma_f32_16x16x32_bf16 v[52:55], a[120:123], v[36:39], v[52:55]
  buffer_load_dwordx4 v5, s[4:7], s26 offen offset:1024 sc1 lds
  v_mfma_f32_16x16x32_bf16 v[60:63], a[124:127], v[36:39], v[60:63]
  v_mfma_f32_16x16x32_bf16 v[68:71], a[128:131], v[36:39], v[68:71]
  s_waitcnt lgkmcnt(3)
  v_mfma_f32_16x16x32_bf16 v[48:51], a[132:135], v[40:43], v[48:51]
  ds_read_b128 v[24:27], v7 offset:13312
  v_mfma_f32_16x16x32_bf16 v[56:59], a[136:139], v[40:43], v[56:59]
  ds_read_b128 v[28:31], v7 offset:33792
  v_mfma_f32_16x16x32_bf16 v[64:67], a[140:143], v[40:43], v[64:67]
  buffer_load_dwordx4 v5, s[4:7], s26 offen offset:2048 sc1 lds
  s_waitcnt lgkmcnt(4)
  v_mfma_f32_16x16x32_bf16 v[52:55], a[132:135], v[44:47], v[52:55]
  v_mfma_f32_16x16x32_bf16 v[60:63], a[136:139], v[44:47], v[60:63]
  v_mfma_f32_16x16x32_bf16 v[68:71], a[140:143], v[44:47], v[68:71]
  buffer_load_dwordx4 v5, s[4:7], s26 offen offset:3072 sc1 lds
  s_waitcnt lgkmcnt(3)
  v_mfma_f32_16x16x32_bf16 v[48:51], a[144:147], v[16:19], v[48:51]
  ds_read_b128 v[32:35], v7 offset:14336
  v_mfma_f32_16x16x32_bf16 v[56:59], a[148:151], v[16:19], v[56:59]
  ds_read_b128 v[36:39], v7 offset:34816
  v_mfma_f32_16x16x32_bf16 v[64:67], a[152:155], v[16:19], v[64:67]
  s_waitcnt lgkmcnt(4)
  v_mfma_f32_16x16x32_bf16 v[52:55], a[144:147], v[20:23], v[52:55]
  s_add_u32 m0, s22, 8192
  s_add_u32 s26, s23, 8192
  buffer_load_dwordx4 v5, s[4:7], s26 offen offset:0 sc1 lds
  v_mfma_f32_16x16x32_bf16 v[60:63], a[148:151], v[20:23], v[60:63]
  v_mfma_f32_16x16x32_bf16 v[68:71], a[152:155], v[20:23], v[68:71]
  s_waitcnt lgkmcnt(3)
  v_mfma_f32_16x16x32_bf16 v[48:51], a[156:159], v[24:27], v[48:51]
  ds_read_b128 v[40:43], v7 offset:15360
  v_mfma_f32_16x16x32_bf16 v[56:59], a[160:163], v[24:27], v[56:59]
  ds_read_b128 v[44:47], v7 offset:35840
  v_mfma_f32_16x16x32_bf16 v[64:67], a[164:167], v[24:27], v[64:67]
  buffer_load_dwordx4 v5, s[4:7], s26 offen offset:1024 sc1 lds
  s_waitcnt lgkmcnt(4)
  v_mfma_f32_16x16x32_bf16 v[52:55], a[156:159], v[28:31], v[52:55]
  v_mfma_f32_16x16x32_bf16 v[60:63], a[160:163], v[28:31], v[60:63]
  v_mfma_f32_16x16x32_bf16 v[68:71], a[164:167], v[28:31], v[68:71]
  s_waitcnt lgkmcnt(3)
  v_mfma_f32_16x16x32_bf16 v[48:51], a[168:171], v[32:35], v[48:51]
  ds_read_b128 v[16:19], v7 offset:16384
  v_mfma_f32_16x16x32_bf16 v[56:59], a[172:175], v[32:35], v[56:59]
  ds_read_b128 v[20:23], v7 offset:36864
  v_mfma_f32_16x16x32_bf16 v[64:67], a[176:179], v[32:35], v[64:67]
  s_waitcnt lgkmcnt(4)
  v_mfma_f32_16x16x32_bf16 v[52:55], a[168:171], v[36:39], v[52:55]
  v_mfma_f32_16x16x32_bf16 v[60:63], a[172:175], v[36:39], v[60:63]
  v_mfma_f32_16x16x32_bf16 v[68:71], a[176:179], v[36:39], v[68:71]
  s_waitcnt lgkmcnt(3)
  v_mfma_f32_16x16x32_bf16 v[48:51], a[180:183], v[40:43], v[48:51]
  ds_read_b128 v[24:27], v7 offset:17408
  v_mfma_f32_16x16x32_bf16 v[56:59], a[184:187], v[40:43], v[56:59]
  ds_read_b128 v[28:31], v7 offset:37888
  v_mfma_f32_16x16x32_bf16 v[64:67], a[188:191], v[40:43], v[64:67]
  s_waitcnt lgkmcnt(4)
  v_mfma_f32_16x16x32_bf16 v[52:55], a[180:183], v[44:47], v[52:55]
  s_waitcnt vmcnt(10)
  s_mov_b64 exec, 1
  buffer_store_dword v9, v6, s[4:7], s34 offen sc1
  s_mov_b64 exec, -1
  v_mfma_f32_16x16x32_bf16 v[60:63], a[184:187], v[44:47], v[60:63]
  v_mfma_f32_16x16x32_bf16 v[68:71], a[188:191], v[44:47], v[68:71]
  s_waitcnt lgkmcnt(3)
  v_mfma_f32_16x16x32_bf16 v[48:51], a[192:195], v[16:19], v[48:51]
  ds_read_b128 v[32:35], v7 offset:18432
  v_mfma_f32_16x16x32_bf16 v[56:59], a[196:199], v[16:19], v[56:59]
  ds_read_b128 v[36:39], v7 offset:38912
  v_mfma_f32_16x16x32_bf16 v[64:67], a[200:203], v[16:19], v[64:67]
  s_waitcnt lgkmcnt(4)
  v_mfma_f32_16x16x32_bf16 v[52:55], a[192:195], v[20:23], v[52:55]
  v_mfma_f32_16x16x32_bf16 v[60:63], a[196:199], v[20:23], v[60:63]
  v_mfma_f32_16x16x32_bf16 v[68:71], a[200:203], v[20:23], v[68:71]
  s_waitcnt lgkmcnt(3)
  v_mfma_f32_16x16x32_bf16 v[48:51], a[204:207], v[24:27], v[48:51]
  ds_read_b128 v[40:43], v7 offset:19456
  v_mfma_f32_16x16x32_bf16 v[56:59], a[208:211], v[24:27], v[56:59]
  ds_read_b128 v[44:47], v7 offset:39936
  v_mfma_f32_16x16x32_bf16 v[64:67], a[212:215], v[24:27], v[64:67]
  s_waitcnt lgkmcnt(4)
  v_mfma_f32_16x16x32_bf16 v[52:55], a[204:207], v[28:31], v[52:55]
  v_mfma_f32_16x16x32_bf16 v[60:63], a[208:211], v[28:31], v[60:63]
  v_mfma_f32_16x16x32_bf16 v[68:71], a[212:215], v[28:31], v[68:71]
  s_waitcnt lgkmcnt(3)
  v_mfma_f32_16x16x32_bf16 v[48:51], a[216:219], v[32:35], v[48:51]
  ds_read_b128 v[16:19], v8 offset:0
  v_mfma_f32_16x16x32_bf16 v[56:59], a[220:223], v[32:35], v[56:59]
  ds_read_b128 v[20:23], v8 offset:20480
  v_mfma_f32_16x16x32_bf16 v[64:67], a[224:227], v[32:35], v[64:67]
  s_waitcnt lgkmcnt(4)
  v_mfma_f32_16x16x32_bf16 v[52:55], a[216:219], v[36:39], v[52:55]
  v_mfma_f32_16x16x32_bf16 v[60:63], a[220:223], v[36:39], v[60:63]
  v_mfma_f32_16x16x32_bf16 v[68:71], a[224:227], v[36:39], v[68:71]
  s_waitcnt lgkmcnt(3)
  v_mfma_f32_16x16x32_bf16 v[48:51], a[228:231], v[40:43], v[48:51]
  ds_read_b128 v[24:27], v8 offset:1024
  v_mfma_f32_16x16x32_bf16 v[56:59], a[232:235], v[40:43], v[56:59]
  ds_read_b128 v[28:31], v8 offset:21504
  v_mfma_f32_16x16x32_bf16 v[64:67], a[236:239], v[40:43], v[64:67]
  s_waitcnt lgkmcnt(4)
  v_mfma_f32_16x16x32_bf16 v[52:55], a[228:231], v[44:47], v[52:55]
  v_mfma_f32_16x16x32_bf16 v[60:63], a[232:235], v[44:47], v[60:63]
  v_mfma_f32_16x16x32_bf16 v[68:71], a[236:239], v[44:47], v[68:71]
  s_mov_b32 s28, s29
  s_add_u32 s20, s20, 1
  s_waitcnt lgkmcnt(0)
  s_branch L_proj_loop
L_proj_fin:
  v_cvt_pk_bf16_f32 v96, v72, v73
  v_cvt_pk_bf16_f32 v97, v74, v75
  v_cvt_pk_bf16_f32 v98, v76, v77
  v_cvt_pk_bf16_f32 v99, v78, v79
  buffer_store_dwordx4 v[96:99], v4, s[4:7], s43 offen offset:0 sc1
  v_cvt_pk_bf16_f32 v100, v80, v81
  v_cvt_pk_bf16_f32 v101, v82, v83
  v_cvt_pk_bf16_f32 v102, v84, v85
  v_cvt_pk_bf16_f32 v103, v86, v87
  buffer_store_dwordx4 v[100:103], v4, s[4:7], s43 offen offset:1024 sc1
  v_cvt_pk_bf16_f32 v104, v88, v89
  v_cvt_pk_bf16_f32 v105, v90, v91
  v_cvt_pk_bf16_f32 v106, v92, v93
  v_cvt_pk_bf16_f32 v107, v94, v95
  buffer_store_dwordx4 v[104:107], v4, s[4:7], s43 offen offset:2048 sc1
  v_mov_b32 v9, s20
  s_waitcnt vmcnt(0)
  s_mov_b64 exec, 1
  buffer_store_dword v9, v6, s[4:7], s34 offen sc1
  s_mov_b64 exec, -1
  s_waitcnt vmcnt(0) lgkmcnt(0)
  s_barrier
  s_min_u32 s22, s27, 2
  s_lshl_b32 s22, s22, 5
  s_add_u32 s18, s18, s22
  s_branch L_second
L_second:
  s_cmp_lt_u32 s18, 48
  s_cbranch_scc1 L_F1
  s_sub_u32 s18, s18, 48
  s_cmp_lt_u32 s18, 40
  s_cbranch_scc1 L_F2
  s_add_u32 s50, s18, 400
  s_mov_b32 s51, 40
  s_mov_b32 s52, 640
  s_waitcnt vmcnt(0)
  s_branch L_T_m_in
L_T_m:
  s_sleep 4
L_T_m_in:
  buffer_load_dword v4, off, s[96:99], 0 offset:64 sc1
  s_add_u32 s39, s39, 1
  s_cmp_gt_u32 s39, 200000
  s_cbranch_scc1 L_exit
  s_waitcnt vmcnt(0)
  v_cmp_gt_u32 vcc, 40, v4
  s_cbranch_vccnz L_T_m
  s_branch L_T
L_F1:
  s_load_dwordx4 s[28:31], s[0:1], 64
  s_lshr_b32 s20, s18, 3
  s_and_b32 s33, s18, 7
  s_mul_i32 s32, s33, 384
  s_waitcnt lgkmcnt(0)
  s_mov_b32 s8, s28
  s_mov_b32 s9, s29
  s_mov_b32 s10, 1966080
  s_mov_b32 s11, 0x20000
  s_mov_b32 s12, s30
  s_mov_b32 s13, s31
  s_mov_b32 s14, 3072
  s_mov_b32 s15, 0x20000
  v_lshrrev_b32 v16, 3, v1
  v_and_b32 v17, 7, v1
  v_lshrrev_b32 v19, 1, v17
  v_lshrrev_b32 v20, 1, v16
  v_xor_b32 v19, v19, v20
  v_lshlrev_b32 v18, 5, v19
  v_and_b32 v19, 1, v17
  v_lshl_add_u32 v18, v19, 4, v18
  v_lshrrev_b32 v19, 2, v16
  v_and_b32 v20, 3, v16
  v_lshl_add_u32 v21, v19, 3, v20
  s_lshr_b32 s22, s17, 1
  s_lshl_b32 s22, s22, 5
  s_and_b32 s23, s17, 1
  s_lshl_b32 s23, s23, 2
  s_add_u32 s22, s22, s23
  v_add_u32 v21, s22, v21
  s_mov_b32 s22, 3072
  v_mul_lo_u32 v21, v21, s22
  v_add_u32 v21, v21, v18
  s_mul_i32 s24, s17, 6144
  s_and_b32 s25, s17, 1
  s_mul_i32 s25, s25, 10240
  s_lshr_b32 s22, s17, 1
  s_mul_i32 s22, s22, 5120
  s_add_u32 s25, s25, s22
  v_bfe_u32 v16, v1, 2, 3
  v_and_b32 v17, 3, v1
  v_lshlrev_b32 v17, 3, v17
  v_lshl_add_u32 v17, v16, 7, v17
  v_lshrrev_b32 v16, 1, v16
  v_lshrrev_b32 v20, 5, v1
  s_mul_i32 s22, s17, 3
  s_add_u32 s22, s22, 0
  s_and_b32 s23, s22, 3
  s_lshr_b32 s22, s22, 2
  s_lshl_b32 s22, s22, 10
  v_xor_b32 v19, s23, v16
  v_lshl_add_u32 v22, v19, 5, v17
  v_add_u32 v22, s22, v22
  v_mul_u32_u24 v19, 3072, v20
  v_add_u32 v22, v22, v19
  s_mul_i32 s22, s17, 3
  s_add_u32 s22, s22, 1
  s_and_b32 s23, s22, 3
  s_lshr_b32 s22, s22, 2
  s_lshl_b32 s22, s22, 10
  v_xor_b32 v19, s23, v16
  v_lshl_add_u32 v23, v19, 5, v17
  v_add_u32 v23, s22, v23
  v_mul_u32_u24 v19, 3072, v20
  v_add_u32 v23, v23, v19
  s_mul_i32 s22, s17, 3
  s_add_u32 s22, s22, 2
  s_and_b32 s23, s22, 3
  s_lshr_b32 s22, s22, 2
  s_lshl_b32 s22, s22, 10
  v_xor_b32 v19, s23, v16
  v_lshl_add_u32 v24, v19, 5, v17
  v_add_u32 v24, s22, v24
  v_mul_u32_u24 v19, 3072, v20
  v_add_u32 v24, v24, v19
  s_add_u32 m0, s24, 0
  s_add_u32 s26, s32, 0
  buffer_load_dwordx4 v21, s[8:11], s26 offen  lds
  s_add_u32 m0, s24, 1024
  s_add_u32 s26, s32, 128
  buffer_load_dwordx4 v21, s[8:11], s26 offen  lds
  s_add_u32 m0, s24, 2048
  s_add_u32 s26, s32, 256
  buffer_load_dwordx4 v21, s[8:11], s26 offen  lds
  s_add_u32 m0, s24, 3072
  s_add_u32 s26, s32, 49152
  buffer_load_dwordx4 v21, s[8:11], s26 offen  lds
  s_add_u32 m0, s24, 4096
  s_add_u32 s26, s32, 49280
  buffer_load_dwordx4 v21, s[8:11], s26 offen  lds
  s_add_u32 m0, s24, 5120
  s_add_u32 s26, s32, 49408
  buffer_load_dwordx4 v21, s[8:11], s26 offen  lds
  s_add_u32 m0, s24, 24576
  s_add_u32 s26, s32, 196608
  buffer_load_dwordx4 v21, s[8:11], s26 offen  lds
  s_add_u32 m0, s24, 25600
  s_add_u32 s26, s32, 196736
  buffer_load_dwordx4 v21, s[8:11], s26 offen  lds
  s_add_u32 m0, s24, 26624
  s_add_u32 s26, s32, 196864
  buffer_load_dwordx4 v21, s[8:11], s26 offen  lds
  s_add_u32 m0, s24, 27648
  s_add_u32 s26, s32, 245760
  buffer_load_dwordx4 v21, s[8:11], s26 offen  lds
  s_add_u32 m0, s24, 28672
  s_add_u32 s26, s32, 245888
  buffer_load_dwordx4 v21, s[8:11], s26 offen  lds
  s_add_u32 m0, s24, 29696
  s_add_u32 s26, s32, 246016
  buffer_load_dwordx4 v21, s[8:11], s26 offen  lds
  s_add_u32 m0, s24, 49152
  s_add_u32 s26, s32, 393216
  buffer_load_dwordx4 v21, s[8:11], s26 offen  lds
  s_add_u32 m0, s24, 50176
  s_add_u32 s26, s32, 393344
  buffer_load_dwordx4 v21, s[8:11], s26 offen  lds
  s_add_u32 m0, s24, 51200
  s_add_u32 s26, s32, 393472
  buffer_load_dwordx4 v21, s[8:11], s26 offen  lds
  s_add_u32 m0, s24, 52224
  s_add_u32 s26, s32, 442368
  buffer_load_dwordx4 v21, s[8:11], s26 offen  lds
  s_add_u32 m0, s24, 53248
  s_add_u32 s26, s32, 442496
  buffer_load_dwordx4 v21, s[8:11], s26 offen  lds
  s_add_u32 m0, s24, 54272
  s_add_u32 s26, s32, 442624
  buffer_load_dwordx4 v21, s[8:11], s26 offen  lds
  s_add_u32 m0, s24, 73728
  s_add_u32 s26, s32, 589824
  buffer_load_dwordx4 v21, s[8:11], s26 offen  lds
  s_add_u32 m0, s24, 74752
  s_add_u32 s26, s32, 589952
  buffer_load_dwordx4 v21, s[8:11], s26 offen  lds
  s_add_u32 m0, s24, 75776
  s_add_u32 s26, s32, 590080
  buffer_load_dwordx4 v21, s[8:11], s26 offen  lds
  s_add_u32 m0, s24, 76800
  s_add_u32 s26, s32, 638976
  buffer_load_dwordx4 v21, s[8:11], s26 offen  lds
  s_add_u32 m0, s24, 77824
  s_add_u32 s26, s32, 639104
  buffer_load_dwordx4 v21, s[8:11], s26 offen  lds
  s_add_u32 m0, s24, 78848
  s_add_u32 s26, s32, 639232
  buffer_load_dwordx4 v21, s[8:11], s26 offen  lds
  s_add_u32 m0, s24, 98304
  s_add_u32 s26, s32, 786432
  buffer_load_dwordx4 v21, s[8:11], s26 offen  lds
  s_add_u32 m0, s24, 99328
  s_add_u32 s26, s32, 786560
  buffer_load_dwordx4 v21, s[8:11], s26 offen  lds
  s_add_u32 m0, s24, 100352
  s_add_u32 s26, s32, 786688
  buffer_load_dwordx4 v21, s[8:11], s26 offen  lds
  s_add_u32 m0, s24, 101376
  s_add_u32 s26, s32, 835584
  buffer_load_dwordx4 v21, s[8:11], s26 offen  lds
  s_add_u32 m0, s24, 102400
  s_add_u32 s26, s32, 835712
  buffer_load_dwordx4 v21, s[8:11], s26 offen  lds
  s_add_u32 m0, s24, 103424
  s_add_u32 s26, s32, 835840
  buffer_load_dwordx4 v21, s[8:11], s26 offen  lds
  s_waitcnt vmcnt(24)
  s_barrier
  s_add_u32 m0, s24, 122880
  s_add_u32 s26, s32, 983040
  buffer_load_dwordx4 v21, s[8:11], s26 offen  lds
  s_add_u32 m0, s24, 123904
  s_add_u32 s26, s32, 983168
  buffer_load_dwordx4 v21, s[8:11], s26 offen  lds
  s_add_u32 m0, s24, 124928
  s_add_u32 s26, s32, 983296
  buffer_load_dwordx4 v21, s[8:11], s26 offen  lds
  s_add_u32 m0, s24, 125952
  s_add_u32 s26, s32, 1032192
  buffer_load_dwordx4 v21, s[8:11], s26 offen  lds
  s_add_u32 m0, s24, 126976
  s_add_u32 s26, s32, 1032320
  buffer_load_dwordx4 v21, s[8:11], s26 offen  lds
  s_add_u32 m0, s24, 128000
  s_add_u32 s26, s32, 1032448
  buffer_load_dwordx4 v21, s[8:11], s26 offen  lds
  v_add_u32 v25, 0, v22
  v_add_u32 v26, 0, v23
  v_add_u32 v27, 0, v24
  ds_read_b64_tr_b16 a[0:1], v25 offset:0
  ds_read_b64_tr_b16 a[2:3], v25 offset:6144
  ds_read_b64_tr_b16 a[12:13], v25 offset:12288
  ds_read_b64_tr_b16 a[14:15], v25 offset:18432
  ds_read_b64_tr_b16 a[4:5], v26 offset:0
  ds_read_b64_tr_b16 a[6:7], v26 offset:6144
  ds_read_b64_tr_b16 a[16:17], v26 offset:12288
  ds_read_b64_tr_b16 a[18:19], v26 offset:18432
  ds_read_b64_tr_b16 a[8:9], v27 offset:0
  ds_read_b64_tr_b16 a[10:11], v27 offset:6144
  ds_read_b64_tr_b16 a[20:21], v27 offset:12288
  ds_read_b64_tr_b16 a[22:23], v27 offset:18432
  s_waitcnt lgkmcnt(0)
  s_waitcnt vmcnt(24)
  s_barrier
  s_add_u32 m0, s24, 0
  s_add_u32 s26, s32, 1179648
  buffer_load_dwordx4 v21, s[8:11], s26 offen  lds
  s_add_u32 m0, s24, 1024
  s_add_u32 s26, s32, 1179776
  buffer_load_dwordx4 v21, s[8:11], s26 offen  lds
  s_add_u32 m0, s24, 2048
  s_add_u32 s26, s32, 1179904
  buffer_load_dwordx4 v21, s[8:11], s26 offen  lds
  s_add_u32 m0, s24, 3072
  s_add_u32 s26, s32, 1228800
  buffer_load_dwordx4 v21, s[8:11], s26 offen  lds
  s_add_u32 m0, s24, 4096
  s_add_u32 s26, s32, 1228928
  buffer_load_dwordx4 v21, s[8:11], s26 offen  lds
  s_add_u32 m0, s24, 5120
  s_add_u32 s26, s32, 1229056
  buffer_load_dwordx4 v21, s[8:11], s26 offen  lds
  v_add_u32 v25, 24576, v22
  v_add_u32 v26, 24576, v23
  v_add_u32 v27, 24576, v24
  ds_read_b64_tr_b16 a[24:25], v25 offset:0
  ds_read_b64_tr_b16 a[26:27], v25 offset:6144
  ds_read_b64_tr_b16 a[36:37], v25 offset:12288
  ds_read_b64_tr_b16 a[38:39], v25 offset:18432
  ds_read_b64_tr_b16 a[28:29], v26 offset:0
  ds_read_b64_tr_b16 a[30:31], v26 offset:6144
  ds_read_b64_tr_b16 a[40:41], v26 offset:12288
  ds_read_b64_tr_b16 a[42:43], v26 offset:18432
  ds_read_b64_tr_b16 a[32:33], v27 offset:0
  ds_read_b64_tr_b16 a[34:35], v27 offset:6144
  ds_read_b64_tr_b16 a[44:45], v27 offset:12288
  ds_read_b64_tr_b16 a[46:47], v27 offset:18432
  s_waitcnt lgkmcnt(0)
  s_waitcnt vmcnt(24)
  s_barrier
  s_add_u32 m0, s24, 24576
  s_add_u32 s26, s32, 1376256
  buffer_load_dwordx4 v21, s[8:11], s26 offen  lds
  s_add_u32 m0, s24, 25600
  s_add_u32 s26, s32, 1376384
  buffer_load_dwordx4 v21, s[8:11], s26 offen  lds
  s_add_u32 m0, s24, 26624
  s_add_u32 s26, s32, 1376512
  buffer_load_dwordx4 v21, s[8:11], s26 offen  lds
  s_add_u32 m0, s24, 27648
  s_add_u32 s26, s32, 1425408
  buffer_load_dwordx4 v21, s[8:11], s26 offen  lds
  s_add_u32 m0, s24, 28672
  s_add_u32 s26, s32, 1425536
  buffer_load_dwordx4 v21, s[8:11], s26 offen  lds
  s_add_u32 m0, s24, 29696
  s_add_u32 s26, s32, 1425664
  buffer_load_dwordx4 v21, s[8:11], s26 offen  lds
  v_add_u32 v25, 49152, v22
  v_add_u32 v26, 49152, v23
  v_add_u32 v27, 49152, v24
  ds_read_b64_tr_b16 a[48:49], v25 offset:0
  ds_read_b64_tr_b16 a[50:51], v25 offset:6144
  ds_read_b64_tr_b16 a[60:61], v25 offset:12288
  ds_read_b64_tr_b16 a[62:63], v25 offset:18432
  ds_read_b64_tr_b16 a[52:53], v26 offset:0
  ds_read_b64_tr_b16 a[54:55], v26 offset:6144
  ds_read_b64_tr_b16 a[64:65], v26 offset:12288
  ds_read_b64_tr_b16 a[66:67], v26 offset:18432
  ds_read_b64_tr_b16 a[56:57], v27 offset:0
  ds_read_b64_tr_b16 a[58:59], v27 offset:6144
  ds_read_b64_tr_b16 a[68:69], v27 offset:12288
  ds_read_b64_tr_b16 a[70:71], v27 offset:18432
  s_waitcnt lgkmcnt(0)
  s_waitcnt vmcnt(24)
  s_barrier
  s_add_u32 m0, s24, 49152
  s_add_u32 s26, s32, 1572864
  buffer_load_dwordx4 v21, s[8:11], s26 offen  lds
  s_add_u32 m0, s24, 50176
  s_add_u32 s26, s32, 1572992
  buffer_load_dwordx4 v21, s[8:11], s26 offen  lds
  s_add_u32 m0, s24, 51200
  s_add_u32 s26, s32, 1573120
  buffer_load_dwordx4 v21, s[8:11], s26 offen  lds
  s_add_u32 m0, s24, 52224
  s_add_u32 s26, s32, 1622016
  buffer_load_dwordx4 v21, s[8:11], s26 offen  lds
  s_add_u32 m0, s24, 53248
  s_add_u32 s26, s32, 1622144
  buffer_load_dwordx4 v21, s[8:11], s26 offen  lds
  s_add_u32 m0, s24, 54272
  s_add_u32 s26, s32, 1622272
  buffer_load_dwordx4 v21, s[8:11], s26 offen  lds
  v_add_u32 v25, 73728, v22
  v_add_u32 v26, 73728, v23
  v_add_u32 v27, 73728, v24
  ds_read_b64_tr_b16 a[72:73], v25 offset:0
  ds_read_b64_tr_b16 a[74:75], v25 offset:6144
  ds_read_b64_tr_b16 a[84:85], v25 offset:12288
  ds_read_b64_tr_b16 a[86:87], v25 offset:18432
  ds_read_b64_tr_b16 a[76:77], v26 offset:0
  ds_read_b64_tr_b16 a[78:79], v26 offset:6144
  ds_read_b64_tr_b16 a[88:89], v26 offset:12288
  ds_read_b64_tr_b16 a[90:91], v26 offset:18432
  ds_read_b64_tr_b16 a[80:81], v27 offset:0
  ds_read_b64_tr_b16 a[82:83], v27 offset:6144
  ds_read_b64_tr_b16 a[92:93], v27 offset:12288
  ds_read_b64_tr_b16 a[94:95], v27 offset:18432
  s_waitcnt lgkmcnt(0)
  s_waitcnt vmcnt(24)
  s_barrier
  s_add_u32 m0, s24, 73728
  s_add_u32 s26, s32, 1769472
  buffer_load_dwordx4 v21, s[8:11], s26 offen  lds
  s_add_u32 m0, s24, 74752
  s_add_u32 s26, s32, 1769600
  buffer_load_dwordx4 v21, s[8:11], s26 offen  lds
  s_add_u32 m0, s24, 75776
  s_add_u32 s26, s32, 1769728
  buffer_load_dwordx4 v21, s[8:11], s26 offen  lds
  s_add_u32 m0, s24, 76800
  s_add_u32 s26, s32, 1818624
  buffer_load_dwordx4 v21, s[8:11], s26 offen  lds
  s_add_u32 m0, s24, 77824
  s_add_u32 s26, s32, 1818752
  buffer_load_dwordx4 v21, s[8:11], s26 offen  lds
  s_add_u32 m0, s24, 78848
  s_add_u32 s26, s32, 1818880
  buffer_load_dwordx4 v21, s[8:11], s26 offen  lds
  v_add_u32 v25, 98304, v22
  v_add_u32 v26, 98304, v23
  v_add_u32 v27, 98304, v24
  ds_read_b64_tr_b16 a[96:97], v25 offset:0
  ds_read_b64_tr_b16 a[98:99], v25 offset:6144
  ds_read_b64_tr_b16 a[108:109], v25 offset:12288
  ds_read_b64_tr_b16 a[110:111], v25 offset:18432
  ds_read_b64_tr_b16 a[100:101], v26 offset:0
  ds_read_b64_tr_b16 a[102:103], v26 offset:6144
  ds_read_b64_tr_b16 a[112:113], v26 offset:12288
  ds_read_b64_tr_b16 a[114:115], v26 offset:18432
  ds_read_b64_tr_b16 a[104:105], v27 offset:0
  ds_read_b64_tr_b16 a[106:107], v27 offset:6144
  ds_read_b64_tr_b16 a[116:117], v27 offset:12288
  ds_read_b64_tr_b16 a[118:119], v27 offset:18432
  s_waitcnt lgkmcnt(0)
  s_waitcnt vmcnt(24)
  s_barrier
  v_add_u32 v25, 122880, v22
  v_add_u32 v26, 122880, v23
  v_add_u32 v27, 122880, v24
  ds_read_b64_tr_b16 a[120:121], v25 offset:0
  ds_read_b64_tr_b16 a[122:123], v25 offset:6144
  ds_read_b64_tr_b16 a[132:133], v25 offset:12288
  ds_read_b64_tr_b16 a[134:135], v25 offset:18432
  ds_read_b64_tr_b16 a[124:125], v26 offset:0
  ds_read_b64_tr_b16 a[126:127], v26 offset:6144
  ds_read_b64_tr_b16 a[136:137], v26 offset:12288
  ds_read_b64_tr_b16 a[138:139], v26 offset:18432
  ds_read_b64_tr_b16 a[128:129], v27 offset:0
  ds_read_b64_tr_b16 a[130:131], v27 offset:6144
  ds_read_b64_tr_b16 a[140:141], v27 offset:12288
  ds_read_b64_tr_b16 a[142:143], v27 offset:18432
  s_waitcnt lgkmcnt(0)
  s_waitcnt vmcnt(18)
  s_barrier
  v_add_u32 v25, 0, v22
  v_add_u32 v26, 0, v23
  v_add_u32 v27, 0, v24
  ds_read_b64_tr_b16 a[144:145], v25 offset:0
  ds_read_b64_tr_b16 a[146:147], v25 offset:6144
  ds_read_b64_tr_b16 a[156:157], v25 offset:12288
  ds_read_b64_tr_b16 a[158:159], v25 offset:18432
  ds_read_b64_tr_b16 a[148:149], v26 offset:0
  ds_read_b64_tr_b16 a[150:151], v26 offset:6144
  ds_read_b64_tr_b16 a[160:161], v26 offset:12288
  ds_read_b64_tr_b16 a[162:163], v26 offset:18432
  ds_read_b64_tr_b16 a[152:153], v27 offset:0
  ds_read_b64_tr_b16 a[154:155], v27 offset:6144
  ds_read_b64_tr_b16 a[164:165], v27 offset:12288
  ds_read_b64_tr_b16 a[166:167], v27 offset:18432
  s_waitcnt lgkmcnt(0)
  s_waitcnt vmcnt(12)
  s_barrier
  v_add_u32 v25, 24576, v22
  v_add_u32 v26, 24576, v23
  v_add_u32 v27, 24576, v24
  ds_read_b64_tr_b16 a[168:169], v25 offset:0
  ds_read_b64_tr_b16 a[170:171], v25 offset:6144
  ds_read_b64_tr_b16 a[180:181], v25 offset:12288
  ds_read_b64_tr_b16 a[182:183], v25 offset:18432
  ds_read_b64_tr_b16 a[172:173], v26 offset:0
  ds_read_b64_tr_b16 a[174:175], v26 offset:6144
  ds_read_b64_tr_b16 a[184:185], v26 offset:12288
  ds_read_b64_tr_b16 a[186:187], v26 offset:18432
  ds_read_b64_tr_b16 a[176:177], v27 offset:0
  ds_read_b64_tr_b16 a[178:179], v27 offset:6144
  ds_read_b64_tr_b16 a[188:189], v27 offset:12288
  ds_read_b64_tr_b16 a[190:191], v27 offset:18432
  s_waitcnt lgkmcnt(0)
  s_waitcnt vmcnt(6)
  s_barrier
  v_add_u32 v25, 49152, v22
  v_add_u32 v26, 49152, v23
  v_add_u32 v27, 49152, v24
  ds_read_b64_tr_b16 a[192:193], v25 offset:0
  ds_read_b64_tr_b16 a[194:195], v25 offset:6144
  ds_read_b64_tr_b16 a[204:205], v25 offset:12288
  ds_read_b64_tr_b16 a[206:207], v25 offset:18432
  ds_read_b64_tr_b16 a[196:197], v26 offset:0
  ds_read_b64_tr_b16 a[198:199], v26 offset:6144
  ds_read_b64_tr_b16 a[208:209], v26 offset:12288
  ds_read_b64_tr_b16 a[210:211], v26 offset:18432
  ds_read_b64_tr_b16 a[200:201], v27 offset:0
  ds_read_b64_tr_b16 a[202:203], v27 offset:6144
  ds_read_b64_tr_b16 a[212:213], v27 offset:12288
  ds_read_b64_tr_b16 a[214:215], v27 offset:18432
  s_waitcnt lgkmcnt(0)
  s_waitcnt vmcnt(0)
  s_barrier
  v_add_u32 v25, 73728, v22
  v_add_u32 v26, 73728, v23
  v_add_u32 v27, 73728, v24
  ds_read_b64_tr_b16 a[216:217], v25 offset:0
  ds_read_b64_tr_b16 a[218:219], v25 offset:6144
  ds_read_b64_tr_b16 a[228:229], v25 offset:12288
  ds_read_b64_tr_b16 a[230:231], v25 offset:18432
  ds_read_b64_tr_b16 a[220:221], v26 offset:0
  ds_read_b64_tr_b16 a[222:223], v26 offset:6144
  ds_read_b64_tr_b16 a[232:233], v26 offset:12288
  ds_read_b64_tr_b16 a[234:235], v26 offset:18432
  ds_read_b64_tr_b16 a[224:225], v27 offset:0
  ds_read_b64_tr_b16 a[226:227], v27 offset:6144
  ds_read_b64_tr_b16 a[236:237], v27 offset:12288
  ds_read_b64_tr_b16 a[238:239], v27 offset:18432
  s_waitcnt lgkmcnt(0)
  s_waitcnt vmcnt(0)
  s_barrier
  s_branch L_F1_m_in
L_F1_m:
  s_sleep 4
L_F1_m_in:
  buffer_load_dword v4, off, s[96:99], 0 offset:64 sc1
  s_add_u32 s39, s39, 1
  s_cmp_gt_u32 s39, 200000
  s_cbranch_scc1 L_exit
  s_waitcnt vmcnt(0)
  v_cmp_gt_u32 vcc, 40, v4
  s_cbranch_vccnz L_F1_m
  s_mul_i32 s22, s17, 96
  s_add_u32 s22, s22, s32
  v_lshlrev_b32 v4, 3, v2
  buffer_load_dwordx2 v[96:97], v4, s[12:15], s22 offen offset:0
  buffer_load_dwordx2 v[98:99], v4, s[12:15], s22 offen offset:32
  buffer_load_dwordx2 v[100:101], v4, s[12:15], s22 offen offset:64
  v_lshlrev_b32 v4, 5, v2
  s_mov_b32 s22, 10240
  s_mov_b32 s23, 7680
  buffer_load_dwordx4 v[128:131], v4, s[4:7], s22 offen offset:0 sc1
  buffer_load_dwordx4 v[132:135], v4, s[4:7], s22 offen offset:16 sc1
  buffer_load_dwordx4 v[136:139], v4, s[4:7], s23 offen offset:0 sc1
  buffer_load_dwordx4 v[140:143], v4, s[4:7], s23 offen offset:16 sc1
  buffer_load_dwordx4 v[144:147], v4, s[4:7], s22 offen offset:128 sc1
  buffer_load_dwordx4 v[148:151], v4, s[4:7], s22 offen offset:144 sc1
  buffer_load_dwordx4 v[152:155], v4, s[4:7], s23 offen offset:128 sc1
  buffer_load_dwordx4 v[156:159], v4, s[4:7], s23 offen offset:144 sc1
  buffer_load_dwordx4 v[160:163], v4, s[4:7], s22 offen offset:256 sc1
  buffer_load_dwordx4 v[164:167], v4, s[4:7], s22 offen offset:272 sc1
  buffer_load_dwordx4 v[168:171], v4, s[4:7], s23 offen offset:256 sc1
  buffer_load_dwordx4 v[172:175], v4, s[4:7], s23 offen offset:272 sc1
  buffer_load_dwordx4 v[176:179], v4, s[4:7], s22 offen offset:384 sc1
  buffer_load_dwordx4 v[180:183], v4, s[4:7], s22 offen offset:400 sc1
  buffer_load_dwordx4 v[184:187], v4, s[4:7], s23 offen offset:384 sc1
  buffer_load_dwordx4 v[188:191], v4, s[4:7], s23 offen offset:400 sc1
  buffer_load_dwordx4 v[192:195], v4, s[4:7], s22 offen offset:512 sc1
  buffer_load_dwordx4 v[196:199], v4, s[4:7], s22 offen offset:528 sc1
  buffer_load_dwordx4 v[200:203], v4, s[4:7], s23 offen offset:512 sc1
  buffer_load_dwordx4 v[204:207], v4, s[4:7], s23 offen offset:528 sc1
  s_waitcnt vmcnt(19)
  v_cvt_pk_bf16_f32 v16, v128, v129
  v_cvt_pk_bf16_f32 v17, v130, v131
  s_waitcnt vmcnt(18)
  v_cvt_pk_bf16_f32 v18, v132, v133
  v_cvt_pk_bf16_f32 v19, v134, v135
  s_nop 1
  v_mfma_f32_16x16x32_bf16 v[104:107], a[0:3], v[16:19], 0
  v_mfma_f32_16x16x32_bf16 v[112:115], a[4:7], v[16:19], 0
  v_mfma_f32_16x16x32_bf16 v[120:123], a[8:11], v[16:19], 0
  s_waitcnt vmcnt(17)
  v_cvt_pk_bf16_f32 v20, v136, v137
  v_cvt_pk_bf16_f32 v21, v138, v139
  s_waitcnt vmcnt(16)
  v_cvt_pk_bf16_f32 v22, v140, v141
  v_cvt_pk_bf16_f32 v23, v142, v143
  s_nop 1
  v_mfma_f32_16x16x32_bf16 v[108:111], a[0:3], v[20:23], 0
  v_mfma_f32_16x16x32_bf16 v[116:119], a[4:7], v[20:23], 0
  v_mfma_f32_16x16x32_bf16 v[124:127], a[8:11], v[20:23], 0
  s_waitcnt vmcnt(15)
  v_cvt_pk_bf16_f32 v24, v144, v145
  v_cvt_pk_bf16_f32 v25, v146, v147
  s_waitcnt vmcnt(14)
  v_cvt_pk_bf16_f32 v26, v148, v149
  v_cvt_pk_bf16_f32 v27, v150, v151
  s_nop 1
  v_mfma_f32_16x16x32_bf16 v[104:107], a[12:15], v[24:27], v[104:107]
  v_mfma_f32_16x16x32_bf16 v[112:115], a[16:19], v[24:27], v[112:115]
  v_mfma_f32_16x16x32_bf16 v[120:123], a[20:23], v[24:27], v[120:123]
  s_waitcnt vmcnt(13)
  v_cvt_pk_bf16_f32 v28, v152, v153
  v_cvt_pk_bf16_f32 v29, v154, v155
  s_waitcnt vmcnt(12)
  v_cvt_pk_bf16_f32 v30, v156, v157
  v_cvt_pk_bf16_f32 v31, v158, v159
  s_nop 1
  v_mfma_f32_16x16x32_bf16 v[108:111], a[12:15], v[28:31], v[108:111]
  v_mfma_f32_16x16x32_bf16 v[116:119], a[16:19], v[28:31], v[116:119]
  v_mfma_f32_16x16x32_bf16 v[124:127], a[20:23], v[28:31], v[124:127]
  s_waitcnt vmcnt(11)
  v_cvt_pk_bf16_f32 v32, v160, v161
  v_cvt_pk_bf16_f32 v33, v162, v163
  s_waitcnt vmcnt(10)
  v_cvt_pk_bf16_f32 v34, v164, v165
  v_cvt_pk_bf16_f32 v35, v166, v167
  s_nop 1
  v_mfma_f32_16x16x32_bf16 v[104:107], a[24:27], v[32:35], v[104:107]
  v_mfma_f32_16x16x32_bf16 v[112:115], a[28:31], v[32:35], v[112:115]
  v_mfma_f32_16x16x32_bf16 v[120:123], a[32:35], v[32:35], v[120:123]
  s_waitcnt vmcnt(9)
  v_cvt_pk_bf16_f32 v36, v168, v169
  v_cvt_pk_bf16_f32 v37, v170, v171
  s_waitcnt vmcnt(8)
  v_cvt_pk_bf16_f32 v38, v172, v173
  v_cvt_pk_bf16_f32 v39, v174, v175
  s_nop 1
  v_mfma_f32_16x16x32_bf16 v[108:111], a[24:27], v[36:39], v[108:111]
  v_mfma_f32_16x16x32_bf16 v[116:119], a[28:31], v[36:39], v[116:119]
  v_mfma_f32_16x16x32_bf16 v[124:127], a[32:35], v[36:39], v[124:127]
  s_waitcnt vmcnt(7)
  v_cvt_pk_bf16_f32 v40, v176, v177
  v_cvt_pk_bf16_f32 v41, v178, v179
  s_waitcnt vmcnt(6)
  v_cvt_pk_bf16_f32 v42, v180, v181
  v_cvt_pk_bf16_f32 v43, v182, v183
  s_nop 1
  v_mfma_f32_16x16x32_bf16 v[104:107], a[36:39], v[40:43], v[104:107]
  v_mfma_f32_16x16x32_bf16 v[112:115], a[40:43], v[40:43], v[112:115]
  v_mfma_f32_16x16x32_bf16 v[120:123], a[44:47], v[40:43], v[120:123]
  s_waitcnt vmcnt(5)
  v_cvt_pk_bf16_f32 v44, v184, v185
  v_cvt_pk_bf16_f32 v45, v186, v187
  s_waitcnt vmcnt(4)
  v_cvt_pk_bf16_f32 v46, v188, v189
  v_cvt_pk_bf16_f32 v47, v190, v191
  s_nop 1
  v_mfma_f32_16x16x32_bf16 v[108:111], a[36:39], v[44:47], v[108:111]
  v_mfma_f32_16x16x32_bf16 v[116:119], a[40:43], v[44:47], v[116:119]
  v_mfma_f32_16x16x32_bf16 v[124:127], a[44:47], v[44:47], v[124:127]
  s_waitcnt vmcnt(3)
  v_cvt_pk_bf16_f32 v48, v192, v193
  v_cvt_pk_bf16_f32 v49, v194, v195
  s_waitcnt vmcnt(2)
  v_cvt_pk_bf16_f32 v50, v196, v197
  v_cvt_pk_bf16_f32 v51, v198, v199
  s_nop 1
  v_mfma_f32_16x16x32_bf16 v[104:107], a[48:51], v[48:51], v[104:107]
  v_mfma_f32_16x16x32_bf16 v[112:115], a[52:55], v[48:51], v[112:115]
  v_mfma_f32_16x16x32_bf16 v[120:123], a[56:59], v[48:51], v[120:123]
  s_waitcnt vmcnt(1)
  v_cvt_pk_bf16_f32 v52, v200, v201
  v_cvt_pk_bf16_f32 v53, v202, v203
  s_waitcnt vmcnt(0)
  v_cvt_pk_bf16_f32 v54, v204, v205
  v_cvt_pk_bf16_f32 v55, v206, v207
  s_nop 1
  v_mfma_f32_16x16x32_bf16 v[108:111], a[48:51], v[52:55], v[108:111]
  v_mfma_f32_16x16x32_bf16 v[116:119], a[52:55], v[52:55], v[116:119]
  v_mfma_f32_16x16x32_bf16 v[124:127], a[56:59], v[52:55], v[124:127]
  buffer_load_dwordx4 v[128:131], v4, s[4:7], s22 offen offset:640 sc1
  buffer_load_dwordx4 v[132:135], v4, s[4:7], s22 offen offset:656 sc1
  buffer_load_dwordx4 v[136:139], v4, s[4:7], s23 offen offset:640 sc1
  buffer_load_dwordx4 v[140:143], v4, s[4:7], s23 offen offset:656 sc1
  buffer_load_dwordx4 v[144:147], v4, s[4:7], s22 offen offset:768 sc1
  buffer_load_dwordx4 v[148:151], v4, s[4:7], s22 offen offset:784 sc1
  buffer_load_dwordx4 v[152:155], v4, s[4:7], s23 offen offset:768 sc1
  buffer_load_dwordx4 v[156:159], v4, s[4:7], s23 offen offset:784 sc1
  buffer_load_dwordx4 v[160:163], v4, s[4:7], s22 offen offset:896 sc1
  buffer_load_dwordx4 v[164:167], v4, s[4:7], s22 offen offset:912 sc1
  buffer_load_dwordx4 v[168:171], v4, s[4:7], s23 offen offset:896 sc1
  buffer_load_dwordx4 v[172:175], v4, s[4:7], s23 offen offset:912 sc1
  buffer_load_dwordx4 v[176:179], v4, s[4:7], s22 offen offset:1024 sc1
  buffer_load_dwordx4 v[180:183], v4, s[4:7], s22 offen offset:1040 sc1
  buffer_load_dwordx4 v[184:187], v4, s[4:7], s23 offen offset:1024 sc1
  buffer_load_dwordx4 v[188:191], v4, s[4:7], s23 offen offset:1040 sc1
  buffer_load_dwordx4 v[192:195], v4, s[4:7], s22 offen offset:1152 sc1
  buffer_load_dwordx4 v[196:199], v4, s[4:7], s22 offen offset:1168 sc1
  buffer_load_dwordx4 v[200:203], v4, s[4:7], s23 offen offset:1152 sc1
  buffer_load_dwordx4 v[204:207], v4, s[4:7], s23 offen offset:1168 sc1
  s_waitcnt vmcnt(19)
  v_cvt_pk_bf16_f32 v16, v128, v129
  v_cvt_pk_bf16_f32 v17, v130, v131
  s_waitcnt vmcnt(18)
  v_cvt_pk_bf16_f32 v18, v132, v133
  v_cvt_pk_bf16_f32 v19, v134, v135
  s_nop 1
  v_mfma_f32_16x16x32_bf16 v[104:107], a[60:63], v[16:19], v[104:107]
  v_mfma_f32_16x16x32_bf16 v[112:115], a[64:67], v[16:19], v[112:115]
  v_mfma_f32_16x16x32_bf16 v[120:123], a[68:71], v[16:19], v[120:123]
  s_waitcnt vmcnt(17)
  v_cvt_pk_bf16_f32 v20, v136, v137
  v_cvt_pk_bf16_f32 v21, v138, v139
  s_waitcnt vmcnt(16)
  v_cvt_pk_bf16_f32 v22, v140, v141
  v_cvt_pk_bf16_f32 v23, v142, v143
  s_nop 1
  v_mfma_f32_16x16x32_bf16 v[108:111], a[60:63], v[20:23], v[108:111]
  v_mfma_f32_16x16x32_bf16 v[116:119], a[64:67], v[20:23], v[116:119]
  v_mfma_f32_16x16x32_bf16 v[124:127], a[68:71], v[20:23], v[124:127]
  s_waitcnt vmcnt(15)
  v_cvt_pk_bf16_f32 v24, v144, v145
  v_cvt_pk_bf16_f32 v25, v146, v147
  s_waitcnt vmcnt(14)
  v_cvt_pk_bf16_f32 v26, v148, v149
  v_cvt_pk_bf16_f32 v27, v150, v151
  s_nop 1
  v_mfma_f32_16x16x32_bf16 v[104:107], a[72:75], v[24:27], v[104:107]
  v_mfma_f32_16x16x32_bf16 v[112:115], a[76:79], v[24:27], v[112:115]
  v_mfma_f32_16x16x32_bf16 v[120:123], a[80:83], v[24:27], v[120:123]
  s_waitcnt vmcnt(13)
  v_cvt_pk_bf16_f32 v28, v152, v153
  v_cvt_pk_bf16_f32 v29, v154, v155
  s_waitcnt vmcnt(12)
  v_cvt_pk_bf16_f32 v30, v156, v157
  v_cvt_pk_bf16_f32 v31, v158, v159
  s_nop 1
  v_mfma_f32_16x16x32_bf16 v[108:111], a[72:75], v[28:31], v[108:111]
  v_mfma_f32_16x16x32_bf16 v[116:119], a[76:79], v[28:31], v[116:119]
  v_mfma_f32_16x16x32_bf16 v[124:127], a[80:83], v[28:31], v[124:127]
  s_waitcnt vmcnt(11)
  v_cvt_pk_bf16_f32 v32, v160, v161
  v_cvt_pk_bf16_f32 v33, v162, v163
  s_waitcnt vmcnt(10)
  v_cvt_pk_bf16_f32 v34, v164, v165
  v_cvt_pk_bf16_f32 v35, v166, v167
  s_nop 1
  v_mfma_f32_16x16x32_bf16 v[104:107], a[84:87], v[32:35], v[104:107]
  v_mfma_f32_16x16x32_bf16 v[112:115], a[88:91], v[32:35], v[112:115]
  v_mfma_f32_16x16x32_bf16 v[120:123], a[92:95], v[32:35], v[120:123]
  s_waitcnt vmcnt(9)
  v_cvt_pk_bf16_f32 v36, v168, v169
  v_cvt_pk_bf16_f32 v37, v170, v171
  s_waitcnt vmcnt(8)
  v_cvt_pk_bf16_f32 v38, v172, v173
  v_cvt_pk_bf16_f32 v39, v174, v175
  s_nop 1
  v_mfma_f32_16x16x32_bf16 v[108:111], a[84:87], v[36:39], v[108:111]
  v_mfma_f32_16x16x32_bf16 v[116:119], a[88:91], v[36:39], v[116:119]
  v_mfma_f32_16x16x32_bf16 v[124:127], a[92:95], v[36:39], v[124:127]
  s_waitcnt vmcnt(7)
  v_cvt_pk_bf16_f32 v40, v176, v177
  v_cvt_pk_bf16_f32 v41, v178, v179
  s_waitcnt vmcnt(6)
  v_cvt_pk_bf16_f32 v42, v180, v181
  v_cvt_pk_bf16_f32 v43, v182, v183
  s_nop 1
  v_mfma_f32_16x16x32_bf16 v[104:107], a[96:99], v[40:43], v[104:107]
  v_mfma_f32_16x16x32_bf16 v[112:115], a[100:103], v[40:43], v[112:115]
  v_mfma_f32_16x16x32_bf16 v[120:123], a[104:107], v[40:43], v[120:123]
  s_waitcnt vmcnt(5)
  v_cvt_pk_bf16_f32 v44, v184, v185
  v_cvt_pk_bf16_f32 v45, v186, v187
  s_waitcnt vmcnt(4)
  v_cvt_pk_bf16_f32 v46, v188, v189
  v_cvt_pk_bf16_f32 v47, v190, v191
  s_nop 1
  v_mfma_f32_16x16x32_bf16 v[108:111], a[96:99], v[44:47], v[108:111]
  v_mfma_f32_16x16x32_bf16 v[116:119], a[100:103], v[44:47], v[116:119]
  v_mfma_f32_16x16x32_bf16 v[124:127], a[104:107], v[44:47], v[124:127]
  s_waitcnt vmcnt(3)
  v_cvt_pk_bf16_f32 v48, v192, v193
  v_cvt_pk_bf16_f32 v49, v194, v195
  s_waitcnt vmcnt(2)
  v_cvt_pk_bf16_f32 v50, v196, v197
  v_cvt_pk_bf16_f32 v51, v198, v199
  s_nop 1
  v_mfma_f32_16x16x32_bf16 v[104:107], a[108:111], v[48:51], v[104:107]
  v_mfma_f32_16x16x32_bf16 v[112:115], a[112:115], v[48:51], v[112:115]
  v_mfma_f32_16x16x32_bf16 v[120:123], a[116:119], v[48:51], v[120:123]
  s_waitcnt vmcnt(1)
  v_cvt_pk_bf16_f32 v52, v200, v201
  v_cvt_pk_bf16_f32 v53, v202, v203
  s_waitcnt vmcnt(0)
  v_cvt_pk_bf16_f32 v54, v204, v205
  v_cvt_pk_bf16_f32 v55, v206, v207
  s_nop 1
  v_mfma_f32_16x16x32_bf16 v[108:111], a[108:111], v[52:55], v[108:111]
  v_mfma_f32_16x16x32_bf16 v[116:119], a[112:115], v[52:55], v[116:119]
  v_mfma_f32_16x16x32_bf16 v[124:127], a[116:119], v[52:55], v[124:127]
  buffer_load_dwordx4 v[128:131], v4, s[4:7], s22 offen offset:1280 sc1
  buffer_load_dwordx4 v[132:135], v4, s[4:7], s22 offen offset:1296 sc1
  buffer_load_dwordx4 v[136:139], v4, s[4:7], s23 offen offset:1280 sc1
  buffer_load_dwordx4 v[140:143], v4, s[4:7], s23 offen offset:1296 sc1
  buffer_load_dwordx4 v[144:147], v4, s[4:7], s22 offen offset:1408 sc1
  buffer_load_dwordx4 v[148:151], v4, s[4:7], s22 offen offset:1424 sc1
  buffer_load_dwordx4 v[152:155], v4, s[4:7], s23 offen offset:1408 sc1
  buffer_load_dwordx4 v[156:159], v4, s[4:7], s23 offen offset:1424 sc1
  buffer_load_dwordx4 v[160:163], v4, s[4:7], s22 offen offset:1536 sc1
  buffer_load_dwordx4 v[164:167], v4, s[4:7], s22 offen offset:1552 sc1
  buffer_load_dwordx4 v[168:171], v4, s[4:7], s23 offen offset:1536 sc1
  buffer_load_dwordx4 v[172:175], v4, s[4:7], s23 offen offset:1552 sc1
  buffer_load_dwordx4 v[176:179], v4, s[4:7], s22 offen offset:1664 sc1
  buffer_load_dwordx4 v[180:183], v4, s[4:7], s22 offen offset:1680 sc1
  buffer_load_dwordx4 v[184:187], v4, s[4:7], s23 offen offset:1664 sc1
  buffer_load_dwordx4 v[188:191], v4, s[4:7], s23 offen offset:1680 sc1
  buffer_load_dwordx4 v[192:195], v4, s[4:7], s22 offen offset:1792 sc1
  buffer_load_dwordx4 v[196:199], v4, s[4:7], s22 offen offset:1808 sc1
  buffer_load_dwordx4 v[200:203], v4, s[4:7], s23 offen offset:1792 sc1
  buffer_load_dwordx4 v[204:207], v4, s[4:7], s23 offen offset:1808 sc1
  s_waitcnt vmcnt(19)
  v_cvt_pk_bf16_f32 v16, v128, v129
  v_cvt_pk_bf16_f32 v17, v130, v131
  s_waitcnt vmcnt(18)
  v_cvt_pk_bf16_f32 v18, v132, v133
  v_cvt_pk_bf16_f32 v19, v134, v135
  s_nop 1
  v_mfma_f32_16x16x32_bf16 v[104:107], a[120:123], v[16:19], v[104:107]
  v_mfma_f32_16x16x32_bf16 v[112:115], a[124:127], v[16:19], v[112:115]
  v_mfma_f32_16x16x32_bf16 v[120:123], a[128:131], v[16:19], v[120:123]
  s_waitcnt vmcnt(17)
  v_cvt_pk_bf16_f32 v20, v136, v137
  v_cvt_pk_bf16_f32 v21, v138, v139
  s_waitcnt vmcnt(16)
  v_cvt_pk_bf16_f32 v22, v140, v141
  v_cvt_pk_bf16_f32 v23, v142, v143
  s_nop 1
  v_mfma_f32_16x16x32_bf16 v[108:111], a[120:123], v[20:23], v[108:111]
  v_mfma_f32_16x16x32_bf16 v[116:119], a[124:127], v[20:23], v[116:119]
  v_mfma_f32_16x16x32_bf16 v[124:127], a[128:131], v[20:23], v[124:127]
  s_waitcnt vmcnt(15)
  v_cvt_pk_bf16_f32 v24, v144, v145
  v_cvt_pk_bf16_f32 v25, v146, v147
  s_waitcnt vmcnt(14)
  v_cvt_pk_bf16_f32 v26, v148, v149
  v_cvt_pk_bf16_f32 v27, v150, v151
  s_nop 1
  v_mfma_f32_16x16x32_bf16 v[104:107], a[132:135], v[24:27], v[104:107]
  v_mfma_f32_16x16x32_bf16 v[112:115], a[136:139], v[24:27], v[112:115]
  v_mfma_f32_16x16x32_bf16 v[120:123], a[140:143], v[24:27], v[120:123]
  s_waitcnt vmcnt(13)
  v_cvt_pk_bf16_f32 v28, v152, v153
  v_cvt_pk_bf16_f32 v29, v154, v155
  s_waitcnt vmcnt(12)
  v_cvt_pk_bf16_f32 v30, v156, v157
  v_cvt_pk_bf16_f32 v31, v158, v159
  s_nop 1
  v_mfma_f32_16x16x32_bf16 v[108:111], a[132:135], v[28:31], v[108:111]
  v_mfma_f32_16x16x32_bf16 v[116:119], a[136:139], v[28:31], v[116:119]
  v_mfma_f32_16x16x32_bf16 v[124:127], a[140:143], v[28:31], v[124:127]
  s_waitcnt vmcnt(11)
  v_cvt_pk_bf16_f32 v32, v160, v161
  v_cvt_pk_bf16_f32 v33, v162, v163
  s_waitcnt vmcnt(10)
  v_cvt_pk_bf16_f32 v34, v164, v165
  v_cvt_pk_bf16_f32 v35, v166, v167
  s_nop 1
  v_mfma_f32_16x16x32_bf16 v[104:107], a[144:147], v[32:35], v[104:107]
  v_mfma_f32_16x16x32_bf16 v[112:115], a[148:151], v[32:35], v[112:115]
  v_mfma_f32_16x16x32_bf16 v[120:123], a[152:155], v[32:35], v[120:123]
  s_waitcnt vmcnt(9)
  v_cvt_pk_bf16_f32 v36, v168, v169
  v_cvt_pk_bf16_f32 v37, v170, v171
  s_waitcnt vmcnt(8)
  v_cvt_pk_bf16_f32 v38, v172, v173
  v_cvt_pk_bf16_f32 v39, v174, v175
  s_nop 1
  v_mfma_f32_16x16x32_bf16 v[108:111], a[144:147], v[36:39], v[108:111]
  v_mfma_f32_16x16x32_bf16 v[116:119], a[148:151], v[36:39], v[116:119]
  v_mfma_f32_16x16x32_bf16 v[124:127], a[152:155], v[36:39], v[124:127]
  s_waitcnt vmcnt(7)
  v_cvt_pk_bf16_f32 v40, v176, v177
  v_cvt_pk_bf16_f32 v41, v178, v179
  s_waitcnt vmcnt(6)
  v_cvt_pk_bf16_f32 v42, v180, v181
  v_cvt_pk_bf16_f32 v43, v182, v183
  s_nop 1
  v_mfma_f32_16x16x32_bf16 v[104:107], a[156:159], v[40:43], v[104:107]
  v_mfma_f32_16x16x32_bf16 v[112:115], a[160:163], v[40:43], v[112:115]
  v_mfma_f32_16x16x32_bf16 v[120:123], a[164:167], v[40:43], v[120:123]
  s_waitcnt vmcnt(5)
  v_cvt_pk_bf16_f32 v44, v184, v185
  v_cvt_pk_bf16_f32 v45, v186, v187
  s_waitcnt vmcnt(4)
  v_cvt_pk_bf16_f32 v46, v188, v189
  v_cvt_pk_bf16_f32 v47, v190, v191
  s_nop 1
  v_mfma_f32_16x16x32_bf16 v[108:111], a[156:159], v[44:47], v[108:111]
  v_mfma_f32_16x16x32_bf16 v[116:119], a[160:163], v[44:47], v[116:119]
  v_mfma_f32_16x16x32_bf16 v[124:127], a[164:167], v[44:47], v[124:127]
  s_waitcnt vmcnt(3)
  v_cvt_pk_bf16_f32 v48, v192, v193
  v_cvt_pk_bf16_f32 v49, v194, v195
  s_waitcnt vmcnt(2)
  v_cvt_pk_bf16_f32 v50, v196, v197
  v_cvt_pk_bf16_f32 v51, v198, v199
  s_nop 1
  v_mfma_f32_16x16x32_bf16 v[104:107], a[168:171], v[48:51], v[104:107]
  v_mfma_f32_16x16x32_bf16 v[112:115], a[172:175], v[48:51], v[112:115]
  v_mfma_f32_16x16x32_bf16 v[120:123], a[176:179], v[48:51], v[120:123]
  s_waitcnt vmcnt(1)
  v_cvt_pk_bf16_f32 v52, v200, v201
  v_cvt_pk_bf16_f32 v53, v202, v203
  s_waitcnt vmcnt(0)
  v_cvt_pk_bf16_f32 v54, v204, v205
  v_cvt_pk_bf16_f32 v55, v206, v207
  s_nop 1
  v_mfma_f32_16x16x32_bf16 v[108:111], a[168:171], v[52:55], v[108:111]
  v_mfma_f32_16x16x32_bf16 v[116:119], a[172:175], v[52:55], v[116:119]
  v_mfma_f32_16x16x32_bf16 v[124:127], a[176:179], v[52:55], v[124:127]
  buffer_load_dwordx4 v[128:131], v4, s[4:7], s22 offen offset:1920 sc1
  buffer_load_dwordx4 v[132:135], v4, s[4:7], s22 offen offset:1936 sc1
  buffer_load_dwordx4 v[136:139], v4, s[4:7], s23 offen offset:1920 sc1
  buffer_load_dwordx4 v[140:143], v4, s[4:7], s23 offen offset:1936 sc1
  buffer_load_dwordx4 v[144:147], v4, s[4:7], s22 offen offset:2048 sc1
  buffer_load_dwordx4 v[148:151], v4, s[4:7], s22 offen offset:2064 sc1
  buffer_load_dwordx4 v[152:155], v4, s[4:7], s23 offen offset:2048 sc1
  buffer_load_dwordx4 v[156:159], v4, s[4:7], s23 offen offset:2064 sc1
  buffer_load_dwordx4 v[160:163], v4, s[4:7], s22 offen offset:2176 sc1
  buffer_load_dwordx4 v[164:167], v4, s[4:7], s22 offen offset:2192 sc1
  buffer_load_dwordx4 v[168:171], v4, s[4:7], s23 offen offset:2176 sc1
  buffer_load_dwordx4 v[172:175], v4, s[4:7], s23 offen offset:2192 sc1
  buffer_load_dwordx4 v[176:179], v4, s[4:7], s22 offen offset:2304 sc1
  buffer_load_dwordx4 v[180:183], v4, s[4:7], s22 offen offset:2320 sc1
  buffer_load_dwordx4 v[184:187], v4, s[4:7], s23 offen offset:2304 sc1
  buffer_load_dwordx4 v[188:191], v4, s[4:7], s23 offen offset:2320 sc1
  buffer_load_dwordx4 v[192:195], v4, s[4:7], s22 offen offset:2432 sc1
  buffer_load_dwordx4 v[196:199], v4, s[4:7], s22 offen offset:2448 sc1
  buffer_load_dwordx4 v[200:203], v4, s[4:7], s23 offen offset:2432 sc1
  buffer_load_dwordx4 v[204:207], v4, s[4:7], s23 offen offset:2448 sc1
  s_waitcnt vmcnt(19)
  v_cvt_pk_bf16_f32 v16, v128, v129
  v_cvt_pk_bf16_f32 v17, v130, v131
  s_waitcnt vmcnt(18)
  v_cvt_pk_bf16_f32 v18, v132, v133
  v_cvt_pk_bf16_f32 v19, v134, v135
  s_nop 1
  v_mfma_f32_16x16x32_bf16 v[104:107], a[180:183], v[16:19], v[104:107]
  v_mfma_f32_16x16x32_bf16 v[112:115], a[184:187], v[16:19], v[112:115]
  v_mfma_f32_16x16x32_bf16 v[120:123], a[188:191], v[16:19], v[120:123]
  s_waitcnt vmcnt(17)
  v_cvt_pk_bf16_f32 v20, v136, v137
  v_cvt_pk_bf16_f32 v21, v138, v139
  s_waitcnt vmcnt(16)
  v_cvt_pk_bf16_f32 v22, v140, v141
  v_cvt_pk_bf16_f32 v23, v142, v143
  s_nop 1
  v_mfma_f32_16x16x32_bf16 v[108:111], a[180:183], v[20:23], v[108:111]
  v_mfma_f32_16x16x32_bf16 v[116:119], a[184:187], v[20:23], v[116:119]
  v_mfma_f32_16x16x32_bf16 v[124:127], a[188:191], v[20:23], v[124:127]
  s_waitcnt vmcnt(15)
  v_cvt_pk_bf16_f32 v24, v144, v145
  v_cvt_pk_bf16_f32 v25, v146, v147
  s_waitcnt vmcnt(14)
  v_cvt_pk_bf16_f32 v26, v148, v149
  v_cvt_pk_bf16_f32 v27, v150, v151
  s_nop 1
  v_mfma_f32_16x16x32_bf16 v[104:107], a[192:195], v[24:27], v[104:107]
  v_mfma_f32_16x16x32_bf16 v[112:115], a[196:199], v[24:27], v[112:115]
  v_mfma_f32_16x16x32_bf16 v[120:123], a[200:203], v[24:27], v[120:123]
  s_waitcnt vmcnt(13)
  v_cvt_pk_bf16_f32 v28, v152, v153
  v_cvt_pk_bf16_f32 v29, v154, v155
  s_waitcnt vmcnt(12)
  v_cvt_pk_bf16_f32 v30, v156, v157
  v_cvt_pk_bf16_f32 v31, v158, v159
  s_nop 1
  v_mfma_f32_16x16x32_bf16 v[108:111], a[192:195], v[28:31], v[108:111]
  v_mfma_f32_16x16x32_bf16 v[116:119], a[196:199], v[28:31], v[116:119]
  v_mfma_f32_16x16x32_bf16 v[124:127], a[200:203], v[28:31], v[124:127]
  s_waitcnt vmcnt(11)
  v_cvt_pk_bf16_f32 v32, v160, v161
  v_cvt_pk_bf16_f32 v33, v162, v163
  s_waitcnt vmcnt(10)
  v_cvt_pk_bf16_f32 v34, v164, v165
  v_cvt_pk_bf16_f32 v35, v166, v167
  s_nop 1
  v_mfma_f32_16x16x32_bf16 v[104:107], a[204:207], v[32:35], v[104:107]
  v_mfma_f32_16x16x32_bf16 v[112:115], a[208:211], v[32:35], v[112:115]
  v_mfma_f32_16x16x32_bf16 v[120:123], a[212:215], v[32:35], v[120:123]
  s_waitcnt vmcnt(9)
  v_cvt_pk_bf16_f32 v36, v168, v169
  v_cvt_pk_bf16_f32 v37, v170, v171
  s_waitcnt vmcnt(8)
  v_cvt_pk_bf16_f32 v38, v172, v173
  v_cvt_pk_bf16_f32 v39, v174, v175
  s_nop 1
  v_mfma_f32_16x16x32_bf16 v[108:111], a[204:207], v[36:39], v[108:111]
  v_mfma_f32_16x16x32_bf16 v[116:119], a[208:211], v[36:39], v[116:119]
  v_mfma_f32_16x16x32_bf16 v[124:127], a[212:215], v[36:39], v[124:127]
  s_waitcnt vmcnt(7)
  v_cvt_pk_bf16_f32 v40, v176, v177
  v_cvt_pk_bf16_f32 v41, v178, v179
  s_waitcnt vmcnt(6)
  v_cvt_pk_bf16_f32 v42, v180, v181
  v_cvt_pk_bf16_f32 v43, v182, v183
  s_nop 1
  v_mfma_f32_16x16x32_bf16 v[104:107], a[216:219], v[40:43], v[104:107]
  v_mfma_f32_16x16x32_bf16 v[112:115], a[220:223], v[40:43], v[112:115]
  v_mfma_f32_16x16x32_bf16 v[120:123], a[224:227], v[40:43], v[120:123]
  s_waitcnt vmcnt(5)
  v_cvt_pk_bf16_f32 v44, v184, v185
  v_cvt_pk_bf16_f32 v45, v186, v187
  s_waitcnt vmcnt(4)
  v_cvt_pk_bf16_f32 v46, v188, v189
  v_cvt_pk_bf16_f32 v47, v190, v191
  s_nop 1
  v_mfma_f32_16x16x32_bf16 v[108:111], a[216:219], v[44:47], v[108:111]
  v_mfma_f32_16x16x32_bf16 v[116:119], a[220:223], v[44:47], v[116:119]
  v_mfma_f32_16x16x32_bf16 v[124:127], a[224:227], v[44:47], v[124:127]
  s_waitcnt vmcnt(3)
  v_cvt_pk_bf16_f32 v48, v192, v193
  v_cvt_pk_bf16_f32 v49, v194, v195
  s_waitcnt vmcnt(2)
  v_cvt_pk_bf16_f32 v50, v196, v197
  v_cvt_pk_bf16_f32 v51, v198, v199
  s_nop 1
  v_mfma_f32_16x16x32_bf16 v[104:107], a[228:231], v[48:51], v[104:107]
  v_mfma_f32_16x16x32_bf16 v[112:115], a[232:235], v[48:51], v[112:115]
  v_mfma_f32_16x16x32_bf16 v[120:123], a[236:239], v[48:51], v[120:123]
  s_waitcnt vmcnt(1)
  v_cvt_pk_bf16_f32 v52, v200, v201
  v_cvt_pk_bf16_f32 v53, v202, v203
  s_waitcnt vmcnt(0)
  v_cvt_pk_bf16_f32 v54, v204, v205
  v_cvt_pk_bf16_f32 v55, v206, v207
  s_nop 1
  v_mfma_f32_16x16x32_bf16 v[108:111], a[228:231], v[52:55], v[108:111]
  v_mfma_f32_16x16x32_bf16 v[116:119], a[232:235], v[52:55], v[116:119]
  v_mfma_f32_16x16x32_bf16 v[124:127], a[236:239], v[52:55], v[124:127]
  v_lshlrev_b32 v8, 16, v96
  v_and_b32 v9, 0xffff0000, v96
  v_lshlrev_b32 v10, 16, v97
  v_and_b32 v11, 0xffff0000, v97
  v_add_f32 v108, v108, v8
  v_add_f32 v109, v109, v9
  v_add_f32 v110, v110, v10
  v_add_f32 v111, v111, v11
  v_lshlrev_b32 v8, 16, v98
  v_and_b32 v9, 0xffff0000, v98
  v_lshlrev_b32 v10, 16, v99
  v_and_b32 v11, 0xffff0000, v99
  v_add_f32 v116, v116, v8
  v_add_f32 v117, v117, v9
  v_add_f32 v118, v118, v10
  v_add_f32 v119, v119, v11
  v_lshlrev_b32 v8, 16, v100
  v_and_b32 v9, 0xffff0000, v100
  v_lshlrev_b32 v10, 16, v101
  v_and_b32 v11, 0xffff0000, v101
  v_add_f32 v124, v124, v8
  v_add_f32 v125, v125, v9
  v_add_f32 v126, v126, v10
  v_add_f32 v127, v127, v11
  v_lshlrev_b32 v4, 4, v1
  s_mul_i32 s42, s17, 10240
  v_add_u32 v5, s42, v4
  v_mov_b32 v6, 0
  v_mov_b32 v7, v4
  v_min_u32 v8, 9, v1
  v_lshlrev_b32 v8, 6, v8
  v_mul_u32_u24 v9, 640, v2
  v_lshl_add_u32 v9, v3, 3, v9
  s_mul_i32 s36, s33, 12288
  s_mul_i32 s22, s17, 3072
  s_add_u32 s36, s36, s22
  s_add_u32 s36, s36, 16777216
  s_lshl_b32 s34, s18, 7
  s_xor_b32 s22, s19, 8192
  s_add_u32 s34, s34, s22
  s_add_u32 s34, s34, 7503872
  s_mov_b32 s28, 0
  s_mov_b32 s44, 0xc0135761
  s_mov_b32 s45, 0xbdd2d3e8
  s_mov_b32 s46, 0x3acccccd
  s_mov_b32 s39, 0
L_F1_loop:
  s_add_u32 s31, s20, 1
  s_mul_i32 s35, s20, 640
  s_add_u32 s35, s35, 196608
  s_cmp_lg_u32 s17, 0
  s_cbranch_scc1 L_F1_w_b
  s_branch L_F1_w_in
L_F1_w:
  s_sleep 3
L_F1_w_in:
  buffer_load_dword v15, v8, s[4:7], s35 offen sc1
  s_add_u32 s39, s39, 1
  s_cmp_gt_u32 s39, 200000
  s_cbranch_scc1 L_exit
  s_waitcnt vmcnt(0)
  v_cmp_gt_u32 vcc, s31, v15
  s_cbranch_vccnz L_F1_w
L_F1_w_b:
  s_barrier
  s_mul_i32 s23, s20, 40960
  s_add_u32 s23, s23, 251658240
  s_add_u32 s22, s42, s28
  s_add_u32 m0, s22, 0
  s_add_u32 s26, s23, 0
  buffer_load_dwordx4 v5, s[4:7], s26 offen offset:0 sc1 lds
  buffer_load_dwordx4 v5, s[4:7], s26 offen offset:1024 sc1 lds
  buffer_load_dwordx4 v5, s[4:7], s26 offen offset:2048 sc1 lds
  buffer_load_dwordx4 v5, s[4:7], s26 offen offset:3072 sc1 lds
  s_add_u32 m0, s22, 4096
  s_add_u32 s26, s23, 4096
  buffer_load_dwordx4 v5, s[4:7], s26 offen offset:0 sc1 lds
  buffer_load_dwordx4 v5, s[4:7], s26 offen offset:1024 sc1 lds
  buffer_load_dwordx4 v5, s[4:7], s26 offen offset:2048 sc1 lds
  buffer_load_dwordx4 v5, s[4:7], s26 offen offset:3072 sc1 lds
  s_add_u32 m0, s22, 8192
  s_add_u32 s26, s23, 8192
  buffer_load_dwordx4 v5, s[4:7], s26 offen offset:0 sc1 lds
  buffer_load_dwordx4 v5, s[4:7], s26 offen offset:1024 sc1 lds
  s_mul_i32 s23, s20, 5120
  s_add_u32 s23, s23, 262144
  buffer_load_dwordx2 v[128:129], v9, s[4:7], s23 offen offset:0 sc1
  buffer_load_dwordx2 v[130:131], v9, s[4:7], s23 offen offset:128 sc1
  buffer_load_dwordx2 v[132:133], v9, s[4:7], s23 offen offset:256 sc1
  buffer_load_dwordx2 v[134:135], v9, s[4:7], s23 offen offset:384 sc1
  buffer_load_dwordx2 v[136:137], v9, s[4:7], s23 offen offset:512 sc1
  buffer_load_dwordx2 v[140:141], v9, s[4:7], s23 offen offset:2560 sc1
  buffer_load_dwordx2 v[142:143], v9, s[4:7], s23 offen offset:2688 sc1
  buffer_load_dwordx2 v[144:145], v9, s[4:7], s23 offen offset:2816 sc1
  buffer_load_dwordx2 v[146:147], v9, s[4:7], s23 offen offset:2944 sc1
  buffer_load_dwordx2 v[148:149], v9, s[4:7], s23 offen offset:3072 sc1
  s_waitcnt vmcnt(10)
  s_barrier
  ds_read_b128 v[16:19], v7 offset:0
  ds_read_b128 v[20:23], v7 offset:20480
  ds_read_b128 v[24:27], v7 offset:1024
  ds_read_b128 v[28:31], v7 offset:21504
  s_waitcnt lgkmcnt(3)
  v_mfma_f32_16x16x32_bf16 v[48:51], a[0:3], v[16:19], 0
  ds_read_b128 v[32:35], v7 offset:2048
  v_mfma_f32_16x16x32_bf16 v[56:59], a[4:7], v[16:19], 0
  ds_read_b128 v[36:39], v7 offset:22528
  v_mfma_f32_16x16x32_bf16 v[64:67], a[8:11], v[16:19], 0
  s_waitcnt lgkmcnt(4)
  v_mfma_f32_16x16x32_bf16 v[52:55], a[0:3], v[20:23], 0
  v_mfma_f32_16x16x32_bf16 v[60:63], a[4:7], v[20:23], 0
  v_mfma_f32_16x16x32_bf16 v[68:71], a[8:11], v[20:23], 0
  s_waitcnt lgkmcnt(3)
  v_mfma_f32_16x16x32_bf16 v[48:51], a[12:15], v[24:27], v[48:51]
  ds_read_b128 v[40:43], v7 offset:3072
  v_mfma_f32_16x16x32_bf16 v[56:59], a[16:19], v[24:27], v[56:59]
  ds_read_b128 v[44:47], v7 offset:23552
  v_mfma_f32_16x16x32_bf16 v[64:67], a[20:23], v[24:27], v[64:67]
  s_waitcnt lgkmcnt(4)
  v_mfma_f32_16x16x32_bf16 v[52:55], a[12:15], v[28:31], v[52:55]
  v_mfma_f32_16x16x32_bf16 v[60:63], a[16:19], v[28:31], v[60:63]
  v_mfma_f32_16x16x32_bf16 v[68:71], a[20:23], v[28:31], v[68:71]
  s_waitcnt lgkmcnt(3)
  v_mfma_f32_16x16x32_bf16 v[48:51], a[24:27], v[32:35], v[48:51]
  ds_read_b128 v[16:19], v7 offset:4096
  v_mfma_f32_16x16x32_bf16 v[56:59], a[28:31], v[32:35], v[56:59]
  ds_read_b128 v[20:23], v7 offset:24576
  v_mfma_f32_16x16x32_bf16 v[64:67], a[32:35], v[32:35], v[64:67]
  s_waitcnt lgkmcnt(4)
  v_mfma_f32_16x16x32_bf16 v[52:55], a[24:27], v[36:39], v[52:55]
  v_mfma_f32_16x16x32_bf16 v[60:63], a[28:31], v[36:39], v[60:63]
  v_mfma_f32_16x16x32_bf16 v[68:71], a[32:35], v[36:39], v[68:71]
  s_waitcnt lgkmcnt(3)
  v_mfma_f32_16x16x32_bf16 v[48:51], a[36:39], v[40:43], v[48:51]
  ds_read_b128 v[24:27], v7 offset:5120
  v_mfma_f32_16x16x32_bf16 v[56:59], a[40:43], v[40:43], v[56:59]
  ds_read_b128 v[28:31], v7 offset:25600
  v_mfma_f32_16x16x32_bf16 v[64:67], a[44:47], v[40:43], v[64:67]
  s_waitcnt vmcnt(8)
  v_add_f32 v128, v128, v130
  s_waitcnt lgkmcnt(4)
  v_mfma_f32_16x16x32_bf16 v[52:55], a[36:39], v[44:47], v[52:55]
  v_add_f32 v129, v129, v131
  v_mfma_f32_16x16x32_bf16 v[60:63], a[40:43], v[44:47], v[60:63]
  v_mfma_f32_16x16x32_bf16 v[68:71], a[44:47], v[44:47], v[68:71]
  s_waitcnt vmcnt(7)
  v_add_f32 v128, v128, v132
  s_waitcnt lgkmcnt(3)
  v_mfma_f32_16x16x32_bf16 v[48:51], a[48:51], v[16:19], v[48:51]
  ds_read_b128 v[32:35], v7 offset:6144
  v_add_f32 v129, v129, v133
  v_mfma_f32_16x16x32_bf16 v[56:59], a[52:55], v[16:19], v[56:59]
  ds_read_b128 v[36:39], v7 offset:26624
  v_mfma_f32_16x16x32_bf16 v[64:67], a[56:59], v[16:19], v[64:67]
  s_waitcnt vmcnt(6)
  v_add_f32 v128, v128, v134
  s_waitcnt lgkmcnt(4)
  v_mfma_f32_16x16x32_bf16 v[52:55], a[48:51], v[20:23], v[52:55]
  v_add_f32 v129, v129, v135
  v_mfma_f32_16x16x32_bf16 v[60:63], a[52:55], v[20:23], v[60:63]
  v_mfma_f32_16x16x32_bf16 v[68:71], a[56:59], v[20:23], v[68:71]
  s_waitcnt vmcnt(5)
  v_add_f32 v128, v128, v136
  s_waitcnt lgkmcnt(3)
  v_mfma_f32_16x16x32_bf16 v[48:51], a[60:63], v[24:27], v[48:51]
  ds_read_b128 v[40:43], v7 offset:7168
  v_add_f32 v129, v129, v137
  v_mfma_f32_16x16x32_bf16 v[56:59], a[64:67], v[24:27], v[56:59]
  ds_read_b128 v[44:47], v7 offset:27648
  v_mfma_f32_16x16x32_bf16 v[64:67], a[68:71], v[24:27], v[64:67]
  v_mov_b32 v130, v128
  s_waitcnt lgkmcnt(4)
  v_mfma_f32_16x16x32_bf16 v[52:55], a[60:63], v[28:31], v[52:55]
  v_mov_b32 v131, v129
  v_mfma_f32_16x16x32_bf16 v[60:63], a[64:67], v[28:31], v[60:63]
  v_mfma_f32_16x16x32_bf16 v[68:71], a[68:71], v[28:31], v[68:71]
  v_permlane16_swap_b32 v130, v128
  s_waitcnt lgkmcnt(3)
  v_mfma_f32_16x16x32_bf16 v[48:51], a[72:75], v[32:35], v[48:51]
  ds_read_b128 v[16:19], v7 offset:8192
  v_permlane16_swap_b32 v131, v129
  v_mfma_f32_16x16x32_bf16 v[56:59], a[76:79], v[32:35], v[56:59]
  ds_read_b128 v[20:23], v7 offset:28672
  v_mfma_f32_16x16x32_bf16 v[64:67], a[80:83], v[32:35], v[64:67]
  v_add_f32 v128, v128, v130
  s_waitcnt lgkmcnt(4)
  v_mfma_f32_16x16x32_bf16 v[52:55], a[72:75], v[36:39], v[52:55]
  v_add_f32 v129, v129, v131
  v_mfma_f32_16x16x32_bf16 v[60:63], a[76:79], v[36:39], v[60:63]
  v_mfma_f32_16x16x32_bf16 v[68:71], a[80:83], v[36:39], v[68:71]
  v_mov_b32 v130, v128
  s_waitcnt lgkmcnt(3)
  v_mfma_f32_16x16x32_bf16 v[48:51], a[84:87], v[40:43], v[48:51]
  ds_read_b128 v[24:27], v7 offset:9216
  v_mov_b32 v131, v129
  v_mfma_f32_16x16x32_bf16 v[56:59], a[88:91], v[40:43], v[56:59]
  ds_read_b128 v[28:31], v7 offset:29696
  v_mfma_f32_16x16x32_bf16 v[64:67], a[92:95], v[40:43], v[64:67]
  v_permlane32_swap_b32 v130, v128
  s_waitcnt lgkmcnt(4)
  v_mfma_f32_16x16x32_bf16 v[52:55], a[84:87], v[44:47], v[52:55]
  v_permlane32_swap_b32 v131, v129
  v_mfma_f32_16x16x32_bf16 v[60:63], a[88:91], v[44:47], v[60:63]
  v_mfma_f32_16x16x32_bf16 v[68:71], a[92:95], v[44:47], v[68:71]
  v_add_f32 v128, v128, v130
  s_waitcnt lgkmcnt(3)
  v_mfma_f32_16x16x32_bf16 v[48:51], a[96:99], v[16:19], v[48:51]
  ds_read_b128 v[32:35], v7 offset:10240
  v_add_f32 v129, v129, v131
  v_mfma_f32_16x16x32_bf16 v[56:59], a[100:103], v[16:19], v[56:59]
  ds_read_b128 v[36:39], v7 offset:30720
  v_mfma_f32_16x16x32_bf16 v[64:67], a[104:107], v[16:19], v[64:67]
  v_mul_f32 v128, s46, v128
  s_waitcnt lgkmcnt(4)
  v_mfma_f32_16x16x32_bf16 v[52:55], a[96:99], v[20:23], v[52:55]
  v_mul_f32 v130, v128, v128
  v_mfma_f32_16x16x32_bf16 v[60:63], a[100:103], v[20:23], v[60:63]
  v_mfma_f32_16x16x32_bf16 v[68:71], a[104:107], v[20:23], v[68:71]
  v_fma_f32 v129, v129, s46, -v130
  s_waitcnt lgkmcnt(3)
  v_mfma_f32_16x16x32_bf16 v[48:51], a[108:111], v[24:27], v[48:51]
  ds_read_b128 v[40:43], v7 offset:11264
  v_max_f32 v129, 0, v129
  v_mfma_f32_16x16x32_bf16 v[56:59], a[112:115], v[24:27], v[56:59]
  ds_read_b128 v[44:47], v7 offset:31744
  v_mfma_f32_16x16x32_bf16 v[64:67], a[116:119], v[24:27], v[64:67]
  v_add_f32 v129, 0x3727c5ac, v129
  s_waitcnt lgkmcnt(4)
  v_mfma_f32_16x16x32_bf16 v[52:55], a[108:111], v[28:31], v[52:55]
  v_rsq_f32 v129, v129
  v_mfma_f32_16x16x32_bf16 v[60:63], a[112:115], v[28:31], v[60:63]
  v_mfma_f32_16x16x32_bf16 v[68:71], a[116:119], v[28:31], v[68:71]
  s_waitcnt vmcnt(3)
  v_add_f32 v140, v140, v142
  s_waitcnt lgkmcnt(3)
  v_mfma_f32_16x16x32_bf16 v[48:51], a[120:123], v[32:35], v[48:51]
  ds_read_b128 v[16:19], v7 offset:12288
  v_add_f32 v141, v141, v143
  v_mfma_f32_16x16x32_bf16 v[56:59], a[124:127], v[32:35], v[56:59]
  ds_read_b128 v[20:23], v7 offset:32768
  v_mfma_f32_16x16x32_bf16 v[64:67], a[128:131], v[32:35], v[64:67]
  s_waitcnt vmcnt(2)
  v_add_f32 v140, v140, v144
  s_waitcnt lgkmcnt(4)
  v_mfma_f32_16x16x32_bf16 v[52:55], a[120:123], v[36:39], v[52:55]
  v_add_f32 v141, v141, v145
  v_mfma_f32_16x16x32_bf16 v[60:63], a[124:127], v[36:39], v[60:63]
  v_mfma_f32_16x16x32_bf16 v[68:71], a[128:131], v[36:39], v[68:71]
  s_waitcnt vmcnt(1)
  v_add_f32 v140, v140, v146
  s_waitcnt lgkmcnt(3)
  v_mfma_f32_16x16x32_bf16 v[48:51], a[132:135], v[40:43], v[48:51]
  ds_read_b128 v[24:27], v7 offset:13312
  v_add_f32 v141, v141, v147
  v_mfma_f32_16x16x32_bf16 v[56:59], a[136:139], v[40:43], v[56:59]
  ds_read_b128 v[28:31], v7 offset:33792
  v_mfma_f32_16x16x32_bf16 v[64:67], a[140:143], v[40:43], v[64:67]
  s_waitcnt vmcnt(0)
  v_add_f32 v140, v140, v148
  s_waitcnt lgkmcnt(4)
  v_mfma_f32_16x16x32_bf16 v[52:55], a[132:135], v[44:47], v[52:55]
  v_add_f32 v141, v141, v149
  v_mfma_f32_16x16x32_bf16 v[60:63], a[136:139], v[44:47], v[60:63]
  v_mfma_f32_16x16x32_bf16 v[68:71], a[140:143], v[44:47], v[68:71]
  v_mov_b32 v142, v140
  s_waitcnt lgkmcnt(3)
  v_mfma_f32_16x16x32_bf16 v[48:51], a[144:147], v[16:19], v[48:51]
  ds_read_b128 v[32:35], v7 offset:14336
  v_mov_b32 v143, v141
  v_mfma_f32_16x16x32_bf16 v[56:59], a[148:151], v[16:19], v[56:59]
  ds_read_b128 v[36:39], v7 offset:34816
  v_mfma_f32_16x16x32_bf16 v[64:67], a[152:155], v[16:19], v[64:67]
  v_permlane16_swap_b32 v142, v140
  s_waitcnt lgkmcnt(4)
  v_mfma_f32_16x16x32_bf16 v[52:55], a[144:147], v[20:23], v[52:55]
  v_permlane16_swap_b32 v143, v141
  v_mfma_f32_16x16x32_bf16 v[60:63], a[148:151], v[20:23], v[60:63]
  v_mfma_f32_16x16x32_bf16 v[68:71], a[152:155], v[20:23], v[68:71]
  v_add_f32 v140, v140, v142
  s_waitcnt lgkmcnt(3)
  v_mfma_f32_16x16x32_bf16 v[48:51], a[156:159], v[24:27], v[48:51]
  ds_read_b128 v[40:43], v7 offset:15360
  v_add_f32 v141, v141, v143
  v_mfma_f32_16x16x32_bf16 v[56:59], a[160:163], v[24:27], v[56:59]
  ds_read_b128 v[44:47], v7 offset:35840
  v_mfma_f32_16x16x32_bf16 v[64:67], a[164:167], v[24:27], v[64:67]
  v_mov_b32 v142, v140
  s_waitcnt lgkmcnt(4)
  v_mfma_f32_16x16x32_bf16 v[52:55], a[156:159], v[28:31], v[52:55]
  v_mov_b32 v143, v141
  v_mfma_f32_16x16x32_bf16 v[60:63], a[160:163], v[28:31], v[60:63]
  v_mfma_f32_16x16x32_bf16 v[68:71], a[164:167], v[28:31], v[68:71]
  v_permlane32_swap_b32 v142, v140
  s_waitcnt lgkmcnt(3)
  v_mfma_f32_16x16x32_bf16 v[48:51], a[168:171], v[32:35], v[48:51]
  ds_read_b128 v[16:19], v7 offset:16384
  v_permlane32_swap_b32 v143, v141
  v_mfma_f32_16x16x32_bf16 v[56:59], a[172:175], v[32:35], v[56:59]
  ds_read_b128 v[20:23], v7 offset:36864
  v_mfma_f32_16x16x32_bf16 v[64:67], a[176:179], v[32:35], v[64:67]
  v_add_f32 v140, v140, v142
  s_waitcnt lgkmcnt(4)
  v_mfma_f32_16x16x32_bf16 v[52:55], a[168:171], v[36:39], v[52:55]
  v_add_f32 v141, v141, v143
  v_mfma_f32_16x16x32_bf16 v[60:63], a[172:175], v[36:39], v[60:63]
  v_mfma_f32_16x16x32_bf16 v[68:71], a[176:179], v[36:39], v[68:71]
  v_mul_f32 v140, s46, v140
  s_waitcnt lgkmcnt(3)
  v_mfma_f32_16x16x32_bf16 v[48:51], a[180:183], v[40:43], v[48:51]
  ds_read_b128 v[24:27], v7 offset:17408
  v_mul_f32 v142, v140, v140
  v_mfma_f32_16x16x32_bf16 v[56:59], a[184:187], v[40:43], v[56:59]
  ds_read_b128 v[28:31], v7 offset:37888
  v_mfma_f32_16x16x32_bf16 v[64:67], a[188:191], v[40:43], v[64:67]
  v_fma_f32 v141, v141, s46, -v142
  s_waitcnt lgkmcnt(4)
  v_mfma_f32_16x16x32_bf16 v[52:55], a[180:183], v[44:47], v[52:55]
  v_max_f32 v141, 0, v141
  v_mfma_f32_16x16x32_bf16 v[60:63], a[184:187], v[44:47], v[60:63]
  v_mfma_f32_16x16x32_bf16 v[68:71], a[188:191], v[44:47], v[68:71]
  v_add_f32 v141, 0x3727c5ac, v141
  s_waitcnt lgkmcnt(3)
  v_mfma_f32_16x16x32_bf16 v[48:51], a[192:195], v[16:19], v[48:51]
  ds_read_b128 v[32:35], v7 offset:18432
  v_rsq_f32 v141, v141
  v_mfma_f32_16x16x32_bf16 v[56:59], a[196:199], v[16:19], v[56:59]
  ds_read_b128 v[36:39], v7 offset:38912
  v_mfma_f32_16x16x32_bf16 v[64:67], a[200:203], v[16:19], v[64:67]
  s_waitcnt lgkmcnt(4)
  v_mfma_f32_16x16x32_bf16 v[52:55], a[192:195], v[20:23], v[52:55]
  v_mfma_f32_16x16x32_bf16 v[60:63], a[196:199], v[20:23], v[60:63]
  v_mfma_f32_16x16x32_bf16 v[68:71], a[200:203], v[20:23], v[68:71]
  s_waitcnt lgkmcnt(3)
  v_mfma_f32_16x16x32_bf16 v[48:51], a[204:207], v[24:27], v[48:51]
  ds_read_b128 v[40:43], v7 offset:19456
  v_mfma_f32_16x16x32_bf16 v[56:59], a[208:211], v[24:27], v[56:59]
  ds_read_b128 v[44:47], v7 offset:39936
  v_mfma_f32_16x16x32_bf16 v[64:67], a[212:215], v[24:27], v[64:67]
  s_waitcnt lgkmcnt(4)
  v_mfma_f32_16x16x32_bf16 v[52:55], a[204:207], v[28:31], v[52:55]
  v_mfma_f32_16x16x32_bf16 v[60:63], a[208:211], v[28:31], v[60:63]
  v_mfma_f32_16x16x32_bf16 v[68:71], a[212:215], v[28:31], v[68:71]
  s_waitcnt lgkmcnt(3)
  v_mfma_f32_16x16x32_bf16 v[48:51], a[216:219], v[32:35], v[48:51]
  v_mfma_f32_16x16x32_bf16 v[56:59], a[220:223], v[32:35], v[56:59]
  v_mfma_f32_16x16x32_bf16 v[64:67], a[224:227], v[32:35], v[64:67]
  s_waitcnt lgkmcnt(2)
  v_mfma_f32_16x16x32_bf16 v[52:55], a[216:219], v[36:39], v[52:55]
  v_mfma_f32_16x16x32_bf16 v[60:63], a[220:223], v[36:39], v[60:63]
  v_mfma_f32_16x16x32_bf16 v[68:71], a[224:227], v[36:39], v[68:71]
  s_waitcnt lgkmcnt(1)
  v_mfma_f32_16x16x32_bf16 v[48:51], a[228:231], v[40:43], v[48:51]
  v_mfma_f32_16x16x32_bf16 v[56:59], a[232:235], v[40:43], v[56:59]
  v_mfma_f32_16x16x32_bf16 v[64:67], a[236:239], v[40:43], v[64:67]
  s_waitcnt lgkmcnt(0)
  v_mfma_f32_16x16x32_bf16 v[52:55], a[228:231], v[44:47], v[52:55]
  v_mfma_f32_16x16x32_bf16 v[60:63], a[232:235], v[44:47], v[60:63]
  v_mfma_f32_16x16x32_bf16 v[68:71], a[236:239], v[44:47], v[68:71]
  v_mov_b32 v92, s44
  s_mul_i32 s23, s20, 98304
  s_add_u32 s23, s23, s36
  v_fma_f32 v48, -v128, v104, v48
  v_fma_f32 v49, -v128, v105, v49
  v_fma_f32 v50, -v128, v106, v50
  v_fma_f32 v51, -v128, v107, v51
  v_fma_f32 v48, v48, v129, v108
  v_fma_f32 v49, v49, v129, v109
  v_fma_f32 v50, v50, v129, v110
  v_fma_f32 v51, v51, v129, v111
  v_pk_mul_f32 v[88:89], v[48:49], v[48:49]
  v_pk_mul_f32 v[90:91], v[50:51], v[50:51]
  v_fma_f32 v88, v88, s45, v92
  v_fma_f32 v89, v89, s45, v92
  v_fma_f32 v90, v90, s45, v92
  v_fma_f32 v91, v91, s45, v92
  v_pk_mul_f32 v[88:89], v[88:89], v[48:49]
  v_pk_mul_f32 v[90:91], v[90:91], v[50:51]
  v_exp_f32 v88, v88
  v_exp_f32 v89, v89
  v_exp_f32 v90, v90
  v_exp_f32 v91, v91
  v_pk_add_f32 v[88:89], v[88:89], 1.0 op_sel_hi:[1,0]
  v_pk_add_f32 v[90:91], v[90:91], 1.0 op_sel_hi:[1,0]
  v_rcp_f32 v88, v88
  v_rcp_f32 v89, v89
  v_rcp_f32 v90, v90
  v_rcp_f32 v91, v91
  v_pk_mul_f32 v[48:49], v[48:49], v[88:89]
  v_pk_mul_f32 v[50:51], v[50:51], v[90:91]
  v_fma_f32 v52, -v140, v104, v52
  v_fma_f32 v53, -v140, v105, v53
  v_fma_f32 v54, -v140, v106, v54
  v_fma_f32 v55, -v140, v107, v55
  v_fma_f32 v52, v52, v141, v108
  v_fma_f32 v53, v53, v141, v109
  v_fma_f32 v54, v54, v141, v110
  v_fma_f32 v55, v55, v141, v111
  v_pk_mul_f32 v[88:89], v[52:53], v[52:53]
  v_pk_mul_f32 v[90:91], v[54:55], v[54:55]
  v_fma_f32 v88, v88, s45, v92
  v_fma_f32 v89, v89, s45, v92
  v_fma_f32 v90, v90, s45, v92
  v_fma_f32 v91, v91, s45, v92
  v_pk_mul_f32 v[88:89], v[88:89], v[52:53]
  v_pk_mul_f32 v[90:91], v[90:91], v[54:55]
  v_exp_f32 v88, v88
  v_exp_f32 v89, v89
  v_exp_f32 v90, v90
  v_exp_f32 v91, v91
  v_pk_add_f32 v[88:89], v[88:89], 1.0 op_sel_hi:[1,0]
  v_pk_add_f32 v[90:91], v[90:91], 1.0 op_sel_hi:[1,0]
  v_rcp_f32 v88, v88
  v_rcp_f32 v89, v89
  v_rcp_f32 v90, v90
  v_rcp_f32 v91, v91
  v_pk_mul_f32 v[52:53], v[52:53], v[88:89]
  v_pk_mul_f32 v[54:55], v[54:55], v[90:91]
  v_cvt_pk_bf16_f32 v72, v48, v49
  v_cvt_pk_bf16_f32 v73, v50, v51
  v_cvt_pk_bf16_f32 v74, v52, v53
  v_cvt_pk_bf16_f32 v75, v54, v55
  buffer_store_dwordx4 v[72:75], v4, s[4:7], s23 offen offset:0 sc1
  v_fma_f32 v56, -v128, v112, v56
  v_fma_f32 v57, -v128, v113, v57
  v_fma_f32 v58, -v128, v114, v58
  v_fma_f32 v59, -v128, v115, v59
  v_fma_f32 v56, v56, v129, v116
  v_fma_f32 v57, v57, v129, v117
  v_fma_f32 v58, v58, v129, v118
  v_fma_f32 v59, v59, v129, v119
  v_pk_mul_f32 v[88:89], v[56:57], v[56:57]
  v_pk_mul_f32 v[90:91], v[58:59], v[58:59]
  v_fma_f32 v88, v88, s45, v92
  v_fma_f32 v89, v89, s45, v92
  v_fma_f32 v90, v90, s45, v92
  v_fma_f32 v91, v91, s45, v92
  v_pk_mul_f32 v[88:89], v[88:89], v[56:57]
  v_pk_mul_f32 v[90:91], v[90:91], v[58:59]
  v_exp_f32 v88, v88
  v_exp_f32 v89, v89
  v_exp_f32 v90, v90
  v_exp_f32 v91, v91
  v_pk_add_f32 v[88:89], v[88:89], 1.0 op_sel_hi:[1,0]
  v_pk_add_f32 v[90:91], v[90:91], 1.0 op_sel_hi:[1,0]
  v_rcp_f32 v88, v88
  v_rcp_f32 v89, v89
  v_rcp_f32 v90, v90
  v_rcp_f32 v91, v91
  v_pk_mul_f32 v[56:57], v[56:57], v[88:89]
  v_pk_mul_f32 v[58:59], v[58:59], v[90:91]
  v_fma_f32 v60, -v140, v112, v60
  v_fma_f32 v61, -v140, v113, v61
  v_fma_f32 v62, -v140, v114, v62
  v_fma_f32 v63, -v140, v115, v63
  v_fma_f32 v60, v60, v141, v116
  v_fma_f32 v61, v61, v141, v117
  v_fma_f32 v62, v62, v141, v118
  v_fma_f32 v63, v63, v141, v119
  v_pk_mul_f32 v[88:89], v[60:61], v[60:61]
  v_pk_mul_f32 v[90:91], v[62:63], v[62:63]
  v_fma_f32 v88, v88, s45, v92
  v_fma_f32 v89, v89, s45, v92
  v_fma_f32 v90, v90, s45, v92
  v_fma_f32 v91, v91, s45, v92
  v_pk_mul_f32 v[88:89], v[88:89], v[60:61]
  v_pk_mul_f32 v[90:91], v[90:91], v[62:63]
  v_exp_f32 v88, v88
  v_exp_f32 v89, v89
  v_exp_f32 v90, v90
  v_exp_f32 v91, v91
  v_pk_add_f32 v[88:89], v[88:89], 1.0 op_sel_hi:[1,0]
  v_pk_add_f32 v[90:91], v[90:91], 1.0 op_sel_hi:[1,0]
  v_rcp_f32 v88, v88
  v_rcp_f32 v89, v89
  v_rcp_f32 v90, v90
  v_rcp_f32 v91, v91
  v_pk_mul_f32 v[60:61], v[60:61], v[88:89]
  v_pk_mul_f32 v[62:63], v[62:63], v[90:91]
  v_cvt_pk_bf16_f32 v76, v56, v57
  v_cvt_pk_bf16_f32 v77, v58, v59
  v_cvt_pk_bf16_f32 v78, v60, v61
  v_cvt_pk_bf16_f32 v79, v62, v63
  buffer_store_dwordx4 v[76:79], v4, s[4:7], s23 offen offset:1024 sc1
  v_fma_f32 v64, -v128, v120, v64
  v_fma_f32 v65, -v128, v121, v65
  v_fma_f32 v66, -v128, v122, v66
  v_fma_f32 v67, -v128, v123, v67
  v_fma_f32 v64, v64, v129, v124
  v_fma_f32 v65, v65, v129, v125
  v_fma_f32 v66, v66, v129, v126
  v_fma_f32 v67, v67, v129, v127
  v_pk_mul_f32 v[88:89], v[64:65], v[64:65]
  v_pk_mul_f32 v[90:91], v[66:67], v[66:67]
  v_fma_f32 v88, v88, s45, v92
  v_fma_f32 v89, v89, s45, v92
  v_fma_f32 v90, v90, s45, v92
  v_fma_f32 v91, v91, s45, v92
  v_pk_mul_f32 v[88:89], v[88:89], v[64:65]
  v_pk_mul_f32 v[90:91], v[90:91], v[66:67]
  v_exp_f32 v88, v88
  v_exp_f32 v89, v89
  v_exp_f32 v90, v90
  v_exp_f32 v91, v91
  v_pk_add_f32 v[88:89], v[88:89], 1.0 op_sel_hi:[1,0]
  v_pk_add_f32 v[90:91], v[90:91], 1.0 op_sel_hi:[1,0]
  v_rcp_f32 v88, v88
  v_rcp_f32 v89, v89
  v_rcp_f32 v90, v90
  v_rcp_f32 v91, v91
  v_pk_mul_f32 v[64:65], v[64:65], v[88:89]
  v_pk_mul_f32 v[66:67], v[66:67], v[90:91]
  v_fma_f32 v68, -v140, v120, v68
  v_fma_f32 v69, -v140, v121, v69
  v_fma_f32 v70, -v140, v122, v70
  v_fma_f32 v71, -v140, v123, v71
  v_fma_f32 v68, v68, v141, v124
  v_fma_f32 v69, v69, v141, v125
  v_fma_f32 v70, v70, v141, v126
  v_fma_f32 v71, v71, v141, v127
  v_pk_mul_f32 v[88:89], v[68:69], v[68:69]
  v_pk_mul_f32 v[90:91], v[70:71], v[70:71]
  v_fma_f32 v88, v88, s45, v92
  v_fma_f32 v89, v89, s45, v92
  v_fma_f32 v90, v90, s45, v92
  v_fma_f32 v91, v91, s45, v92
  v_pk_mul_f32 v[88:89], v[88:89], v[68:69]
  v_pk_mul_f32 v[90:91], v[90:91], v[70:71]
  v_exp_f32 v88, v88
  v_exp_f32 v89, v89
  v_exp_f32 v90, v90
  v_exp_f32 v91, v91
  v_pk_add_f32 v[88:89], v[88:89], 1.0 op_sel_hi:[1,0]
  v_pk_add_f32 v[90:91], v[90:91], 1.0 op_sel_hi:[1,0]
  v_rcp_f32 v88, v88
  v_rcp_f32 v89, v89
  v_rcp_f32 v90, v90
  v_rcp_f32 v91, v91
  v_pk_mul_f32 v[68:69], v[68:69], v[88:89]
  v_pk_mul_f32 v[70:71], v[70:71], v[90:91]
  v_cvt_pk_bf16_f32 v80, v64, v65
  v_cvt_pk_bf16_f32 v81, v66, v67
  v_cvt_pk_bf16_f32 v82, v68, v69
  v_cvt_pk_bf16_f32 v83, v70, v71
  buffer_store_dwordx4 v[80:83], v4, s[4:7], s23 offen offset:2048 sc1
  s_xor_b32 s28, s28, 65536
  v_xor_b32 v7, 0x10000, v7
  v_mov_b32 v15, s31
  s_cmp_lg_u32 s17, 0
  s_waitcnt vmcnt(0)
  s_barrier
  s_cbranch_scc1 L_F1_pf
  s_mov_b64 exec, 1
  buffer_store_dword v15, v6, s[4:7], s34 offen sc1
  s_mov_b64 exec, -1
L_F1_pf:
  s_add_u32 s20, s20, 6
  s_cmp_lt_u32 s20, 64
  s_cbranch_scc1 L_F1_loop
  s_endpgm
L_F2:
  s_load_dwordx4 s[28:31], s[0:1], 80
  s_load_dwordx2 s[34:35], s[0:1], 112
  s_mul_i32 s20, s18, 6554
  s_lshr_b32 s20, s20, 16
  s_mul_i32 s3, s20, 10
  s_sub_u32 s18, s18, s3
  s_waitcnt lgkmcnt(0)
  s_mov_b32 s8, s28
  s_mov_b32 s9, s29
  s_mov_b32 s10, 1966080
  s_mov_b32 s11, 0x20000
  s_mov_b32 s12, s30
  s_mov_b32 s13, s31
  s_mov_b32 s14, 1280
  s_mov_b32 s15, 0x20000
  s_mov_b32 s48, s34
  s_mov_b32 s49, s35
  s_mov_b32 s50, 2621440
  s_mov_b32 s51, 0x20000
  v_lshrrev_b32 v8, 3, v1
  v_and_b32 v9, 7, v1
  v_lshrrev_b32 v10, 1, v9
  v_lshrrev_b32 v11, 1, v8
  v_xor_b32 v10, v10, v11
  v_lshlrev_b32 v10, 5, v10
  v_and_b32 v9, 1, v9
  v_lshl_add_u32 v10, v9, 4, v10
  v_mul_u32_u24 v8, 1280, v8
  v_add_u32 v8, v8, v10
  s_mul_i32 s32, s17, 491520
  s_lshl_b32 s22, s18, 7
  s_add_u32 s32, s32, s22
  s_mul_i32 s33, s17, 32768
  v_bfe_u32 v9, v1, 2, 3
  v_and_b32 v10, 3, v1
  v_lshlrev_b32 v10, 3, v10
  v_lshl_add_u32 v10, v9, 7, v10
  v_lshrrev_b32 v9, 1, v9
  v_lshrrev_b32 v11, 5, v1
  v_lshl_add_u32 v10, v11, 10, v10
  v_add_u32 v10, s33, v10
  s_waitcnt vmcnt(0)
  v_xor_b32 v11, 0, v9
  v_lshl_add_u32 v12, v11, 5, v10
  v_xor_b32 v11, 1, v9
  v_lshl_add_u32 v13, v11, 5, v10
  v_xor_b32 v11, 2, v9
  v_lshl_add_u32 v14, v11, 5, v10
  v_xor_b32 v11, 3, v9
  v_lshl_add_u32 v15, v11, 5, v10
  s_add_u32 m0, s33, 0
  s_add_u32 s26, s32, 0
  buffer_load_dwordx4 v8, s[8:11], s26 offen lds
  s_add_u32 m0, s33, 1024
  s_add_u32 s26, s32, 10240
  buffer_load_dwordx4 v8, s[8:11], s26 offen lds
  s_add_u32 m0, s33, 2048
  s_add_u32 s26, s32, 20480
  buffer_load_dwordx4 v8, s[8:11], s26 offen lds
  s_add_u32 m0, s33, 3072
  s_add_u32 s26, s32, 30720
  buffer_load_dwordx4 v8, s[8:11], s26 offen lds
  s_add_u32 m0, s33, 4096
  s_add_u32 s26, s32, 40960
  buffer_load_dwordx4 v8, s[8:11], s26 offen lds
  s_add_u32 m0, s33, 5120
  s_add_u32 s26, s32, 51200
  buffer_load_dwordx4 v8, s[8:11], s26 offen lds
  s_add_u32 m0, s33, 6144
  s_add_u32 s26, s32, 61440
  buffer_load_dwordx4 v8, s[8:11], s26 offen lds
  s_add_u32 m0, s33, 7168
  s_add_u32 s26, s32, 71680
  buffer_load_dwordx4 v8, s[8:11], s26 offen lds
  s_add_u32 m0, s33, 8192
  s_add_u32 s26, s32, 81920
  buffer_load_dwordx4 v8, s[8:11], s26 offen lds
  s_add_u32 m0, s33, 9216
  s_add_u32 s26, s32, 92160
  buffer_load_dwordx4 v8, s[8:11], s26 offen lds
  s_add_u32 m0, s33, 10240
  s_add_u32 s26, s32, 102400
  buffer_load_dwordx4 v8, s[8:11], s26 offen lds
  s_add_u32 m0, s33, 11264
  s_add_u32 s26, s32, 112640
  buffer_load_dwordx4 v8, s[8:11], s26 offen lds
  s_add_u32 m0, s33, 12288
  s_add_u32 s26, s32, 122880
  buffer_load_dwordx4 v8, s[8:11], s26 offen lds
  s_add_u32 m0, s33, 13312
  s_add_u32 s26, s32, 133120
  buffer_load_dwordx4 v8, s[8:11], s26 offen lds
  s_add_u32 m0, s33, 14336
  s_add_u32 s26, s32, 143360
  buffer_load_dwordx4 v8, s[8:11], s26 offen lds
  s_add_u32 m0, s33, 15360
  s_add_u32 s26, s32, 153600
  buffer_load_dwordx4 v8, s[8:11], s26 offen lds
  s_add_u32 m0, s33, 16384
  s_add_u32 s26, s32, 163840
  buffer_load_dwordx4 v8, s[8:11], s26 offen lds
  s_add_u32 m0, s33, 17408
  s_add_u32 s26, s32, 174080
  buffer_load_dwordx4 v8, s[8:11], s26 offen lds
  s_add_u32 m0, s33, 18432
  s_add_u32 s26, s32, 184320
  buffer_load_dwordx4 v8, s[8:11], s26 offen lds
  s_add_u32 m0, s33, 19456
  s_add_u32 s26, s32, 194560
  buffer_load_dwordx4 v8, s[8:11], s26 offen lds
  s_add_u32 m0, s33, 20480
  s_add_u32 s26, s32, 204800
  buffer_load_dwordx4 v8, s[8:11], s26 offen lds
  s_add_u32 m0, s33, 21504
  s_add_u32 s26, s32, 215040
  buffer_load_dwordx4 v8, s[8:11], s26 offen lds
  s_add_u32 m0, s33, 22528
  s_add_u32 s26, s32, 225280
  buffer_load_dwordx4 v8, s[8:11], s26 offen lds
  s_add_u32 m0, s33, 23552
  s_add_u32 s26, s32, 235520
  buffer_load_dwordx4 v8, s[8:11], s26 offen lds
  s_add_u32 m0, s33, 24576
  s_add_u32 s26, s32, 245760
  buffer_load_dwordx4 v8, s[8:11], s26 offen lds
  s_add_u32 m0, s33, 25600
  s_add_u32 s26, s32, 256000
  buffer_load_dwordx4 v8, s[8:11], s26 offen lds
  s_add_u32 m0, s33, 26624
  s_add_u32 s26, s32, 266240
  buffer_load_dwordx4 v8, s[8:11], s26 offen lds
  s_add_u32 m0, s33, 27648
  s_add_u32 s26, s32, 276480
  buffer_load_dwordx4 v8, s[8:11], s26 offen lds
  s_add_u32 m0, s33, 28672
  s_add_u32 s26, s32, 286720
  buffer_load_dwordx4 v8, s[8:11], s26 offen lds
  s_add_u32 m0, s33, 29696
  s_add_u32 s26, s32, 296960
  buffer_load_dwordx4 v8, s[8:11], s26 offen lds
  s_add_u32 m0, s33, 30720
  s_add_u32 s26, s32, 307200
  buffer_load_dwordx4 v8, s[8:11], s26 offen lds
  s_add_u32 m0, s33, 31744
  s_add_u32 s26, s32, 317440
  buffer_load_dwordx4 v8, s[8:11], s26 offen lds
  s_waitcnt vmcnt(30)
  ds_read_b64_tr_b16 a[0:1], v12 offset:0
  ds_read_b64_tr_b16 a[4:5], v13 offset:0
  ds_read_b64_tr_b16 a[8:9], v14 offset:0
  ds_read_b64_tr_b16 a[12:13], v15 offset:0
  s_waitcnt lgkmcnt(0)
  s_add_u32 m0, s33, 0
  s_add_u32 s26, s32, 327680
  buffer_load_dwordx4 v8, s[8:11], s26 offen lds
  s_add_u32 m0, s33, 1024
  s_add_u32 s26, s32, 337920
  buffer_load_dwordx4 v8, s[8:11], s26 offen lds
  s_waitcnt vmcnt(30)
  ds_read_b64_tr_b16 a[2:3], v12 offset:2048
  ds_read_b64_tr_b16 a[6:7], v13 offset:2048
  ds_read_b64_tr_b16 a[10:11], v14 offset:2048
  ds_read_b64_tr_b16 a[14:15], v15 offset:2048
  s_waitcnt lgkmcnt(0)
  s_add_u32 m0, s33, 2048
  s_add_u32 s26, s32, 348160
  buffer_load_dwordx4 v8, s[8:11], s26 offen lds
  s_add_u32 m0, s33, 3072
  s_add_u32 s26, s32, 358400
  buffer_load_dwordx4 v8, s[8:11], s26 offen lds
  s_waitcnt vmcnt(30)
  ds_read_b64_tr_b16 a[16:17], v12 offset:4096
  ds_read_b64_tr_b16 a[20:21], v13 offset:4096
  ds_read_b64_tr_b16 a[24:25], v14 offset:4096
  ds_read_b64_tr_b16 a[28:29], v15 offset:4096
  s_waitcnt lgkmcnt(0)
  s_add_u32 m0, s33, 4096
  s_add_u32 s26, s32, 368640
  buffer_load_dwordx4 v8, s[8:11], s26 offen lds
  s_add_u32 m0, s33, 5120
  s_add_u32 s26, s32, 378880
  buffer_load_dwordx4 v8, s[8:11], s26 offen lds
  s_waitcnt vmcnt(30)
  ds_read_b64_tr_b16 a[18:19], v12 offset:6144
  ds_read_b64_tr_b16 a[22:23], v13 offset:6144
  ds_read_b64_tr_b16 a[26:27], v14 offset:6144
  ds_read_b64_tr_b16 a[30:31], v15 offset:6144
  s_waitcnt lgkmcnt(0)
  s_add_u32 m0, s33, 6144
  s_add_u32 s26, s32, 389120
  buffer_load_dwordx4 v8, s[8:11], s26 offen lds
  s_add_u32 m0, s33, 7168
  s_add_u32 s26, s32, 399360
  buffer_load_dwordx4 v8, s[8:11], s26 offen lds
  s_waitcnt vmcnt(30)
  ds_read_b64_tr_b16 a[32:33], v12 offset:8192
  ds_read_b64_tr_b16 a[36:37], v13 offset:8192
  ds_read_b64_tr_b16 a[40:41], v14 offset:8192
  ds_read_b64_tr_b16 a[44:45], v15 offset:8192
  s_waitcnt lgkmcnt(0)
  s_add_u32 m0, s33, 8192
  s_add_u32 s26, s32, 409600
  buffer_load_dwordx4 v8, s[8:11], s26 offen lds
  s_add_u32 m0, s33, 9216
  s_add_u32 s26, s32, 419840
  buffer_load_dwordx4 v8, s[8:11], s26 offen lds
  s_waitcnt vmcnt(30)
  ds_read_b64_tr_b16 a[34:35], v12 offset:10240
  ds_read_b64_tr_b16 a[38:39], v13 offset:10240
  ds_read_b64_tr_b16 a[42:43], v14 offset:10240
  ds_read_b64_tr_b16 a[46:47], v15 offset:10240
  s_waitcnt lgkmcnt(0)
  s_add_u32 m0, s33, 10240
  s_add_u32 s26, s32, 430080
  buffer_load_dwordx4 v8, s[8:11], s26 offen lds
  s_add_u32 m0, s33, 11264
  s_add_u32 s26, s32, 440320
  buffer_load_dwordx4 v8, s[8:11], s26 offen lds
  s_waitcnt vmcnt(30)
  ds_read_b64_tr_b16 a[48:49], v12 offset:12288
  ds_read_b64_tr_b16 a[52:53], v13 offset:12288
  ds_read_b64_tr_b16 a[56:57], v14 offset:12288
  ds_read_b64_tr_b16 a[60:61], v15 offset:12288
  s_waitcnt lgkmcnt(0)
  s_add_u32 m0, s33, 12288
  s_add_u32 s26, s32, 450560
  buffer_load_dwordx4 v8, s[8:11], s26 offen lds
  s_add_u32 m0, s33, 13312
  s_add_u32 s26, s32, 460800
  buffer_load_dwordx4 v8, s[8:11], s26 offen lds
  s_waitcnt vmcnt(30)
  ds_read_b64_tr_b16 a[50:51], v12 offset:14336
  ds_read_b64_tr_b16 a[54:55], v13 offset:14336
  ds_read_b64_tr_b16 a[58:59], v14 offset:14336
  ds_read_b64_tr_b16 a[62:63], v15 offset:14336
  s_waitcnt lgkmcnt(0)
  s_add_u32 m0, s33, 14336
  s_add_u32 s26, s32, 471040
  buffer_load_dwordx4 v8, s[8:11], s26 offen lds
  s_add_u32 m0, s33, 15360
  s_add_u32 s26, s32, 481280
  buffer_load_dwordx4 v8, s[8:11], s26 offen lds
  s_waitcnt vmcnt(30)
  ds_read_b64_tr_b16 a[64:65], v12 offset:16384
  ds_read_b64_tr_b16 a[68:69], v13 offset:16384
  ds_read_b64_tr_b16 a[72:73], v14 offset:16384
  ds_read_b64_tr_b16 a[76:77], v15 offset:16384
  s_waitcnt vmcnt(28)
  ds_read_b64_tr_b16 a[66:67], v12 offset:18432
  ds_read_b64_tr_b16 a[70:71], v13 offset:18432
  ds_read_b64_tr_b16 a[74:75], v14 offset:18432
  ds_read_b64_tr_b16 a[78:79], v15 offset:18432
  s_waitcnt vmcnt(26)
  ds_read_b64_tr_b16 a[80:81], v12 offset:20480
  ds_read_b64_tr_b16 a[84:85], v13 offset:20480
  ds_read_b64_tr_b16 a[88:89], v14 offset:20480
  ds_read_b64_tr_b16 a[92:93], v15 offset:20480
  s_waitcnt vmcnt(24)
  ds_read_b64_tr_b16 a[82:83], v12 offset:22528
  ds_read_b64_tr_b16 a[86:87], v13 offset:22528
  ds_read_b64_tr_b16 a[90:91], v14 offset:22528
  ds_read_b64_tr_b16 a[94:95], v15 offset:22528
  s_waitcnt vmcnt(22)
  ds_read_b64_tr_b16 a[96:97], v12 offset:24576
  ds_read_b64_tr_b16 a[100:101], v13 offset:24576
  ds_read_b64_tr_b16 a[104:105], v14 offset:24576
  ds_read_b64_tr_b16 a[108:109], v15 offset:24576
  s_waitcnt vmcnt(20)
  ds_read_b64_tr_b16 a[98:99], v12 offset:26624
  ds_read_b64_tr_b16 a[102:103], v13 offset:26624
  ds_read_b64_tr_b16 a[106:107], v14 offset:26624
  ds_read_b64_tr_b16 a[110:111], v15 offset:26624
  s_waitcnt vmcnt(18)
  ds_read_b64_tr_b16 a[112:113], v12 offset:28672
  ds_read_b64_tr_b16 a[116:117], v13 offset:28672
  ds_read_b64_tr_b16 a[120:121], v14 offset:28672
  ds_read_b64_tr_b16 a[124:125], v15 offset:28672
  s_waitcnt vmcnt(16)
  ds_read_b64_tr_b16 a[114:115], v12 offset:30720
  ds_read_b64_tr_b16 a[118:119], v13 offset:30720
  ds_read_b64_tr_b16 a[122:123], v14 offset:30720
  ds_read_b64_tr_b16 a[126:127], v15 offset:30720
  s_waitcnt vmcnt(14)
  ds_read_b64_tr_b16 a[128:129], v12 offset:0
  ds_read_b64_tr_b16 a[132:133], v13 offset:0
  ds_read_b64_tr_b16 a[136:137], v14 offset:0
  ds_read_b64_tr_b16 a[140:141], v15 offset:0
  s_waitcnt vmcnt(12)
  ds_read_b64_tr_b16 a[130:131], v12 offset:2048
  ds_read_b64_tr_b16 a[134:135], v13 offset:2048
  ds_read_b64_tr_b16 a[138:139], v14 offset:2048
  ds_read_b64_tr_b16 a[142:143], v15 offset:2048
  s_waitcnt vmcnt(10)
  ds_read_b64_tr_b16 a[144:145], v12 offset:4096
  ds_read_b64_tr_b16 a[148:149], v13 offset:4096
  ds_read_b64_tr_b16 a[152:153], v14 offset:4096
  ds_read_b64_tr_b16 a[156:157], v15 offset:4096
  s_waitcnt vmcnt(8)
  ds_read_b64_tr_b16 a[146:147], v12 offset:6144
  ds_read_b64_tr_b16 a[150:151], v13 offset:6144
  ds_read_b64_tr_b16 a[154:155], v14 offset:6144
  ds_read_b64_tr_b16 a[158:159], v15 offset:6144
  s_waitcnt vmcnt(6)
  ds_read_b64_tr_b16 a[160:161], v12 offset:8192
  ds_read_b64_tr_b16 a[164:165], v13 offset:8192
  ds_read_b64_tr_b16 a[168:169], v14 offset:8192
  ds_read_b64_tr_b16 a[172:173], v15 offset:8192
  s_waitcnt vmcnt(4)
  ds_read_b64_tr_b16 a[162:163], v12 offset:10240
  ds_read_b64_tr_b16 a[166:167], v13 offset:10240
  ds_read_b64_tr_b16 a[170:171], v14 offset:10240
  ds_read_b64_tr_b16 a[174:175], v15 offset:10240
  s_waitcnt vmcnt(2)
  ds_read_b64_tr_b16 a[176:177], v12 offset:12288
  ds_read_b64_tr_b16 a[180:181], v13 offset:12288
  ds_read_b64_tr_b16 a[184:185], v14 offset:12288
  ds_read_b64_tr_b16 a[188:189], v15 offset:12288
  s_waitcnt vmcnt(0)
  ds_read_b64_tr_b16 a[178:179], v12 offset:14336
  ds_read_b64_tr_b16 a[182:183], v13 offset:14336
  ds_read_b64_tr_b16 a[186:187], v14 offset:14336
  ds_read_b64_tr_b16 a[190:191], v15 offset:14336
  s_waitcnt lgkmcnt(0)
  s_barrier
  s_branch L_F2_m_in
L_F2_m:
  s_sleep 4
L_F2_m_in:
  buffer_load_dword v4, off, s[96:99], 0 offset:64 sc1
  s_add_u32 s39, s39, 1
  s_cmp_gt_u32 s39, 200000
  s_cbranch_scc1 L_exit
  s_waitcnt vmcnt(0)
  v_cmp_gt_u32 vcc, 40, v4
  s_cbranch_vccnz L_F2_m
  v_lshlrev_b32 v4, 4, v1
  s_lshl_b32 s22, s18, 7
  s_lshl_b32 s23, s17, 5
  s_add_u32 s40, s22, s23
  v_lshlrev_b32 v7, 3, v2
  buffer_load_dwordx2 v[8:9], v7, s[12:15], s40 offen
  v_lshlrev_b32 v7, 4, v2
  s_lshl_b32 s22, s40, 1
  s_add_u32 s22, s22, 12800
  buffer_load_dwordx4 v[160:163], v7, s[4:7], s22 offen sc1
  v_mul_u32_u24 v6, 1280, v3
  v_lshl_add_u32 v6, v2, 3, v6
  s_waitcnt vmcnt(1)
  v_lshlrev_b32 v16, 16, v8
  v_and_b32 v17, 0xffff0000, v8
  v_lshlrev_b32 v18, 16, v9
  v_and_b32 v19, 0xffff0000, v9
  s_lshl_b32 s22, s17, 13
  v_add_u32 v5, s22, v4
  s_lshl_b32 s22, s17, 11
  v_add_u32 v10, s22, v4
  s_mul_i32 s41, s17, 24576
  s_add_u32 s41, s41, 16777216
  v_and_b32 v11, 7, v1
  v_lshlrev_b32 v11, 7, v11
  s_xor_b32 s22, s19, 8192
  v_add_u32 v11, s22, v11
  v_lshrrev_b32 v12, 1, v2
  v_lshlrev_b32 v12, 8, v12
  v_lshl_add_u32 v12, v3, 4, v12
  v_and_b32 v13, 1, v2
  v_lshl_add_u32 v12, v13, 3, v12
  s_lshl_b32 s44, s18, 11
  s_lshl_b32 s22, s17, 9
  s_add_u32 s44, s44, s22
  s_add_u32 s44, s44, 13631488
  s_mov_b32 s39, 0
  s_waitcnt vmcnt(0)
L_F2_loop:
  s_add_u32 s31, s20, 1
  s_mul_i32 s22, s20, 10923
  s_lshr_b32 s22, s22, 16
  s_mul_i32 s22, s22, 6
  s_sub_u32 s35, s20, s22
  s_lshl_b32 s35, s35, 10
  s_add_u32 s35, s35, 7503872
  s_cmp_lg_u32 s17, 0
  s_cbranch_scc1 L_F2_w_b
  s_branch L_F2_w_in
L_F2_w:
  s_sleep 3
L_F2_w_in:
  buffer_load_dword v15, v11, s[4:7], s35 offen sc1
  s_add_u32 s39, s39, 1
  s_cmp_gt_u32 s39, 200000
  s_cbranch_scc1 L_exit
  s_waitcnt vmcnt(0)
  v_cmp_gt_u32 vcc, s31, v15
  s_cbranch_vccnz L_F2_w
L_F2_w_b:
  s_barrier
  s_mul_i32 s23, s20, 98304
  s_add_u32 s23, s23, s41
  s_add_u32 s22, s23, 0
  buffer_load_dwordx4 v[64:67], v4, s[4:7], s22 offen offset:0 sc1
  buffer_load_dwordx4 v[68:71], v4, s[4:7], s22 offen offset:1024 sc1
  buffer_load_dwordx4 v[72:75], v4, s[4:7], s22 offen offset:2048 sc1
  buffer_load_dwordx4 v[76:79], v4, s[4:7], s22 offen offset:3072 sc1
  s_add_u32 s22, s23, 4096
  buffer_load_dwordx4 v[80:83], v4, s[4:7], s22 offen offset:0 sc1
  buffer_load_dwordx4 v[84:87], v4, s[4:7], s22 offen offset:1024 sc1
  buffer_load_dwordx4 v[88:91], v4, s[4:7], s22 offen offset:2048 sc1
  buffer_load_dwordx4 v[92:95], v4, s[4:7], s22 offen offset:3072 sc1
  s_add_u32 s22, s23, 8192
  buffer_load_dwordx4 v[96:99], v4, s[4:7], s22 offen offset:0 sc1
  buffer_load_dwordx4 v[100:103], v4, s[4:7], s22 offen offset:1024 sc1
  buffer_load_dwordx4 v[104:107], v4, s[4:7], s22 offen offset:2048 sc1
  buffer_load_dwordx4 v[108:111], v4, s[4:7], s22 offen offset:3072 sc1
  s_add_u32 s22, s23, 12288
  buffer_load_dwordx4 v[112:115], v4, s[4:7], s22 offen offset:0 sc1
  buffer_load_dwordx4 v[116:119], v4, s[4:7], s22 offen offset:1024 sc1
  buffer_load_dwordx4 v[120:123], v4, s[4:7], s22 offen offset:2048 sc1
  buffer_load_dwordx4 v[124:127], v4, s[4:7], s22 offen offset:3072 sc1
  s_add_u32 s22, s23, 16384
  buffer_load_dwordx4 v[128:131], v4, s[4:7], s22 offen offset:0 sc1
  buffer_load_dwordx4 v[132:135], v4, s[4:7], s22 offen offset:1024 sc1
  buffer_load_dwordx4 v[136:139], v4, s[4:7], s22 offen offset:2048 sc1
  buffer_load_dwordx4 v[140:143], v4, s[4:7], s22 offen offset:3072 sc1
  s_add_u32 s22, s23, 20480
  buffer_load_dwordx4 v[144:147], v4, s[4:7], s22 offen offset:0 sc1
  buffer_load_dwordx4 v[148:151], v4, s[4:7], s22 offen offset:1024 sc1
  buffer_load_dwordx4 v[152:155], v4, s[4:7], s22 offen offset:2048 sc1
  buffer_load_dwordx4 v[156:159], v4, s[4:7], s22 offen offset:3072 sc1
  s_mul_i32 s23, s20, 40960
  s_add_u32 s42, s23, s40
  s_add_u32 s43, s42, 20480
  s_mul_i32 s22, s20, 40960
  s_add_u32 s22, s22, s44
  buffer_load_dwordx2 v[20:21], v12, s[4:7], s22 offen sc1
  s_add_u32 s22, s22, 20480
  buffer_load_dwordx2 v[22:23], v12, s[4:7], s22 offen sc1
  s_waitcnt vmcnt(24)
  v_swap_b32 v66, v68
  v_swap_b32 v67, v69
  s_nop 1
  v_mfma_f32_16x16x32_bf16 v[24:27], a[0:3], v[64:67], 0
  v_mfma_f32_16x16x32_bf16 v[28:31], a[0:3], v[68:71], 0
  v_mfma_f32_16x16x32_bf16 v[32:35], a[4:7], v[64:67], 0
  v_mfma_f32_16x16x32_bf16 v[36:39], a[4:7], v[68:71], 0
  v_mfma_f32_16x16x32_bf16 v[40:43], a[8:11], v[64:67], 0
  v_mfma_f32_16x16x32_bf16 v[44:47], a[8:11], v[68:71], 0
  v_mfma_f32_16x16x32_bf16 v[48:51], a[12:15], v[64:67], 0
  v_mfma_f32_16x16x32_bf16 v[52:55], a[12:15], v[68:71], 0
  s_waitcnt vmcnt(22)
  v_swap_b32 v74, v76
  v_swap_b32 v75, v77
  s_nop 1
  v_mfma_f32_16x16x32_bf16 v[24:27], a[16:19], v[72:75], v[24:27]
  v_mfma_f32_16x16x32_bf16 v[28:31], a[16:19], v[76:79], v[28:31]
  v_mfma_f32_16x16x32_bf16 v[32:35], a[20:23], v[72:75], v[32:35]
  v_mfma_f32_16x16x32_bf16 v[36:39], a[20:23], v[76:79], v[36:39]
  v_mfma_f32_16x16x32_bf16 v[40:43], a[24:27], v[72:75], v[40:43]
  v_mfma_f32_16x16x32_bf16 v[44:47], a[24:27], v[76:79], v[44:47]
  v_mfma_f32_16x16x32_bf16 v[48:51], a[28:31], v[72:75], v[48:51]
  v_mfma_f32_16x16x32_bf16 v[52:55], a[28:31], v[76:79], v[52:55]
  s_waitcnt vmcnt(20)
  v_swap_b32 v82, v84
  v_swap_b32 v83, v85
  s_nop 1
  v_mfma_f32_16x16x32_bf16 v[24:27], a[32:35], v[80:83], v[24:27]
  v_mfma_f32_16x16x32_bf16 v[28:31], a[32:35], v[84:87], v[28:31]
  v_mfma_f32_16x16x32_bf16 v[32:35], a[36:39], v[80:83], v[32:35]
  v_mfma_f32_16x16x32_bf16 v[36:39], a[36:39], v[84:87], v[36:39]
  v_mfma_f32_16x16x32_bf16 v[40:43], a[40:43], v[80:83], v[40:43]
  v_mfma_f32_16x16x32_bf16 v[44:47], a[40:43], v[84:87], v[44:47]
  v_mfma_f32_16x16x32_bf16 v[48:51], a[44:47], v[80:83], v[48:51]
  v_mfma_f32_16x16x32_bf16 v[52:55], a[44:47], v[84:87], v[52:55]
  s_waitcnt vmcnt(18)
  v_swap_b32 v90, v92
  v_swap_b32 v91, v93
  s_nop 1
  v_mfma_f32_16x16x32_bf16 v[24:27], a[48:51], v[88:91], v[24:27]
  v_mfma_f32_16x16x32_bf16 v[28:31], a[48:51], v[92:95], v[28:31]
  v_mfma_f32_16x16x32_bf16 v[32:35], a[52:55], v[88:91], v[32:35]
  v_mfma_f32_16x16x32_bf16 v[36:39], a[52:55], v[92:95], v[36:39]
  v_mfma_f32_16x16x32_bf16 v[40:43], a[56:59], v[88:91], v[40:43]
  v_mfma_f32_16x16x32_bf16 v[44:47], a[56:59], v[92:95], v[44:47]
  v_mfma_f32_16x16x32_bf16 v[48:51], a[60:63], v[88:91], v[48:51]
  v_mfma_f32_16x16x32_bf16 v[52:55], a[60:63], v[92:95], v[52:55]
  s_waitcnt vmcnt(16)
  v_swap_b32 v98, v100
  v_swap_b32 v99, v101
  s_nop 1
  v_mfma_f32_16x16x32_bf16 v[24:27], a[64:67], v[96:99], v[24:27]
  v_mfma_f32_16x16x32_bf16 v[28:31], a[64:67], v[100:103], v[28:31]
  v_mfma_f32_16x16x32_bf16 v[32:35], a[68:71], v[96:99], v[32:35]
  v_mfma_f32_16x16x32_bf16 v[36:39], a[68:71], v[100:103], v[36:39]
  v_mfma_f32_16x16x32_bf16 v[40:43], a[72:75], v[96:99], v[40:43]
  v_mfma_f32_16x16x32_bf16 v[44:47], a[72:75], v[100:103], v[44:47]
  v_mfma_f32_16x16x32_bf16 v[48:51], a[76:79], v[96:99], v[48:51]
  v_mfma_f32_16x16x32_bf16 v[52:55], a[76:79], v[100:103], v[52:55]
  s_waitcnt vmcnt(14)
  v_swap_b32 v106, v108
  v_swap_b32 v107, v109
  s_nop 1
  v_mfma_f32_16x16x32_bf16 v[24:27], a[80:83], v[104:107], v[24:27]
  v_mfma_f32_16x16x32_bf16 v[28:31], a[80:83], v[108:111], v[28:31]
  v_mfma_f32_16x16x32_bf16 v[32:35], a[84:87], v[104:107], v[32:35]
  v_mfma_f32_16x16x32_bf16 v[36:39], a[84:87], v[108:111], v[36:39]
  v_mfma_f32_16x16x32_bf16 v[40:43], a[88:91], v[104:107], v[40:43]
  v_mfma_f32_16x16x32_bf16 v[44:47], a[88:91], v[108:111], v[44:47]
  v_mfma_f32_16x16x32_bf16 v[48:51], a[92:95], v[104:107], v[48:51]
  v_mfma_f32_16x16x32_bf16 v[52:55], a[92:95], v[108:111], v[52:55]
  s_waitcnt vmcnt(12)
  v_swap_b32 v114, v116
  v_swap_b32 v115, v117
  s_nop 1
  v_mfma_f32_16x16x32_bf16 v[24:27], a[96:99], v[112:115], v[24:27]
  v_mfma_f32_16x16x32_bf16 v[28:31], a[96:99], v[116:119], v[28:31]
  v_mfma_f32_16x16x32_bf16 v[32:35], a[100:103], v[112:115], v[32:35]
  v_mfma_f32_16x16x32_bf16 v[36:39], a[100:103], v[116:119], v[36:39]
  v_mfma_f32_16x16x32_bf16 v[40:43], a[104:107], v[112:115], v[40:43]
  v_mfma_f32_16x16x32_bf16 v[44:47], a[104:107], v[116:119], v[44:47]
  v_mfma_f32_16x16x32_bf16 v[48:51], a[108:111], v[112:115], v[48:51]
  v_mfma_f32_16x16x32_bf16 v[52:55], a[108:111], v[116:119], v[52:55]
  s_waitcnt vmcnt(10)
  v_swap_b32 v122, v124
  v_swap_b32 v123, v125
  s_nop 1
  v_mfma_f32_16x16x32_bf16 v[24:27], a[112:115], v[120:123], v[24:27]
  v_mfma_f32_16x16x32_bf16 v[28:31], a[112:115], v[124:127], v[28:31]
  v_mfma_f32_16x16x32_bf16 v[32:35], a[116:119], v[120:123], v[32:35]
  v_mfma_f32_16x16x32_bf16 v[36:39], a[116:119], v[124:127], v[36:39]
  v_mfma_f32_16x16x32_bf16 v[40:43], a[120:123], v[120:123], v[40:43]
  v_mfma_f32_16x16x32_bf16 v[44:47], a[120:123], v[124:127], v[44:47]
  v_mfma_f32_16x16x32_bf16 v[48:51], a[124:127], v[120:123], v[48:51]
  v_mfma_f32_16x16x32_bf16 v[52:55], a[124:127], v[124:127], v[52:55]
  s_waitcnt vmcnt(8)
  v_swap_b32 v130, v132
  v_swap_b32 v131, v133
  s_nop 1
  v_mfma_f32_16x16x32_bf16 v[24:27], a[128:131], v[128:131], v[24:27]
  v_mfma_f32_16x16x32_bf16 v[28:31], a[128:131], v[132:135], v[28:31]
  v_mfma_f32_16x16x32_bf16 v[32:35], a[132:135], v[128:131], v[32:35]
  v_mfma_f32_16x16x32_bf16 v[36:39], a[132:135], v[132:135], v[36:39]
  v_mfma_f32_16x16x32_bf16 v[40:43], a[136:139], v[128:131], v[40:43]
  v_mfma_f32_16x16x32_bf16 v[44:47], a[136:139], v[132:135], v[44:47]
  v_mfma_f32_16x16x32_bf16 v[48:51], a[140:143], v[128:131], v[48:51]
  v_mfma_f32_16x16x32_bf16 v[52:55], a[140:143], v[132:135], v[52:55]
  s_waitcnt vmcnt(6)
  v_swap_b32 v138, v140
  v_swap_b32 v139, v141
  s_nop 1
  v_mfma_f32_16x16x32_bf16 v[24:27], a[144:147], v[136:139], v[24:27]
  v_mfma_f32_16x16x32_bf16 v[28:31], a[144:147], v[140:143], v[28:31]
  v_mfma_f32_16x16x32_bf16 v[32:35], a[148:151], v[136:139], v[32:35]
  v_mfma_f32_16x16x32_bf16 v[36:39], a[148:151], v[140:143], v[36:39]
  v_mfma_f32_16x16x32_bf16 v[40:43], a[152:155], v[136:139], v[40:43]
  v_mfma_f32_16x16x32_bf16 v[44:47], a[152:155], v[140:143], v[44:47]
  v_mfma_f32_16x16x32_bf16 v[48:51], a[156:159], v[136:139], v[48:51]
  v_mfma_f32_16x16x32_bf16 v[52:55], a[156:159], v[140:143], v[52:55]
  s_waitcnt vmcnt(4)
  v_swap_b32 v146, v148
  v_swap_b32 v147, v149
  s_nop 1
  v_mfma_f32_16x16x32_bf16 v[24:27], a[160:163], v[144:147], v[24:27]
  v_mfma_f32_16x16x32_bf16 v[28:31], a[160:163], v[148:151], v[28:31]
  v_mfma_f32_16x16x32_bf16 v[32:35], a[164:167], v[144:147], v[32:35]
  v_mfma_f32_16x16x32_bf16 v[36:39], a[164:167], v[148:151], v[36:39]
  v_mfma_f32_16x16x32_bf16 v[40:43], a[168:171], v[144:147], v[40:43]
  v_mfma_f32_16x16x32_bf16 v[44:47], a[168:171], v[148:151], v[44:47]
  v_mfma_f32_16x16x32_bf16 v[48:51], a[172:175], v[144:147], v[48:51]
  v_mfma_f32_16x16x32_bf16 v[52:55], a[172:175], v[148:151], v[52:55]
  s_waitcnt vmcnt(2)
  v_swap_b32 v154, v156
  v_swap_b32 v155, v157
  s_nop 1
  v_mfma_f32_16x16x32_bf16 v[24:27], a[176:179], v[152:155], v[24:27]
  v_mfma_f32_16x16x32_bf16 v[28:31], a[176:179], v[156:159], v[28:31]
  v_mfma_f32_16x16x32_bf16 v[32:35], a[180:183], v[152:155], v[32:35]
  v_mfma_f32_16x16x32_bf16 v[36:39], a[180:183], v[156:159], v[36:39]
  v_mfma_f32_16x16x32_bf16 v[40:43], a[184:187], v[152:155], v[40:43]
  v_mfma_f32_16x16x32_bf16 v[44:47], a[184:187], v[156:159], v[44:47]
  v_mfma_f32_16x16x32_bf16 v[48:51], a[188:191], v[152:155], v[48:51]
  v_mfma_f32_16x16x32_bf16 v[52:55], a[188:191], v[156:159], v[52:55]
  ds_write_b128 v5, v[24:27] offset:0
  ds_write_b128 v5, v[28:31] offset:1024
  ds_write_b128 v5, v[32:35] offset:2048
  ds_write_b128 v5, v[36:39] offset:3072
  ds_write_b128 v5, v[40:43] offset:4096
  ds_write_b128 v5, v[44:47] offset:5120
  ds_write_b128 v5, v[48:51] offset:6144
  s_nop 0
  ds_write_b128 v5, v[52:55] offset:7168
  s_waitcnt lgkmcnt(0)
  s_barrier
  ds_read_b128 v[64:67], v10 offset:0
  ds_read_b128 v[68:71], v10 offset:1024
  ds_read_b128 v[72:75], v10 offset:8192
  ds_read_b128 v[76:79], v10 offset:9216
  ds_read_b128 v[80:83], v10 offset:16384
  ds_read_b128 v[84:87], v10 offset:17408
  ds_read_b128 v[88:91], v10 offset:24576
  ds_read_b128 v[92:95], v10 offset:25600
  s_waitcnt lgkmcnt(5)
  v_pk_add_f32 v[64:65], v[64:65], v[72:73]
  s_waitcnt lgkmcnt(1)
  v_pk_add_f32 v[80:81], v[80:81], v[88:89]
  v_pk_add_f32 v[66:67], v[66:67], v[74:75]
  v_pk_add_f32 v[82:83], v[82:83], v[90:91]
  v_pk_add_f32 v[68:69], v[68:69], v[76:77]
  s_waitcnt lgkmcnt(0)
  v_pk_add_f32 v[84:85], v[84:85], v[92:93]
  v_pk_add_f32 v[70:71], v[70:71], v[78:79]
  v_pk_add_f32 v[86:87], v[86:87], v[94:95]
  v_pk_add_f32 v[64:65], v[64:65], v[80:81]
  v_pk_add_f32 v[66:67], v[66:67], v[82:83]
  v_pk_add_f32 v[68:69], v[68:69], v[84:85]
  v_pk_add_f32 v[70:71], v[70:71], v[86:87]
  v_add_f32 v64, v64, v16
  v_add_f32 v65, v65, v17
  v_add_f32 v66, v66, v18
  v_add_f32 v67, v67, v19
  s_waitcnt vmcnt(1)
  v_lshlrev_b32 v72, 16, v20
  v_and_b32 v73, 0xffff0000, v20
  v_lshlrev_b32 v74, 16, v21
  v_and_b32 v75, 0xffff0000, v21
  v_fmac_f32 v72, v64, v160
  v_fmac_f32 v73, v65, v161
  v_fmac_f32 v74, v66, v162
  v_fmac_f32 v75, v67, v163
  v_cvt_pk_bf16_f32 v56, v72, v73
  v_cvt_pk_bf16_f32 v57, v74, v75
  buffer_store_dwordx2 v[56:57], v6, s[48:51], s42 offen
  v_add_f32 v68, v68, v16
  v_add_f32 v69, v69, v17
  v_add_f32 v70, v70, v18
  v_add_f32 v71, v71, v19
  s_waitcnt vmcnt(1)
  v_lshlrev_b32 v72, 16, v22
  v_and_b32 v73, 0xffff0000, v22
  v_lshlrev_b32 v74, 16, v23
  v_and_b32 v75, 0xffff0000, v23
  v_fmac_f32 v72, v68, v160
  v_fmac_f32 v73, v69, v161
  v_fmac_f32 v74, v70, v162
  v_fmac_f32 v75, v71, v163
  v_cvt_pk_bf16_f32 v58, v72, v73
  v_cvt_pk_bf16_f32 v59, v74, v75
  buffer_store_dwordx2 v[58:59], v6, s[48:51], s43 offen
  v_xor_b32 v5, 32768, v5
  v_xor_b32 v10, 32768, v10
  s_add_u32 s20, s20, 4
  s_cmp_lt_u32 s20, 64
  s_cbranch_scc1 L_F2_loop
  s_endpgm
L_ow:
  s_mul_i32 s32, s18, 245760
  v_lshrrev_b32 v16, 3, v1
  v_and_b32 v17, 7, v1
  v_lshrrev_b32 v19, 1, v17
  v_lshrrev_b32 v20, 1, v16
  v_xor_b32 v19, v19, v20
  v_lshlrev_b32 v18, 5, v19
  v_and_b32 v19, 1, v17
  v_lshl_add_u32 v18, v19, 4, v18
  v_mov_b32 v21, v16
  s_and_b32 s22, s17, 1
  s_lshl_b32 s22, s22, 3
  v_add_u32 v21, s22, v21
  s_mov_b32 s22, 1280
  v_mul_lo_u32 v21, v21, s22
  v_add_u32 v21, v21, v18
  s_lshr_b32 s22, s17, 1
  s_mul_i32 s22, s22, 640
  v_add_u32 v21, s22, v21
  s_mul_i32 s24, s17, 6144
  s_and_b32 s25, s17, 1
  s_mul_i32 s25, s25, 10240
  s_lshr_b32 s22, s17, 1
  s_mul_i32 s22, s22, 5120
  s_add_u32 s25, s25, s22
  v_bfe_u32 v16, v1, 2, 3
  v_and_b32 v17, 3, v1
  v_lshlrev_b32 v17, 3, v17
  v_lshl_add_u32 v17, v16, 7, v17
  v_lshrrev_b32 v16, 1, v16
  v_lshrrev_b32 v20, 5, v1
  s_mul_i32 s22, s17, 10
  s_add_u32 s22, s22, 0
  s_and_b32 s23, s22, 3
  s_lshr_b32 s22, s22, 2
  s_lshl_b32 s22, s22, 10
  v_xor_b32 v19, s23, v16
  v_lshl_add_u32 v22, v19, 5, v17
  v_add_u32 v22, s22, v22
  v_mul_u32_u24 v19, 10240, v20
  v_add_u32 v22, v22, v19
  s_mul_i32 s22, s17, 10
  s_add_u32 s22, s22, 1
  s_and_b32 s23, s22, 3
  s_lshr_b32 s22, s22, 2
  s_lshl_b32 s22, s22, 10
  v_xor_b32 v19, s23, v16
  v_lshl_add_u32 v23, v19, 5, v17
  v_add_u32 v23, s22, v23
  v_mul_u32_u24 v19, 10240, v20
  v_add_u32 v23, v23, v19
  s_mul_i32 s22, s17, 10
  s_add_u32 s22, s22, 2
  s_and_b32 s23, s22, 3
  s_lshr_b32 s22, s22, 2
  s_lshl_b32 s22, s22, 10
  v_xor_b32 v19, s23, v16
  v_lshl_add_u32 v24, v19, 5, v17
  v_add_u32 v24, s22, v24
  v_mul_u32_u24 v19, 10240, v20
  v_add_u32 v24, v24, v19
  s_mul_i32 s22, s17, 10
  s_add_u32 s22, s22, 3
  s_and_b32 s23, s22, 3
  s_lshr_b32 s22, s22, 2
  s_lshl_b32 s22, s22, 10
  v_xor_b32 v19, s23, v16
  v_lshl_add_u32 v25, v19, 5, v17
  v_add_u32 v25, s22, v25
  v_mul_u32_u24 v19, 10240, v20
  v_add_u32 v25, v25, v19
  s_mul_i32 s22, s17, 10
  s_add_u32 s22, s22, 4
  s_and_b32 s23, s22, 3
  s_lshr_b32 s22, s22, 2
  s_lshl_b32 s22, s22, 10
  v_xor_b32 v19, s23, v16
  v_lshl_add_u32 v26, v19, 5, v17
  v_add_u32 v26, s22, v26
  v_mul_u32_u24 v19, 10240, v20
  v_add_u32 v26, v26, v19
  s_mul_i32 s22, s17, 10
  s_add_u32 s22, s22, 5
  s_and_b32 s23, s22, 3
  s_lshr_b32 s22, s22, 2
  s_lshl_b32 s22, s22, 10
  v_xor_b32 v19, s23, v16
  v_lshl_add_u32 v27, v19, 5, v17
  v_add_u32 v27, s22, v27
  v_mul_u32_u24 v19, 10240, v20
  v_add_u32 v27, v27, v19
  s_mul_i32 s22, s17, 10
  s_add_u32 s22, s22, 6
  s_and_b32 s23, s22, 3
  s_lshr_b32 s22, s22, 2
  s_lshl_b32 s22, s22, 10
  v_xor_b32 v19, s23, v16
  v_lshl_add_u32 v28, v19, 5, v17
  v_add_u32 v28, s22, v28
  v_mul_u32_u24 v19, 10240, v20
  v_add_u32 v28, v28, v19
  s_mul_i32 s22, s17, 10
  s_add_u32 s22, s22, 7
  s_and_b32 s23, s22, 3
  s_lshr_b32 s22, s22, 2
  s_lshl_b32 s22, s22, 10
  v_xor_b32 v19, s23, v16
  v_lshl_add_u32 v29, v19, 5, v17
  v_add_u32 v29, s22, v29
  v_mul_u32_u24 v19, 10240, v20
  v_add_u32 v29, v29, v19
  s_mul_i32 s22, s17, 10
  s_add_u32 s22, s22, 8
  s_and_b32 s23, s22, 3
  s_lshr_b32 s22, s22, 2
  s_lshl_b32 s22, s22, 10
  v_xor_b32 v19, s23, v16
  v_lshl_add_u32 v30, v19, 5, v17
  v_add_u32 v30, s22, v30
  v_mul_u32_u24 v19, 10240, v20
  v_add_u32 v30, v30, v19
  s_mul_i32 s22, s17, 10
  s_add_u32 s22, s22, 9
  s_and_b32 s23, s22, 3
  s_lshr_b32 s22, s22, 2
  s_lshl_b32 s22, s22, 10
  v_xor_b32 v19, s23, v16
  v_lshl_add_u32 v31, v19, 5, v17
  v_add_u32 v31, s22, v31
  v_mul_u32_u24 v19, 10240, v20
  v_add_u32 v31, v31, v19
  s_add_u32 m0, s25, 0
  s_add_u32 s26, s32, 0
  buffer_load_dwordx4 v21, s[8:11], s26 offen  lds
  s_add_u32 m0, s25, 1024
  s_add_u32 s26, s32, 128
  buffer_load_dwordx4 v21, s[8:11], s26 offen  lds
  s_add_u32 m0, s25, 2048
  s_add_u32 s26, s32, 256
  buffer_load_dwordx4 v21, s[8:11], s26 offen  lds
  s_add_u32 m0, s25, 3072
  s_add_u32 s26, s32, 384
  buffer_load_dwordx4 v21, s[8:11], s26 offen  lds
  s_add_u32 m0, s25, 4096
  s_add_u32 s26, s32, 512
  buffer_load_dwordx4 v21, s[8:11], s26 offen  lds
  s_waitcnt vmcnt(0)
  s_barrier
  s_add_u32 m0, s25, 24576
  s_add_u32 s26, s32, 20480
  buffer_load_dwordx4 v21, s[8:11], s26 offen  lds
  s_add_u32 m0, s25, 25600
  s_add_u32 s26, s32, 20608
  buffer_load_dwordx4 v21, s[8:11], s26 offen  lds
  s_add_u32 m0, s25, 26624
  s_add_u32 s26, s32, 20736
  buffer_load_dwordx4 v21, s[8:11], s26 offen  lds
  s_add_u32 m0, s25, 27648
  s_add_u32 s26, s32, 20864
  buffer_load_dwordx4 v21, s[8:11], s26 offen  lds
  s_add_u32 m0, s25, 28672
  s_add_u32 s26, s32, 20992
  buffer_load_dwordx4 v21, s[8:11], s26 offen  lds
  s_add_u32 m0, s25, 49152
  s_add_u32 s26, s32, 40960
  buffer_load_dwordx4 v21, s[8:11], s26 offen  lds
  s_add_u32 m0, s25, 50176
  s_add_u32 s26, s32, 41088
  buffer_load_dwordx4 v21, s[8:11], s26 offen  lds
  s_add_u32 m0, s25, 51200
  s_add_u32 s26, s32, 41216
  buffer_load_dwordx4 v21, s[8:11], s26 offen  lds
  s_add_u32 m0, s25, 52224
  s_add_u32 s26, s32, 41344
  buffer_load_dwordx4 v21, s[8:11], s26 offen  lds
  s_add_u32 m0, s25, 53248
  s_add_u32 s26, s32, 41472
  buffer_load_dwordx4 v21, s[8:11], s26 offen  lds
  s_add_u32 m0, s25, 73728
  s_add_u32 s26, s32, 61440
  buffer_load_dwordx4 v21, s[8:11], s26 offen  lds
  s_add_u32 m0, s25, 74752
  s_add_u32 s26, s32, 61568
  buffer_load_dwordx4 v21, s[8:11], s26 offen  lds
  s_add_u32 m0, s25, 75776
  s_add_u32 s26, s32, 61696
  buffer_load_dwordx4 v21, s[8:11], s26 offen  lds
  s_add_u32 m0, s25, 76800
  s_add_u32 s26, s32, 61824
  buffer_load_dwordx4 v21, s[8:11], s26 offen  lds
  s_add_u32 m0, s25, 77824
  s_add_u32 s26, s32, 61952
  buffer_load_dwordx4 v21, s[8:11], s26 offen  lds
  s_add_u32 m0, s25, 98304
  s_add_u32 s26, s32, 81920
  buffer_load_dwordx4 v21, s[8:11], s26 offen  lds
  s_add_u32 m0, s25, 99328
  s_add_u32 s26, s32, 82048
  buffer_load_dwordx4 v21, s[8:11], s26 offen  lds
  s_add_u32 m0, s25, 100352
  s_add_u32 s26, s32, 82176
  buffer_load_dwordx4 v21, s[8:11], s26 offen  lds
  s_add_u32 m0, s25, 101376
  s_add_u32 s26, s32, 82304
  buffer_load_dwordx4 v21, s[8:11], s26 offen  lds
  s_add_u32 m0, s25, 102400
  s_add_u32 s26, s32, 82432
  buffer_load_dwordx4 v21, s[8:11], s26 offen  lds
  s_add_u32 m0, s25, 122880
  s_add_u32 s26, s32, 102400
  buffer_load_dwordx4 v21, s[8:11], s26 offen  lds
  s_add_u32 m0, s25, 123904
  s_add_u32 s26, s32, 102528
  buffer_load_dwordx4 v21, s[8:11], s26 offen  lds
  s_add_u32 m0, s25, 124928
  s_add_u32 s26, s32, 102656
  buffer_load_dwordx4 v21, s[8:11], s26 offen  lds
  s_add_u32 m0, s25, 125952
  s_add_u32 s26, s32, 102784
  buffer_load_dwordx4 v21, s[8:11], s26 offen  lds
  s_add_u32 m0, s25, 126976
  s_add_u32 s26, s32, 102912
  buffer_load_dwordx4 v21, s[8:11], s26 offen  lds
  v_add_u32 v32, 0, v22
  v_add_u32 v33, 0, v23
  v_add_u32 v34, 0, v24
  v_add_u32 v35, 0, v25
  v_add_u32 v36, 0, v26
  v_add_u32 v37, 0, v27
  v_add_u32 v38, 0, v28
  v_add_u32 v39, 0, v29
  v_add_u32 v40, 0, v30
  v_add_u32 v41, 0, v31
  ds_read_b64_tr_b16 a[0:1], v32 offset:0
  ds_read_b64_tr_b16 a[24:25], v33 offset:0
  ds_read_b64_tr_b16 a[48:49], v34 offset:0
  ds_read_b64_tr_b16 a[72:73], v35 offset:0
  ds_read_b64_tr_b16 a[96:97], v36 offset:0
  ds_read_b64_tr_b16 a[120:121], v37 offset:0
  ds_read_b64_tr_b16 a[144:145], v38 offset:0
  ds_read_b64_tr_b16 a[168:169], v39 offset:0
  ds_read_b64_tr_b16 a[192:193], v40 offset:0
  ds_read_b64_tr_b16 a[216:217], v41 offset:0
  s_waitcnt lgkmcnt(0)
  s_waitcnt vmcnt(20)
  s_barrier
  s_add_u32 m0, s25, 0
  s_add_u32 s26, s32, 122880
  buffer_load_dwordx4 v21, s[8:11], s26 offen  lds
  s_add_u32 m0, s25, 1024
  s_add_u32 s26, s32, 123008
  buffer_load_dwordx4 v21, s[8:11], s26 offen  lds
  s_add_u32 m0, s25, 2048
  s_add_u32 s26, s32, 123136
  buffer_load_dwordx4 v21, s[8:11], s26 offen  lds
  s_add_u32 m0, s25, 3072
  s_add_u32 s26, s32, 123264
  buffer_load_dwordx4 v21, s[8:11], s26 offen  lds
  s_add_u32 m0, s25, 4096
  s_add_u32 s26, s32, 123392
  buffer_load_dwordx4 v21, s[8:11], s26 offen  lds
  v_add_u32 v32, 24576, v22
  v_add_u32 v33, 24576, v23
  v_add_u32 v34, 24576, v24
  v_add_u32 v35, 24576, v25
  v_add_u32 v36, 24576, v26
  v_add_u32 v37, 24576, v27
  v_add_u32 v38, 24576, v28
  v_add_u32 v39, 24576, v29
  v_add_u32 v40, 24576, v30
  v_add_u32 v41, 24576, v31
  ds_read_b64_tr_b16 a[2:3], v32 offset:0
  ds_read_b64_tr_b16 a[26:27], v33 offset:0
  ds_read_b64_tr_b16 a[50:51], v34 offset:0
  ds_read_b64_tr_b16 a[74:75], v35 offset:0
  ds_read_b64_tr_b16 a[98:99], v36 offset:0
  ds_read_b64_tr_b16 a[122:123], v37 offset:0
  ds_read_b64_tr_b16 a[146:147], v38 offset:0
  ds_read_b64_tr_b16 a[170:171], v39 offset:0
  ds_read_b64_tr_b16 a[194:195], v40 offset:0
  ds_read_b64_tr_b16 a[218:219], v41 offset:0
  s_waitcnt lgkmcnt(0)
  s_waitcnt vmcnt(20)
  s_barrier
  s_add_u32 m0, s25, 24576
  s_add_u32 s26, s32, 143360
  buffer_load_dwordx4 v21, s[8:11], s26 offen  lds
  s_add_u32 m0, s25, 25600
  s_add_u32 s26, s32, 143488
  buffer_load_dwordx4 v21, s[8:11], s26 offen  lds
  s_add_u32 m0, s25, 26624
  s_add_u32 s26, s32, 143616
  buffer_load_dwordx4 v21, s[8:11], s26 offen  lds
  s_add_u32 m0, s25, 27648
  s_add_u32 s26, s32, 143744
  buffer_load_dwordx4 v21, s[8:11], s26 offen  lds
  s_add_u32 m0, s25, 28672
  s_add_u32 s26, s32, 143872
  buffer_load_dwordx4 v21, s[8:11], s26 offen  lds
  v_add_u32 v32, 49152, v22
  v_add_u32 v33, 49152, v23
  v_add_u32 v34, 49152, v24
  v_add_u32 v35, 49152, v25
  v_add_u32 v36, 49152, v26
  v_add_u32 v37, 49152, v27
  v_add_u32 v38, 49152, v28
  v_add_u32 v39, 49152, v29
  v_add_u32 v40, 49152, v30
  v_add_u32 v41, 49152, v31
  ds_read_b64_tr_b16 a[4:5], v32 offset:0
  ds_read_b64_tr_b16 a[28:29], v33 offset:0
  ds_read_b64_tr_b16 a[52:53], v34 offset:0
  ds_read_b64_tr_b16 a[76:77], v35 offset:0
  ds_read_b64_tr_b16 a[100:101], v36 offset:0
  ds_read_b64_tr_b16 a[124:125], v37 offset:0
  ds_read_b64_tr_b16 a[148:149], v38 offset:0
  ds_read_b64_tr_b16 a[172:173], v39 offset:0
  ds_read_b64_tr_b16 a[196:197], v40 offset:0
  ds_read_b64_tr_b16 a[220:221], v41 offset:0
  s_waitcnt lgkmcnt(0)
  s_waitcnt vmcnt(20)
  s_barrier
  s_add_u32 m0, s25, 49152
  s_add_u32 s26, s32, 163840
  buffer_load_dwordx4 v21, s[8:11], s26 offen  lds
  s_add_u32 m0, s25, 50176
  s_add_u32 s26, s32, 163968
  buffer_load_dwordx4 v21, s[8:11], s26 offen  lds
  s_add_u32 m0, s25, 51200
  s_add_u32 s26, s32, 164096
  buffer_load_dwordx4 v21, s[8:11], s26 offen  lds
  s_add_u32 m0, s25, 52224
  s_add_u32 s26, s32, 164224
  buffer_load_dwordx4 v21, s[8:11], s26 offen  lds
  s_add_u32 m0, s25, 53248
  s_add_u32 s26, s32, 164352
  buffer_load_dwordx4 v21, s[8:11], s26 offen  lds
  v_add_u32 v32, 73728, v22
  v_add_u32 v33, 73728, v23
  v_add_u32 v34, 73728, v24
  v_add_u32 v35, 73728, v25
  v_add_u32 v36, 73728, v26
  v_add_u32 v37, 73728, v27
  v_add_u32 v38, 73728, v28
  v_add_u32 v39, 73728, v29
  v_add_u32 v40, 73728, v30
  v_add_u32 v41, 73728, v31
  ds_read_b64_tr_b16 a[6:7], v32 offset:0
  ds_read_b64_tr_b16 a[30:31], v33 offset:0
  ds_read_b64_tr_b16 a[54:55], v34 offset:0
  ds_read_b64_tr_b16 a[78:79], v35 offset:0
  ds_read_b64_tr_b16 a[102:103], v36 offset:0
  ds_read_b64_tr_b16 a[126:127], v37 offset:0
  ds_read_b64_tr_b16 a[150:151], v38 offset:0
  ds_read_b64_tr_b16 a[174:175], v39 offset:0
  ds_read_b64_tr_b16 a[198:199], v40 offset:0
  ds_read_b64_tr_b16 a[222:223], v41 offset:0
  s_waitcnt lgkmcnt(0)
  s_waitcnt vmcnt(20)
  s_barrier
  s_add_u32 m0, s25, 73728
  s_add_u32 s26, s32, 184320
  buffer_load_dwordx4 v21, s[8:11], s26 offen  lds
  s_add_u32 m0, s25, 74752
  s_add_u32 s26, s32, 184448
  buffer_load_dwordx4 v21, s[8:11], s26 offen  lds
  s_add_u32 m0, s25, 75776
  s_add_u32 s26, s32, 184576
  buffer_load_dwordx4 v21, s[8:11], s26 offen  lds
  s_add_u32 m0, s25, 76800
  s_add_u32 s26, s32, 184704
  buffer_load_dwordx4 v21, s[8:11], s26 offen  lds
  s_add_u32 m0, s25, 77824
  s_add_u32 s26, s32, 184832
  buffer_load_dwordx4 v21, s[8:11], s26 offen  lds
  v_add_u32 v32, 98304, v22
  v_add_u32 v33, 98304, v23
  v_add_u32 v34, 98304, v24
  v_add_u32 v35, 98304, v25
  v_add_u32 v36, 98304, v26
  v_add_u32 v37, 98304, v27
  v_add_u32 v38, 98304, v28
  v_add_u32 v39, 98304, v29
  v_add_u32 v40, 98304, v30
  v_add_u32 v41, 98304, v31
  ds_read_b64_tr_b16 a[8:9], v32 offset:0
  ds_read_b64_tr_b16 a[32:33], v33 offset:0
  ds_read_b64_tr_b16 a[56:57], v34 offset:0
  ds_read_b64_tr_b16 a[80:81], v35 offset:0
  ds_read_b64_tr_b16 a[104:105], v36 offset:0
  ds_read_b64_tr_b16 a[128:129], v37 offset:0
  ds_read_b64_tr_b16 a[152:153], v38 offset:0
  ds_read_b64_tr_b16 a[176:177], v39 offset:0
  ds_read_b64_tr_b16 a[200:201], v40 offset:0
  ds_read_b64_tr_b16 a[224:225], v41 offset:0
  s_waitcnt lgkmcnt(0)
  s_waitcnt vmcnt(20)
  s_barrier
  s_add_u32 m0, s25, 98304
  s_add_u32 s26, s32, 204800
  buffer_load_dwordx4 v21, s[8:11], s26 offen  lds
  s_add_u32 m0, s25, 99328
  s_add_u32 s26, s32, 204928
  buffer_load_dwordx4 v21, s[8:11], s26 offen  lds
  s_add_u32 m0, s25, 100352
  s_add_u32 s26, s32, 205056
  buffer_load_dwordx4 v21, s[8:11], s26 offen  lds
  s_add_u32 m0, s25, 101376
  s_add_u32 s26, s32, 205184
  buffer_load_dwordx4 v21, s[8:11], s26 offen  lds
  s_add_u32 m0, s25, 102400
  s_add_u32 s26, s32, 205312
  buffer_load_dwordx4 v21, s[8:11], s26 offen  lds
  v_add_u32 v32, 122880, v22
  v_add_u32 v33, 122880, v23
  v_add_u32 v34, 122880, v24
  v_add_u32 v35, 122880, v25
  v_add_u32 v36, 122880, v26
  v_add_u32 v37, 122880, v27
  v_add_u32 v38, 122880, v28
  v_add_u32 v39, 122880, v29
  v_add_u32 v40, 122880, v30
  v_add_u32 v41, 122880, v31
  ds_read_b64_tr_b16 a[10:11], v32 offset:0
  ds_read_b64_tr_b16 a[34:35], v33 offset:0
  ds_read_b64_tr_b16 a[58:59], v34 offset:0
  ds_read_b64_tr_b16 a[82:83], v35 offset:0
  ds_read_b64_tr_b16 a[106:107], v36 offset:0
  ds_read_b64_tr_b16 a[130:131], v37 offset:0
  ds_read_b64_tr_b16 a[154:155], v38 offset:0
  ds_read_b64_tr_b16 a[178:179], v39 offset:0
  ds_read_b64_tr_b16 a[202:203], v40 offset:0
  ds_read_b64_tr_b16 a[226:227], v41 offset:0
  s_waitcnt lgkmcnt(0)
  s_waitcnt vmcnt(20)
  s_barrier
  s_add_u32 m0, s25, 122880
  s_add_u32 s26, s32, 225280
  buffer_load_dwordx4 v21, s[8:11], s26 offen  lds
  s_add_u32 m0, s25, 123904
  s_add_u32 s26, s32, 225408
  buffer_load_dwordx4 v21, s[8:11], s26 offen  lds
  s_add_u32 m0, s25, 124928
  s_add_u32 s26, s32, 225536
  buffer_load_dwordx4 v21, s[8:11], s26 offen  lds
  s_add_u32 m0, s25, 125952
  s_add_u32 s26, s32, 225664
  buffer_load_dwordx4 v21, s[8:11], s26 offen  lds
  s_add_u32 m0, s25, 126976
  s_add_u32 s26, s32, 225792
  buffer_load_dwordx4 v21, s[8:11], s26 offen  lds
  v_add_u32 v32, 0, v22
  v_add_u32 v33, 0, v23
  v_add_u32 v34, 0, v24
  v_add_u32 v35, 0, v25
  v_add_u32 v36, 0, v26
  v_add_u32 v37, 0, v27
  v_add_u32 v38, 0, v28
  v_add_u32 v39, 0, v29
  v_add_u32 v40, 0, v30
  v_add_u32 v41, 0, v31
  ds_read_b64_tr_b16 a[12:13], v32 offset:0
  ds_read_b64_tr_b16 a[36:37], v33 offset:0
  ds_read_b64_tr_b16 a[60:61], v34 offset:0
  ds_read_b64_tr_b16 a[84:85], v35 offset:0
  ds_read_b64_tr_b16 a[108:109], v36 offset:0
  ds_read_b64_tr_b16 a[132:133], v37 offset:0
  ds_read_b64_tr_b16 a[156:157], v38 offset:0
  ds_read_b64_tr_b16 a[180:181], v39 offset:0
  ds_read_b64_tr_b16 a[204:205], v40 offset:0
  ds_read_b64_tr_b16 a[228:229], v41 offset:0
  s_waitcnt lgkmcnt(0)
  s_waitcnt vmcnt(20)
  s_barrier
  v_add_u32 v32, 24576, v22
  v_add_u32 v33, 24576, v23
  v_add_u32 v34, 24576, v24
  v_add_u32 v35, 24576, v25
  v_add_u32 v36, 24576, v26
  v_add_u32 v37, 24576, v27
  v_add_u32 v38, 24576, v28
  v_add_u32 v39, 24576, v29
  v_add_u32 v40, 24576, v30
  v_add_u32 v41, 24576, v31
  ds_read_b64_tr_b16 a[14:15], v32 offset:0
  ds_read_b64_tr_b16 a[38:39], v33 offset:0
  ds_read_b64_tr_b16 a[62:63], v34 offset:0
  ds_read_b64_tr_b16 a[86:87], v35 offset:0
  ds_read_b64_tr_b16 a[110:111], v36 offset:0
  ds_read_b64_tr_b16 a[134:135], v37 offset:0
  ds_read_b64_tr_b16 a[158:159], v38 offset:0
  ds_read_b64_tr_b16 a[182:183], v39 offset:0
  ds_read_b64_tr_b16 a[206:207], v40 offset:0
  ds_read_b64_tr_b16 a[230:231], v41 offset:0
  s_waitcnt lgkmcnt(0)
  s_waitcnt vmcnt(15)
  s_barrier
  v_add_u32 v32, 49152, v22
  v_add_u32 v33, 49152, v23
  v_add_u32 v34, 49152, v24
  v_add_u32 v35, 49152, v25
  v_add_u32 v36, 49152, v26
  v_add_u32 v37, 49152, v27
  v_add_u32 v38, 49152, v28
  v_add_u32 v39, 49152, v29
  v_add_u32 v40, 49152, v30
  v_add_u32 v41, 49152, v31
  ds_read_b64_tr_b16 a[16:17], v32 offset:0
  ds_read_b64_tr_b16 a[40:41], v33 offset:0
  ds_read_b64_tr_b16 a[64:65], v34 offset:0
  ds_read_b64_tr_b16 a[88:89], v35 offset:0
  ds_read_b64_tr_b16 a[112:113], v36 offset:0
  ds_read_b64_tr_b16 a[136:137], v37 offset:0
  ds_read_b64_tr_b16 a[160:161], v38 offset:0
  ds_read_b64_tr_b16 a[184:185], v39 offset:0
  ds_read_b64_tr_b16 a[208:209], v40 offset:0
  ds_read_b64_tr_b16 a[232:233], v41 offset:0
  s_waitcnt lgkmcnt(0)
  s_waitcnt vmcnt(10)
  s_barrier
  v_add_u32 v32, 73728, v22
  v_add_u32 v33, 73728, v23
  v_add_u32 v34, 73728, v24
  v_add_u32 v35, 73728, v25
  v_add_u32 v36, 73728, v26
  v_add_u32 v37, 73728, v27
  v_add_u32 v38, 73728, v28
  v_add_u32 v39, 73728, v29
  v_add_u32 v40, 73728, v30
  v_add_u32 v41, 73728, v31
  ds_read_b64_tr_b16 a[18:19], v32 offset:0
  ds_read_b64_tr_b16 a[42:43], v33 offset:0
  ds_read_b64_tr_b16 a[66:67], v34 offset:0
  ds_read_b64_tr_b16 a[90:91], v35 offset:0
  ds_read_b64_tr_b16 a[114:115], v36 offset:0
  ds_read_b64_tr_b16 a[138:139], v37 offset:0
  ds_read_b64_tr_b16 a[162:163], v38 offset:0
  ds_read_b64_tr_b16 a[186:187], v39 offset:0
  ds_read_b64_tr_b16 a[210:211], v40 offset:0
  ds_read_b64_tr_b16 a[234:235], v41 offset:0
  s_waitcnt lgkmcnt(0)
  s_waitcnt vmcnt(5)
  s_barrier
  buffer_load_dword v48, off, s[96:99], 0 offset:128 sc1
  buffer_load_dword v49, off, s[96:99], s94 sc1
  v_add_u32 v32, 98304, v22
  v_add_u32 v33, 98304, v23
  v_add_u32 v34, 98304, v24
  v_add_u32 v35, 98304, v25
  v_add_u32 v36, 98304, v26
  v_add_u32 v37, 98304, v27
  v_add_u32 v38, 98304, v28
  v_add_u32 v39, 98304, v29
  v_add_u32 v40, 98304, v30
  v_add_u32 v41, 98304, v31
  ds_read_b64_tr_b16 a[20:21], v32 offset:0
  ds_read_b64_tr_b16 a[44:45], v33 offset:0
  ds_read_b64_tr_b16 a[68:69], v34 offset:0
  ds_read_b64_tr_b16 a[92:93], v35 offset:0
  ds_read_b64_tr_b16 a[116:117], v36 offset:0
  ds_read_b64_tr_b16 a[140:141], v37 offset:0
  ds_read_b64_tr_b16 a[164:165], v38 offset:0
  ds_read_b64_tr_b16 a[188:189], v39 offset:0
  ds_read_b64_tr_b16 a[212:213], v40 offset:0
  ds_read_b64_tr_b16 a[236:237], v41 offset:0
  s_waitcnt lgkmcnt(0)
  s_waitcnt vmcnt(2)
  s_barrier
  v_add_u32 v32, 122880, v22
  v_add_u32 v33, 122880, v23
  v_add_u32 v34, 122880, v24
  v_add_u32 v35, 122880, v25
  v_add_u32 v36, 122880, v26
  v_add_u32 v37, 122880, v27
  v_add_u32 v38, 122880, v28
  v_add_u32 v39, 122880, v29
  v_add_u32 v40, 122880, v30
  v_add_u32 v41, 122880, v31
  ds_read_b64_tr_b16 a[22:23], v32 offset:0
  ds_read_b64_tr_b16 a[46:47], v33 offset:0
  ds_read_b64_tr_b16 a[70:71], v34 offset:0
  ds_read_b64_tr_b16 a[94:95], v35 offset:0
  ds_read_b64_tr_b16 a[118:119], v36 offset:0
  ds_read_b64_tr_b16 a[142:143], v37 offset:0
  ds_read_b64_tr_b16 a[166:167], v38 offset:0
  ds_read_b64_tr_b16 a[190:191], v39 offset:0
  ds_read_b64_tr_b16 a[214:215], v40 offset:0
  ds_read_b64_tr_b16 a[238:239], v41 offset:0
  s_waitcnt lgkmcnt(0)
  s_waitcnt vmcnt(0)
  s_barrier
  v_mov_b32 v50, 163824
  s_cmp_lg_u32 s17, 0
  s_cbranch_scc1 L_wh2_b
  s_branch L_wh2_t
L_wh2:
  s_sleep 3
L_wh2_in:
  buffer_load_dword v48, off, s[96:99], 0 offset:128 sc1
  buffer_load_dword v49, off, s[96:99], s94 sc1
  s_add_u32 s39, s39, 1
  s_cmp_gt_u32 s39, 200000
  s_cbranch_scc1 L_exit
  s_waitcnt vmcnt(0)
L_wh2_t:
  v_readfirstlane_b32 s19, v48
  v_readfirstlane_b32 s74, v49
  s_nop 0
  s_and_b32 s22, s19, 255
  s_cmp_lt_u32 s22, 64
  s_cbranch_scc1 L_wh2
  s_and_b32 s22, s74, 255
  s_cmp_lt_u32 s22, 26
  s_cbranch_scc1 L_wh2
  ds_write_b64 v50, v[48:49]
  s_waitcnt lgkmcnt(0)
L_wh2_b:
  s_barrier
  ds_read_b64 v[48:49], v50
  s_waitcnt lgkmcnt(0)
  v_readfirstlane_b32 s19, v48
  v_readfirstlane_b32 s74, v49
  s_nop 0
  s_and_b32 s19, s19, 512
  s_lshl_b32 s19, s19, 4
  s_mul_i32 s22, s95, 26
  s_sub_u32 s74, s74, s22
  s_lshl_b32 s34, s18, 8
  s_add_u32 s34, s34, 7438336
  s_add_u32 s34, s34, s19
  s_lshl_b32 s22, s17, 6
  s_add_u32 s34, s34, s22
  s_lshl_b32 s35, s18, 8
  s_add_u32 s35, s35, 7421952
  s_add_u32 s35, s35, s19
  s_xor_b32 s35, s35, 8192
  v_lshlrev_b32 v4, 4, v1
  v_and_b32 v5, 3, v1
  v_lshlrev_b32 v5, 6, v5
  v_mov_b32 v6, 0
  s_mul_i32 s36, s18, 12288
  s_mul_i32 s22, s17, 3072
  s_add_u32 s36, s36, s22
  s_add_u32 s36, s36, 75497472
  s_lshl_b32 s37, s18, 10
  s_mul_i32 s22, s17, 327680
  s_add_u32 s37, s37, s22
  s_add_u32 s37, s37, 100663296
  s_mul_i32 s38, s17, 3072
  s_mov_b32 s28, 0
  s_mov_b32 s29, 12288
  s_mov_b32 s20, 0
  s_mov_b32 s39, 0
  s_mov_b32 s31, 1
  s_branch L_ow_w0_in
L_ow_w0:
  s_sleep 2
L_ow_w0_in:
  buffer_load_dword v9, v5, s[4:7], s35 offen sc1
  s_add_u32 s39, s39, 1
  s_cmp_gt_u32 s39, 200000
  s_cbranch_scc1 L_exit
  s_waitcnt vmcnt(0)
  v_cmp_gt_u32 vcc, s31, v9
  s_cbranch_vccnz L_ow_w0
  s_mov_b32 s31, 0
  s_mov_b32 s30, 0
  s_min_u32 s23, s31, 63
  s_mul_i32 s23, s23, 393216
  s_add_u32 s23, s23, s36
  s_add_u32 m0, s38, s30
  s_nop 0
  buffer_load_dwordx4 v4, s[4:7], s23 offen offset:0 sc1 lds
  buffer_load_dwordx4 v4, s[4:7], s23 offen offset:1024 sc1 lds
  buffer_load_dwordx4 v4, s[4:7], s23 offen offset:2048 sc1 lds
  s_waitcnt vmcnt(0)
  s_barrier
  v_add_u32 v140, 0, v4
  v_add_u32 v141, 2048, v4
  v_add_u32 v142, 4096, v4
  v_add_u32 v143, 6144, v4
  v_add_u32 v144, 8192, v4
  v_add_u32 v145, 10240, v4
  ds_read2_b64 v[16:19], v140 offset0:0 offset1:128
  ds_read2_b64 v[20:23], v140 offset0:1 offset1:129
  ds_read2_b64 v[24:27], v141 offset0:0 offset1:128
  ds_read2_b64 v[28:31], v141 offset0:1 offset1:129
  ds_read2_b64 v[32:35], v142 offset0:0 offset1:128
  ds_read2_b64 v[36:39], v142 offset0:1 offset1:129
  ds_read2_b64 v[40:43], v143 offset0:0 offset1:128
  ds_read2_b64 v[44:47], v143 offset0:1 offset1:129
  ds_read2_b64 v[48:51], v144 offset0:0 offset1:128
  ds_read2_b64 v[52:55], v144 offset0:1 offset1:129
  ds_read2_b64 v[56:59], v145 offset0:0 offset1:128
  ds_read2_b64 v[60:63], v145 offset0:1 offset1:129
  s_mov_b32 s43, s37
  s_mov_b32 s28, 0
  s_waitcnt lgkmcnt(0)
L_ow_e:
  v_mfma_f32_16x16x32_bf16 v[112:115], v[16:19], a[0:3], 0
  v_mfma_f32_16x16x32_bf16 v[116:119], v[20:23], a[0:3], 0
  v_mfma_f32_16x16x32_bf16 v[112:115], v[24:27], a[4:7], v[112:115]
  v_mfma_f32_16x16x32_bf16 v[116:119], v[28:31], a[4:7], v[116:119]
  v_mfma_f32_16x16x32_bf16 v[112:115], v[32:35], a[8:11], v[112:115]
  v_mfma_f32_16x16x32_bf16 v[116:119], v[36:39], a[8:11], v[116:119]
  v_mfma_f32_16x16x32_bf16 v[112:115], v[40:43], a[12:15], v[112:115]
  v_mfma_f32_16x16x32_bf16 v[116:119], v[44:47], a[12:15], v[116:119]
  v_mfma_f32_16x16x32_bf16 v[112:115], v[48:51], a[16:19], v[112:115]
  v_mfma_f32_16x16x32_bf16 v[116:119], v[52:55], a[16:19], v[116:119]
  v_mfma_f32_16x16x32_bf16 v[112:115], v[56:59], a[20:23], v[112:115]
  v_mfma_f32_16x16x32_bf16 v[116:119], v[60:63], a[20:23], v[116:119]
  v_mfma_f32_16x16x32_bf16 v[120:123], v[16:19], a[24:27], 0
  v_mfma_f32_16x16x32_bf16 v[124:127], v[20:23], a[24:27], 0
  v_mfma_f32_16x16x32_bf16 v[120:123], v[24:27], a[28:31], v[120:123]
  v_cvt_pk_bf16_f32 v128, v112, v113
  v_mfma_f32_16x16x32_bf16 v[124:127], v[28:31], a[28:31], v[124:127]
  v_cvt_pk_bf16_f32 v129, v116, v117
  v_mfma_f32_16x16x32_bf16 v[120:123], v[32:35], a[32:35], v[120:123]
  v_cvt_pk_bf16_f32 v130, v114, v115
  v_mfma_f32_16x16x32_bf16 v[124:127], v[36:39], a[32:35], v[124:127]
  v_cvt_pk_bf16_f32 v131, v118, v119
  v_mfma_f32_16x16x32_bf16 v[120:123], v[40:43], a[36:39], v[120:123]
  buffer_store_dwordx4 v[128:131], v4, s[4:7], s43 offen sc1
  v_mfma_f32_16x16x32_bf16 v[124:127], v[44:47], a[36:39], v[124:127]
  s_add_u32 s43, s43, 32768
  v_mfma_f32_16x16x32_bf16 v[120:123], v[48:51], a[40:43], v[120:123]
  v_mfma_f32_16x16x32_bf16 v[124:127], v[52:55], a[40:43], v[124:127]
  v_mfma_f32_16x16x32_bf16 v[120:123], v[56:59], a[44:47], v[120:123]
  v_mfma_f32_16x16x32_bf16 v[124:127], v[60:63], a[44:47], v[124:127]
  v_mfma_f32_16x16x32_bf16 v[112:115], v[16:19], a[48:51], 0
  v_mfma_f32_16x16x32_bf16 v[116:119], v[20:23], a[48:51], 0
  v_mfma_f32_16x16x32_bf16 v[112:115], v[24:27], a[52:55], v[112:115]
  v_cvt_pk_bf16_f32 v132, v120, v121
  v_mfma_f32_16x16x32_bf16 v[116:119], v[28:31], a[52:55], v[116:119]
  v_cvt_pk_bf16_f32 v133, v124, v125
  v_mfma_f32_16x16x32_bf16 v[112:115], v[32:35], a[56:59], v[112:115]
  v_cvt_pk_bf16_f32 v134, v122, v123
  v_mfma_f32_16x16x32_bf16 v[116:119], v[36:39], a[56:59], v[116:119]
  v_cvt_pk_bf16_f32 v135, v126, v127
  v_mfma_f32_16x16x32_bf16 v[112:115], v[40:43], a[60:63], v[112:115]
  buffer_store_dwordx4 v[132:135], v4, s[4:7], s43 offen sc1
  v_mfma_f32_16x16x32_bf16 v[116:119], v[44:47], a[60:63], v[116:119]
  s_add_u32 s43, s43, 32768
  v_mfma_f32_16x16x32_bf16 v[112:115], v[48:51], a[64:67], v[112:115]
  v_mfma_f32_16x16x32_bf16 v[116:119], v[52:55], a[64:67], v[116:119]
  v_mfma_f32_16x16x32_bf16 v[112:115], v[56:59], a[68:71], v[112:115]
  v_mfma_f32_16x16x32_bf16 v[116:119], v[60:63], a[68:71], v[116:119]
  v_mfma_f32_16x16x32_bf16 v[120:123], v[16:19], a[72:75], 0
  v_mfma_f32_16x16x32_bf16 v[124:127], v[20:23], a[72:75], 0
  v_mfma_f32_16x16x32_bf16 v[120:123], v[24:27], a[76:79], v[120:123]
  v_cvt_pk_bf16_f32 v128, v112, v113
  v_mfma_f32_16x16x32_bf16 v[124:127], v[28:31], a[76:79], v[124:127]
  v_cvt_pk_bf16_f32 v129, v116, v117
  v_mfma_f32_16x16x32_bf16 v[120:123], v[32:35], a[80:83], v[120:123]
  v_cvt_pk_bf16_f32 v130, v114, v115
  v_mfma_f32_16x16x32_bf16 v[124:127], v[36:39], a[80:83], v[124:127]
  v_cvt_pk_bf16_f32 v131, v118, v119
  v_mfma_f32_16x16x32_bf16 v[120:123], v[40:43], a[84:87], v[120:123]
  buffer_store_dwordx4 v[128:131], v4, s[4:7], s43 offen sc1
  v_mfma_f32_16x16x32_bf16 v[124:127], v[44:47], a[84:87], v[124:127]
  s_add_u32 s43, s43, 32768
  v_mfma_f32_16x16x32_bf16 v[120:123], v[48:51], a[88:91], v[120:123]
  v_mfma_f32_16x16x32_bf16 v[124:127], v[52:55], a[88:91], v[124:127]
  v_mfma_f32_16x16x32_bf16 v[120:123], v[56:59], a[92:95], v[120:123]
  v_mfma_f32_16x16x32_bf16 v[124:127], v[60:63], a[92:95], v[124:127]
  v_mfma_f32_16x16x32_bf16 v[112:115], v[16:19], a[96:99], 0
  v_mfma_f32_16x16x32_bf16 v[116:119], v[20:23], a[96:99], 0
  v_mfma_f32_16x16x32_bf16 v[112:115], v[24:27], a[100:103], v[112:115]
  v_cvt_pk_bf16_f32 v132, v120, v121
  v_mfma_f32_16x16x32_bf16 v[116:119], v[28:31], a[100:103], v[116:119]
  v_cvt_pk_bf16_f32 v133, v124, v125
  v_mfma_f32_16x16x32_bf16 v[112:115], v[32:35], a[104:107], v[112:115]
  v_cvt_pk_bf16_f32 v134, v122, v123
  v_mfma_f32_16x16x32_bf16 v[116:119], v[36:39], a[104:107], v[116:119]
  v_cvt_pk_bf16_f32 v135, v126, v127
  v_mfma_f32_16x16x32_bf16 v[112:115], v[40:43], a[108:111], v[112:115]
  buffer_store_dwordx4 v[132:135], v4, s[4:7], s43 offen sc1
  v_mfma_f32_16x16x32_bf16 v[116:119], v[44:47], a[108:111], v[116:119]
  s_add_u32 s43, s43, 32768
  v_mfma_f32_16x16x32_bf16 v[112:115], v[48:51], a[112:115], v[112:115]
  v_mfma_f32_16x16x32_bf16 v[116:119], v[52:55], a[112:115], v[116:119]
  v_mfma_f32_16x16x32_bf16 v[112:115], v[56:59], a[116:119], v[112:115]
  v_mfma_f32_16x16x32_bf16 v[116:119], v[60:63], a[116:119], v[116:119]
  v_mfma_f32_16x16x32_bf16 v[120:123], v[16:19], a[120:123], 0
  v_mfma_f32_16x16x32_bf16 v[124:127], v[20:23], a[120:123], 0
  v_mfma_f32_16x16x32_bf16 v[120:123], v[24:27], a[124:127], v[120:123]
  v_cvt_pk_bf16_f32 v128, v112, v113
  v_mfma_f32_16x16x32_bf16 v[124:127], v[28:31], a[124:127], v[124:127]
  v_cvt_pk_bf16_f32 v129, v116, v117
  v_mfma_f32_16x16x32_bf16 v[120:123], v[32:35], a[128:131], v[120:123]
  v_cvt_pk_bf16_f32 v130, v114, v115
  v_mfma_f32_16x16x32_bf16 v[124:127], v[36:39], a[128:131], v[124:127]
  v_cvt_pk_bf16_f32 v131, v118, v119
  v_mfma_f32_16x16x32_bf16 v[120:123], v[40:43], a[132:135], v[120:123]
  buffer_store_dwordx4 v[128:131], v4, s[4:7], s43 offen sc1
  v_mfma_f32_16x16x32_bf16 v[124:127], v[44:47], a[132:135], v[124:127]
  s_add_u32 s43, s43, 32768
  v_mfma_f32_16x16x32_bf16 v[120:123], v[48:51], a[136:139], v[120:123]
  v_mfma_f32_16x16x32_bf16 v[124:127], v[52:55], a[136:139], v[124:127]
  v_mfma_f32_16x16x32_bf16 v[120:123], v[56:59], a[140:143], v[120:123]
  v_mfma_f32_16x16x32_bf16 v[124:127], v[60:63], a[140:143], v[124:127]
  buffer_load_dword v9, v5, s[4:7], s35 offen sc1
  v_mfma_f32_16x16x32_bf16 v[112:115], v[16:19], a[144:147], 0
  v_mfma_f32_16x16x32_bf16 v[116:119], v[20:23], a[144:147], 0
  v_mfma_f32_16x16x32_bf16 v[112:115], v[24:27], a[148:151], v[112:115]
  v_cvt_pk_bf16_f32 v132, v120, v121
  v_mfma_f32_16x16x32_bf16 v[116:119], v[28:31], a[148:151], v[116:119]
  v_cvt_pk_bf16_f32 v133, v124, v125
  v_mfma_f32_16x16x32_bf16 v[112:115], v[32:35], a[152:155], v[112:115]
  v_cvt_pk_bf16_f32 v134, v122, v123
  v_mfma_f32_16x16x32_bf16 v[116:119], v[36:39], a[152:155], v[116:119]
  v_cvt_pk_bf16_f32 v135, v126, v127
  v_mfma_f32_16x16x32_bf16 v[112:115], v[40:43], a[156:159], v[112:115]
  buffer_store_dwordx4 v[132:135], v4, s[4:7], s43 offen sc1
  v_mfma_f32_16x16x32_bf16 v[116:119], v[44:47], a[156:159], v[116:119]
  s_add_u32 s43, s43, 32768
  v_mfma_f32_16x16x32_bf16 v[112:115], v[48:51], a[160:163], v[112:115]
  v_mfma_f32_16x16x32_bf16 v[116:119], v[52:55], a[160:163], v[116:119]
  v_mfma_f32_16x16x32_bf16 v[112:115], v[56:59], a[164:167], v[112:115]
  v_mfma_f32_16x16x32_bf16 v[116:119], v[60:63], a[164:167], v[116:119]
  v_mfma_f32_16x16x32_bf16 v[120:123], v[16:19], a[168:171], 0
  v_mfma_f32_16x16x32_bf16 v[124:127], v[20:23], a[168:171], 0
  v_mfma_f32_16x16x32_bf16 v[120:123], v[24:27], a[172:175], v[120:123]
  v_cvt_pk_bf16_f32 v128, v112, v113
  v_mfma_f32_16x16x32_bf16 v[124:127], v[28:31], a[172:175], v[124:127]
  v_cvt_pk_bf16_f32 v129, v116, v117
  v_mfma_f32_16x16x32_bf16 v[120:123], v[32:35], a[176:179], v[120:123]
  v_cvt_pk_bf16_f32 v130, v114, v115
  v_mfma_f32_16x16x32_bf16 v[124:127], v[36:39], a[176:179], v[124:127]
  v_cvt_pk_bf16_f32 v131, v118, v119
  v_mfma_f32_16x16x32_bf16 v[120:123], v[40:43], a[180:183], v[120:123]
  buffer_store_dwordx4 v[128:131], v4, s[4:7], s43 offen sc1
  v_mfma_f32_16x16x32_bf16 v[124:127], v[44:47], a[180:183], v[124:127]
  s_add_u32 s43, s43, 32768
  v_mfma_f32_16x16x32_bf16 v[120:123], v[48:51], a[184:187], v[120:123]
  v_mfma_f32_16x16x32_bf16 v[124:127], v[52:55], a[184:187], v[124:127]
  v_mfma_f32_16x16x32_bf16 v[120:123], v[56:59], a[188:191], v[120:123]
  v_mfma_f32_16x16x32_bf16 v[124:127], v[60:63], a[188:191], v[124:127]
  v_mfma_f32_16x16x32_bf16 v[112:115], v[16:19], a[192:195], 0
  v_mfma_f32_16x16x32_bf16 v[116:119], v[20:23], a[192:195], 0
  v_mfma_f32_16x16x32_bf16 v[112:115], v[24:27], a[196:199], v[112:115]
  v_cvt_pk_bf16_f32 v132, v120, v121
  v_mfma_f32_16x16x32_bf16 v[116:119], v[28:31], a[196:199], v[116:119]
  v_cvt_pk_bf16_f32 v133, v124, v125
  v_mfma_f32_16x16x32_bf16 v[112:115], v[32:35], a[200:203], v[112:115]
  v_cvt_pk_bf16_f32 v134, v122, v123
  v_mfma_f32_16x16x32_bf16 v[116:119], v[36:39], a[200:203], v[116:119]
  v_cvt_pk_bf16_f32 v135, v126, v127
  v_mfma_f32_16x16x32_bf16 v[112:115], v[40:43], a[204:207], v[112:115]
  buffer_store_dwordx4 v[132:135], v4, s[4:7], s43 offen sc1
  v_mfma_f32_16x16x32_bf16 v[116:119], v[44:47], a[204:207], v[116:119]
  s_add_u32 s43, s43, 32768
  v_mfma_f32_16x16x32_bf16 v[112:115], v[48:51], a[208:211], v[112:115]
  v_mfma_f32_16x16x32_bf16 v[116:119], v[52:55], a[208:211], v[116:119]
  v_mfma_f32_16x16x32_bf16 v[112:115], v[56:59], a[212:215], v[112:115]
  v_mfma_f32_16x16x32_bf16 v[116:119], v[60:63], a[212:215], v[116:119]
  v_mfma_f32_16x16x32_bf16 v[120:123], v[16:19], a[216:219], 0
  v_mfma_f32_16x16x32_bf16 v[124:127], v[20:23], a[216:219], 0
  v_mfma_f32_16x16x32_bf16 v[120:123], v[24:27], a[220:223], v[120:123]
  v_cvt_pk_bf16_f32 v128, v112, v113
  v_mfma_f32_16x16x32_bf16 v[124:127], v[28:31], a[220:223], v[124:127]
  v_cvt_pk_bf16_f32 v129, v116, v117
  v_mfma_f32_16x16x32_bf16 v[120:123], v[32:35], a[224:227], v[120:123]
  v_cvt_pk_bf16_f32 v130, v114, v115
  v_mfma_f32_16x16x32_bf16 v[124:127], v[36:39], a[224:227], v[124:127]
  v_cvt_pk_bf16_f32 v131, v118, v119
  v_mfma_f32_16x16x32_bf16 v[120:123], v[40:43], a[228:231], v[120:123]
  buffer_store_dwordx4 v[128:131], v4, s[4:7], s43 offen sc1
  v_mfma_f32_16x16x32_bf16 v[124:127], v[44:47], a[228:231], v[124:127]
  s_add_u32 s43, s43, 32768
  v_mfma_f32_16x16x32_bf16 v[120:123], v[48:51], a[232:235], v[120:123]
  v_mfma_f32_16x16x32_bf16 v[124:127], v[52:55], a[232:235], v[124:127]
  v_mfma_f32_16x16x32_bf16 v[120:123], v[56:59], a[236:239], v[120:123]
  v_mfma_f32_16x16x32_bf16 v[124:127], v[60:63], a[236:239], v[124:127]
  s_nop 3
  v_cvt_pk_bf16_f32 v132, v120, v121
  s_nop 2
  v_cvt_pk_bf16_f32 v133, v124, v125
  v_cvt_pk_bf16_f32 v134, v122, v123
  v_cvt_pk_bf16_f32 v135, v126, v127
  buffer_store_dwordx4 v[132:135], v4, s[4:7], s43 offen sc1
  s_add_u32 s43, s43, 32768
  s_add_u32 s43, s43, 983040
  s_add_u32 s20, s20, 1
  v_mov_b32 v8, s20
  s_add_u32 s31, s20, 1
  s_add_u32 s28, s28, 12288
  s_cmp_eq_u32 s28, 36864
  s_cselect_b32 s28, 0, s28
  s_waitcnt vmcnt(5)
  v_cmp_gt_u32 vcc, s31, v9
  s_cbranch_vccnz L_ow_e1
  s_min_u32 s23, s20, 63
  s_mul_i32 s23, s23, 393216
  s_add_u32 s23, s23, s36
  s_add_u32 m0, s38, s28
  s_nop 0
  buffer_load_dwordx4 v4, s[4:7], s23 offen offset:0 sc1 lds
  buffer_load_dwordx4 v4, s[4:7], s23 offen offset:1024 sc1 lds
  buffer_load_dwordx4 v4, s[4:7], s23 offen offset:2048 sc1 lds
  s_waitcnt vmcnt(3)
  s_mov_b64 exec, 1
  buffer_store_dword v8, v6, s[4:7], s34 offen sc1
  s_mov_b64 exec, -1
  s_waitcnt vmcnt(1)
  s_branch L_ow_e2
L_ow_e1:
  s_waitcnt vmcnt(0)
  s_mov_b64 exec, 1
  buffer_store_dword v8, v6, s[4:7], s34 offen sc1
  s_mov_b64 exec, -1
  s_branch L_ow_w1_in
L_ow_w1:
  s_sleep 2
L_ow_w1_in:
  buffer_load_dword v9, v5, s[4:7], s35 offen sc1
  s_add_u32 s39, s39, 1
  s_cmp_gt_u32 s39, 200000
  s_cbranch_scc1 L_exit
  s_waitcnt vmcnt(0)
  v_cmp_gt_u32 vcc, s31, v9
  s_cbranch_vccnz L_ow_w1
  s_min_u32 s23, s20, 63
  s_mul_i32 s23, s23, 393216
  s_add_u32 s23, s23, s36
  s_add_u32 m0, s38, s28
  s_nop 0
  buffer_load_dwordx4 v4, s[4:7], s23 offen offset:0 sc1 lds
  buffer_load_dwordx4 v4, s[4:7], s23 offen offset:1024 sc1 lds
  buffer_load_dwordx4 v4, s[4:7], s23 offen offset:2048 sc1 lds
  s_waitcnt vmcnt(0)
L_ow_e2:
  s_add_u32 s22, s28, 0
  v_add_u32 v140, s22, v4
  s_add_u32 s22, s28, 2048
  v_add_u32 v141, s22, v4
  s_add_u32 s22, s28, 4096
  v_add_u32 v142, s22, v4
  s_add_u32 s22, s28, 6144
  v_add_u32 v143, s22, v4
  s_add_u32 s22, s28, 8192
  v_add_u32 v144, s22, v4
  s_add_u32 s22, s28, 10240
  v_add_u32 v145, s22, v4
  s_barrier
  ds_read2_b64 v[16:19], v140 offset0:0 offset1:128
  ds_read2_b64 v[20:23], v140 offset0:1 offset1:129
  ds_read2_b64 v[24:27], v141 offset0:0 offset1:128
  ds_read2_b64 v[28:31], v141 offset0:1 offset1:129
  ds_read2_b64 v[32:35], v142 offset0:0 offset1:128
  ds_read2_b64 v[36:39], v142 offset0:1 offset1:129
  ds_read2_b64 v[40:43], v143 offset0:0 offset1:128
  ds_read2_b64 v[44:47], v143 offset0:1 offset1:129
  ds_read2_b64 v[48:51], v144 offset0:0 offset1:128
  ds_read2_b64 v[52:55], v144 offset0:1 offset1:129
  ds_read2_b64 v[56:59], v145 offset0:0 offset1:128
  ds_read2_b64 v[60:63], v145 offset0:1 offset1:129
  s_waitcnt lgkmcnt(0)
  s_cmp_lt_u32 s20, 2
  s_cbranch_scc1 L_ow_e
  s_add_u32 s31, s20, 2
  s_branch L_ow_w2_in
L_ow_w2:
  s_sleep 2
L_ow_w2_in:
  buffer_load_dword v9, v5, s[4:7], s35 offen sc1
  s_add_u32 s39, s39, 1
  s_cmp_gt_u32 s39, 200000
  s_cbranch_scc1 L_exit
  s_waitcnt vmcnt(0)
  v_cmp_gt_u32 vcc, s31, v9
  s_cbranch_vccnz L_ow_w2
  s_add_u32 s28, s28, 12288
  s_cmp_eq_u32 s28, 36864
  s_cselect_b32 s28, 0, s28
  s_add_u32 s31, s20, 1
  s_min_u32 s23, s31, 63
  s_mul_i32 s23, s23, 393216
  s_add_u32 s23, s23, s36
  s_add_u32 m0, s38, s28
  s_nop 0
  buffer_load_dwordx4 v4, s[4:7], s23 offen offset:0 sc1 lds
  buffer_load_dwordx4 v4, s[4:7], s23 offen offset:1024 sc1 lds
  buffer_load_dwordx4 v4, s[4:7], s23 offen offset:2048 sc1 lds
  v_mfma_f32_16x16x32_bf16 v[112:115], v[16:19], a[0:3], 0
  v_mfma_f32_16x16x32_bf16 v[116:119], v[20:23], a[0:3], 0
  v_mfma_f32_16x16x32_bf16 v[112:115], v[24:27], a[4:7], v[112:115]
  v_mfma_f32_16x16x32_bf16 v[116:119], v[28:31], a[4:7], v[116:119]
  v_mfma_f32_16x16x32_bf16 v[112:115], v[32:35], a[8:11], v[112:115]
  v_mfma_f32_16x16x32_bf16 v[116:119], v[36:39], a[8:11], v[116:119]
  v_mfma_f32_16x16x32_bf16 v[112:115], v[40:43], a[12:15], v[112:115]
  v_mfma_f32_16x16x32_bf16 v[116:119], v[44:47], a[12:15], v[116:119]
  v_mfma_f32_16x16x32_bf16 v[112:115], v[48:51], a[16:19], v[112:115]
  v_mfma_f32_16x16x32_bf16 v[116:119], v[52:55], a[16:19], v[116:119]
  v_mfma_f32_16x16x32_bf16 v[112:115], v[56:59], a[20:23], v[112:115]
  buffer_load_dword v9, v5, s[4:7], s35 offen sc1
  s_add_u32 s31, s20, 3
  s_min_u32 s31, s31, 64
  v_mfma_f32_16x16x32_bf16 v[116:119], v[60:63], a[20:23], v[116:119]
  v_mfma_f32_16x16x32_bf16 v[120:123], v[16:19], a[24:27], 0
  v_mfma_f32_16x16x32_bf16 v[124:127], v[20:23], a[24:27], 0
  v_mfma_f32_16x16x32_bf16 v[120:123], v[24:27], a[28:31], v[120:123]
  v_cvt_pk_bf16_f32 v128, v112, v113
  v_mfma_f32_16x16x32_bf16 v[124:127], v[28:31], a[28:31], v[124:127]
  v_cvt_pk_bf16_f32 v129, v116, v117
  v_mfma_f32_16x16x32_bf16 v[120:123], v[32:35], a[32:35], v[120:123]
  v_cvt_pk_bf16_f32 v130, v114, v115
  v_mfma_f32_16x16x32_bf16 v[124:127], v[36:39], a[32:35], v[124:127]
  v_cvt_pk_bf16_f32 v131, v118, v119
  v_mfma_f32_16x16x32_bf16 v[120:123], v[40:43], a[36:39], v[120:123]
  v_mfma_f32_16x16x32_bf16 v[124:127], v[44:47], a[36:39], v[124:127]
  buffer_store_dwordx4 v[128:131], v4, s[4:7], s43 offen sc1
  v_mfma_f32_16x16x32_bf16 v[120:123], v[48:51], a[40:43], v[120:123]
  s_add_u32 s43, s43, 32768
  v_mfma_f32_16x16x32_bf16 v[124:127], v[52:55], a[40:43], v[124:127]
  v_mfma_f32_16x16x32_bf16 v[120:123], v[56:59], a[44:47], v[120:123]
  v_mfma_f32_16x16x32_bf16 v[124:127], v[60:63], a[44:47], v[124:127]
  v_mfma_f32_16x16x32_bf16 v[112:115], v[16:19], a[48:51], 0
  v_mfma_f32_16x16x32_bf16 v[116:119], v[20:23], a[48:51], 0
  v_mfma_f32_16x16x32_bf16 v[112:115], v[24:27], a[52:55], v[112:115]
  v_cvt_pk_bf16_f32 v132, v120, v121
  v_mfma_f32_16x16x32_bf16 v[116:119], v[28:31], a[52:55], v[116:119]
  v_cvt_pk_bf16_f32 v133, v124, v125
  v_mfma_f32_16x16x32_bf16 v[112:115], v[32:35], a[56:59], v[112:115]
  v_cvt_pk_bf16_f32 v134, v122, v123
  v_mfma_f32_16x16x32_bf16 v[116:119], v[36:39], a[56:59], v[116:119]
  v_cvt_pk_bf16_f32 v135, v126, v127
  v_mfma_f32_16x16x32_bf16 v[112:115], v[40:43], a[60:63], v[112:115]
  v_mfma_f32_16x16x32_bf16 v[116:119], v[44:47], a[60:63], v[116:119]
  buffer_store_dwordx4 v[132:135], v4, s[4:7], s43 offen sc1
  v_mfma_f32_16x16x32_bf16 v[112:115], v[48:51], a[64:67], v[112:115]
  s_add_u32 s43, s43, 32768
  v_mfma_f32_16x16x32_bf16 v[116:119], v[52:55], a[64:67], v[116:119]
  v_mfma_f32_16x16x32_bf16 v[112:115], v[56:59], a[68:71], v[112:115]
  v_mfma_f32_16x16x32_bf16 v[116:119], v[60:63], a[68:71], v[116:119]
  v_mfma_f32_16x16x32_bf16 v[120:123], v[16:19], a[72:75], 0
  s_add_u32 s46, s28, 0
  v_mfma_f32_16x16x32_bf16 v[124:127], v[20:23], a[72:75], 0
  s_add_u32 s47, s28, 2048
  v_mfma_f32_16x16x32_bf16 v[120:123], v[24:27], a[76:79], v[120:123]
  s_add_u32 s48, s28, 4096
  v_cvt_pk_bf16_f32 v128, v112, v113
  v_mfma_f32_16x16x32_bf16 v[124:127], v[28:31], a[76:79], v[124:127]
  s_add_u32 s49, s28, 6144
  v_cvt_pk_bf16_f32 v129, v116, v117
  v_mfma_f32_16x16x32_bf16 v[120:123], v[32:35], a[80:83], v[120:123]
  s_add_u32 s50, s28, 8192
  v_cvt_pk_bf16_f32 v130, v114, v115
  v_mfma_f32_16x16x32_bf16 v[124:127], v[36:39], a[80:83], v[124:127]
  s_add_u32 s51, s28, 10240
  v_cvt_pk_bf16_f32 v131, v118, v119
  v_mfma_f32_16x16x32_bf16 v[120:123], v[40:43], a[84:87], v[120:123]
  v_mfma_f32_16x16x32_bf16 v[124:127], v[44:47], a[84:87], v[124:127]
  buffer_store_dwordx4 v[128:131], v4, s[4:7], s43 offen sc1
  v_mfma_f32_16x16x32_bf16 v[120:123], v[48:51], a[88:91], v[120:123]
  s_add_u32 s43, s43, 32768
  v_mfma_f32_16x16x32_bf16 v[124:127], v[52:55], a[88:91], v[124:127]
  v_mfma_f32_16x16x32_bf16 v[120:123], v[56:59], a[92:95], v[120:123]
  v_mfma_f32_16x16x32_bf16 v[124:127], v[60:63], a[92:95], v[124:127]
  v_mfma_f32_16x16x32_bf16 v[112:115], v[16:19], a[96:99], 0
  v_add_u32 v140, s46, v4
  v_mfma_f32_16x16x32_bf16 v[116:119], v[20:23], a[96:99], 0
  v_add_u32 v141, s47, v4
  v_mfma_f32_16x16x32_bf16 v[112:115], v[24:27], a[100:103], v[112:115]
  v_cvt_pk_bf16_f32 v132, v120, v121
  v_add_u32 v142, s48, v4
  v_mfma_f32_16x16x32_bf16 v[116:119], v[28:31], a[100:103], v[116:119]
  v_cvt_pk_bf16_f32 v133, v124, v125
  v_add_u32 v143, s49, v4
  v_mfma_f32_16x16x32_bf16 v[112:115], v[32:35], a[104:107], v[112:115]
  v_cvt_pk_bf16_f32 v134, v122, v123
  v_add_u32 v144, s50, v4
  v_mfma_f32_16x16x32_bf16 v[116:119], v[36:39], a[104:107], v[116:119]
  v_cvt_pk_bf16_f32 v135, v126, v127
  v_add_u32 v145, s51, v4
  v_mfma_f32_16x16x32_bf16 v[112:115], v[40:43], a[108:111], v[112:115]
  v_mfma_f32_16x16x32_bf16 v[116:119], v[44:47], a[108:111], v[116:119]
  buffer_store_dwordx4 v[132:135], v4, s[4:7], s43 offen sc1
  v_mfma_f32_16x16x32_bf16 v[112:115], v[48:51], a[112:115], v[112:115]
  s_add_u32 s43, s43, 32768
  v_mfma_f32_16x16x32_bf16 v[116:119], v[52:55], a[112:115], v[116:119]
  v_mfma_f32_16x16x32_bf16 v[112:115], v[56:59], a[116:119], v[112:115]
  v_mov_b32 v8, s20
  v_mfma_f32_16x16x32_bf16 v[116:119], v[60:63], a[116:119], v[116:119]
  s_waitcnt vmcnt(4)
  s_barrier
  v_cmp_gt_u32 vcc, s31, v9
  s_cbranch_vccz L_ow_x01_go
  s_branch L_ow_x01_in
L_ow_x01:
  s_sleep 2
L_ow_x01_in:
  buffer_load_dword v9, v5, s[4:7], s35 offen sc1
  s_add_u32 s39, s39, 1
  s_cmp_gt_u32 s39, 200000
  s_cbranch_scc1 L_exit
  s_waitcnt vmcnt(0)
  v_cmp_gt_u32 vcc, s31, v9
  s_cbranch_vccnz L_ow_x01
L_ow_x01_go:
  s_add_u32 s30, s28, 12288
  s_cmp_eq_u32 s30, 36864
  s_cselect_b32 s30, 0, s30
  s_add_u32 s31, s20, 2
  v_mfma_f32_16x16x32_bf16 v[120:123], v[16:19], a[120:123], 0
  s_min_u32 s23, s31, 63
  s_mul_i32 s23, s23, 393216
  v_mfma_f32_16x16x32_bf16 v[124:127], v[20:23], a[120:123], 0
  s_add_u32 s23, s23, s36
  s_add_u32 m0, s38, s30
  v_mfma_f32_16x16x32_bf16 v[120:123], v[24:27], a[124:127], v[120:123]
  v_cvt_pk_bf16_f32 v128, v112, v113
  v_mfma_f32_16x16x32_bf16 v[124:127], v[28:31], a[124:127], v[124:127]
  v_cvt_pk_bf16_f32 v129, v116, v117
  v_mfma_f32_16x16x32_bf16 v[120:123], v[32:35], a[128:131], v[120:123]
  v_cvt_pk_bf16_f32 v130, v114, v115
  v_mfma_f32_16x16x32_bf16 v[124:127], v[36:39], a[128:131], v[124:127]
  v_cvt_pk_bf16_f32 v131, v118, v119
  v_mfma_f32_16x16x32_bf16 v[120:123], v[40:43], a[132:135], v[120:123]
  buffer_load_dwordx4 v4, s[4:7], s23 offen offset:0 sc1 lds
  v_mfma_f32_16x16x32_bf16 v[124:127], v[44:47], a[132:135], v[124:127]
  buffer_store_dwordx4 v[128:131], v4, s[4:7], s43 offen sc1
  v_mfma_f32_16x16x32_bf16 v[120:123], v[48:51], a[136:139], v[120:123]
  s_add_u32 s43, s43, 32768
  v_mfma_f32_16x16x32_bf16 v[124:127], v[52:55], a[136:139], v[124:127]
  buffer_load_dwordx4 v4, s[4:7], s23 offen offset:1024 sc1 lds
  v_mfma_f32_16x16x32_bf16 v[120:123], v[56:59], a[140:143], v[120:123]
  buffer_load_dwordx4 v4, s[4:7], s23 offen offset:2048 sc1 lds
  v_mfma_f32_16x16x32_bf16 v[124:127], v[60:63], a[140:143], v[124:127]
  v_mfma_f32_16x16x32_bf16 v[112:115], v[16:19], a[144:147], 0
  ds_read2_b64 v[64:67], v140 offset0:0 offset1:128
  v_mfma_f32_16x16x32_bf16 v[116:119], v[20:23], a[144:147], 0
  v_mfma_f32_16x16x32_bf16 v[112:115], v[24:27], a[148:151], v[112:115]
  v_cvt_pk_bf16_f32 v132, v120, v121
  v_mfma_f32_16x16x32_bf16 v[116:119], v[28:31], a[148:151], v[116:119]
  ds_read2_b64 v[68:71], v140 offset0:1 offset1:129
  v_cvt_pk_bf16_f32 v133, v124, v125
  v_mfma_f32_16x16x32_bf16 v[112:115], v[32:35], a[152:155], v[112:115]
  v_cvt_pk_bf16_f32 v134, v122, v123
  v_mfma_f32_16x16x32_bf16 v[116:119], v[36:39], a[152:155], v[116:119]
  v_cvt_pk_bf16_f32 v135, v126, v127
  v_mfma_f32_16x16x32_bf16 v[112:115], v[40:43], a[156:159], v[112:115]
  ds_read2_b64 v[72:75], v141 offset0:0 offset1:128
  v_mfma_f32_16x16x32_bf16 v[116:119], v[44:47], a[156:159], v[116:119]
  buffer_store_dwordx4 v[132:135], v4, s[4:7], s43 offen sc1
  v_mfma_f32_16x16x32_bf16 v[112:115], v[48:51], a[160:163], v[112:115]
  s_add_u32 s43, s43, 32768
  v_mfma_f32_16x16x32_bf16 v[116:119], v[52:55], a[160:163], v[116:119]
  ds_read2_b64 v[76:79], v141 offset0:1 offset1:129
  v_mfma_f32_16x16x32_bf16 v[112:115], v[56:59], a[164:167], v[112:115]
  v_mfma_f32_16x16x32_bf16 v[116:119], v[60:63], a[164:167], v[116:119]
  v_mfma_f32_16x16x32_bf16 v[120:123], v[16:19], a[168:171], 0
  ds_read2_b64 v[80:83], v142 offset0:0 offset1:128
  v_mfma_f32_16x16x32_bf16 v[124:127], v[20:23], a[168:171], 0
  v_mfma_f32_16x16x32_bf16 v[120:123], v[24:27], a[172:175], v[120:123]
  v_cvt_pk_bf16_f32 v128, v112, v113
  v_mfma_f32_16x16x32_bf16 v[124:127], v[28:31], a[172:175], v[124:127]
  ds_read2_b64 v[84:87], v142 offset0:1 offset1:129
  v_cvt_pk_bf16_f32 v129, v116, v117
  v_mfma_f32_16x16x32_bf16 v[120:123], v[32:35], a[176:179], v[120:123]
  v_cvt_pk_bf16_f32 v130, v114, v115
  v_mfma_f32_16x16x32_bf16 v[124:127], v[36:39], a[176:179], v[124:127]
  v_cvt_pk_bf16_f32 v131, v118, v119
  v_mfma_f32_16x16x32_bf16 v[120:123], v[40:43], a[180:183], v[120:123]
  ds_read2_b64 v[88:91], v143 offset0:0 offset1:128
  v_mfma_f32_16x16x32_bf16 v[124:127], v[44:47], a[180:183], v[124:127]
  buffer_store_dwordx4 v[128:131], v4, s[4:7], s43 offen sc1
  v_mfma_f32_16x16x32_bf16 v[120:123], v[48:51], a[184:187], v[120:123]
  s_add_u32 s43, s43, 32768
  v_mfma_f32_16x16x32_bf16 v[124:127], v[52:55], a[184:187], v[124:127]
  ds_read2_b64 v[92:95], v143 offset0:1 offset1:129
  v_mfma_f32_16x16x32_bf16 v[120:123], v[56:59], a[188:191], v[120:123]
  v_mfma_f32_16x16x32_bf16 v[124:127], v[60:63], a[188:191], v[124:127]
  v_mfma_f32_16x16x32_bf16 v[112:115], v[16:19], a[192:195], 0
  ds_read2_b64 v[96:99], v144 offset0:0 offset1:128
  v_mfma_f32_16x16x32_bf16 v[116:119], v[20:23], a[192:195], 0
  v_mfma_f32_16x16x32_bf16 v[112:115], v[24:27], a[196:199], v[112:115]
  v_cvt_pk_bf16_f32 v132, v120, v121
  v_mfma_f32_16x16x32_bf16 v[116:119], v[28:31], a[196:199], v[116:119]
  ds_read2_b64 v[100:103], v144 offset0:1 offset1:129
  v_cvt_pk_bf16_f32 v133, v124, v125
  v_mfma_f32_16x16x32_bf16 v[112:115], v[32:35], a[200:203], v[112:115]
  v_cvt_pk_bf16_f32 v134, v122, v123
  v_mfma_f32_16x16x32_bf16 v[116:119], v[36:39], a[200:203], v[116:119]
  v_cvt_pk_bf16_f32 v135, v126, v127
  v_mfma_f32_16x16x32_bf16 v[112:115], v[40:43], a[204:207], v[112:115]
  ds_read2_b64 v[104:107], v145 offset0:0 offset1:128
  v_mfma_f32_16x16x32_bf16 v[116:119], v[44:47], a[204:207], v[116:119]
  buffer_store_dwordx4 v[132:135], v4, s[4:7], s43 offen sc1
  v_mfma_f32_16x16x32_bf16 v[112:115], v[48:51], a[208:211], v[112:115]
  s_add_u32 s43, s43, 32768
  v_mfma_f32_16x16x32_bf16 v[116:119], v[52:55], a[208:211], v[116:119]
  ds_read2_b64 v[108:111], v145 offset0:1 offset1:129
  v_mfma_f32_16x16x32_bf16 v[112:115], v[56:59], a[212:215], v[112:115]
  v_mfma_f32_16x16x32_bf16 v[116:119], v[60:63], a[212:215], v[116:119]
  v_mfma_f32_16x16x32_bf16 v[120:123], v[16:19], a[216:219], 0
  v_mfma_f32_16x16x32_bf16 v[124:127], v[20:23], a[216:219], 0
  v_mfma_f32_16x16x32_bf16 v[120:123], v[24:27], a[220:223], v[120:123]
  v_cvt_pk_bf16_f32 v128, v112, v113
  v_mfma_f32_16x16x32_bf16 v[124:127], v[28:31], a[220:223], v[124:127]
  v_cvt_pk_bf16_f32 v129, v116, v117
  v_mfma_f32_16x16x32_bf16 v[120:123], v[32:35], a[224:227], v[120:123]
  v_cvt_pk_bf16_f32 v130, v114, v115
  v_mfma_f32_16x16x32_bf16 v[124:127], v[36:39], a[224:227], v[124:127]
  v_cvt_pk_bf16_f32 v131, v118, v119
  v_mfma_f32_16x16x32_bf16 v[120:123], v[40:43], a[228:231], v[120:123]
  v_mfma_f32_16x16x32_bf16 v[124:127], v[44:47], a[228:231], v[124:127]
  buffer_store_dwordx4 v[128:131], v4, s[4:7], s43 offen sc1
  v_mfma_f32_16x16x32_bf16 v[120:123], v[48:51], a[232:235], v[120:123]
  s_add_u32 s43, s43, 32768
  v_mfma_f32_16x16x32_bf16 v[124:127], v[52:55], a[232:235], v[124:127]
  v_mfma_f32_16x16x32_bf16 v[120:123], v[56:59], a[236:239], v[120:123]
  v_mfma_f32_16x16x32_bf16 v[124:127], v[60:63], a[236:239], v[124:127]
  s_mov_b32 s28, s30
  s_add_u32 s20, s20, 1
  s_waitcnt lgkmcnt(0)
L_ow_loop:
  v_mfma_f32_16x16x32_bf16 v[112:115], v[64:67], a[0:3], 0
  v_mfma_f32_16x16x32_bf16 v[116:119], v[68:71], a[0:3], 0
  v_mfma_f32_16x16x32_bf16 v[112:115], v[72:75], a[4:7], v[112:115]
  v_cvt_pk_bf16_f32 v132, v120, v121
  v_mfma_f32_16x16x32_bf16 v[116:119], v[76:79], a[4:7], v[116:119]
  v_cvt_pk_bf16_f32 v133, v124, v125
  v_mfma_f32_16x16x32_bf16 v[112:115], v[80:83], a[8:11], v[112:115]
  v_cvt_pk_bf16_f32 v134, v122, v123
  v_mfma_f32_16x16x32_bf16 v[116:119], v[84:87], a[8:11], v[116:119]
  v_cvt_pk_bf16_f32 v135, v126, v127
  v_mfma_f32_16x16x32_bf16 v[112:115], v[88:91], a[12:15], v[112:115]
  v_mfma_f32_16x16x32_bf16 v[116:119], v[92:95], a[12:15], v[116:119]
  buffer_store_dwordx4 v[132:135], v4, s[4:7], s43 offen sc1
  v_mfma_f32_16x16x32_bf16 v[112:115], v[96:99], a[16:19], v[112:115]
  s_add_u32 s43, s43, 32768
  v_mfma_f32_16x16x32_bf16 v[116:119], v[100:103], a[16:19], v[116:119]
  s_add_u32 s43, s43, 983040
  v_mfma_f32_16x16x32_bf16 v[112:115], v[104:107], a[20:23], v[112:115]
  buffer_load_dword v9, v5, s[4:7], s35 offen sc1
  s_add_u32 s31, s20, 3
  s_min_u32 s31, s31, 64
  v_mfma_f32_16x16x32_bf16 v[116:119], v[108:111], a[20:23], v[116:119]
  v_mfma_f32_16x16x32_bf16 v[120:123], v[64:67], a[24:27], 0
  v_mfma_f32_16x16x32_bf16 v[124:127], v[68:71], a[24:27], 0
  v_mfma_f32_16x16x32_bf16 v[120:123], v[72:75], a[28:31], v[120:123]
  v_cvt_pk_bf16_f32 v128, v112, v113
  v_mfma_f32_16x16x32_bf16 v[124:127], v[76:79], a[28:31], v[124:127]
  v_cvt_pk_bf16_f32 v129, v116, v117
  v_mfma_f32_16x16x32_bf16 v[120:123], v[80:83], a[32:35], v[120:123]
  v_cvt_pk_bf16_f32 v130, v114, v115
  v_mfma_f32_16x16x32_bf16 v[124:127], v[84:87], a[32:35], v[124:127]
  v_cvt_pk_bf16_f32 v131, v118, v119
  v_mfma_f32_16x16x32_bf16 v[120:123], v[88:91], a[36:39], v[120:123]
  v_mfma_f32_16x16x32_bf16 v[124:127], v[92:95], a[36:39], v[124:127]
  buffer_store_dwordx4 v[128:131], v4, s[4:7], s43 offen sc1
  v_mfma_f32_16x16x32_bf16 v[120:123], v[96:99], a[40:43], v[120:123]
  s_add_u32 s43, s43, 32768
  v_mfma_f32_16x16x32_bf16 v[124:127], v[100:103], a[40:43], v[124:127]
  v_mfma_f32_16x16x32_bf16 v[120:123], v[104:107], a[44:47], v[120:123]
  v_mfma_f32_16x16x32_bf16 v[124:127], v[108:111], a[44:47], v[124:127]
  v_mfma_f32_16x16x32_bf16 v[112:115], v[64:67], a[48:51], 0
  v_mfma_f32_16x16x32_bf16 v[116:119], v[68:71], a[48:51], 0
  v_mfma_f32_16x16x32_bf16 v[112:115], v[72:75], a[52:55], v[112:115]
  v_cvt_pk_bf16_f32 v132, v120, v121
  v_mfma_f32_16x16x32_bf16 v[116:119], v[76:79], a[52:55], v[116:119]
  v_cvt_pk_bf16_f32 v133, v124, v125
  v_mfma_f32_16x16x32_bf16 v[112:115], v[80:83], a[56:59], v[112:115]
  v_cvt_pk_bf16_f32 v134, v122, v123
  v_mfma_f32_16x16x32_bf16 v[116:119], v[84:87], a[56:59], v[116:119]
  v_cvt_pk_bf16_f32 v135, v126, v127
  v_mfma_f32_16x16x32_bf16 v[112:115], v[88:91], a[60:63], v[112:115]
  v_mfma_f32_16x16x32_bf16 v[116:119], v[92:95], a[60:63], v[116:119]
  buffer_store_dwordx4 v[132:135], v4, s[4:7], s43 offen sc1
  v_mfma_f32_16x16x32_bf16 v[112:115], v[96:99], a[64:67], v[112:115]
  s_add_u32 s43, s43, 32768
  v_mfma_f32_16x16x32_bf16 v[116:119], v[100:103], a[64:67], v[116:119]
  v_mfma_f32_16x16x32_bf16 v[112:115], v[104:107], a[68:71], v[112:115]
  v_mfma_f32_16x16x32_bf16 v[116:119], v[108:111], a[68:71], v[116:119]
  v_mfma_f32_16x16x32_bf16 v[120:123], v[64:67], a[72:75], 0
  s_add_u32 s46, s28, 0
  v_mfma_f32_16x16x32_bf16 v[124:127], v[68:71], a[72:75], 0
  s_add_u32 s47, s28, 2048
  v_mfma_f32_16x16x32_bf16 v[120:123], v[72:75], a[76:79], v[120:123]
  s_add_u32 s48, s28, 4096
  v_cvt_pk_bf16_f32 v128, v112, v113
  v_mfma_f32_16x16x32_bf16 v[124:127], v[76:79], a[76:79], v[124:127]
  s_add_u32 s49, s28, 6144
  v_cvt_pk_bf16_f32 v129, v116, v117
  v_mfma_f32_16x16x32_bf16 v[120:123], v[80:83], a[80:83], v[120:123]
  s_add_u32 s50, s28, 8192
  v_cvt_pk_bf16_f32 v130, v114, v115
  v_mfma_f32_16x16x32_bf16 v[124:127], v[84:87], a[80:83], v[124:127]
  s_add_u32 s51, s28, 10240
  v_cvt_pk_bf16_f32 v131, v118, v119
  v_mfma_f32_16x16x32_bf16 v[120:123], v[88:91], a[84:87], v[120:123]
  v_mfma_f32_16x16x32_bf16 v[124:127], v[92:95], a[84:87], v[124:127]
  buffer_store_dwordx4 v[128:131], v4, s[4:7], s43 offen sc1
  v_mfma_f32_16x16x32_bf16 v[120:123], v[96:99], a[88:91], v[120:123]
  s_add_u32 s43, s43, 32768
  v_mfma_f32_16x16x32_bf16 v[124:127], v[100:103], a[88:91], v[124:127]
  v_mfma_f32_16x16x32_bf16 v[120:123], v[104:107], a[92:95], v[120:123]
  v_mfma_f32_16x16x32_bf16 v[124:127], v[108:111], a[92:95], v[124:127]
  v_mfma_f32_16x16x32_bf16 v[112:115], v[64:67], a[96:99], 0
  v_add_u32 v140, s46, v4
  v_mfma_f32_16x16x32_bf16 v[116:119], v[68:71], a[96:99], 0
  v_add_u32 v141, s47, v4
  v_mfma_f32_16x16x32_bf16 v[112:115], v[72:75], a[100:103], v[112:115]
  v_cvt_pk_bf16_f32 v132, v120, v121
  v_add_u32 v142, s48, v4
  v_mfma_f32_16x16x32_bf16 v[116:119], v[76:79], a[100:103], v[116:119]
  v_cvt_pk_bf16_f32 v133, v124, v125
  v_add_u32 v143, s49, v4
  v_mfma_f32_16x16x32_bf16 v[112:115], v[80:83], a[104:107], v[112:115]
  v_cvt_pk_bf16_f32 v134, v122, v123
  v_add_u32 v144, s50, v4
  v_mfma_f32_16x16x32_bf16 v[116:119], v[84:87], a[104:107], v[116:119]
  v_cvt_pk_bf16_f32 v135, v126, v127
  v_add_u32 v145, s51, v4
  v_mfma_f32_16x16x32_bf16 v[112:115], v[88:91], a[108:111], v[112:115]
  v_mfma_f32_16x16x32_bf16 v[116:119], v[92:95], a[108:111], v[116:119]
  buffer_store_dwordx4 v[132:135], v4, s[4:7], s43 offen sc1
  v_mfma_f32_16x16x32_bf16 v[112:115], v[96:99], a[112:115], v[112:115]
  s_add_u32 s43, s43, 32768
  v_mfma_f32_16x16x32_bf16 v[116:119], v[100:103], a[112:115], v[116:119]
  v_mfma_f32_16x16x32_bf16 v[112:115], v[104:107], a[116:119], v[112:115]
  v_mov_b32 v8, s20
  v_mfma_f32_16x16x32_bf16 v[116:119], v[108:111], a[116:119], v[116:119]
  s_waitcnt vmcnt(4)
  s_barrier
  s_mov_b64 exec, 1
  buffer_store_dword v8, v6, s[4:7], s34 offen sc1
  s_mov_b64 exec, -1
  v_cmp_gt_u32 vcc, s31, v9
  s_cbranch_vccz L_ow_x10_go
  s_branch L_ow_x10_in
L_ow_x10:
  s_sleep 2
L_ow_x10_in:
  buffer_load_dword v9, v5, s[4:7], s35 offen sc1
  s_add_u32 s39, s39, 1
  s_cmp_gt_u32 s39, 200000
  s_cbranch_scc1 L_exit
  s_waitcnt vmcnt(0)
  v_cmp_gt_u32 vcc, s31, v9
  s_cbranch_vccnz L_ow_x10
L_ow_x10_go:
  s_add_u32 s30, s28, 12288
  s_cmp_eq_u32 s30, 36864
  s_cselect_b32 s30, 0, s30
  s_add_u32 s31, s20, 2
  v_mfma_f32_16x16x32_bf16 v[120:123], v[64:67], a[120:123], 0
  s_min_u32 s23, s31, 63
  s_mul_i32 s23, s23, 393216
  v_mfma_f32_16x16x32_bf16 v[124:127], v[68:71], a[120:123], 0
  s_add_u32 s23, s23, s36
  s_add_u32 m0, s38, s30
  v_mfma_f32_16x16x32_bf16 v[120:123], v[72:75], a[124:127], v[120:123]
  v_cvt_pk_bf16_f32 v128, v112, v113
  v_mfma_f32_16x16x32_bf16 v[124:127], v[76:79], a[124:127], v[124:127]
  v_cvt_pk_bf16_f32 v129, v116, v117
  v_mfma_f32_16x16x32_bf16 v[120:123], v[80:83], a[128:131], v[120:123]
  v_cvt_pk_bf16_f32 v130, v114, v115
  v_mfma_f32_16x16x32_bf16 v[124:127], v[84:87], a[128:131], v[124:127]
  v_cvt_pk_bf16_f32 v131, v118, v119
  v_mfma_f32_16x16x32_bf16 v[120:123], v[88:91], a[132:135], v[120:123]
  buffer_load_dwordx4 v4, s[4:7], s23 offen offset:0 sc1 lds
  v_mfma_f32_16x16x32_bf16 v[124:127], v[92:95], a[132:135], v[124:127]
  buffer_store_dwordx4 v[128:131], v4, s[4:7], s43 offen sc1
  v_mfma_f32_16x16x32_bf16 v[120:123], v[96:99], a[136:139], v[120:123]
  s_add_u32 s43, s43, 32768
  v_mfma_f32_16x16x32_bf16 v[124:127], v[100:103], a[136:139], v[124:127]
  buffer_load_dwordx4 v4, s[4:7], s23 offen offset:1024 sc1 lds
  v_mfma_f32_16x16x32_bf16 v[120:123], v[104:107], a[140:143], v[120:123]
  buffer_load_dwordx4 v4, s[4:7], s23 offen offset:2048 sc1 lds
  v_mfma_f32_16x16x32_bf16 v[124:127], v[108:111], a[140:143], v[124:127]
  v_mfma_f32_16x16x32_bf16 v[112:115], v[64:67], a[144:147], 0
  ds_read2_b64 v[16:19], v140 offset0:0 offset1:128
  v_mfma_f32_16x16x32_bf16 v[116:119], v[68:71], a[144:147], 0
  v_mfma_f32_16x16x32_bf16 v[112:115], v[72:75], a[148:151], v[112:115]
  v_cvt_pk_bf16_f32 v132, v120, v121
  v_mfma_f32_16x16x32_bf16 v[116:119], v[76:79], a[148:151], v[116:119]
  ds_read2_b64 v[20:23], v140 offset0:1 offset1:129
  v_cvt_pk_bf16_f32 v133, v124, v125
  v_mfma_f32_16x16x32_bf16 v[112:115], v[80:83], a[152:155], v[112:115]
  v_cvt_pk_bf16_f32 v134, v122, v123
  v_mfma_f32_16x16x32_bf16 v[116:119], v[84:87], a[152:155], v[116:119]
  v_cvt_pk_bf16_f32 v135, v126, v127
  v_mfma_f32_16x16x32_bf16 v[112:115], v[88:91], a[156:159], v[112:115]
  ds_read2_b64 v[24:27], v141 offset0:0 offset1:128
  v_mfma_f32_16x16x32_bf16 v[116:119], v[92:95], a[156:159], v[116:119]
  buffer_store_dwordx4 v[132:135], v4, s[4:7], s43 offen sc1
  v_mfma_f32_16x16x32_bf16 v[112:115], v[96:99], a[160:163], v[112:115]
  s_add_u32 s43, s43, 32768
  v_mfma_f32_16x16x32_bf16 v[116:119], v[100:103], a[160:163], v[116:119]
  ds_read2_b64 v[28:31], v141 offset0:1 offset1:129
  v_mfma_f32_16x16x32_bf16 v[112:115], v[104:107], a[164:167], v[112:115]
  v_mfma_f32_16x16x32_bf16 v[116:119], v[108:111], a[164:167], v[116:119]
  v_mfma_f32_16x16x32_bf16 v[120:123], v[64:67], a[168:171], 0
  ds_read2_b64 v[32:35], v142 offset0:0 offset1:128
  v_mfma_f32_16x16x32_bf16 v[124:127], v[68:71], a[168:171], 0
  v_mfma_f32_16x16x32_bf16 v[120:123], v[72:75], a[172:175], v[120:123]
  v_cvt_pk_bf16_f32 v128, v112, v113
  v_mfma_f32_16x16x32_bf16 v[124:127], v[76:79], a[172:175], v[124:127]
  ds_read2_b64 v[36:39], v142 offset0:1 offset1:129
  v_cvt_pk_bf16_f32 v129, v116, v117
  v_mfma_f32_16x16x32_bf16 v[120:123], v[80:83], a[176:179], v[120:123]
  v_cvt_pk_bf16_f32 v130, v114, v115
  v_mfma_f32_16x16x32_bf16 v[124:127], v[84:87], a[176:179], v[124:127]
  v_cvt_pk_bf16_f32 v131, v118, v119
  v_mfma_f32_16x16x32_bf16 v[120:123], v[88:91], a[180:183], v[120:123]
  ds_read2_b64 v[40:43], v143 offset0:0 offset1:128
  v_mfma_f32_16x16x32_bf16 v[124:127], v[92:95], a[180:183], v[124:127]
  buffer_store_dwordx4 v[128:131], v4, s[4:7], s43 offen sc1
  v_mfma_f32_16x16x32_bf16 v[120:123], v[96:99], a[184:187], v[120:123]
  s_add_u32 s43, s43, 32768
  v_mfma_f32_16x16x32_bf16 v[124:127], v[100:103], a[184:187], v[124:127]
  ds_read2_b64 v[44:47], v143 offset0:1 offset1:129
  v_mfma_f32_16x16x32_bf16 v[120:123], v[104:107], a[188:191], v[120:123]
  v_mfma_f32_16x16x32_bf16 v[124:127], v[108:111], a[188:191], v[124:127]
  v_mfma_f32_16x16x32_bf16 v[112:115], v[64:67], a[192:195], 0
  ds_read2_b64 v[48:51], v144 offset0:0 offset1:128
  v_mfma_f32_16x16x32_bf16 v[116:119], v[68:71], a[192:195], 0
  v_mfma_f32_16x16x32_bf16 v[112:115], v[72:75], a[196:199], v[112:115]
  v_cvt_pk_bf16_f32 v132, v120, v121
  v_mfma_f32_16x16x32_bf16 v[116:119], v[76:79], a[196:199], v[116:119]
  ds_read2_b64 v[52:55], v144 offset0:1 offset1:129
  v_cvt_pk_bf16_f32 v133, v124, v125
  v_mfma_f32_16x16x32_bf16 v[112:115], v[80:83], a[200:203], v[112:115]
  v_cvt_pk_bf16_f32 v134, v122, v123
  v_mfma_f32_16x16x32_bf16 v[116:119], v[84:87], a[200:203], v[116:119]
  v_cvt_pk_bf16_f32 v135, v126, v127
  v_mfma_f32_16x16x32_bf16 v[112:115], v[88:91], a[204:207], v[112:115]
  ds_read2_b64 v[56:59], v145 offset0:0 offset1:128
  v_mfma_f32_16x16x32_bf16 v[116:119], v[92:95], a[204:207], v[116:119]
  buffer_store_dwordx4 v[132:135], v4, s[4:7], s43 offen sc1
  v_mfma_f32_16x16x32_bf16 v[112:115], v[96:99], a[208:211], v[112:115]
  s_add_u32 s43, s43, 32768
  v_mfma_f32_16x16x32_bf16 v[116:119], v[100:103], a[208:211], v[116:119]
  ds_read2_b64 v[60:63], v145 offset0:1 offset1:129
  v_mfma_f32_16x16x32_bf16 v[112:115], v[104:107], a[212:215], v[112:115]
  v_mfma_f32_16x16x32_bf16 v[116:119], v[108:111], a[212:215], v[116:119]
  v_mfma_f32_16x16x32_bf16 v[120:123], v[64:67], a[216:219], 0
  v_mfma_f32_16x16x32_bf16 v[124:127], v[68:71], a[216:219], 0
  v_mfma_f32_16x16x32_bf16 v[120:123], v[72:75], a[220:223], v[120:123]
  v_cvt_pk_bf16_f32 v128, v112, v113
  v_mfma_f32_16x16x32_bf16 v[124:127], v[76:79], a[220:223], v[124:127]
  v_cvt_pk_bf16_f32 v129, v116, v117
  v_mfma_f32_16x16x32_bf16 v[120:123], v[80:83], a[224:227], v[120:123]
  v_cvt_pk_bf16_f32 v130, v114, v115
  v_mfma_f32_16x16x32_bf16 v[124:127], v[84:87], a[224:227], v[124:127]
  v_cvt_pk_bf16_f32 v131, v118, v119
  v_mfma_f32_16x16x32_bf16 v[120:123], v[88:91], a[228:231], v[120:123]
  v_mfma_f32_16x16x32_bf16 v[124:127], v[92:95], a[228:231], v[124:127]
  buffer_store_dwordx4 v[128:131], v4, s[4:7], s43 offen sc1
  v_mfma_f32_16x16x32_bf16 v[120:123], v[96:99], a[232:235], v[120:123]
  s_add_u32 s43, s43, 32768
  v_mfma_f32_16x16x32_bf16 v[124:127], v[100:103], a[232:235], v[124:127]
  v_mfma_f32_16x16x32_bf16 v[120:123], v[104:107], a[236:239], v[120:123]
  v_mfma_f32_16x16x32_bf16 v[124:127], v[108:111], a[236:239], v[124:127]
  s_mov_b32 s28, s30
  s_add_u32 s20, s20, 1
  s_waitcnt lgkmcnt(0)
  s_cmp_eq_u32 s20, 64
  s_nop 1
  s_cbranch_scc1 L_ow_fin
  v_mfma_f32_16x16x32_bf16 v[112:115], v[16:19], a[0:3], 0
  v_mfma_f32_16x16x32_bf16 v[116:119], v[20:23], a[0:3], 0
  v_mfma_f32_16x16x32_bf16 v[112:115], v[24:27], a[4:7], v[112:115]
  v_cvt_pk_bf16_f32 v132, v120, v121
  v_mfma_f32_16x16x32_bf16 v[116:119], v[28:31], a[4:7], v[116:119]
  v_cvt_pk_bf16_f32 v133, v124, v125
  v_mfma_f32_16x16x32_bf16 v[112:115], v[32:35], a[8:11], v[112:115]
  v_cvt_pk_bf16_f32 v134, v122, v123
  v_mfma_f32_16x16x32_bf16 v[116:119], v[36:39], a[8:11], v[116:119]
  v_cvt_pk_bf16_f32 v135, v126, v127
  v_mfma_f32_16x16x32_bf16 v[112:115], v[40:43], a[12:15], v[112:115]
  v_mfma_f32_16x16x32_bf16 v[116:119], v[44:47], a[12:15], v[116:119]
  buffer_store_dwordx4 v[132:135], v4, s[4:7], s43 offen sc1
  v_mfma_f32_16x16x32_bf16 v[112:115], v[48:51], a[16:19], v[112:115]
  s_add_u32 s43, s43, 32768
  v_mfma_f32_16x16x32_bf16 v[116:119], v[52:55], a[16:19], v[116:119]
  s_add_u32 s43, s43, 983040
  v_mfma_f32_16x16x32_bf16 v[112:115], v[56:59], a[20:23], v[112:115]
  buffer_load_dword v9, v5, s[4:7], s35 offen sc1
  s_add_u32 s31, s20, 3
  s_min_u32 s31, s31, 64
  v_mfma_f32_16x16x32_bf16 v[116:119], v[60:63], a[20:23], v[116:119]
  v_mfma_f32_16x16x32_bf16 v[120:123], v[16:19], a[24:27], 0
  v_mfma_f32_16x16x32_bf16 v[124:127], v[20:23], a[24:27], 0
  v_mfma_f32_16x16x32_bf16 v[120:123], v[24:27], a[28:31], v[120:123]
  v_cvt_pk_bf16_f32 v128, v112, v113
  v_mfma_f32_16x16x32_bf16 v[124:127], v[28:31], a[28:31], v[124:127]
  v_cvt_pk_bf16_f32 v129, v116, v117
  v_mfma_f32_16x16x32_bf16 v[120:123], v[32:35], a[32:35], v[120:123]
  v_cvt_pk_bf16_f32 v130, v114, v115
  v_mfma_f32_16x16x32_bf16 v[124:127], v[36:39], a[32:35], v[124:127]
  v_cvt_pk_bf16_f32 v131, v118, v119
  v_mfma_f32_16x16x32_bf16 v[120:123], v[40:43], a[36:39], v[120:123]
  v_mfma_f32_16x16x32_bf16 v[124:127], v[44:47], a[36:39], v[124:127]
  buffer_store_dwordx4 v[128:131], v4, s[4:7], s43 offen sc1
  v_mfma_f32_16x16x32_bf16 v[120:123], v[48:51], a[40:43], v[120:123]
  s_add_u32 s43, s43, 32768
  v_mfma_f32_16x16x32_bf16 v[124:127], v[52:55], a[40:43], v[124:127]
  v_mfma_f32_16x16x32_bf16 v[120:123], v[56:59], a[44:47], v[120:123]
  v_mfma_f32_16x16x32_bf16 v[124:127], v[60:63], a[44:47], v[124:127]
  v_mfma_f32_16x16x32_bf16 v[112:115], v[16:19], a[48:51], 0
  v_mfma_f32_16x16x32_bf16 v[116:119], v[20:23], a[48:51], 0
  v_mfma_f32_16x16x32_bf16 v[112:115], v[24:27], a[52:55], v[112:115]
  v_cvt_pk_bf16_f32 v132, v120, v121
  v_mfma_f32_16x16x32_bf16 v[116:119], v[28:31], a[52:55], v[116:119]
  v_cvt_pk_bf16_f32 v133, v124, v125
  v_mfma_f32_16x16x32_bf16 v[112:115], v[32:35], a[56:59], v[112:115]
  v_cvt_pk_bf16_f32 v134, v122, v123
  v_mfma_f32_16x16x32_bf16 v[116:119], v[36:39], a[56:59], v[116:119]
  v_cvt_pk_bf16_f32 v135, v126, v127
  v_mfma_f32_16x16x32_bf16 v[112:115], v[40:43], a[60:63], v[112:115]
  v_mfma_f32_16x16x32_bf16 v[116:119], v[44:47], a[60:63], v[116:119]
  buffer_store_dwordx4 v[132:135], v4, s[4:7], s43 offen sc1
  v_mfma_f32_16x16x32_bf16 v[112:115], v[48:51], a[64:67], v[112:115]
  s_add_u32 s43, s43, 32768
  v_mfma_f32_16x16x32_bf16 v[116:119], v[52:55], a[64:67], v[116:119]
  v_mfma_f32_16x16x32_bf16 v[112:115], v[56:59], a[68:71], v[112:115]
  v_mfma_f32_16x16x32_bf16 v[116:119], v[60:63], a[68:71], v[116:119]
  v_mfma_f32_16x16x32_bf16 v[120:123], v[16:19], a[72:75], 0
  s_add_u32 s46, s28, 0
  v_mfma_f32_16x16x32_bf16 v[124:127], v[20:23], a[72:75], 0
  s_add_u32 s47, s28, 2048
  v_mfma_f32_16x16x32_bf16 v[120:123], v[24:27], a[76:79], v[120:123]
  s_add_u32 s48, s28, 4096
  v_cvt_pk_bf16_f32 v128, v112, v113
  v_mfma_f32_16x16x32_bf16 v[124:127], v[28:31], a[76:79], v[124:127]
  s_add_u32 s49, s28, 6144
  v_cvt_pk_bf16_f32 v129, v116, v117
  v_mfma_f32_16x16x32_bf16 v[120:123], v[32:35], a[80:83], v[120:123]
  s_add_u32 s50, s28, 8192
  v_cvt_pk_bf16_f32 v130, v114, v115
  v_mfma_f32_16x16x32_bf16 v[124:127], v[36:39], a[80:83], v[124:127]
  s_add_u32 s51, s28, 10240
  v_cvt_pk_bf16_f32 v131, v118, v119
  v_mfma_f32_16x16x32_bf16 v[120:123], v[40:43], a[84:87], v[120:123]
  v_mfma_f32_16x16x32_bf16 v[124:127], v[44:47], a[84:87], v[124:127]
  buffer_store_dwordx4 v[128:131], v4, s[4:7], s43 offen sc1
  v_mfma_f32_16x16x32_bf16 v[120:123], v[48:51], a[88:91], v[120:123]
  s_add_u32 s43, s43, 32768
  v_mfma_f32_16x16x32_bf16 v[124:127], v[52:55], a[88:91], v[124:127]
  v_mfma_f32_16x16x32_bf16 v[120:123], v[56:59], a[92:95], v[120:123]
  v_mfma_f32_16x16x32_bf16 v[124:127], v[60:63], a[92:95], v[124:127]
  v_mfma_f32_16x16x32_bf16 v[112:115], v[16:19], a[96:99], 0
  v_add_u32 v140, s46, v4
  v_mfma_f32_16x16x32_bf16 v[116:119], v[20:23], a[96:99], 0
  v_add_u32 v141, s47, v4
  v_mfma_f32_16x16x32_bf16 v[112:115], v[24:27], a[100:103], v[112:115]
  v_cvt_pk_bf16_f32 v132, v120, v121
  v_add_u32 v142, s48, v4
  v_mfma_f32_16x16x32_bf16 v[116:119], v[28:31], a[100:103], v[116:119]
  v_cvt_pk_bf16_f32 v133, v124, v125
  v_add_u32 v143, s49, v4
  v_mfma_f32_16x16x32_bf16 v[112:115], v[32:35], a[104:107], v[112:115]
  v_cvt_pk_bf16_f32 v134, v122, v123
  v_add_u32 v144, s50, v4
  v_mfma_f32_16x16x32_bf16 v[116:119], v[36:39], a[104:107], v[116:119]
  v_cvt_pk_bf16_f32 v135, v126, v127
  v_add_u32 v145, s51, v4
  v_mfma_f32_16x16x32_bf16 v[112:115], v[40:43], a[108:111], v[112:115]
  v_mfma_f32_16x16x32_bf16 v[116:119], v[44:47], a[108:111], v[116:119]
  buffer_store_dwordx4 v[132:135], v4, s[4:7], s43 offen sc1
  v_mfma_f32_16x16x32_bf16 v[112:115], v[48:51], a[112:115], v[112:115]
  s_add_u32 s43, s43, 32768
  v_mfma_f32_16x16x32_bf16 v[116:119], v[52:55], a[112:115], v[116:119]
  v_mfma_f32_16x16x32_bf16 v[112:115], v[56:59], a[116:119], v[112:115]
  v_mov_b32 v8, s20
  v_mfma_f32_16x16x32_bf16 v[116:119], v[60:63], a[116:119], v[116:119]
  s_waitcnt vmcnt(4)
  s_barrier
  s_mov_b64 exec, 1
  buffer_store_dword v8, v6, s[4:7], s34 offen sc1
  s_mov_b64 exec, -1
  v_cmp_gt_u32 vcc, s31, v9
  s_cbranch_vccz L_ow_x00_go
  s_branch L_ow_x00_in
L_ow_x00:
  s_sleep 2
L_ow_x00_in:
  buffer_load_dword v9, v5, s[4:7], s35 offen sc1
  s_add_u32 s39, s39, 1
  s_cmp_gt_u32 s39, 200000
  s_cbranch_scc1 L_exit
  s_waitcnt vmcnt(0)
  v_cmp_gt_u32 vcc, s31, v9
  s_cbranch_vccnz L_ow_x00
L_ow_x00_go:
  s_add_u32 s30, s28, 12288
  s_cmp_eq_u32 s30, 36864
  s_cselect_b32 s30, 0, s30
  s_add_u32 s31, s20, 2
  v_mfma_f32_16x16x32_bf16 v[120:123], v[16:19], a[120:123], 0
  s_min_u32 s23, s31, 63
  s_mul_i32 s23, s23, 393216
  v_mfma_f32_16x16x32_bf16 v[124:127], v[20:23], a[120:123], 0
  s_add_u32 s23, s23, s36
  s_add_u32 m0, s38, s30
  v_mfma_f32_16x16x32_bf16 v[120:123], v[24:27], a[124:127], v[120:123]
  v_cvt_pk_bf16_f32 v128, v112, v113
  v_mfma_f32_16x16x32_bf16 v[124:127], v[28:31], a[124:127], v[124:127]
  v_cvt_pk_bf16_f32 v129, v116, v117
  v_mfma_f32_16x16x32_bf16 v[120:123], v[32:35], a[128:131], v[120:123]
  v_cvt_pk_bf16_f32 v130, v114, v115
  v_mfma_f32_16x16x32_bf16 v[124:127], v[36:39], a[128:131], v[124:127]
  v_cvt_pk_bf16_f32 v131, v118, v119
  v_mfma_f32_16x16x32_bf16 v[120:123], v[40:43], a[132:135], v[120:123]
  buffer_load_dwordx4 v4, s[4:7], s23 offen offset:0 sc1 lds
  v_mfma_f32_16x16x32_bf16 v[124:127], v[44:47], a[132:135], v[124:127]
  buffer_store_dwordx4 v[128:131], v4, s[4:7], s43 offen sc1
  v_mfma_f32_16x16x32_bf16 v[120:123], v[48:51], a[136:139], v[120:123]
  s_add_u32 s43, s43, 32768
  v_mfma_f32_16x16x32_bf16 v[124:127], v[52:55], a[136:139], v[124:127]
  buffer_load_dwordx4 v4, s[4:7], s23 offen offset:1024 sc1 lds
  v_mfma_f32_16x16x32_bf16 v[120:123], v[56:59], a[140:143], v[120:123]
  buffer_load_dwordx4 v4, s[4:7], s23 offen offset:2048 sc1 lds
  v_mfma_f32_16x16x32_bf16 v[124:127], v[60:63], a[140:143], v[124:127]
  v_mfma_f32_16x16x32_bf16 v[112:115], v[16:19], a[144:147], 0
  ds_read2_b64 v[64:67], v140 offset0:0 offset1:128
  v_mfma_f32_16x16x32_bf16 v[116:119], v[20:23], a[144:147], 0
  v_mfma_f32_16x16x32_bf16 v[112:115], v[24:27], a[148:151], v[112:115]
  v_cvt_pk_bf16_f32 v132, v120, v121
  v_mfma_f32_16x16x32_bf16 v[116:119], v[28:31], a[148:151], v[116:119]
  ds_read2_b64 v[68:71], v140 offset0:1 offset1:129
  v_cvt_pk_bf16_f32 v133, v124, v125
  v_mfma_f32_16x16x32_bf16 v[112:115], v[32:35], a[152:155], v[112:115]
  v_cvt_pk_bf16_f32 v134, v122, v123
  v_mfma_f32_16x16x32_bf16 v[116:119], v[36:39], a[152:155], v[116:119]
  v_cvt_pk_bf16_f32 v135, v126, v127
  v_mfma_f32_16x16x32_bf16 v[112:115], v[40:43], a[156:159], v[112:115]
  ds_read2_b64 v[72:75], v141 offset0:0 offset1:128
  v_mfma_f32_16x16x32_bf16 v[116:119], v[44:47], a[156:159], v[116:119]
  buffer_store_dwordx4 v[132:135], v4, s[4:7], s43 offen sc1
  v_mfma_f32_16x16x32_bf16 v[112:115], v[48:51], a[160:163], v[112:115]
  s_add_u32 s43, s43, 32768
  v_mfma_f32_16x16x32_bf16 v[116:119], v[52:55], a[160:163], v[116:119]
  ds_read2_b64 v[76:79], v141 offset0:1 offset1:129
  v_mfma_f32_16x16x32_bf16 v[112:115], v[56:59], a[164:167], v[112:115]
  v_mfma_f32_16x16x32_bf16 v[116:119], v[60:63], a[164:167], v[116:119]
  v_mfma_f32_16x16x32_bf16 v[120:123], v[16:19], a[168:171], 0
  ds_read2_b64 v[80:83], v142 offset0:0 offset1:128
  v_mfma_f32_16x16x32_bf16 v[124:127], v[20:23], a[168:171], 0
  v_mfma_f32_16x16x32_bf16 v[120:123], v[24:27], a[172:175], v[120:123]
  v_cvt_pk_bf16_f32 v128, v112, v113
  v_mfma_f32_16x16x32_bf16 v[124:127], v[28:31], a[172:175], v[124:127]
  ds_read2_b64 v[84:87], v142 offset0:1 offset1:129
  v_cvt_pk_bf16_f32 v129, v116, v117
  v_mfma_f32_16x16x32_bf16 v[120:123], v[32:35], a[176:179], v[120:123]
  v_cvt_pk_bf16_f32 v130, v114, v115
  v_mfma_f32_16x16x32_bf16 v[124:127], v[36:39], a[176:179], v[124:127]
  v_cvt_pk_bf16_f32 v131, v118, v119
  v_mfma_f32_16x16x32_bf16 v[120:123], v[40:43], a[180:183], v[120:123]
  ds_read2_b64 v[88:91], v143 offset0:0 offset1:128
  v_mfma_f32_16x16x32_bf16 v[124:127], v[44:47], a[180:183], v[124:127]
  buffer_store_dwordx4 v[128:131], v4, s[4:7], s43 offen sc1
  v_mfma_f32_16x16x32_bf16 v[120:123], v[48:51], a[184:187], v[120:123]
  s_add_u32 s43, s43, 32768
  v_mfma_f32_16x16x32_bf16 v[124:127], v[52:55], a[184:187], v[124:127]
  ds_read2_b64 v[92:95], v143 offset0:1 offset1:129
  v_mfma_f32_16x16x32_bf16 v[120:123], v[56:59], a[188:191], v[120:123]
  v_mfma_f32_16x16x32_bf16 v[124:127], v[60:63], a[188:191], v[124:127]
  v_mfma_f32_16x16x32_bf16 v[112:115], v[16:19], a[192:195], 0
  ds_read2_b64 v[96:99], v144 offset0:0 offset1:128
  v_mfma_f32_16x16x32_bf16 v[116:119], v[20:23], a[192:195], 0
  v_mfma_f32_16x16x32_bf16 v[112:115], v[24:27], a[196:199], v[112:115]
  v_cvt_pk_bf16_f32 v132, v120, v121
  v_mfma_f32_16x16x32_bf16 v[116:119], v[28:31], a[196:199], v[116:119]
  ds_read2_b64 v[100:103], v144 offset0:1 offset1:129
  v_cvt_pk_bf16_f32 v133, v124, v125
  v_mfma_f32_16x16x32_bf16 v[112:115], v[32:35], a[200:203], v[112:115]
  v_cvt_pk_bf16_f32 v134, v122, v123
  v_mfma_f32_16x16x32_bf16 v[116:119], v[36:39], a[200:203], v[116:119]
  v_cvt_pk_bf16_f32 v135, v126, v127
  v_mfma_f32_16x16x32_bf16 v[112:115], v[40:43], a[204:207], v[112:115]
  ds_read2_b64 v[104:107], v145 offset0:0 offset1:128
  v_mfma_f32_16x16x32_bf16 v[116:119], v[44:47], a[204:207], v[116:119]
  buffer_store_dwordx4 v[132:135], v4, s[4:7], s43 offen sc1
  v_mfma_f32_16x16x32_bf16 v[112:115], v[48:51], a[208:211], v[112:115]
  s_add_u32 s43, s43, 32768
  v_mfma_f32_16x16x32_bf16 v[116:119], v[52:55], a[208:211], v[116:119]
  ds_read2_b64 v[108:111], v145 offset0:1 offset1:129
  v_mfma_f32_16x16x32_bf16 v[112:115], v[56:59], a[212:215], v[112:115]
  v_mfma_f32_16x16x32_bf16 v[116:119], v[60:63], a[212:215], v[116:119]
  v_mfma_f32_16x16x32_bf16 v[120:123], v[16:19], a[216:219], 0
  v_mfma_f32_16x16x32_bf16 v[124:127], v[20:23], a[216:219], 0
  v_mfma_f32_16x16x32_bf16 v[120:123], v[24:27], a[220:223], v[120:123]
  v_cvt_pk_bf16_f32 v128, v112, v113
  v_mfma_f32_16x16x32_bf16 v[124:127], v[28:31], a[220:223], v[124:127]
  v_cvt_pk_bf16_f32 v129, v116, v117
  v_mfma_f32_16x16x32_bf16 v[120:123], v[32:35], a[224:227], v[120:123]
  v_cvt_pk_bf16_f32 v130, v114, v115
  v_mfma_f32_16x16x32_bf16 v[124:127], v[36:39], a[224:227], v[124:127]
  v_cvt_pk_bf16_f32 v131, v118, v119
  v_mfma_f32_16x16x32_bf16 v[120:123], v[40:43], a[228:231], v[120:123]
  v_mfma_f32_16x16x32_bf16 v[124:127], v[44:47], a[228:231], v[124:127]
  buffer_store_dwordx4 v[128:131], v4, s[4:7], s43 offen sc1
  v_mfma_f32_16x16x32_bf16 v[120:123], v[48:51], a[232:235], v[120:123]
  s_add_u32 s43, s43, 32768
  v_mfma_f32_16x16x32_bf16 v[124:127], v[52:55], a[232:235], v[124:127]
  v_mfma_f32_16x16x32_bf16 v[120:123], v[56:59], a[236:239], v[120:123]
  v_mfma_f32_16x16x32_bf16 v[124:127], v[60:63], a[236:239], v[124:127]
  s_mov_b32 s28, s30
  s_add_u32 s20, s20, 1
  s_waitcnt lgkmcnt(0)
  s_branch L_ow_loop
L_ow_fin:
  v_cvt_pk_bf16_f32 v132, v120, v121
  v_cvt_pk_bf16_f32 v133, v124, v125
  v_cvt_pk_bf16_f32 v134, v122, v123
  v_cvt_pk_bf16_f32 v135, v126, v127
  buffer_store_dwordx4 v[132:135], v4, s[4:7], s43 offen sc1
  s_add_u32 s43, s43, 32768
  s_waitcnt vmcnt(0)
  v_mov_b32 v8, s20
  s_mov_b64 exec, 1
  buffer_store_dword v8, v6, s[4:7], s34 offen sc1
  s_mov_b64 exec, -1
  s_barrier
  s_add_u32 s18, s18, 96
  s_branch L_second
L_V:
  s_mul_i32 s32, s18, 384
  s_mul_i32 s33, s18, 245760
  v_lshrrev_b32 v40, 3, v1
  v_and_b32 v41, 7, v1
  v_lshrrev_b32 v43, 1, v41
  v_lshrrev_b32 v44, 1, v40
  v_xor_b32 v43, v43, v44
  v_lshlrev_b32 v42, 5, v43
  v_and_b32 v43, 1, v41
  v_lshl_add_u32 v42, v43, 4, v42
  v_lshrrev_b32 v43, 2, v40
  v_and_b32 v44, 3, v40
  v_lshl_add_u32 v45, v43, 3, v44
  s_and_b32 s22, s17, 1
  s_lshl_b32 s22, s22, 4
  v_add_u32 v45, s22, v45
  s_mov_b32 s22, 1280
  v_mul_lo_u32 v45, v45, s22
  v_add_u32 v45, v45, v42
  s_lshr_b32 s22, s17, 1
  s_mul_i32 s22, s22, 640
  v_add_u32 v45, s22, v45
  v_bfe_u32 v43, v40, 1, 1
  v_lshlrev_b32 v46, 3, v43
  v_lshrrev_b32 v43, 2, v40
  v_lshl_add_u32 v46, v43, 2, v46
  v_and_b32 v43, 1, v40
  v_add_u32 v46, v46, v43
  s_lshr_b32 s22, s17, 1
  s_lshl_b32 s22, s22, 5
  s_and_b32 s23, s17, 1
  s_lshl_b32 s23, s23, 1
  s_add_u32 s22, s22, s23
  v_add_u32 v46, s22, v46
  s_mov_b32 s22, 12288
  v_mul_lo_u32 v46, v46, s22
  v_add_u32 v46, v46, v42
  s_mul_i32 s24, s17, 6144
  s_and_b32 s25, s17, 1
  s_mul_i32 s25, s25, 10240
  s_lshr_b32 s22, s17, 1
  s_mul_i32 s22, s22, 5120
  s_add_u32 s25, s25, s22
  v_bfe_u32 v40, v1, 2, 3
  v_and_b32 v41, 3, v1
  v_lshlrev_b32 v41, 3, v41
  v_lshl_add_u32 v41, v40, 7, v41
  v_lshrrev_b32 v40, 1, v40
  v_lshrrev_b32 v44, 5, v1
  s_mul_i32 s22, s17, 3
  s_add_u32 s22, s22, 0
  s_and_b32 s23, s22, 3
  s_lshr_b32 s22, s22, 2
  s_lshl_b32 s22, s22, 10
  v_xor_b32 v43, s23, v40
  v_lshl_add_u32 v47, v43, 5, v41
  v_add_u32 v47, s22, v47
  v_mul_u32_u24 v43, 3072, v44
  v_add_u32 v47, v47, v43
  s_mul_i32 s22, s17, 3
  s_add_u32 s22, s22, 1
  s_and_b32 s23, s22, 3
  s_lshr_b32 s22, s22, 2
  s_lshl_b32 s22, s22, 10
  v_xor_b32 v43, s23, v40
  v_lshl_add_u32 v48, v43, 5, v41
  v_add_u32 v48, s22, v48
  v_mul_u32_u24 v43, 3072, v44
  v_add_u32 v48, v48, v43
  s_mul_i32 s22, s17, 3
  s_add_u32 s22, s22, 2
  s_and_b32 s23, s22, 3
  s_lshr_b32 s22, s22, 2
  s_lshl_b32 s22, s22, 10
  v_xor_b32 v43, s23, v40
  v_lshl_add_u32 v49, v43, 5, v41
  v_add_u32 v49, s22, v49
  v_mul_u32_u24 v43, 3072, v44
  v_add_u32 v49, v49, v43
  s_mul_i32 s22, s17, 10
  s_add_u32 s22, s22, 0
  s_and_b32 s23, s22, 3
  s_lshr_b32 s22, s22, 2
  s_lshl_b32 s22, s22, 10
  v_xor_b32 v43, s23, v40
  v_lshl_add_u32 v50, v43, 5, v41
  v_add_u32 v50, s22, v50
  v_mul_u32_u24 v43, 10240, v44
  v_add_u32 v50, v50, v43
  s_mul_i32 s22, s17, 10
  s_add_u32 s22, s22, 1
  s_and_b32 s23, s22, 3
  s_lshr_b32 s22, s22, 2
  s_lshl_b32 s22, s22, 10
  v_xor_b32 v43, s23, v40
  v_lshl_add_u32 v51, v43, 5, v41
  v_add_u32 v51, s22, v51
  v_mul_u32_u24 v43, 10240, v44
  v_add_u32 v51, v51, v43
  s_mul_i32 s22, s17, 10
  s_add_u32 s22, s22, 2
  s_and_b32 s23, s22, 3
  s_lshr_b32 s22, s22, 2
  s_lshl_b32 s22, s22, 10
  v_xor_b32 v43, s23, v40
  v_lshl_add_u32 v52, v43, 5, v41
  v_add_u32 v52, s22, v52
  v_mul_u32_u24 v43, 10240, v44
  v_add_u32 v52, v52, v43
  s_mul_i32 s22, s17, 10
  s_add_u32 s22, s22, 3
  s_and_b32 s23, s22, 3
  s_lshr_b32 s22, s22, 2
  s_lshl_b32 s22, s22, 10
  v_xor_b32 v43, s23, v40
  v_lshl_add_u32 v53, v43, 5, v41
  v_add_u32 v53, s22, v53
  v_mul_u32_u24 v43, 10240, v44
  v_add_u32 v53, v53, v43
  s_mul_i32 s22, s17, 10
  s_add_u32 s22, s22, 4
  s_and_b32 s23, s22, 3
  s_lshr_b32 s22, s22, 2
  s_lshl_b32 s22, s22, 10
  v_xor_b32 v43, s23, v40
  v_lshl_add_u32 v54, v43, 5, v41
  v_add_u32 v54, s22, v54
  v_mul_u32_u24 v43, 10240, v44
  v_add_u32 v54, v54, v43
  s_mul_i32 s22, s17, 10
  s_add_u32 s22, s22, 5
  s_and_b32 s23, s22, 3
  s_lshr_b32 s22, s22, 2
  s_lshl_b32 s22, s22, 10
  v_xor_b32 v43, s23, v40
  v_lshl_add_u32 v55, v43, 5, v41
  v_add_u32 v55, s22, v55
  v_mul_u32_u24 v43, 10240, v44
  v_add_u32 v55, v55, v43
  s_mul_i32 s22, s17, 10
  s_add_u32 s22, s22, 6
  s_and_b32 s23, s22, 3
  s_lshr_b32 s22, s22, 2
  s_lshl_b32 s22, s22, 10
  v_xor_b32 v43, s23, v40
  v_lshl_add_u32 v56, v43, 5, v41
  v_add_u32 v56, s22, v56
  v_mul_u32_u24 v43, 10240, v44
  v_add_u32 v56, v56, v43
  s_mul_i32 s22, s17, 10
  s_add_u32 s22, s22, 7
  s_and_b32 s23, s22, 3
  s_lshr_b32 s22, s22, 2
  s_lshl_b32 s22, s22, 10
  v_xor_b32 v43, s23, v40
  v_lshl_add_u32 v57, v43, 5, v41
  v_add_u32 v57, s22, v57
  v_mul_u32_u24 v43, 10240, v44
  v_add_u32 v57, v57, v43
  s_mul_i32 s22, s17, 10
  s_add_u32 s22, s22, 8
  s_and_b32 s23, s22, 3
  s_lshr_b32 s22, s22, 2
  s_lshl_b32 s22, s22, 10
  v_xor_b32 v43, s23, v40
  v_lshl_add_u32 v58, v43, 5, v41
  v_add_u32 v58, s22, v58
  v_mul_u32_u24 v43, 10240, v44
  v_add_u32 v58, v58, v43
  s_mul_i32 s22, s17, 10
  s_add_u32 s22, s22, 9
  s_and_b32 s23, s22, 3
  s_lshr_b32 s22, s22, 2
  s_lshl_b32 s22, s22, 10
  v_xor_b32 v43, s23, v40
  v_lshl_add_u32 v59, v43, 5, v41
  v_add_u32 v59, s22, v59
  v_mul_u32_u24 v43, 10240, v44
  v_add_u32 v59, v59, v43
  s_add_u32 m0, s25, 0
  s_add_u32 s26, s33, 0
  buffer_load_dwordx4 v45, s[12:15], s26 offen  lds
  s_add_u32 m0, s25, 1024
  s_add_u32 s26, s33, 128
  buffer_load_dwordx4 v45, s[12:15], s26 offen  lds
  s_add_u32 m0, s25, 2048
  s_add_u32 s26, s33, 256
  buffer_load_dwordx4 v45, s[12:15], s26 offen  lds
  s_add_u32 m0, s25, 3072
  s_add_u32 s26, s33, 384
  buffer_load_dwordx4 v45, s[12:15], s26 offen  lds
  s_add_u32 m0, s25, 4096
  s_add_u32 s26, s33, 512
  buffer_load_dwordx4 v45, s[12:15], s26 offen  lds
  s_mul_i32 s22, s17, 6144
  v_lshlrev_b32 v43, 4, v1
  v_add_u32 v43, s22, v43
  s_waitcnt vmcnt(0)
  s_barrier
  s_add_u32 m0, s24, 24576
  s_add_u32 s26, s32, 0
  buffer_load_dwordx4 v46, s[8:11], s26 offen  lds
  s_add_u32 m0, s24, 25600
  s_add_u32 s26, s32, 128
  buffer_load_dwordx4 v46, s[8:11], s26 offen  lds
  s_add_u32 m0, s24, 26624
  s_add_u32 s26, s32, 256
  buffer_load_dwordx4 v46, s[8:11], s26 offen  lds
  s_add_u32 m0, s24, 27648
  s_add_u32 s26, s32, 196608
  buffer_load_dwordx4 v46, s[8:11], s26 offen  lds
  s_add_u32 m0, s24, 28672
  s_add_u32 s26, s32, 196736
  buffer_load_dwordx4 v46, s[8:11], s26 offen  lds
  s_add_u32 m0, s24, 29696
  s_add_u32 s26, s32, 196864
  buffer_load_dwordx4 v46, s[8:11], s26 offen  lds
  s_add_u32 m0, s25, 49152
  s_add_u32 s26, s33, 5120
  buffer_load_dwordx4 v45, s[12:15], s26 offen  lds
  s_add_u32 m0, s25, 50176
  s_add_u32 s26, s33, 5248
  buffer_load_dwordx4 v45, s[12:15], s26 offen  lds
  s_add_u32 m0, s25, 51200
  s_add_u32 s26, s33, 5376
  buffer_load_dwordx4 v45, s[12:15], s26 offen  lds
  s_add_u32 m0, s25, 52224
  s_add_u32 s26, s33, 5504
  buffer_load_dwordx4 v45, s[12:15], s26 offen  lds
  s_add_u32 m0, s25, 53248
  s_add_u32 s26, s33, 5632
  buffer_load_dwordx4 v45, s[12:15], s26 offen  lds
  s_add_u32 m0, s25, 73728
  s_add_u32 s26, s33, 40960
  buffer_load_dwordx4 v45, s[12:15], s26 offen  lds
  s_add_u32 m0, s25, 74752
  s_add_u32 s26, s33, 41088
  buffer_load_dwordx4 v45, s[12:15], s26 offen  lds
  s_add_u32 m0, s25, 75776
  s_add_u32 s26, s33, 41216
  buffer_load_dwordx4 v45, s[12:15], s26 offen  lds
  s_add_u32 m0, s25, 76800
  s_add_u32 s26, s33, 41344
  buffer_load_dwordx4 v45, s[12:15], s26 offen  lds
  s_add_u32 m0, s25, 77824
  s_add_u32 s26, s33, 41472
  buffer_load_dwordx4 v45, s[12:15], s26 offen  lds
  s_add_u32 m0, s24, 98304
  s_add_u32 s26, s32, 786432
  buffer_load_dwordx4 v46, s[8:11], s26 offen  lds
  s_add_u32 m0, s24, 99328
  s_add_u32 s26, s32, 786560
  buffer_load_dwordx4 v46, s[8:11], s26 offen  lds
  s_add_u32 m0, s24, 100352
  s_add_u32 s26, s32, 786688
  buffer_load_dwordx4 v46, s[8:11], s26 offen  lds
  s_add_u32 m0, s24, 101376
  s_add_u32 s26, s32, 983040
  buffer_load_dwordx4 v46, s[8:11], s26 offen  lds
  s_add_u32 m0, s24, 102400
  s_add_u32 s26, s32, 983168
  buffer_load_dwordx4 v46, s[8:11], s26 offen  lds
  s_add_u32 m0, s24, 103424
  s_add_u32 s26, s32, 983296
  buffer_load_dwordx4 v46, s[8:11], s26 offen  lds
  s_add_u32 m0, s25, 122880
  s_add_u32 s26, s33, 46080
  buffer_load_dwordx4 v45, s[12:15], s26 offen  lds
  s_add_u32 m0, s25, 123904
  s_add_u32 s26, s33, 46208
  buffer_load_dwordx4 v45, s[12:15], s26 offen  lds
  s_add_u32 m0, s25, 124928
  s_add_u32 s26, s33, 46336
  buffer_load_dwordx4 v45, s[12:15], s26 offen  lds
  s_add_u32 m0, s25, 125952
  s_add_u32 s26, s33, 46464
  buffer_load_dwordx4 v45, s[12:15], s26 offen  lds
  s_add_u32 m0, s25, 126976
  s_add_u32 s26, s33, 46592
  buffer_load_dwordx4 v45, s[12:15], s26 offen  lds
  v_add_u32 v60, 0, v50
  v_add_u32 v61, 0, v51
  v_add_u32 v62, 0, v52
  v_add_u32 v63, 0, v53
  v_add_u32 v64, 0, v54
  v_add_u32 v65, 0, v55
  v_add_u32 v66, 0, v56
  v_add_u32 v67, 0, v57
  v_add_u32 v68, 0, v58
  v_add_u32 v69, 0, v59
  ds_read_b64_tr_b16 a[0:1], v60 offset:0
  ds_read_b64_tr_b16 a[24:25], v61 offset:0
  ds_read_b64_tr_b16 a[48:49], v62 offset:0
  ds_read_b64_tr_b16 a[72:73], v63 offset:0
  ds_read_b64_tr_b16 a[96:97], v64 offset:0
  ds_read_b64_tr_b16 a[120:121], v65 offset:0
  ds_read_b64_tr_b16 a[144:145], v66 offset:0
  ds_read_b64_tr_b16 a[168:169], v67 offset:0
  ds_read_b64_tr_b16 a[192:193], v68 offset:0
  ds_read_b64_tr_b16 a[216:217], v69 offset:0
  s_waitcnt lgkmcnt(0)
  s_waitcnt vmcnt(21)
  s_barrier
  s_add_u32 m0, s25, 0
  s_add_u32 s26, s33, 81920
  buffer_load_dwordx4 v45, s[12:15], s26 offen  lds
  s_add_u32 m0, s25, 1024
  s_add_u32 s26, s33, 82048
  buffer_load_dwordx4 v45, s[12:15], s26 offen  lds
  s_add_u32 m0, s25, 2048
  s_add_u32 s26, s33, 82176
  buffer_load_dwordx4 v45, s[12:15], s26 offen  lds
  s_add_u32 m0, s25, 3072
  s_add_u32 s26, s33, 82304
  buffer_load_dwordx4 v45, s[12:15], s26 offen  lds
  s_add_u32 m0, s25, 4096
  s_add_u32 s26, s33, 82432
  buffer_load_dwordx4 v45, s[12:15], s26 offen  lds
  v_add_u32 v60, 24576, v47
  v_add_u32 v61, 24576, v48
  v_add_u32 v62, 24576, v49
  ds_read_b64_tr_b16 a[240:241], v60 offset:0
  ds_read_b64_tr_b16 a[242:243], v60 offset:6144
  ds_read_b64_tr_b16 a[244:245], v60 offset:12288
  ds_read_b64_tr_b16 a[246:247], v60 offset:18432
  ds_read_b64_tr_b16 a[248:249], v61 offset:0
  ds_read_b64_tr_b16 a[250:251], v61 offset:6144
  ds_read_b64_tr_b16 a[252:253], v61 offset:12288
  ds_read_b64_tr_b16 a[254:255], v61 offset:18432
  ds_read_b64_tr_b16 v[128:129], v62 offset:0
  ds_read_b64_tr_b16 v[130:131], v62 offset:6144
  ds_read_b64_tr_b16 v[132:133], v62 offset:12288
  ds_read_b64_tr_b16 v[134:135], v62 offset:18432
  s_waitcnt lgkmcnt(0)
  s_waitcnt vmcnt(21)
  s_barrier
  s_add_u32 m0, s24, 24576
  s_add_u32 s26, s32, 1572864
  buffer_load_dwordx4 v46, s[8:11], s26 offen  lds
  s_add_u32 m0, s24, 25600
  s_add_u32 s26, s32, 1572992
  buffer_load_dwordx4 v46, s[8:11], s26 offen  lds
  s_add_u32 m0, s24, 26624
  s_add_u32 s26, s32, 1573120
  buffer_load_dwordx4 v46, s[8:11], s26 offen  lds
  s_add_u32 m0, s24, 27648
  s_add_u32 s26, s32, 1769472
  buffer_load_dwordx4 v46, s[8:11], s26 offen  lds
  s_add_u32 m0, s24, 28672
  s_add_u32 s26, s32, 1769600
  buffer_load_dwordx4 v46, s[8:11], s26 offen  lds
  s_add_u32 m0, s24, 29696
  s_add_u32 s26, s32, 1769728
  buffer_load_dwordx4 v46, s[8:11], s26 offen  lds
  v_add_u32 v60, 49152, v50
  v_add_u32 v61, 49152, v51
  v_add_u32 v62, 49152, v52
  v_add_u32 v63, 49152, v53
  v_add_u32 v64, 49152, v54
  v_add_u32 v65, 49152, v55
  v_add_u32 v66, 49152, v56
  v_add_u32 v67, 49152, v57
  v_add_u32 v68, 49152, v58
  v_add_u32 v69, 49152, v59
  ds_read_b64_tr_b16 a[2:3], v60 offset:0
  ds_read_b64_tr_b16 a[26:27], v61 offset:0
  ds_read_b64_tr_b16 a[50:51], v62 offset:0
  ds_read_b64_tr_b16 a[74:75], v63 offset:0
  ds_read_b64_tr_b16 a[98:99], v64 offset:0
  ds_read_b64_tr_b16 a[122:123], v65 offset:0
  ds_read_b64_tr_b16 a[146:147], v66 offset:0
  ds_read_b64_tr_b16 a[170:171], v67 offset:0
  ds_read_b64_tr_b16 a[194:195], v68 offset:0
  ds_read_b64_tr_b16 a[218:219], v69 offset:0
  s_waitcnt lgkmcnt(0)
  s_waitcnt vmcnt(22)
  s_barrier
  s_add_u32 m0, s25, 49152
  s_add_u32 s26, s33, 87040
  buffer_load_dwordx4 v45, s[12:15], s26 offen  lds
  s_add_u32 m0, s25, 50176
  s_add_u32 s26, s33, 87168
  buffer_load_dwordx4 v45, s[12:15], s26 offen  lds
  s_add_u32 m0, s25, 51200
  s_add_u32 s26, s33, 87296
  buffer_load_dwordx4 v45, s[12:15], s26 offen  lds
  s_add_u32 m0, s25, 52224
  s_add_u32 s26, s33, 87424
  buffer_load_dwordx4 v45, s[12:15], s26 offen  lds
  s_add_u32 m0, s25, 53248
  s_add_u32 s26, s33, 87552
  buffer_load_dwordx4 v45, s[12:15], s26 offen  lds
  v_add_u32 v60, 73728, v50
  v_add_u32 v61, 73728, v51
  v_add_u32 v62, 73728, v52
  v_add_u32 v63, 73728, v53
  v_add_u32 v64, 73728, v54
  v_add_u32 v65, 73728, v55
  v_add_u32 v66, 73728, v56
  v_add_u32 v67, 73728, v57
  v_add_u32 v68, 73728, v58
  v_add_u32 v69, 73728, v59
  ds_read_b64_tr_b16 a[4:5], v60 offset:0
  ds_read_b64_tr_b16 a[28:29], v61 offset:0
  ds_read_b64_tr_b16 a[52:53], v62 offset:0
  ds_read_b64_tr_b16 a[76:77], v63 offset:0
  ds_read_b64_tr_b16 a[100:101], v64 offset:0
  ds_read_b64_tr_b16 a[124:125], v65 offset:0
  ds_read_b64_tr_b16 a[148:149], v66 offset:0
  ds_read_b64_tr_b16 a[172:173], v67 offset:0
  ds_read_b64_tr_b16 a[196:197], v68 offset:0
  ds_read_b64_tr_b16 a[220:221], v69 offset:0
  s_waitcnt lgkmcnt(0)
  s_waitcnt vmcnt(21)
  s_barrier
  s_add_u32 m0, s25, 73728
  s_add_u32 s26, s33, 122880
  buffer_load_dwordx4 v45, s[12:15], s26 offen  lds
  s_add_u32 m0, s25, 74752
  s_add_u32 s26, s33, 123008
  buffer_load_dwordx4 v45, s[12:15], s26 offen  lds
  s_add_u32 m0, s25, 75776
  s_add_u32 s26, s33, 123136
  buffer_load_dwordx4 v45, s[12:15], s26 offen  lds
  s_add_u32 m0, s25, 76800
  s_add_u32 s26, s33, 123264
  buffer_load_dwordx4 v45, s[12:15], s26 offen  lds
  s_add_u32 m0, s25, 77824
  s_add_u32 s26, s33, 123392
  buffer_load_dwordx4 v45, s[12:15], s26 offen  lds
  v_add_u32 v60, 98304, v47
  v_add_u32 v61, 98304, v48
  v_add_u32 v62, 98304, v49
  ds_read_b64_tr_b16 v[136:137], v60 offset:0
  ds_read_b64_tr_b16 v[138:139], v60 offset:6144
  ds_read_b64_tr_b16 v[140:141], v60 offset:12288
  ds_read_b64_tr_b16 v[142:143], v60 offset:18432
  ds_read_b64_tr_b16 v[144:145], v61 offset:0
  ds_read_b64_tr_b16 v[146:147], v61 offset:6144
  ds_read_b64_tr_b16 v[148:149], v61 offset:12288
  ds_read_b64_tr_b16 v[150:151], v61 offset:18432
  ds_read_b64_tr_b16 v[152:153], v62 offset:0
  ds_read_b64_tr_b16 v[154:155], v62 offset:6144
  ds_read_b64_tr_b16 v[156:157], v62 offset:12288
  ds_read_b64_tr_b16 v[158:159], v62 offset:18432
  s_waitcnt lgkmcnt(0)
  s_waitcnt vmcnt(21)
  s_barrier
  s_add_u32 m0, s24, 98304
  s_add_u32 s26, s32, 2359296
  buffer_load_dwordx4 v46, s[8:11], s26 offen  lds
  s_add_u32 m0, s24, 99328
  s_add_u32 s26, s32, 2359424
  buffer_load_dwordx4 v46, s[8:11], s26 offen  lds
  s_add_u32 m0, s24, 100352
  s_add_u32 s26, s32, 2359552
  buffer_load_dwordx4 v46, s[8:11], s26 offen  lds
  s_add_u32 m0, s24, 101376
  s_add_u32 s26, s32, 2555904
  buffer_load_dwordx4 v46, s[8:11], s26 offen  lds
  s_add_u32 m0, s24, 102400
  s_add_u32 s26, s32, 2556032
  buffer_load_dwordx4 v46, s[8:11], s26 offen  lds
  s_add_u32 m0, s24, 103424
  s_add_u32 s26, s32, 2556160
  buffer_load_dwordx4 v46, s[8:11], s26 offen  lds
  v_add_u32 v60, 122880, v50
  v_add_u32 v61, 122880, v51
  v_add_u32 v62, 122880, v52
  v_add_u32 v63, 122880, v53
  v_add_u32 v64, 122880, v54
  v_add_u32 v65, 122880, v55
  v_add_u32 v66, 122880, v56
  v_add_u32 v67, 122880, v57
  v_add_u32 v68, 122880, v58
  v_add_u32 v69, 122880, v59
  ds_read_b64_tr_b16 a[6:7], v60 offset:0
  ds_read_b64_tr_b16 a[30:31], v61 offset:0
  ds_read_b64_tr_b16 a[54:55], v62 offset:0
  ds_read_b64_tr_b16 a[78:79], v63 offset:0
  ds_read_b64_tr_b16 a[102:103], v64 offset:0
  ds_read_b64_tr_b16 a[126:127], v65 offset:0
  ds_read_b64_tr_b16 a[150:151], v66 offset:0
  ds_read_b64_tr_b16 a[174:175], v67 offset:0
  ds_read_b64_tr_b16 a[198:199], v68 offset:0
  ds_read_b64_tr_b16 a[222:223], v69 offset:0
  s_waitcnt lgkmcnt(0)
  s_waitcnt vmcnt(22)
  s_barrier
  s_add_u32 m0, s25, 122880
  s_add_u32 s26, s33, 128000
  buffer_load_dwordx4 v45, s[12:15], s26 offen  lds
  s_add_u32 m0, s25, 123904
  s_add_u32 s26, s33, 128128
  buffer_load_dwordx4 v45, s[12:15], s26 offen  lds
  s_add_u32 m0, s25, 124928
  s_add_u32 s26, s33, 128256
  buffer_load_dwordx4 v45, s[12:15], s26 offen  lds
  s_add_u32 m0, s25, 125952
  s_add_u32 s26, s33, 128384
  buffer_load_dwordx4 v45, s[12:15], s26 offen  lds
  s_add_u32 m0, s25, 126976
  s_add_u32 s26, s33, 128512
  buffer_load_dwordx4 v45, s[12:15], s26 offen  lds
  v_add_u32 v60, 0, v50
  v_add_u32 v61, 0, v51
  v_add_u32 v62, 0, v52
  v_add_u32 v63, 0, v53
  v_add_u32 v64, 0, v54
  v_add_u32 v65, 0, v55
  v_add_u32 v66, 0, v56
  v_add_u32 v67, 0, v57
  v_add_u32 v68, 0, v58
  v_add_u32 v69, 0, v59
  ds_read_b64_tr_b16 a[8:9], v60 offset:0
  ds_read_b64_tr_b16 a[32:33], v61 offset:0
  ds_read_b64_tr_b16 a[56:57], v62 offset:0
  ds_read_b64_tr_b16 a[80:81], v63 offset:0
  ds_read_b64_tr_b16 a[104:105], v64 offset:0
  ds_read_b64_tr_b16 a[128:129], v65 offset:0
  ds_read_b64_tr_b16 a[152:153], v66 offset:0
  ds_read_b64_tr_b16 a[176:177], v67 offset:0
  ds_read_b64_tr_b16 a[200:201], v68 offset:0
  ds_read_b64_tr_b16 a[224:225], v69 offset:0
  s_waitcnt lgkmcnt(0)
  s_waitcnt vmcnt(21)
  s_barrier
  s_add_u32 m0, s25, 0
  s_add_u32 s26, s33, 163840
  buffer_load_dwordx4 v45, s[12:15], s26 offen  lds
  s_add_u32 m0, s25, 1024
  s_add_u32 s26, s33, 163968
  buffer_load_dwordx4 v45, s[12:15], s26 offen  lds
  s_add_u32 m0, s25, 2048
  s_add_u32 s26, s33, 164096
  buffer_load_dwordx4 v45, s[12:15], s26 offen  lds
  s_add_u32 m0, s25, 3072
  s_add_u32 s26, s33, 164224
  buffer_load_dwordx4 v45, s[12:15], s26 offen  lds
  s_add_u32 m0, s25, 4096
  s_add_u32 s26, s33, 164352
  buffer_load_dwordx4 v45, s[12:15], s26 offen  lds
  v_add_u32 v60, 24576, v47
  v_add_u32 v61, 24576, v48
  v_add_u32 v62, 24576, v49
  ds_read_b64_tr_b16 v[160:161], v60 offset:0
  ds_read_b64_tr_b16 v[162:163], v60 offset:6144
  ds_read_b64_tr_b16 v[164:165], v60 offset:12288
  ds_read_b64_tr_b16 v[166:167], v60 offset:18432
  ds_read_b64_tr_b16 v[168:169], v61 offset:0
  ds_read_b64_tr_b16 v[170:171], v61 offset:6144
  ds_read_b64_tr_b16 v[172:173], v61 offset:12288
  ds_read_b64_tr_b16 v[174:175], v61 offset:18432
  ds_read_b64_tr_b16 v[176:177], v62 offset:0
  ds_read_b64_tr_b16 v[178:179], v62 offset:6144
  ds_read_b64_tr_b16 v[180:181], v62 offset:12288
  ds_read_b64_tr_b16 v[182:183], v62 offset:18432
  s_waitcnt lgkmcnt(0)
  s_waitcnt vmcnt(21)
  s_barrier
  s_add_u32 m0, s24, 24576
  s_add_u32 s26, s32, 3145728
  buffer_load_dwordx4 v46, s[8:11], s26 offen  lds
  s_add_u32 m0, s24, 25600
  s_add_u32 s26, s32, 3145856
  buffer_load_dwordx4 v46, s[8:11], s26 offen  lds
  s_add_u32 m0, s24, 26624
  s_add_u32 s26, s32, 3145984
  buffer_load_dwordx4 v46, s[8:11], s26 offen  lds
  s_add_u32 m0, s24, 27648
  s_add_u32 s26, s32, 3342336
  buffer_load_dwordx4 v46, s[8:11], s26 offen  lds
  s_add_u32 m0, s24, 28672
  s_add_u32 s26, s32, 3342464
  buffer_load_dwordx4 v46, s[8:11], s26 offen  lds
  s_add_u32 m0, s24, 29696
  s_add_u32 s26, s32, 3342592
  buffer_load_dwordx4 v46, s[8:11], s26 offen  lds
  v_add_u32 v60, 49152, v50
  v_add_u32 v61, 49152, v51
  v_add_u32 v62, 49152, v52
  v_add_u32 v63, 49152, v53
  v_add_u32 v64, 49152, v54
  v_add_u32 v65, 49152, v55
  v_add_u32 v66, 49152, v56
  v_add_u32 v67, 49152, v57
  v_add_u32 v68, 49152, v58
  v_add_u32 v69, 49152, v59
  ds_read_b64_tr_b16 a[10:11], v60 offset:0
  ds_read_b64_tr_b16 a[34:35], v61 offset:0
  ds_read_b64_tr_b16 a[58:59], v62 offset:0
  ds_read_b64_tr_b16 a[82:83], v63 offset:0
  ds_read_b64_tr_b16 a[106:107], v64 offset:0
  ds_read_b64_tr_b16 a[130:131], v65 offset:0
  ds_read_b64_tr_b16 a[154:155], v66 offset:0
  ds_read_b64_tr_b16 a[178:179], v67 offset:0
  ds_read_b64_tr_b16 a[202:203], v68 offset:0
  ds_read_b64_tr_b16 a[226:227], v69 offset:0
  s_waitcnt lgkmcnt(0)
  s_waitcnt vmcnt(22)
  s_barrier
  s_add_u32 m0, s25, 49152
  s_add_u32 s26, s33, 168960
  buffer_load_dwordx4 v45, s[12:15], s26 offen  lds
  s_add_u32 m0, s25, 50176
  s_add_u32 s26, s33, 169088
  buffer_load_dwordx4 v45, s[12:15], s26 offen  lds
  s_add_u32 m0, s25, 51200
  s_add_u32 s26, s33, 169216
  buffer_load_dwordx4 v45, s[12:15], s26 offen  lds
  s_add_u32 m0, s25, 52224
  s_add_u32 s26, s33, 169344
  buffer_load_dwordx4 v45, s[12:15], s26 offen  lds
  s_add_u32 m0, s25, 53248
  s_add_u32 s26, s33, 169472
  buffer_load_dwordx4 v45, s[12:15], s26 offen  lds
  v_add_u32 v60, 73728, v50
  v_add_u32 v61, 73728, v51
  v_add_u32 v62, 73728, v52
  v_add_u32 v63, 73728, v53
  v_add_u32 v64, 73728, v54
  v_add_u32 v65, 73728, v55
  v_add_u32 v66, 73728, v56
  v_add_u32 v67, 73728, v57
  v_add_u32 v68, 73728, v58
  v_add_u32 v69, 73728, v59
  ds_read_b64_tr_b16 a[12:13], v60 offset:0
  ds_read_b64_tr_b16 a[36:37], v61 offset:0
  ds_read_b64_tr_b16 a[60:61], v62 offset:0
  ds_read_b64_tr_b16 a[84:85], v63 offset:0
  ds_read_b64_tr_b16 a[108:109], v64 offset:0
  ds_read_b64_tr_b16 a[132:133], v65 offset:0
  ds_read_b64_tr_b16 a[156:157], v66 offset:0
  ds_read_b64_tr_b16 a[180:181], v67 offset:0
  ds_read_b64_tr_b16 a[204:205], v68 offset:0
  ds_read_b64_tr_b16 a[228:229], v69 offset:0
  s_waitcnt lgkmcnt(0)
  s_waitcnt vmcnt(21)
  s_barrier
  s_add_u32 m0, s25, 73728
  s_add_u32 s26, s33, 204800
  buffer_load_dwordx4 v45, s[12:15], s26 offen  lds
  s_add_u32 m0, s25, 74752
  s_add_u32 s26, s33, 204928
  buffer_load_dwordx4 v45, s[12:15], s26 offen  lds
  s_add_u32 m0, s25, 75776
  s_add_u32 s26, s33, 205056
  buffer_load_dwordx4 v45, s[12:15], s26 offen  lds
  s_add_u32 m0, s25, 76800
  s_add_u32 s26, s33, 205184
  buffer_load_dwordx4 v45, s[12:15], s26 offen  lds
  s_add_u32 m0, s25, 77824
  s_add_u32 s26, s33, 205312
  buffer_load_dwordx4 v45, s[12:15], s26 offen  lds
  v_add_u32 v60, 98304, v47
  v_add_u32 v61, 98304, v48
  v_add_u32 v62, 98304, v49
  ds_read_b64_tr_b16 v[184:185], v60 offset:0
  ds_read_b64_tr_b16 v[186:187], v60 offset:6144
  ds_read_b64_tr_b16 v[188:189], v60 offset:12288
  ds_read_b64_tr_b16 v[190:191], v60 offset:18432
  ds_read_b64_tr_b16 v[192:193], v61 offset:0
  ds_read_b64_tr_b16 v[194:195], v61 offset:6144
  ds_read_b64_tr_b16 v[196:197], v61 offset:12288
  ds_read_b64_tr_b16 v[198:199], v61 offset:18432
  ds_read_b64_tr_b16 v[200:201], v62 offset:0
  ds_read_b64_tr_b16 v[202:203], v62 offset:6144
  ds_read_b64_tr_b16 v[204:205], v62 offset:12288
  ds_read_b64_tr_b16 v[206:207], v62 offset:18432
  s_waitcnt lgkmcnt(0)
  s_waitcnt vmcnt(21)
  s_barrier
  s_add_u32 m0, s24, 98304
  s_add_u32 s26, s32, 3932160
  buffer_load_dwordx4 v46, s[8:11], s26 offen  lds
  s_add_u32 m0, s24, 99328
  s_add_u32 s26, s32, 3932288
  buffer_load_dwordx4 v46, s[8:11], s26 offen  lds
  s_add_u32 m0, s24, 100352
  s_add_u32 s26, s32, 3932416
  buffer_load_dwordx4 v46, s[8:11], s26 offen  lds
  s_add_u32 m0, s24, 101376
  s_add_u32 s26, s32, 4128768
  buffer_load_dwordx4 v46, s[8:11], s26 offen  lds
  s_add_u32 m0, s24, 102400
  s_add_u32 s26, s32, 4128896
  buffer_load_dwordx4 v46, s[8:11], s26 offen  lds
  s_add_u32 m0, s24, 103424
  s_add_u32 s26, s32, 4129024
  buffer_load_dwordx4 v46, s[8:11], s26 offen  lds
  v_add_u32 v60, 122880, v50
  v_add_u32 v61, 122880, v51
  v_add_u32 v62, 122880, v52
  v_add_u32 v63, 122880, v53
  v_add_u32 v64, 122880, v54
  v_add_u32 v65, 122880, v55
  v_add_u32 v66, 122880, v56
  v_add_u32 v67, 122880, v57
  v_add_u32 v68, 122880, v58
  v_add_u32 v69, 122880, v59
  ds_read_b64_tr_b16 a[14:15], v60 offset:0
  ds_read_b64_tr_b16 a[38:39], v61 offset:0
  ds_read_b64_tr_b16 a[62:63], v62 offset:0
  ds_read_b64_tr_b16 a[86:87], v63 offset:0
  ds_read_b64_tr_b16 a[110:111], v64 offset:0
  ds_read_b64_tr_b16 a[134:135], v65 offset:0
  ds_read_b64_tr_b16 a[158:159], v66 offset:0
  ds_read_b64_tr_b16 a[182:183], v67 offset:0
  ds_read_b64_tr_b16 a[206:207], v68 offset:0
  ds_read_b64_tr_b16 a[230:231], v69 offset:0
  s_waitcnt lgkmcnt(0)
  s_waitcnt vmcnt(22)
  s_barrier
  s_add_u32 m0, s25, 122880
  s_add_u32 s26, s33, 209920
  buffer_load_dwordx4 v45, s[12:15], s26 offen  lds
  s_add_u32 m0, s25, 123904
  s_add_u32 s26, s33, 210048
  buffer_load_dwordx4 v45, s[12:15], s26 offen  lds
  s_add_u32 m0, s25, 124928
  s_add_u32 s26, s33, 210176
  buffer_load_dwordx4 v45, s[12:15], s26 offen  lds
  s_add_u32 m0, s25, 125952
  s_add_u32 s26, s33, 210304
  buffer_load_dwordx4 v45, s[12:15], s26 offen  lds
  s_add_u32 m0, s25, 126976
  s_add_u32 s26, s33, 210432
  buffer_load_dwordx4 v45, s[12:15], s26 offen  lds
  v_add_u32 v60, 0, v50
  v_add_u32 v61, 0, v51
  v_add_u32 v62, 0, v52
  v_add_u32 v63, 0, v53
  v_add_u32 v64, 0, v54
  v_add_u32 v65, 0, v55
  v_add_u32 v66, 0, v56
  v_add_u32 v67, 0, v57
  v_add_u32 v68, 0, v58
  v_add_u32 v69, 0, v59
  ds_read_b64_tr_b16 a[16:17], v60 offset:0
  ds_read_b64_tr_b16 a[40:41], v61 offset:0
  ds_read_b64_tr_b16 a[64:65], v62 offset:0
  ds_read_b64_tr_b16 a[88:89], v63 offset:0
  ds_read_b64_tr_b16 a[112:113], v64 offset:0
  ds_read_b64_tr_b16 a[136:137], v65 offset:0
  ds_read_b64_tr_b16 a[160:161], v66 offset:0
  ds_read_b64_tr_b16 a[184:185], v67 offset:0
  ds_read_b64_tr_b16 a[208:209], v68 offset:0
  ds_read_b64_tr_b16 a[232:233], v69 offset:0
  s_waitcnt lgkmcnt(0)
  s_waitcnt vmcnt(21)
  s_barrier
  s_add_u32 m0, s24, 0
  s_add_u32 s26, s32, 4718592
  buffer_load_dwordx4 v46, s[8:11], s26 offen  lds
  s_add_u32 m0, s24, 1024
  s_add_u32 s26, s32, 4718720
  buffer_load_dwordx4 v46, s[8:11], s26 offen  lds
  s_add_u32 m0, s24, 2048
  s_add_u32 s26, s32, 4718848
  buffer_load_dwordx4 v46, s[8:11], s26 offen  lds
  s_add_u32 m0, s24, 3072
  s_add_u32 s26, s32, 4915200
  buffer_load_dwordx4 v46, s[8:11], s26 offen  lds
  s_add_u32 m0, s24, 4096
  s_add_u32 s26, s32, 4915328
  buffer_load_dwordx4 v46, s[8:11], s26 offen  lds
  s_add_u32 m0, s24, 5120
  s_add_u32 s26, s32, 4915456
  buffer_load_dwordx4 v46, s[8:11], s26 offen  lds
  v_add_u32 v60, 24576, v47
  v_add_u32 v61, 24576, v48
  v_add_u32 v62, 24576, v49
  ds_read_b64_tr_b16 v[208:209], v60 offset:0
  ds_read_b64_tr_b16 v[210:211], v60 offset:6144
  ds_read_b64_tr_b16 v[212:213], v60 offset:12288
  ds_read_b64_tr_b16 v[214:215], v60 offset:18432
  ds_read_b64_tr_b16 v[216:217], v61 offset:0
  ds_read_b64_tr_b16 v[218:219], v61 offset:6144
  ds_read_b64_tr_b16 v[220:221], v61 offset:12288
  ds_read_b64_tr_b16 v[222:223], v61 offset:18432
  ds_read_b64_tr_b16 v[224:225], v62 offset:0
  ds_read_b64_tr_b16 v[226:227], v62 offset:6144
  ds_read_b64_tr_b16 v[228:229], v62 offset:12288
  ds_read_b64_tr_b16 v[230:231], v62 offset:18432
  s_waitcnt lgkmcnt(0)
  s_waitcnt vmcnt(22)
  s_barrier
  s_add_u32 m0, s24, 24576
  s_add_u32 s26, s32, 5505024
  buffer_load_dwordx4 v46, s[8:11], s26 offen  lds
  s_add_u32 m0, s24, 25600
  s_add_u32 s26, s32, 5505152
  buffer_load_dwordx4 v46, s[8:11], s26 offen  lds
  s_add_u32 m0, s24, 26624
  s_add_u32 s26, s32, 5505280
  buffer_load_dwordx4 v46, s[8:11], s26 offen  lds
  s_add_u32 m0, s24, 27648
  s_add_u32 s26, s32, 5701632
  buffer_load_dwordx4 v46, s[8:11], s26 offen  lds
  s_add_u32 m0, s24, 28672
  s_add_u32 s26, s32, 5701760
  buffer_load_dwordx4 v46, s[8:11], s26 offen  lds
  s_add_u32 m0, s24, 29696
  s_add_u32 s26, s32, 5701888
  buffer_load_dwordx4 v46, s[8:11], s26 offen  lds
  v_add_u32 v60, 49152, v50
  v_add_u32 v61, 49152, v51
  v_add_u32 v62, 49152, v52
  v_add_u32 v63, 49152, v53
  v_add_u32 v64, 49152, v54
  v_add_u32 v65, 49152, v55
  v_add_u32 v66, 49152, v56
  v_add_u32 v67, 49152, v57
  v_add_u32 v68, 49152, v58
  v_add_u32 v69, 49152, v59
  ds_read_b64_tr_b16 a[18:19], v60 offset:0
  ds_read_b64_tr_b16 a[42:43], v61 offset:0
  ds_read_b64_tr_b16 a[66:67], v62 offset:0
  ds_read_b64_tr_b16 a[90:91], v63 offset:0
  ds_read_b64_tr_b16 a[114:115], v64 offset:0
  ds_read_b64_tr_b16 a[138:139], v65 offset:0
  ds_read_b64_tr_b16 a[162:163], v66 offset:0
  ds_read_b64_tr_b16 a[186:187], v67 offset:0
  ds_read_b64_tr_b16 a[210:211], v68 offset:0
  ds_read_b64_tr_b16 a[234:235], v69 offset:0
  s_waitcnt lgkmcnt(0)
  s_waitcnt vmcnt(23)
  s_barrier
  s_add_u32 m0, s24, 49152
  s_add_u32 s26, s32, 6291456
  buffer_load_dwordx4 v46, s[8:11], s26 offen  lds
  s_add_u32 m0, s24, 50176
  s_add_u32 s26, s32, 6291584
  buffer_load_dwordx4 v46, s[8:11], s26 offen  lds
  s_add_u32 m0, s24, 51200
  s_add_u32 s26, s32, 6291712
  buffer_load_dwordx4 v46, s[8:11], s26 offen  lds
  s_add_u32 m0, s24, 52224
  s_add_u32 s26, s32, 6488064
  buffer_load_dwordx4 v46, s[8:11], s26 offen  lds
  s_add_u32 m0, s24, 53248
  s_add_u32 s26, s32, 6488192
  buffer_load_dwordx4 v46, s[8:11], s26 offen  lds
  s_add_u32 m0, s24, 54272
  s_add_u32 s26, s32, 6488320
  buffer_load_dwordx4 v46, s[8:11], s26 offen  lds
  v_add_u32 v60, 73728, v50
  v_add_u32 v61, 73728, v51
  v_add_u32 v62, 73728, v52
  v_add_u32 v63, 73728, v53
  v_add_u32 v64, 73728, v54
  v_add_u32 v65, 73728, v55
  v_add_u32 v66, 73728, v56
  v_add_u32 v67, 73728, v57
  v_add_u32 v68, 73728, v58
  v_add_u32 v69, 73728, v59
  ds_read_b64_tr_b16 a[20:21], v60 offset:0
  ds_read_b64_tr_b16 a[44:45], v61 offset:0
  ds_read_b64_tr_b16 a[68:69], v62 offset:0
  ds_read_b64_tr_b16 a[92:93], v63 offset:0
  ds_read_b64_tr_b16 a[116:117], v64 offset:0
  ds_read_b64_tr_b16 a[140:141], v65 offset:0
  ds_read_b64_tr_b16 a[164:165], v66 offset:0
  ds_read_b64_tr_b16 a[188:189], v67 offset:0
  ds_read_b64_tr_b16 a[212:213], v68 offset:0
  ds_read_b64_tr_b16 a[236:237], v69 offset:0
  s_waitcnt lgkmcnt(0)
  s_waitcnt vmcnt(23)
  s_barrier
  s_add_u32 m0, s24, 73728
  s_add_u32 s26, s32, 7077888
  buffer_load_dwordx4 v46, s[8:11], s26 offen  lds
  s_add_u32 m0, s24, 74752
  s_add_u32 s26, s32, 7078016
  buffer_load_dwordx4 v46, s[8:11], s26 offen  lds
  s_add_u32 m0, s24, 75776
  s_add_u32 s26, s32, 7078144
  buffer_load_dwordx4 v46, s[8:11], s26 offen  lds
  s_add_u32 m0, s24, 76800
  s_add_u32 s26, s32, 7274496
  buffer_load_dwordx4 v46, s[8:11], s26 offen  lds
  s_add_u32 m0, s24, 77824
  s_add_u32 s26, s32, 7274624
  buffer_load_dwordx4 v46, s[8:11], s26 offen  lds
  s_add_u32 m0, s24, 78848
  s_add_u32 s26, s32, 7274752
  buffer_load_dwordx4 v46, s[8:11], s26 offen  lds
  v_add_u32 v60, 98304, v47
  v_add_u32 v61, 98304, v48
  v_add_u32 v62, 98304, v49
  ds_read_b64_tr_b16 v[232:233], v60 offset:0
  ds_read_b64_tr_b16 v[234:235], v60 offset:6144
  ds_read_b64_tr_b16 v[236:237], v60 offset:12288
  ds_read_b64_tr_b16 v[238:239], v60 offset:18432
  ds_read_b64_tr_b16 v[240:241], v61 offset:0
  ds_read_b64_tr_b16 v[242:243], v61 offset:6144
  ds_read_b64_tr_b16 v[244:245], v61 offset:12288
  ds_read_b64_tr_b16 v[246:247], v61 offset:18432
  ds_read_b64_tr_b16 v[248:249], v62 offset:0
  ds_read_b64_tr_b16 v[250:251], v62 offset:6144
  ds_read_b64_tr_b16 v[252:253], v62 offset:12288
  ds_read_b64_tr_b16 v[254:255], v62 offset:18432
  s_waitcnt lgkmcnt(0)
  s_waitcnt vmcnt(24)
  s_barrier
  v_add_u32 v60, 122880, v50
  v_add_u32 v61, 122880, v51
  v_add_u32 v62, 122880, v52
  v_add_u32 v63, 122880, v53
  v_add_u32 v64, 122880, v54
  v_add_u32 v65, 122880, v55
  v_add_u32 v66, 122880, v56
  v_add_u32 v67, 122880, v57
  v_add_u32 v68, 122880, v58
  v_add_u32 v69, 122880, v59
  ds_read_b64_tr_b16 a[22:23], v60 offset:0
  ds_read_b64_tr_b16 a[46:47], v61 offset:0
  ds_read_b64_tr_b16 a[70:71], v62 offset:0
  ds_read_b64_tr_b16 a[94:95], v63 offset:0
  ds_read_b64_tr_b16 a[118:119], v64 offset:0
  ds_read_b64_tr_b16 a[142:143], v65 offset:0
  ds_read_b64_tr_b16 a[166:167], v66 offset:0
  ds_read_b64_tr_b16 a[190:191], v67 offset:0
  ds_read_b64_tr_b16 a[214:215], v68 offset:0
  ds_read_b64_tr_b16 a[238:239], v69 offset:0
  s_waitcnt lgkmcnt(0)
  s_waitcnt vmcnt(18)
  s_barrier
  v_add_u32 v60, 0, v47
  v_add_u32 v61, 0, v48
  v_add_u32 v62, 0, v49
  v_add_u32 v63, 0, v43
  ds_read_b64_tr_b16 v[76:77], v60 offset:0
  ds_read_b64_tr_b16 v[78:79], v60 offset:6144
  ds_read_b64_tr_b16 v[80:81], v60 offset:12288
  ds_read_b64_tr_b16 v[82:83], v60 offset:18432
  ds_read_b64_tr_b16 v[84:85], v61 offset:0
  ds_read_b64_tr_b16 v[86:87], v61 offset:6144
  ds_read_b64_tr_b16 v[88:89], v61 offset:12288
  ds_read_b64_tr_b16 v[90:91], v61 offset:18432
  ds_read_b64_tr_b16 v[92:93], v62 offset:0
  ds_read_b64_tr_b16 v[94:95], v62 offset:6144
  ds_read_b64_tr_b16 v[96:97], v62 offset:12288
  ds_read_b64_tr_b16 v[98:99], v62 offset:18432
  s_waitcnt lgkmcnt(0)
  s_barrier
  ds_write_b128 v63, v[76:79] offset:0
  ds_write_b128 v63, v[80:83] offset:1024
  ds_write_b128 v63, v[84:87] offset:2048
  ds_write_b128 v63, v[88:91] offset:3072
  ds_write_b128 v63, v[92:95] offset:4096
  ds_write_b128 v63, v[96:99] offset:5120
  s_waitcnt lgkmcnt(0)
  s_waitcnt vmcnt(12)
  s_barrier
  v_add_u32 v60, 24576, v47
  v_add_u32 v61, 24576, v48
  v_add_u32 v62, 24576, v49
  v_add_u32 v63, 24576, v43
  ds_read_b64_tr_b16 v[76:77], v60 offset:0
  ds_read_b64_tr_b16 v[78:79], v60 offset:6144
  ds_read_b64_tr_b16 v[80:81], v60 offset:12288
  ds_read_b64_tr_b16 v[82:83], v60 offset:18432
  ds_read_b64_tr_b16 v[84:85], v61 offset:0
  ds_read_b64_tr_b16 v[86:87], v61 offset:6144
  ds_read_b64_tr_b16 v[88:89], v61 offset:12288
  ds_read_b64_tr_b16 v[90:91], v61 offset:18432
  ds_read_b64_tr_b16 v[92:93], v62 offset:0
  ds_read_b64_tr_b16 v[94:95], v62 offset:6144
  ds_read_b64_tr_b16 v[96:97], v62 offset:12288
  ds_read_b64_tr_b16 v[98:99], v62 offset:18432
  s_waitcnt lgkmcnt(0)
  s_barrier
  ds_write_b128 v63, v[76:79] offset:0
  ds_write_b128 v63, v[80:83] offset:1024
  ds_write_b128 v63, v[84:87] offset:2048
  ds_write_b128 v63, v[88:91] offset:3072
  ds_write_b128 v63, v[92:95] offset:4096
  ds_write_b128 v63, v[96:99] offset:5120
  s_waitcnt lgkmcnt(0)
  s_waitcnt vmcnt(6)
  s_barrier
  buffer_load_dword v72, off, s[96:99], 0 offset:128 sc1
  buffer_load_dword v73, off, s[96:99], s94 sc1
  v_add_u32 v60, 49152, v47
  v_add_u32 v61, 49152, v48
  v_add_u32 v62, 49152, v49
  v_add_u32 v63, 49152, v43
  ds_read_b64_tr_b16 v[76:77], v60 offset:0
  ds_read_b64_tr_b16 v[78:79], v60 offset:6144
  ds_read_b64_tr_b16 v[80:81], v60 offset:12288
  ds_read_b64_tr_b16 v[82:83], v60 offset:18432
  ds_read_b64_tr_b16 v[84:85], v61 offset:0
  ds_read_b64_tr_b16 v[86:87], v61 offset:6144
  ds_read_b64_tr_b16 v[88:89], v61 offset:12288
  ds_read_b64_tr_b16 v[90:91], v61 offset:18432
  ds_read_b64_tr_b16 v[92:93], v62 offset:0
  ds_read_b64_tr_b16 v[94:95], v62 offset:6144
  ds_read_b64_tr_b16 v[96:97], v62 offset:12288
  ds_read_b64_tr_b16 v[98:99], v62 offset:18432
  s_waitcnt lgkmcnt(0)
  s_barrier
  ds_write_b128 v63, v[76:79] offset:0
  ds_write_b128 v63, v[80:83] offset:1024
  ds_write_b128 v63, v[84:87] offset:2048
  ds_write_b128 v63, v[88:91] offset:3072
  ds_write_b128 v63, v[92:95] offset:4096
  ds_write_b128 v63, v[96:99] offset:5120
  s_waitcnt lgkmcnt(0)
  s_waitcnt vmcnt(2)
  s_barrier
  v_add_u32 v60, 73728, v47
  v_add_u32 v61, 73728, v48
  v_add_u32 v62, 73728, v49
  v_add_u32 v63, 73728, v43
  ds_read_b64_tr_b16 v[76:77], v60 offset:0
  ds_read_b64_tr_b16 v[78:79], v60 offset:6144
  ds_read_b64_tr_b16 v[80:81], v60 offset:12288
  ds_read_b64_tr_b16 v[82:83], v60 offset:18432
  ds_read_b64_tr_b16 v[84:85], v61 offset:0
  ds_read_b64_tr_b16 v[86:87], v61 offset:6144
  ds_read_b64_tr_b16 v[88:89], v61 offset:12288
  ds_read_b64_tr_b16 v[90:91], v61 offset:18432
  ds_read_b64_tr_b16 v[92:93], v62 offset:0
  ds_read_b64_tr_b16 v[94:95], v62 offset:6144
  ds_read_b64_tr_b16 v[96:97], v62 offset:12288
  ds_read_b64_tr_b16 v[98:99], v62 offset:18432
  s_waitcnt lgkmcnt(0)
  s_barrier
  ds_write_b128 v63, v[76:79] offset:0
  ds_write_b128 v63, v[80:83] offset:1024
  ds_write_b128 v63, v[84:87] offset:2048
  ds_write_b128 v63, v[88:91] offset:3072
  ds_write_b128 v63, v[92:95] offset:4096
  ds_write_b128 v63, v[96:99] offset:5120
  s_waitcnt lgkmcnt(0)
  s_waitcnt vmcnt(0)
  s_barrier
  v_mov_b32 v74, 163824
  s_cmp_lg_u32 s17, 0
  s_cbranch_scc1 L_wh3_b
  s_branch L_wh3_t
L_wh3:
  s_sleep 3
L_wh3_in:
  buffer_load_dword v72, off, s[96:99], 0 offset:128 sc1
  buffer_load_dword v73, off, s[96:99], s94 sc1
  s_add_u32 s39, s39, 1
  s_cmp_gt_u32 s39, 200000
  s_cbranch_scc1 L_exit
  s_waitcnt vmcnt(0)
L_wh3_t:
  v_readfirstlane_b32 s19, v72
  v_readfirstlane_b32 s74, v73
  s_nop 0
  s_and_b32 s22, s19, 255
  s_cmp_lt_u32 s22, 64
  s_cbranch_scc1 L_wh3
  s_and_b32 s22, s74, 255
  s_cmp_lt_u32 s22, 26
  s_cbranch_scc1 L_wh3
  ds_write_b64 v74, v[72:73]
  s_waitcnt lgkmcnt(0)
L_wh3_b:
  s_barrier
  ds_read_b64 v[72:73], v74
  s_waitcnt lgkmcnt(0)
  v_readfirstlane_b32 s19, v72
  v_readfirstlane_b32 s74, v73
  s_nop 0
  s_and_b32 s19, s19, 512
  s_lshl_b32 s19, s19, 4
  s_mul_i32 s22, s95, 26
  s_sub_u32 s74, s74, s22
  s_mul_i32 s22, s17, 6144
  v_lshlrev_b32 v4, 4, v1
  v_add_u32 v4, s22, v4
  v_add_u32 v5, 49152, v4
  s_mul_i32 s22, s17, 2560
  v_lshlrev_b32 v10, 4, v1
  v_add_u32 v10, s22, v10
  v_add_u32 v12, 147456, v10
  v_lshlrev_b32 v11, 3, v1
  v_add_u32 v11, s22, v11
  v_add_u32 v13, 147456, v11
  v_and_b32 v16, 1, v1
  v_cmp_eq_u32 vcc, 0, v16
  v_mov_b32 v16, 0xeeee
  v_mov_b32 v17, 0x4444
  v_cndmask_b32 v16, v16, v17, vcc
  v_lshlrev_b32 v18, 4, v1
  v_add_u32 v18, 147456, v18
  s_mul_i32 s22, s17, 768
  v_lshlrev_b32 v19, 6, v2
  v_bfe_u32 v15, v1, 1, 1
  v_lshl_add_u32 v19, v15, 4, v19
  v_bfe_u32 v15, v1, 2, 2
  v_lshl_add_u32 v19, v15, 2, v19
  v_and_b32 v15, 1, v1
  v_lshl_add_u32 v19, v15, 1, v19
  v_add_u32 v19, s22, v19
  v_add_u32 v19, 98304, v19
  v_lshlrev_b32 v20, 4, v1
  v_add_u32 v20, 98304, v20
  v_mov_b32 v15, v2
  s_mul_i32 s22, s17, 10
  v_add_u32 v15, s22, v15
  v_lshlrev_b32 v21, 11, v15
  s_and_b32 s22, s18, 7
  s_lshl_b32 s22, s22, 8
  v_add_u32 v21, s22, v21
  v_lshl_add_u32 v21, v3, 4, v21
  s_mov_b32 s41, 0xff81ff81
  s_mov_b32 s39, 0
  s_mov_b32 s20, 0
  v_mov_b32 v124, s41
  v_mov_b32 v125, s41
  v_mov_b32 v126, s41
  v_mov_b32 v127, s41
  s_and_b32 s73, s16, 3
  s_lshl_b32 s73, s73, 19
  s_add_u32 s73, s73, 4194304
  s_lshl_b32 s35, s18, 8
  s_add_u32 s35, s35, 7520256
  s_add_u32 s35, s35, s19
  s_lshl_b32 s22, s17, 6
  s_add_u32 s35, s35, s22
  s_lshr_b32 s44, s18, 3
  s_mul_i32 s44, s44, 81920
  s_add_u32 s44, s44, 184549376
  v_mov_b32 v22, 0
  s_cmp_lg_u32 s74, 0
  s_cbranch_scc1 L_V_safe
L_V_loop:
  s_add_u32 s40, s20, 0
  s_and_b32 s40, s40, 3
  s_lshl_b32 s40, s40, 17
  s_add_u32 s40, s40, s73
  s_add_u32 s42, s40, 16384
  v_mov_b32 v23, s20
  ds_read_b128 v[80:83], v4 offset:0
  ds_read_b128 v[84:87], v4 offset:1024
  ds_read_b128 v[88:91], v4 offset:24576
  ds_read_b128 v[92:95], v4 offset:25600
  ds_read_b128 v[96:99], v5 offset:0
  ds_read_b128 v[100:103], v5 offset:1024
  ds_read_b128 v[104:107], v5 offset:24576
  ds_read_b128 v[108:111], v5 offset:25600
  v_mov_b64 v[64:65], 0
  v_mov_b64 v[66:67], 0
  v_mov_b64 v[68:69], 0
  v_mov_b64 v[70:71], 0
  v_mov_b64 v[72:73], 0
  v_mov_b64 v[74:75], 0
  s_waitcnt lgkmcnt(0)
  s_waitcnt vmcnt(0)
  buffer_load_dwordx4 v[112:115], v10, s[4:7], s40 offen offset:0 sc1
  buffer_load_dwordx4 v[116:119], v10, s[4:7], s40 offen offset:1024 sc1
  buffer_load_dwordx2 v[120:121], v11, s[4:7], s40 offen offset:2048 sc1
  s_sleep 2
L_V_poll:
  buffer_load_dwordx4 v[6:9], v10, s[4:7], s40 offen offset:0 sc1
  buffer_load_dwordx4 v[76:79], v10, s[4:7], s40 offen offset:1024 sc1
  buffer_load_dwordx2 v[2:3], v11, s[4:7], s40 offen offset:2048 sc1
  s_add_u32 s39, s39, 1
  s_cmp_gt_u32 s39, 200000
  s_cbranch_scc1 L_exit
  s_waitcnt vmcnt(5)
  ds_write_b128 v12, v[112:115]
  v_max3_u32 v15, v112, v113, v114
  s_waitcnt vmcnt(4)
  ds_write_b128 v12, v[116:119] offset:1024
  v_max3_u32 v15, v15, v115, v116
  v_max3_u32 v15, v15, v117, v118
  s_waitcnt vmcnt(3)
  ds_write_b64 v13, v[120:121] offset:2048
  v_max3_u32 v15, v15, v119, v120
  v_max_u32 v15, v15, v121
  v_cmp_eq_u32 vcc, s41, v15
  s_cbranch_vccz L_V_poll_ok
  buffer_load_dwordx4 v[112:115], v10, s[4:7], s40 offen offset:0 sc1
  buffer_load_dwordx4 v[116:119], v10, s[4:7], s40 offen offset:1024 sc1
  buffer_load_dwordx2 v[120:121], v11, s[4:7], s40 offen offset:2048 sc1
  s_waitcnt vmcnt(5)
  ds_write_b128 v12, v[6:9]
  v_max3_u32 v15, v6, v7, v8
  s_waitcnt vmcnt(4)
  ds_write_b128 v12, v[76:79] offset:1024
  v_max3_u32 v15, v15, v9, v76
  v_max3_u32 v15, v15, v77, v78
  s_waitcnt vmcnt(3)
  ds_write_b64 v13, v[2:3] offset:2048
  v_max3_u32 v15, v15, v79, v2
  v_max_u32 v15, v15, v3
  v_cmp_eq_u32 vcc, s41, v15
  s_cbranch_vccnz L_V_poll
L_V_poll_ok:
  s_waitcnt lgkmcnt(0)
  s_barrier
  ds_read_b128 v[48:51], v18 offset:6144
  ds_read_b128 v[52:55], v18 offset:7168
  ds_read_b128 v[56:59], v18 offset:8192
  ds_read_b128 v[60:63], v18 offset:9216
  ds_read_b128 v[24:27], v18 offset:0
  ds_read_b128 v[28:31], v18 offset:1024
  s_waitcnt lgkmcnt(5)
  v_smfmac_f32_16x16x64_bf16 v[64:67], v[48:51], v[80:87], v16
  ds_read_b128 v[32:35], v18 offset:2048
  s_waitcnt lgkmcnt(5)
  v_smfmac_f32_16x16x64_bf16 v[64:67], v[52:55], v[88:95], v16
  ds_read_b128 v[36:39], v18 offset:3072
  s_waitcnt lgkmcnt(5)
  v_smfmac_f32_16x16x64_bf16 v[64:67], v[56:59], v[96:103], v16
  ds_read_b128 v[40:43], v18 offset:4096
  s_waitcnt lgkmcnt(5)
  v_smfmac_f32_16x16x64_bf16 v[64:67], v[60:63], v[104:111], v16
  ds_read_b128 v[44:47], v18 offset:5120
  s_waitcnt lgkmcnt(5)
  v_smfmac_f32_16x16x64_bf16 v[64:67], v[24:27], a[240:247], v16
  ds_read_b128 v[80:83], v4 offset:2048
  v_smfmac_f32_16x16x64_bf16 v[68:71], v[24:27], a[248:255], v16
  ds_read_b128 v[84:87], v4 offset:3072
  s_waitcnt lgkmcnt(6)
  v_smfmac_f32_16x16x64_bf16 v[64:67], v[28:31], v[136:143], v16
  ds_read_b128 v[88:91], v4 offset:26624
  v_smfmac_f32_16x16x64_bf16 v[68:71], v[28:31], v[144:151], v16
  ds_read_b128 v[92:95], v4 offset:27648
  s_waitcnt lgkmcnt(7)
  v_smfmac_f32_16x16x64_bf16 v[64:67], v[32:35], v[160:167], v16
  ds_read_b128 v[96:99], v5 offset:2048
  v_smfmac_f32_16x16x64_bf16 v[68:71], v[32:35], v[168:175], v16
  ds_read_b128 v[100:103], v5 offset:3072
  s_waitcnt lgkmcnt(8)
  v_smfmac_f32_16x16x64_bf16 v[64:67], v[36:39], v[184:191], v16
  ds_read_b128 v[104:107], v5 offset:26624
  v_smfmac_f32_16x16x64_bf16 v[68:71], v[36:39], v[192:199], v16
  ds_read_b128 v[108:111], v5 offset:27648
  s_waitcnt lgkmcnt(9)
  v_smfmac_f32_16x16x64_bf16 v[64:67], v[40:43], v[208:215], v16
  v_smfmac_f32_16x16x64_bf16 v[68:71], v[40:43], v[216:223], v16
  s_waitcnt vmcnt(0)
  s_waitcnt lgkmcnt(8)
  v_smfmac_f32_16x16x64_bf16 v[64:67], v[44:47], v[232:239], v16
  s_mov_b64 exec, 1
  buffer_store_dword v23, v22, s[4:7], s35 offen sc1
  s_mov_b64 exec, -1
  v_smfmac_f32_16x16x64_bf16 v[68:71], v[44:47], v[240:247], v16
  s_waitcnt lgkmcnt(6)
  v_smfmac_f32_16x16x64_bf16 v[68:71], v[48:51], v[80:87], v16
  ds_read_b128 v[80:83], v4 offset:4096
  s_waitcnt lgkmcnt(5)
  v_smfmac_f32_16x16x64_bf16 v[68:71], v[52:55], v[88:95], v16
  ds_read_b128 v[84:87], v4 offset:5120
  s_waitcnt lgkmcnt(4)
  v_smfmac_f32_16x16x64_bf16 v[68:71], v[56:59], v[96:103], v16
  ds_read_b128 v[88:91], v4 offset:28672
  s_waitcnt lgkmcnt(3)
  v_smfmac_f32_16x16x64_bf16 v[68:71], v[60:63], v[104:111], v16
  ds_read_b128 v[92:95], v4 offset:29696
  v_add_f32 v64, v64, v65
  v_smfmac_f32_16x16x64_bf16 v[72:75], v[24:27], v[128:135], v16
  ds_read_b128 v[96:99], v5 offset:4096
  v_add_f32 v66, v66, v67
  v_smfmac_f32_16x16x64_bf16 v[72:75], v[28:31], v[152:159], v16
  ds_read_b128 v[100:103], v5 offset:5120
  v_cvt_pk_bf16_f32 v64, v64, v66
  v_smfmac_f32_16x16x64_bf16 v[72:75], v[32:35], v[176:183], v16
  ds_read_b128 v[104:107], v5 offset:28672
  v_add_f32 v68, v68, v69
  v_smfmac_f32_16x16x64_bf16 v[72:75], v[36:39], v[200:207], v16
  ds_read_b128 v[108:111], v5 offset:29696
  v_add_f32 v70, v70, v71
  v_smfmac_f32_16x16x64_bf16 v[72:75], v[40:43], v[224:231], v16
  ds_write_b16 v19, v64 offset:0
  ds_write_b16_d16_hi v19, v64 offset:32
  v_cvt_pk_bf16_f32 v68, v68, v70
  v_smfmac_f32_16x16x64_bf16 v[72:75], v[44:47], v[248:255], v16
  s_waitcnt lgkmcnt(8)
  v_smfmac_f32_16x16x64_bf16 v[72:75], v[48:51], v[80:87], v16
  s_waitcnt lgkmcnt(6)
  v_smfmac_f32_16x16x64_bf16 v[72:75], v[52:55], v[88:95], v16
  s_waitcnt lgkmcnt(4)
  v_smfmac_f32_16x16x64_bf16 v[72:75], v[56:59], v[96:103], v16
  ds_write_b16 v19, v68 offset:256
  s_waitcnt lgkmcnt(3)
  v_smfmac_f32_16x16x64_bf16 v[72:75], v[60:63], v[104:111], v16
  ds_write_b16_d16_hi v19, v68 offset:288
  v_mov_b64 v[24:25], 0
  v_mov_b64 v[26:27], 0
  v_mov_b64 v[28:29], 0
  v_mov_b64 v[30:31], 0
  s_nop 2
  v_add_f32 v72, v72, v73
  v_add_f32 v74, v74, v75
  v_cvt_pk_bf16_f32 v72, v72, v74
  ds_write_b16 v19, v72 offset:512
  ds_write_b16_d16_hi v19, v72 offset:544
  v_mov_b64 v[32:33], 0
  v_mov_b64 v[34:35], 0
  v_mov_b64 v[36:37], 0
  v_mov_b64 v[38:39], 0
  v_mov_b64 v[40:41], 0
  v_mov_b64 v[42:43], 0
  v_mov_b64 v[44:45], 0
  v_mov_b64 v[46:47], 0
  v_mov_b64 v[48:49], 0
  v_mov_b64 v[50:51], 0
  v_mov_b64 v[52:53], 0
  v_mov_b64 v[54:55], 0
  v_mov_b64 v[56:57], 0
  v_mov_b64 v[58:59], 0
  v_mov_b64 v[60:61], 0
  v_mov_b64 v[62:63], 0
  s_waitcnt lgkmcnt(0)
  s_barrier
  ds_read_b128 v[80:83], v20 offset:0
  ds_read_b128 v[84:87], v20 offset:1024
  ds_read_b128 v[88:91], v20 offset:2048
  s_waitcnt lgkmcnt(2)
  v_smfmac_f32_16x16x64_bf16 v[24:27], v[80:83], a[0:7], v16
  s_waitcnt lgkmcnt(1)
  v_smfmac_f32_16x16x64_bf16 v[24:27], v[84:87], a[8:15], v16
  s_waitcnt lgkmcnt(0)
  v_smfmac_f32_16x16x64_bf16 v[24:27], v[88:91], a[16:23], v16
  v_smfmac_f32_16x16x64_bf16 v[28:31], v[80:83], a[24:31], v16
  v_smfmac_f32_16x16x64_bf16 v[28:31], v[84:87], a[32:39], v16
  v_add_f32 v24, v24, v25
  v_smfmac_f32_16x16x64_bf16 v[28:31], v[88:91], a[40:47], v16
  v_add_f32 v26, v26, v27
  v_smfmac_f32_16x16x64_bf16 v[32:35], v[80:83], a[48:55], v16
  v_cvt_pk_bf16_f32 v112, v24, v26
  v_smfmac_f32_16x16x64_bf16 v[32:35], v[84:87], a[56:63], v16
  v_add_f32 v28, v28, v29
  v_smfmac_f32_16x16x64_bf16 v[32:35], v[88:91], a[64:71], v16
  v_add_f32 v30, v30, v31
  v_smfmac_f32_16x16x64_bf16 v[36:39], v[80:83], a[72:79], v16
  v_cvt_pk_bf16_f32 v113, v28, v30
  v_smfmac_f32_16x16x64_bf16 v[36:39], v[84:87], a[80:87], v16
  v_add_f32 v32, v32, v33
  v_smfmac_f32_16x16x64_bf16 v[36:39], v[88:91], a[88:95], v16
  v_add_f32 v34, v34, v35
  v_smfmac_f32_16x16x64_bf16 v[40:43], v[80:83], a[96:103], v16
  v_cvt_pk_bf16_f32 v114, v32, v34
  v_smfmac_f32_16x16x64_bf16 v[40:43], v[84:87], a[104:111], v16
  v_add_f32 v36, v36, v37
  v_smfmac_f32_16x16x64_bf16 v[40:43], v[88:91], a[112:119], v16
  v_add_f32 v38, v38, v39
  v_smfmac_f32_16x16x64_bf16 v[44:47], v[80:83], a[120:127], v16
  v_cvt_pk_bf16_f32 v115, v36, v38
  v_smfmac_f32_16x16x64_bf16 v[44:47], v[84:87], a[128:135], v16
  v_add_f32 v40, v40, v41
  v_smfmac_f32_16x16x64_bf16 v[44:47], v[88:91], a[136:143], v16
  v_add_f32 v42, v42, v43
  v_permlane32_swap_b32 v112, v114
  v_smfmac_f32_16x16x64_bf16 v[48:51], v[80:83], a[144:151], v16
  v_cvt_pk_bf16_f32 v116, v40, v42
  v_permlane32_swap_b32 v113, v115
  v_smfmac_f32_16x16x64_bf16 v[48:51], v[84:87], a[152:159], v16
  v_add_f32 v44, v44, v45
  v_permlane16_swap_b32 v112, v113
  v_smfmac_f32_16x16x64_bf16 v[48:51], v[88:91], a[160:167], v16
  v_add_f32 v46, v46, v47
  v_permlane16_swap_b32 v114, v115
  v_smfmac_f32_16x16x64_bf16 v[52:55], v[80:83], a[168:175], v16
  s_add_u32 s26, s42, 0
  buffer_store_dwordx4 v[112:115], v21, s[4:7], s26 offen
  v_cvt_pk_bf16_f32 v117, v44, v46
  v_smfmac_f32_16x16x64_bf16 v[52:55], v[84:87], a[176:183], v16
  v_add_f32 v48, v48, v49
  v_smfmac_f32_16x16x64_bf16 v[52:55], v[88:91], a[184:191], v16
  v_add_f32 v50, v50, v51
  v_smfmac_f32_16x16x64_bf16 v[56:59], v[80:83], a[192:199], v16
  v_cvt_pk_bf16_f32 v118, v48, v50
  v_smfmac_f32_16x16x64_bf16 v[56:59], v[84:87], a[200:207], v16
  v_add_f32 v52, v52, v53
  v_smfmac_f32_16x16x64_bf16 v[56:59], v[88:91], a[208:215], v16
  v_add_f32 v54, v54, v55
  v_smfmac_f32_16x16x64_bf16 v[60:63], v[80:83], a[216:223], v16
  v_cvt_pk_bf16_f32 v119, v52, v54
  v_smfmac_f32_16x16x64_bf16 v[60:63], v[84:87], a[224:231], v16
  v_add_f32 v56, v56, v57
  v_smfmac_f32_16x16x64_bf16 v[60:63], v[88:91], a[232:239], v16
  v_add_f32 v58, v58, v59
  v_cvt_pk_bf16_f32 v120, v56, v58
  v_permlane32_swap_b32 v116, v118
  v_permlane32_swap_b32 v117, v119
  s_nop 1
  v_permlane16_swap_b32 v116, v117
  v_permlane16_swap_b32 v118, v119
  s_add_u32 s26, s42, 8192
  buffer_store_dwordx4 v[116:119], v21, s[4:7], s26 offen
  v_add_f32 v60, v60, v61
  v_add_f32 v62, v62, v63
  v_cvt_pk_bf16_f32 v121, v60, v62
  v_permlane32_swap_b32 v120, v122
  s_nop 0
  v_permlane32_swap_b32 v121, v123
  s_nop 1
  v_permlane16_swap_b32 v120, v121
  v_permlane16_swap_b32 v122, v123
  s_add_u32 s26, s42, 16384
  s_mov_b32 exec_hi, 0
  buffer_store_dwordx4 v[120:123], v21, s[4:7], s26 offen
  s_mov_b32 exec_hi, -1
  s_xor_b32 s42, s42, 262144
  s_mul_i32 s43, s20, 327680
  s_add_u32 s43, s43, s44
  s_add_u32 s26, s42, 0
  buffer_store_dwordx4 v[124:127], v21, s[4:7], s26 offen
  s_add_u32 s26, s43, 0
  buffer_store_dwordx4 v[112:115], v21, s[4:7], s26 offen sc1
  s_add_u32 s26, s42, 8192
  buffer_store_dwordx4 v[124:127], v21, s[4:7], s26 offen
  s_add_u32 s26, s43, 8192
  buffer_store_dwordx4 v[116:119], v21, s[4:7], s26 offen sc1
  s_mov_b32 exec_hi, 0
  s_add_u32 s26, s42, 16384
  buffer_store_dwordx4 v[124:127], v21, s[4:7], s26 offen
  s_add_u32 s26, s43, 16384
  buffer_store_dwordx4 v[120:123], v21, s[4:7], s26 offen sc1
  s_mov_b32 exec_hi, -1
  s_add_u32 s20, s20, 1
  s_cmp_lt_u32 s20, 64
  s_cbranch_scc1 L_V_loop
  v_mov_b32 v23, s20
  s_waitcnt vmcnt(0)
  s_mov_b64 exec, 1
  buffer_store_dword v23, v22, s[4:7], s35 offen sc1
  s_endpgm
L_V_safe:
L_V_loop_s:
  s_add_u32 s40, s20, 0
  s_and_b32 s40, s40, 3
  s_lshl_b32 s40, s40, 17
  s_add_u32 s40, s40, s73
  s_add_u32 s42, s40, 16384
  v_mov_b32 v23, s20
  ds_read_b128 v[80:83], v4 offset:0
  ds_read_b128 v[84:87], v4 offset:1024
  ds_read_b128 v[88:91], v4 offset:24576
  ds_read_b128 v[92:95], v4 offset:25600
  ds_read_b128 v[96:99], v5 offset:0
  ds_read_b128 v[100:103], v5 offset:1024
  ds_read_b128 v[104:107], v5 offset:24576
  ds_read_b128 v[108:111], v5 offset:25600
  v_mov_b64 v[64:65], 0
  v_mov_b64 v[66:67], 0
  v_mov_b64 v[68:69], 0
  v_mov_b64 v[70:71], 0
  v_mov_b64 v[72:73], 0
  v_mov_b64 v[74:75], 0
  s_waitcnt lgkmcnt(0)
  s_waitcnt vmcnt(0)
  buffer_load_dwordx4 v[112:115], v10, s[4:7], s40 offen offset:0 sc1
  buffer_load_dwordx4 v[116:119], v10, s[4:7], s40 offen offset:1024 sc1
  buffer_load_dwordx2 v[120:121], v11, s[4:7], s40 offen offset:2048 sc1
  s_sleep 2
L_V_poll_s:
  buffer_load_dwordx4 v[6:9], v10, s[4:7], s40 offen offset:0 sc1
  buffer_load_dwordx4 v[76:79], v10, s[4:7], s40 offen offset:1024 sc1
  buffer_load_dwordx2 v[2:3], v11, s[4:7], s40 offen offset:2048 sc1
  s_add_u32 s39, s39, 1
  s_cmp_gt_u32 s39, 200000
  s_cbranch_scc1 L_exit
  s_waitcnt vmcnt(5)
  ds_write_b128 v12, v[112:115]
  v_max3_u32 v15, v112, v113, v114
  s_waitcnt vmcnt(4)
  ds_write_b128 v12, v[116:119] offset:1024
  v_max3_u32 v15, v15, v115, v116
  v_max3_u32 v15, v15, v117, v118
  s_waitcnt vmcnt(3)
  ds_write_b64 v13, v[120:121] offset:2048
  v_max3_u32 v15, v15, v119, v120
  v_max_u32 v15, v15, v121
  v_cmp_eq_u32 vcc, s41, v15
  s_cbranch_vccz L_V_poll_ok_s
  buffer_load_dwordx4 v[112:115], v10, s[4:7], s40 offen offset:0 sc1
  buffer_load_dwordx4 v[116:119], v10, s[4:7], s40 offen offset:1024 sc1
  buffer_load_dwordx2 v[120:121], v11, s[4:7], s40 offen offset:2048 sc1
  s_waitcnt vmcnt(5)
  ds_write_b128 v12, v[6:9]
  v_max3_u32 v15, v6, v7, v8
  s_waitcnt vmcnt(4)
  ds_write_b128 v12, v[76:79] offset:1024
  v_max3_u32 v15, v15, v9, v76
  v_max3_u32 v15, v15, v77, v78
  s_waitcnt vmcnt(3)
  ds_write_b64 v13, v[2:3] offset:2048
  v_max3_u32 v15, v15, v79, v2
  v_max_u32 v15, v15, v3
  v_cmp_eq_u32 vcc, s41, v15
  s_cbranch_vccnz L_V_poll_s
L_V_poll_ok_s:
  s_waitcnt lgkmcnt(0)
  s_barrier
  ds_read_b128 v[48:51], v18 offset:6144
  ds_read_b128 v[52:55], v18 offset:7168
  ds_read_b128 v[56:59], v18 offset:8192
  ds_read_b128 v[60:63], v18 offset:9216
  ds_read_b128 v[24:27], v18 offset:0
  ds_read_b128 v[28:31], v18 offset:1024
  s_waitcnt lgkmcnt(5)
  v_smfmac_f32_16x16x64_bf16 v[64:67], v[48:51], v[80:87], v16
  ds_read_b128 v[32:35], v18 offset:2048
  s_waitcnt lgkmcnt(5)
  v_smfmac_f32_16x16x64_bf16 v[64:67], v[52:55], v[88:95], v16
  ds_read_b128 v[36:39], v18 offset:3072
  s_waitcnt lgkmcnt(5)
  v_smfmac_f32_16x16x64_bf16 v[64:67], v[56:59], v[96:103], v16
  ds_read_b128 v[40:43], v18 offset:4096
  s_waitcnt lgkmcnt(5)
  v_smfmac_f32_16x16x64_bf16 v[64:67], v[60:63], v[104:111], v16
  ds_read_b128 v[44:47], v18 offset:5120
  s_waitcnt lgkmcnt(5)
  v_smfmac_f32_16x16x64_bf16 v[64:67], v[24:27], a[240:247], v16
  ds_read_b128 v[80:83], v4 offset:2048
  v_smfmac_f32_16x16x64_bf16 v[68:71], v[24:27], a[248:255], v16
  ds_read_b128 v[84:87], v4 offset:3072
  s_waitcnt lgkmcnt(6)
  v_smfmac_f32_16x16x64_bf16 v[64:67], v[28:31], v[136:143], v16
  ds_read_b128 v[88:91], v4 offset:26624
  v_smfmac_f32_16x16x64_bf16 v[68:71], v[28:31], v[144:151], v16
  ds_read_b128 v[92:95], v4 offset:27648
  s_waitcnt lgkmcnt(7)
  v_smfmac_f32_16x16x64_bf16 v[64:67], v[32:35], v[160:167], v16
  ds_read_b128 v[96:99], v5 offset:2048
  v_smfmac_f32_16x16x64_bf16 v[68:71], v[32:35], v[168:175], v16
  ds_read_b128 v[100:103], v5 offset:3072
  s_waitcnt lgkmcnt(8)
  v_smfmac_f32_16x16x64_bf16 v[64:67], v[36:39], v[184:191], v16
  ds_read_b128 v[104:107], v5 offset:26624
  v_smfmac_f32_16x16x64_bf16 v[68:71], v[36:39], v[192:199], v16
  ds_read_b128 v[108:111], v5 offset:27648
  s_waitcnt lgkmcnt(9)
  v_smfmac_f32_16x16x64_bf16 v[64:67], v[40:43], v[208:215], v16
  v_smfmac_f32_16x16x64_bf16 v[68:71], v[40:43], v[216:223], v16
  s_waitcnt vmcnt(0)
  s_waitcnt lgkmcnt(8)
  v_smfmac_f32_16x16x64_bf16 v[64:67], v[44:47], v[232:239], v16
  s_mov_b64 exec, 1
  buffer_store_dword v23, v22, s[4:7], s35 offen sc1
  s_mov_b64 exec, -1
  v_smfmac_f32_16x16x64_bf16 v[68:71], v[44:47], v[240:247], v16
  s_waitcnt lgkmcnt(6)
  v_smfmac_f32_16x16x64_bf16 v[68:71], v[48:51], v[80:87], v16
  ds_read_b128 v[80:83], v4 offset:4096
  s_waitcnt lgkmcnt(5)
  v_smfmac_f32_16x16x64_bf16 v[68:71], v[52:55], v[88:95], v16
  ds_read_b128 v[84:87], v4 offset:5120
  s_waitcnt lgkmcnt(4)
  v_smfmac_f32_16x16x64_bf16 v[68:71], v[56:59], v[96:103], v16
  ds_read_b128 v[88:91], v4 offset:28672
  s_waitcnt lgkmcnt(3)
  v_smfmac_f32_16x16x64_bf16 v[68:71], v[60:63], v[104:111], v16
  ds_read_b128 v[92:95], v4 offset:29696
  v_add_f32 v64, v64, v65
  v_smfmac_f32_16x16x64_bf16 v[72:75], v[24:27], v[128:135], v16
  ds_read_b128 v[96:99], v5 offset:4096
  v_add_f32 v66, v66, v67
  v_smfmac_f32_16x16x64_bf16 v[72:75], v[28:31], v[152:159], v16
  ds_read_b128 v[100:103], v5 offset:5120
  v_cvt_pk_bf16_f32 v64, v64, v66
  v_smfmac_f32_16x16x64_bf16 v[72:75], v[32:35], v[176:183], v16
  ds_read_b128 v[104:107], v5 offset:28672
  v_add_f32 v68, v68, v69
  v_smfmac_f32_16x16x64_bf16 v[72:75], v[36:39], v[200:207], v16
  ds_read_b128 v[108:111], v5 offset:29696
  v_add_f32 v70, v70, v71
  v_smfmac_f32_16x16x64_bf16 v[72:75], v[40:43], v[224:231], v16
  ds_write_b16 v19, v64 offset:0
  ds_write_b16_d16_hi v19, v64 offset:32
  v_cvt_pk_bf16_f32 v68, v68, v70
  v_smfmac_f32_16x16x64_bf16 v[72:75], v[44:47], v[248:255], v16
  s_waitcnt lgkmcnt(8)
  v_smfmac_f32_16x16x64_bf16 v[72:75], v[48:51], v[80:87], v16
  s_waitcnt lgkmcnt(6)
  v_smfmac_f32_16x16x64_bf16 v[72:75], v[52:55], v[88:95], v16
  s_waitcnt lgkmcnt(4)
  v_smfmac_f32_16x16x64_bf16 v[72:75], v[56:59], v[96:103], v16
  ds_write_b16 v19, v68 offset:256
  s_waitcnt lgkmcnt(3)
  v_smfmac_f32_16x16x64_bf16 v[72:75], v[60:63], v[104:111], v16
  ds_write_b16_d16_hi v19, v68 offset:288
  v_mov_b64 v[24:25], 0
  v_mov_b64 v[26:27], 0
  v_mov_b64 v[28:29], 0
  v_mov_b64 v[30:31], 0
  s_nop 2
  v_add_f32 v72, v72, v73
  v_add_f32 v74, v74, v75
  v_cvt_pk_bf16_f32 v72, v72, v74
  ds_write_b16 v19, v72 offset:512
  ds_write_b16_d16_hi v19, v72 offset:544
  v_mov_b64 v[32:33], 0
  v_mov_b64 v[34:35], 0
  v_mov_b64 v[36:37], 0
  v_mov_b64 v[38:39], 0
  v_mov_b64 v[40:41], 0
  v_mov_b64 v[42:43], 0
  v_mov_b64 v[44:45], 0
  v_mov_b64 v[46:47], 0
  v_mov_b64 v[48:49], 0
  v_mov_b64 v[50:51], 0
  v_mov_b64 v[52:53], 0
  v_mov_b64 v[54:55], 0
  v_mov_b64 v[56:57], 0
  v_mov_b64 v[58:59], 0
  v_mov_b64 v[60:61], 0
  v_mov_b64 v[62:63], 0
  s_waitcnt lgkmcnt(0)
  s_barrier
  ds_read_b128 v[80:83], v20 offset:0
  ds_read_b128 v[84:87], v20 offset:1024
  ds_read_b128 v[88:91], v20 offset:2048
  s_waitcnt lgkmcnt(2)
  v_smfmac_f32_16x16x64_bf16 v[24:27], v[80:83], a[0:7], v16
  s_waitcnt lgkmcnt(1)
  v_smfmac_f32_16x16x64_bf16 v[24:27], v[84:87], a[8:15], v16
  s_waitcnt lgkmcnt(0)
  v_smfmac_f32_16x16x64_bf16 v[24:27], v[88:91], a[16:23], v16
  v_smfmac_f32_16x16x64_bf16 v[28:31], v[80:83], a[24:31], v16
  v_smfmac_f32_16x16x64_bf16 v[28:31], v[84:87], a[32:39], v16
  v_add_f32 v24, v24, v25
  v_smfmac_f32_16x16x64_bf16 v[28:31], v[88:91], a[40:47], v16
  v_add_f32 v26, v26, v27
  v_smfmac_f32_16x16x64_bf16 v[32:35], v[80:83], a[48:55], v16
  v_cvt_pk_bf16_f32 v112, v24, v26
  v_smfmac_f32_16x16x64_bf16 v[32:35], v[84:87], a[56:63], v16
  v_add_f32 v28, v28, v29
  v_smfmac_f32_16x16x64_bf16 v[32:35], v[88:91], a[64:71], v16
  v_add_f32 v30, v30, v31
  v_smfmac_f32_16x16x64_bf16 v[36:39], v[80:83], a[72:79], v16
  v_cvt_pk_bf16_f32 v113, v28, v30
  v_smfmac_f32_16x16x64_bf16 v[36:39], v[84:87], a[80:87], v16
  v_add_f32 v32, v32, v33
  v_smfmac_f32_16x16x64_bf16 v[36:39], v[88:91], a[88:95], v16
  v_add_f32 v34, v34, v35
  v_smfmac_f32_16x16x64_bf16 v[40:43], v[80:83], a[96:103], v16
  v_cvt_pk_bf16_f32 v114, v32, v34
  v_smfmac_f32_16x16x64_bf16 v[40:43], v[84:87], a[104:111], v16
  v_add_f32 v36, v36, v37
  v_smfmac_f32_16x16x64_bf16 v[40:43], v[88:91], a[112:119], v16
  v_add_f32 v38, v38, v39
  v_smfmac_f32_16x16x64_bf16 v[44:47], v[80:83], a[120:127], v16
  v_cvt_pk_bf16_f32 v115, v36, v38
  v_smfmac_f32_16x16x64_bf16 v[44:47], v[84:87], a[128:135], v16
  v_add_f32 v40, v40, v41
  v_smfmac_f32_16x16x64_bf16 v[44:47], v[88:91], a[136:143], v16
  v_add_f32 v42, v42, v43
  v_permlane32_swap_b32 v112, v114
  v_smfmac_f32_16x16x64_bf16 v[48:51], v[80:83], a[144:151], v16
  v_cvt_pk_bf16_f32 v116, v40, v42
  v_permlane32_swap_b32 v113, v115
  v_smfmac_f32_16x16x64_bf16 v[48:51], v[84:87], a[152:159], v16
  v_add_f32 v44, v44, v45
  v_permlane16_swap_b32 v112, v113
  v_smfmac_f32_16x16x64_bf16 v[48:51], v[88:91], a[160:167], v16
  v_add_f32 v46, v46, v47
  v_permlane16_swap_b32 v114, v115
  v_smfmac_f32_16x16x64_bf16 v[52:55], v[80:83], a[168:175], v16
  s_add_u32 s26, s42, 0
  buffer_store_dwordx4 v[112:115], v21, s[4:7], s26 offen sc1
  v_cvt_pk_bf16_f32 v117, v44, v46
  v_smfmac_f32_16x16x64_bf16 v[52:55], v[84:87], a[176:183], v16
  v_add_f32 v48, v48, v49
  v_smfmac_f32_16x16x64_bf16 v[52:55], v[88:91], a[184:191], v16
  v_add_f32 v50, v50, v51
  v_smfmac_f32_16x16x64_bf16 v[56:59], v[80:83], a[192:199], v16
  v_cvt_pk_bf16_f32 v118, v48, v50
  v_smfmac_f32_16x16x64_bf16 v[56:59], v[84:87], a[200:207], v16
  v_add_f32 v52, v52, v53
  v_smfmac_f32_16x16x64_bf16 v[56:59], v[88:91], a[208:215], v16
  v_add_f32 v54, v54, v55
  v_smfmac_f32_16x16x64_bf16 v[60:63], v[80:83], a[216:223], v16
  v_cvt_pk_bf16_f32 v119, v52, v54
  v_smfmac_f32_16x16x64_bf16 v[60:63], v[84:87], a[224:231], v16
  v_add_f32 v56, v56, v57
  v_smfmac_f32_16x16x64_bf16 v[60:63], v[88:91], a[232:239], v16
  v_add_f32 v58, v58, v59
  v_cvt_pk_bf16_f32 v120, v56, v58
  v_permlane32_swap_b32 v116, v118
  v_permlane32_swap_b32 v117, v119
  s_nop 1
  v_permlane16_swap_b32 v116, v117
  v_permlane16_swap_b32 v118, v119
  s_add_u32 s26, s42, 8192
  buffer_store_dwordx4 v[116:119], v21, s[4:7], s26 offen sc1
  v_add_f32 v60, v60, v61
  v_add_f32 v62, v62, v63
  v_cvt_pk_bf16_f32 v121, v60, v62
  v_permlane32_swap_b32 v120, v122
  s_nop 0
  v_permlane32_swap_b32 v121, v123
  s_nop 1
  v_permlane16_swap_b32 v120, v121
  v_permlane16_swap_b32 v122, v123
  s_add_u32 s26, s42, 16384
  s_mov_b32 exec_hi, 0
  buffer_store_dwordx4 v[120:123], v21, s[4:7], s26 offen sc1
  s_mov_b32 exec_hi, -1
  s_xor_b32 s42, s42, 262144
  s_mul_i32 s43, s20, 327680
  s_add_u32 s43, s43, s44
  s_add_u32 s26, s42, 0
  buffer_store_dwordx4 v[124:127], v21, s[4:7], s26 offen sc1
  s_add_u32 s26, s43, 0
  buffer_store_dwordx4 v[112:115], v21, s[4:7], s26 offen sc1
  s_add_u32 s26, s42, 8192
  buffer_store_dwordx4 v[124:127], v21, s[4:7], s26 offen sc1
  s_add_u32 s26, s43, 8192
  buffer_store_dwordx4 v[116:119], v21, s[4:7], s26 offen sc1
  s_mov_b32 exec_hi, 0
  s_add_u32 s26, s42, 16384
  buffer_store_dwordx4 v[124:127], v21, s[4:7], s26 offen sc1
  s_add_u32 s26, s43, 16384
  buffer_store_dwordx4 v[120:123], v21, s[4:7], s26 offen sc1
  s_mov_b32 exec_hi, -1
  s_add_u32 s20, s20, 1
  s_cmp_lt_u32 s20, 64
  s_cbranch_scc1 L_V_loop_s
  v_mov_b32 v23, s20
  s_waitcnt vmcnt(0)
  s_mov_b64 exec, 1
  buffer_store_dword v23, v22, s[4:7], s35 offen sc1
  s_endpgm
L_A:
  s_mul_i32 s32, s18, 384
  v_lshrrev_b32 v40, 3, v1
  v_and_b32 v41, 7, v1
  v_lshrrev_b32 v43, 1, v41
  v_lshrrev_b32 v44, 1, v40
  v_xor_b32 v43, v43, v44
  v_lshlrev_b32 v42, 5, v43
  v_and_b32 v43, 1, v41
  v_lshl_add_u32 v42, v43, 4, v42
  v_bfe_u32 v43, v40, 1, 1
  v_lshlrev_b32 v45, 3, v43
  v_lshrrev_b32 v43, 2, v40
  v_lshl_add_u32 v45, v43, 2, v45
  v_and_b32 v43, 1, v40
  v_add_u32 v45, v45, v43
  s_lshr_b32 s22, s17, 1
  s_lshl_b32 s22, s22, 5
  s_and_b32 s23, s17, 1
  s_lshl_b32 s23, s23, 1
  s_add_u32 s22, s22, s23
  v_add_u32 v45, s22, v45
  s_mov_b32 s22, 12288
  v_mul_lo_u32 v45, v45, s22
  v_add_u32 v45, v45, v42
  s_mul_i32 s24, s17, 6144
  s_and_b32 s25, s17, 1
  s_mul_i32 s25, s25, 10240
  s_lshr_b32 s22, s17, 1
  s_mul_i32 s22, s22, 5120
  s_add_u32 s25, s25, s22
  v_bfe_u32 v40, v1, 2, 3
  v_and_b32 v41, 3, v1
  v_lshlrev_b32 v41, 3, v41
  v_lshl_add_u32 v41, v40, 7, v41
  v_lshrrev_b32 v40, 1, v40
  v_lshrrev_b32 v44, 5, v1
  s_mul_i32 s22, s17, 3
  s_add_u32 s22, s22, 0
  s_and_b32 s23, s22, 3
  s_lshr_b32 s22, s22, 2
  s_lshl_b32 s22, s22, 10
  v_xor_b32 v43, s23, v40
  v_lshl_add_u32 v46, v43, 5, v41
  v_add_u32 v46, s22, v46
  v_mul_u32_u24 v43, 3072, v44
  v_add_u32 v46, v46, v43
  s_mul_i32 s22, s17, 3
  s_add_u32 s22, s22, 1
  s_and_b32 s23, s22, 3
  s_lshr_b32 s22, s22, 2
  s_lshl_b32 s22, s22, 10
  v_xor_b32 v43, s23, v40
  v_lshl_add_u32 v47, v43, 5, v41
  v_add_u32 v47, s22, v47
  v_mul_u32_u24 v43, 3072, v44
  v_add_u32 v47, v47, v43
  s_mul_i32 s22, s17, 3
  s_add_u32 s22, s22, 2
  s_and_b32 s23, s22, 3
  s_lshr_b32 s22, s22, 2
  s_lshl_b32 s22, s22, 10
  v_xor_b32 v43, s23, v40
  v_lshl_add_u32 v48, v43, 5, v41
  v_add_u32 v48, s22, v48
  v_mul_u32_u24 v43, 3072, v44
  v_add_u32 v48, v48, v43
  s_add_u32 m0, s24, 73728
  s_add_u32 s26, s32, 0
  buffer_load_dwordx4 v45, s[8:11], s26 offen  lds
  s_add_u32 m0, s24, 74752
  s_add_u32 s26, s32, 128
  buffer_load_dwordx4 v45, s[8:11], s26 offen  lds
  s_add_u32 m0, s24, 75776
  s_add_u32 s26, s32, 256
  buffer_load_dwordx4 v45, s[8:11], s26 offen  lds
  s_add_u32 m0, s24, 76800
  s_add_u32 s26, s32, 196608
  buffer_load_dwordx4 v45, s[8:11], s26 offen  lds
  s_add_u32 m0, s24, 77824
  s_add_u32 s26, s32, 196736
  buffer_load_dwordx4 v45, s[8:11], s26 offen  lds
  s_add_u32 m0, s24, 78848
  s_add_u32 s26, s32, 196864
  buffer_load_dwordx4 v45, s[8:11], s26 offen  lds
  s_mul_i32 s22, s17, 6144
  v_lshlrev_b32 v43, 4, v1
  v_add_u32 v43, s22, v43
  s_waitcnt vmcnt(0)
  s_barrier
  s_add_u32 m0, s24, 98304
  s_add_u32 s26, s32, 0
  buffer_load_dwordx4 v45, s[12:15], s26 offen  lds
  s_add_u32 m0, s24, 99328
  s_add_u32 s26, s32, 128
  buffer_load_dwordx4 v45, s[12:15], s26 offen  lds
  s_add_u32 m0, s24, 100352
  s_add_u32 s26, s32, 256
  buffer_load_dwordx4 v45, s[12:15], s26 offen  lds
  s_add_u32 m0, s24, 101376
  s_add_u32 s26, s32, 196608
  buffer_load_dwordx4 v45, s[12:15], s26 offen  lds
  s_add_u32 m0, s24, 102400
  s_add_u32 s26, s32, 196736
  buffer_load_dwordx4 v45, s[12:15], s26 offen  lds
  s_add_u32 m0, s24, 103424
  s_add_u32 s26, s32, 196864
  buffer_load_dwordx4 v45, s[12:15], s26 offen  lds
  s_add_u32 m0, s24, 122880
  s_add_u32 s26, s32, 786432
  buffer_load_dwordx4 v45, s[8:11], s26 offen  lds
  s_add_u32 m0, s24, 123904
  s_add_u32 s26, s32, 786560
  buffer_load_dwordx4 v45, s[8:11], s26 offen  lds
  s_add_u32 m0, s24, 124928
  s_add_u32 s26, s32, 786688
  buffer_load_dwordx4 v45, s[8:11], s26 offen  lds
  s_add_u32 m0, s24, 125952
  s_add_u32 s26, s32, 983040
  buffer_load_dwordx4 v45, s[8:11], s26 offen  lds
  s_add_u32 m0, s24, 126976
  s_add_u32 s26, s32, 983168
  buffer_load_dwordx4 v45, s[8:11], s26 offen  lds
  s_add_u32 m0, s24, 128000
  s_add_u32 s26, s32, 983296
  buffer_load_dwordx4 v45, s[8:11], s26 offen  lds
  s_add_u32 m0, s24, 0
  s_add_u32 s26, s32, 786432
  buffer_load_dwordx4 v45, s[12:15], s26 offen  lds
  s_add_u32 m0, s24, 1024
  s_add_u32 s26, s32, 786560
  buffer_load_dwordx4 v45, s[12:15], s26 offen  lds
  s_add_u32 m0, s24, 2048
  s_add_u32 s26, s32, 786688
  buffer_load_dwordx4 v45, s[12:15], s26 offen  lds
  s_add_u32 m0, s24, 3072
  s_add_u32 s26, s32, 983040
  buffer_load_dwordx4 v45, s[12:15], s26 offen  lds
  s_add_u32 m0, s24, 4096
  s_add_u32 s26, s32, 983168
  buffer_load_dwordx4 v45, s[12:15], s26 offen  lds
  s_add_u32 m0, s24, 5120
  s_add_u32 s26, s32, 983296
  buffer_load_dwordx4 v45, s[12:15], s26 offen  lds
  s_add_u32 m0, s24, 24576
  s_add_u32 s26, s32, 1572864
  buffer_load_dwordx4 v45, s[8:11], s26 offen  lds
  s_add_u32 m0, s24, 25600
  s_add_u32 s26, s32, 1572992
  buffer_load_dwordx4 v45, s[8:11], s26 offen  lds
  s_add_u32 m0, s24, 26624
  s_add_u32 s26, s32, 1573120
  buffer_load_dwordx4 v45, s[8:11], s26 offen  lds
  s_add_u32 m0, s24, 27648
  s_add_u32 s26, s32, 1769472
  buffer_load_dwordx4 v45, s[8:11], s26 offen  lds
  s_add_u32 m0, s24, 28672
  s_add_u32 s26, s32, 1769600
  buffer_load_dwordx4 v45, s[8:11], s26 offen  lds
  s_add_u32 m0, s24, 29696
  s_add_u32 s26, s32, 1769728
  buffer_load_dwordx4 v45, s[8:11], s26 offen  lds
  s_add_u32 m0, s24, 49152
  s_add_u32 s26, s32, 1572864
  buffer_load_dwordx4 v45, s[12:15], s26 offen  lds
  s_add_u32 m0, s24, 50176
  s_add_u32 s26, s32, 1572992
  buffer_load_dwordx4 v45, s[12:15], s26 offen  lds
  s_add_u32 m0, s24, 51200
  s_add_u32 s26, s32, 1573120
  buffer_load_dwordx4 v45, s[12:15], s26 offen  lds
  s_add_u32 m0, s24, 52224
  s_add_u32 s26, s32, 1769472
  buffer_load_dwordx4 v45, s[12:15], s26 offen  lds
  s_add_u32 m0, s24, 53248
  s_add_u32 s26, s32, 1769600
  buffer_load_dwordx4 v45, s[12:15], s26 offen  lds
  s_add_u32 m0, s24, 54272
  s_add_u32 s26, s32, 1769728
  buffer_load_dwordx4 v45, s[12:15], s26 offen  lds
  v_add_u32 v49, 73728, v46
  v_add_u32 v50, 73728, v47
  v_add_u32 v51, 73728, v48
  ds_read_b64_tr_b16 a[0:1], v49 offset:0
  ds_read_b64_tr_b16 a[2:3], v49 offset:6144
  ds_read_b64_tr_b16 a[4:5], v49 offset:12288
  ds_read_b64_tr_b16 a[6:7], v49 offset:18432
  ds_read_b64_tr_b16 a[8:9], v50 offset:0
  ds_read_b64_tr_b16 a[10:11], v50 offset:6144
  ds_read_b64_tr_b16 a[12:13], v50 offset:12288
  ds_read_b64_tr_b16 a[14:15], v50 offset:18432
  ds_read_b64_tr_b16 a[16:17], v51 offset:0
  ds_read_b64_tr_b16 a[18:19], v51 offset:6144
  ds_read_b64_tr_b16 a[20:21], v51 offset:12288
  ds_read_b64_tr_b16 a[22:23], v51 offset:18432
  s_waitcnt lgkmcnt(0)
  s_waitcnt vmcnt(24)
  s_barrier
  s_add_u32 m0, s24, 73728
  s_add_u32 s26, s32, 2359296
  buffer_load_dwordx4 v45, s[8:11], s26 offen  lds
  s_add_u32 m0, s24, 74752
  s_add_u32 s26, s32, 2359424
  buffer_load_dwordx4 v45, s[8:11], s26 offen  lds
  s_add_u32 m0, s24, 75776
  s_add_u32 s26, s32, 2359552
  buffer_load_dwordx4 v45, s[8:11], s26 offen  lds
  s_add_u32 m0, s24, 76800
  s_add_u32 s26, s32, 2555904
  buffer_load_dwordx4 v45, s[8:11], s26 offen  lds
  s_add_u32 m0, s24, 77824
  s_add_u32 s26, s32, 2556032
  buffer_load_dwordx4 v45, s[8:11], s26 offen  lds
  s_add_u32 m0, s24, 78848
  s_add_u32 s26, s32, 2556160
  buffer_load_dwordx4 v45, s[8:11], s26 offen  lds
  v_add_u32 v49, 98304, v46
  v_add_u32 v50, 98304, v47
  v_add_u32 v51, 98304, v48
  ds_read_b64_tr_b16 a[192:193], v49 offset:0
  ds_read_b64_tr_b16 a[194:195], v49 offset:6144
  ds_read_b64_tr_b16 a[196:197], v49 offset:12288
  ds_read_b64_tr_b16 a[198:199], v49 offset:18432
  ds_read_b64_tr_b16 a[200:201], v50 offset:0
  ds_read_b64_tr_b16 a[202:203], v50 offset:6144
  ds_read_b64_tr_b16 a[204:205], v50 offset:12288
  ds_read_b64_tr_b16 a[206:207], v50 offset:18432
  ds_read_b64_tr_b16 a[208:209], v51 offset:0
  ds_read_b64_tr_b16 a[210:211], v51 offset:6144
  ds_read_b64_tr_b16 a[212:213], v51 offset:12288
  ds_read_b64_tr_b16 a[214:215], v51 offset:18432
  s_waitcnt lgkmcnt(0)
  s_waitcnt vmcnt(24)
  s_barrier
  s_add_u32 m0, s24, 98304
  s_add_u32 s26, s32, 2359296
  buffer_load_dwordx4 v45, s[12:15], s26 offen  lds
  s_add_u32 m0, s24, 99328
  s_add_u32 s26, s32, 2359424
  buffer_load_dwordx4 v45, s[12:15], s26 offen  lds
  s_add_u32 m0, s24, 100352
  s_add_u32 s26, s32, 2359552
  buffer_load_dwordx4 v45, s[12:15], s26 offen  lds
  s_add_u32 m0, s24, 101376
  s_add_u32 s26, s32, 2555904
  buffer_load_dwordx4 v45, s[12:15], s26 offen  lds
  s_add_u32 m0, s24, 102400
  s_add_u32 s26, s32, 2556032
  buffer_load_dwordx4 v45, s[12:15], s26 offen  lds
  s_add_u32 m0, s24, 103424
  s_add_u32 s26, s32, 2556160
  buffer_load_dwordx4 v45, s[12:15], s26 offen  lds
  v_add_u32 v49, 122880, v46
  v_add_u32 v50, 122880, v47
  v_add_u32 v51, 122880, v48
  ds_read_b64_tr_b16 a[24:25], v49 offset:0
  ds_read_b64_tr_b16 a[26:27], v49 offset:6144
  ds_read_b64_tr_b16 a[28:29], v49 offset:12288
  ds_read_b64_tr_b16 a[30:31], v49 offset:18432
  ds_read_b64_tr_b16 a[32:33], v50 offset:0
  ds_read_b64_tr_b16 a[34:35], v50 offset:6144
  ds_read_b64_tr_b16 a[36:37], v50 offset:12288
  ds_read_b64_tr_b16 a[38:39], v50 offset:18432
  ds_read_b64_tr_b16 a[40:41], v51 offset:0
  ds_read_b64_tr_b16 a[42:43], v51 offset:6144
  ds_read_b64_tr_b16 a[44:45], v51 offset:12288
  ds_read_b64_tr_b16 a[46:47], v51 offset:18432
  s_waitcnt lgkmcnt(0)
  s_waitcnt vmcnt(24)
  s_barrier
  s_add_u32 m0, s24, 122880
  s_add_u32 s26, s32, 3145728
  buffer_load_dwordx4 v45, s[8:11], s26 offen  lds
  s_add_u32 m0, s24, 123904
  s_add_u32 s26, s32, 3145856
  buffer_load_dwordx4 v45, s[8:11], s26 offen  lds
  s_add_u32 m0, s24, 124928
  s_add_u32 s26, s32, 3145984
  buffer_load_dwordx4 v45, s[8:11], s26 offen  lds
  s_add_u32 m0, s24, 125952
  s_add_u32 s26, s32, 3342336
  buffer_load_dwordx4 v45, s[8:11], s26 offen  lds
  s_add_u32 m0, s24, 126976
  s_add_u32 s26, s32, 3342464
  buffer_load_dwordx4 v45, s[8:11], s26 offen  lds
  s_add_u32 m0, s24, 128000
  s_add_u32 s26, s32, 3342592
  buffer_load_dwordx4 v45, s[8:11], s26 offen  lds
  v_add_u32 v49, 0, v46
  v_add_u32 v50, 0, v47
  v_add_u32 v51, 0, v48
  ds_read_b64_tr_b16 a[216:217], v49 offset:0
  ds_read_b64_tr_b16 a[218:219], v49 offset:6144
  ds_read_b64_tr_b16 a[220:221], v49 offset:12288
  ds_read_b64_tr_b16 a[222:223], v49 offset:18432
  ds_read_b64_tr_b16 a[224:225], v50 offset:0
  ds_read_b64_tr_b16 a[226:227], v50 offset:6144
  ds_read_b64_tr_b16 a[228:229], v50 offset:12288
  ds_read_b64_tr_b16 a[230:231], v50 offset:18432
  ds_read_b64_tr_b16 a[232:233], v51 offset:0
  ds_read_b64_tr_b16 a[234:235], v51 offset:6144
  ds_read_b64_tr_b16 a[236:237], v51 offset:12288
  ds_read_b64_tr_b16 a[238:239], v51 offset:18432
  s_waitcnt lgkmcnt(0)
  s_waitcnt vmcnt(24)
  s_barrier
  s_add_u32 m0, s24, 0
  s_add_u32 s26, s32, 3145728
  buffer_load_dwordx4 v45, s[12:15], s26 offen  lds
  s_add_u32 m0, s24, 1024
  s_add_u32 s26, s32, 3145856
  buffer_load_dwordx4 v45, s[12:15], s26 offen  lds
  s_add_u32 m0, s24, 2048
  s_add_u32 s26, s32, 3145984
  buffer_load_dwordx4 v45, s[12:15], s26 offen  lds
  s_add_u32 m0, s24, 3072
  s_add_u32 s26, s32, 3342336
  buffer_load_dwordx4 v45, s[12:15], s26 offen  lds
  s_add_u32 m0, s24, 4096
  s_add_u32 s26, s32, 3342464
  buffer_load_dwordx4 v45, s[12:15], s26 offen  lds
  s_add_u32 m0, s24, 5120
  s_add_u32 s26, s32, 3342592
  buffer_load_dwordx4 v45, s[12:15], s26 offen  lds
  v_add_u32 v49, 24576, v46
  v_add_u32 v50, 24576, v47
  v_add_u32 v51, 24576, v48
  ds_read_b64_tr_b16 a[48:49], v49 offset:0
  ds_read_b64_tr_b16 a[50:51], v49 offset:6144
  ds_read_b64_tr_b16 a[52:53], v49 offset:12288
  ds_read_b64_tr_b16 a[54:55], v49 offset:18432
  ds_read_b64_tr_b16 a[56:57], v50 offset:0
  ds_read_b64_tr_b16 a[58:59], v50 offset:6144
  ds_read_b64_tr_b16 a[60:61], v50 offset:12288
  ds_read_b64_tr_b16 a[62:63], v50 offset:18432
  ds_read_b64_tr_b16 a[64:65], v51 offset:0
  ds_read_b64_tr_b16 a[66:67], v51 offset:6144
  ds_read_b64_tr_b16 a[68:69], v51 offset:12288
  ds_read_b64_tr_b16 a[70:71], v51 offset:18432
  s_waitcnt lgkmcnt(0)
  s_waitcnt vmcnt(24)
  s_barrier
  s_add_u32 m0, s24, 24576
  s_add_u32 s26, s32, 3932160
  buffer_load_dwordx4 v45, s[8:11], s26 offen  lds
  s_add_u32 m0, s24, 25600
  s_add_u32 s26, s32, 3932288
  buffer_load_dwordx4 v45, s[8:11], s26 offen  lds
  s_add_u32 m0, s24, 26624
  s_add_u32 s26, s32, 3932416
  buffer_load_dwordx4 v45, s[8:11], s26 offen  lds
  s_add_u32 m0, s24, 27648
  s_add_u32 s26, s32, 4128768
  buffer_load_dwordx4 v45, s[8:11], s26 offen  lds
  s_add_u32 m0, s24, 28672
  s_add_u32 s26, s32, 4128896
  buffer_load_dwordx4 v45, s[8:11], s26 offen  lds
  s_add_u32 m0, s24, 29696
  s_add_u32 s26, s32, 4129024
  buffer_load_dwordx4 v45, s[8:11], s26 offen  lds
  v_add_u32 v49, 49152, v46
  v_add_u32 v50, 49152, v47
  v_add_u32 v51, 49152, v48
  ds_read_b64_tr_b16 a[240:241], v49 offset:0
  ds_read_b64_tr_b16 a[242:243], v49 offset:6144
  ds_read_b64_tr_b16 a[244:245], v49 offset:12288
  ds_read_b64_tr_b16 a[246:247], v49 offset:18432
  ds_read_b64_tr_b16 a[248:249], v50 offset:0
  ds_read_b64_tr_b16 a[250:251], v50 offset:6144
  ds_read_b64_tr_b16 a[252:253], v50 offset:12288
  ds_read_b64_tr_b16 a[254:255], v50 offset:18432
  ds_read_b64_tr_b16 v[152:153], v51 offset:0
  ds_read_b64_tr_b16 v[154:155], v51 offset:6144
  ds_read_b64_tr_b16 v[156:157], v51 offset:12288
  ds_read_b64_tr_b16 v[158:159], v51 offset:18432
  s_waitcnt lgkmcnt(0)
  s_waitcnt vmcnt(24)
  s_barrier
  s_add_u32 m0, s24, 49152
  s_add_u32 s26, s32, 3932160
  buffer_load_dwordx4 v45, s[12:15], s26 offen  lds
  s_add_u32 m0, s24, 50176
  s_add_u32 s26, s32, 3932288
  buffer_load_dwordx4 v45, s[12:15], s26 offen  lds
  s_add_u32 m0, s24, 51200
  s_add_u32 s26, s32, 3932416
  buffer_load_dwordx4 v45, s[12:15], s26 offen  lds
  s_add_u32 m0, s24, 52224
  s_add_u32 s26, s32, 4128768
  buffer_load_dwordx4 v45, s[12:15], s26 offen  lds
  s_add_u32 m0, s24, 53248
  s_add_u32 s26, s32, 4128896
  buffer_load_dwordx4 v45, s[12:15], s26 offen  lds
  s_add_u32 m0, s24, 54272
  s_add_u32 s26, s32, 4129024
  buffer_load_dwordx4 v45, s[12:15], s26 offen  lds
  v_add_u32 v49, 73728, v46
  v_add_u32 v50, 73728, v47
  v_add_u32 v51, 73728, v48
  ds_read_b64_tr_b16 a[72:73], v49 offset:0
  ds_read_b64_tr_b16 a[74:75], v49 offset:6144
  ds_read_b64_tr_b16 a[76:77], v49 offset:12288
  ds_read_b64_tr_b16 a[78:79], v49 offset:18432
  ds_read_b64_tr_b16 a[80:81], v50 offset:0
  ds_read_b64_tr_b16 a[82:83], v50 offset:6144
  ds_read_b64_tr_b16 a[84:85], v50 offset:12288
  ds_read_b64_tr_b16 a[86:87], v50 offset:18432
  ds_read_b64_tr_b16 a[88:89], v51 offset:0
  ds_read_b64_tr_b16 a[90:91], v51 offset:6144
  ds_read_b64_tr_b16 a[92:93], v51 offset:12288
  ds_read_b64_tr_b16 a[94:95], v51 offset:18432
  s_waitcnt lgkmcnt(0)
  s_waitcnt vmcnt(24)
  s_barrier
  s_add_u32 m0, s24, 73728
  s_add_u32 s26, s32, 4718592
  buffer_load_dwordx4 v45, s[8:11], s26 offen  lds
  s_add_u32 m0, s24, 74752
  s_add_u32 s26, s32, 4718720
  buffer_load_dwordx4 v45, s[8:11], s26 offen  lds
  s_add_u32 m0, s24, 75776
  s_add_u32 s26, s32, 4718848
  buffer_load_dwordx4 v45, s[8:11], s26 offen  lds
  s_add_u32 m0, s24, 76800
  s_add_u32 s26, s32, 4915200
  buffer_load_dwordx4 v45, s[8:11], s26 offen  lds
  s_add_u32 m0, s24, 77824
  s_add_u32 s26, s32, 4915328
  buffer_load_dwordx4 v45, s[8:11], s26 offen  lds
  s_add_u32 m0, s24, 78848
  s_add_u32 s26, s32, 4915456
  buffer_load_dwordx4 v45, s[8:11], s26 offen  lds
  v_add_u32 v49, 98304, v46
  v_add_u32 v50, 98304, v47
  v_add_u32 v51, 98304, v48
  ds_read_b64_tr_b16 v[160:161], v49 offset:0
  ds_read_b64_tr_b16 v[162:163], v49 offset:6144
  ds_read_b64_tr_b16 v[164:165], v49 offset:12288
  ds_read_b64_tr_b16 v[166:167], v49 offset:18432
  ds_read_b64_tr_b16 v[168:169], v50 offset:0
  ds_read_b64_tr_b16 v[170:171], v50 offset:6144
  ds_read_b64_tr_b16 v[172:173], v50 offset:12288
  ds_read_b64_tr_b16 v[174:175], v50 offset:18432
  ds_read_b64_tr_b16 v[176:177], v51 offset:0
  ds_read_b64_tr_b16 v[178:179], v51 offset:6144
  ds_read_b64_tr_b16 v[180:181], v51 offset:12288
  ds_read_b64_tr_b16 v[182:183], v51 offset:18432
  s_waitcnt lgkmcnt(0)
  s_waitcnt vmcnt(24)
  s_barrier
  s_add_u32 m0, s24, 98304
  s_add_u32 s26, s32, 4718592
  buffer_load_dwordx4 v45, s[12:15], s26 offen  lds
  s_add_u32 m0, s24, 99328
  s_add_u32 s26, s32, 4718720
  buffer_load_dwordx4 v45, s[12:15], s26 offen  lds
  s_add_u32 m0, s24, 100352
  s_add_u32 s26, s32, 4718848
  buffer_load_dwordx4 v45, s[12:15], s26 offen  lds
  s_add_u32 m0, s24, 101376
  s_add_u32 s26, s32, 4915200
  buffer_load_dwordx4 v45, s[12:15], s26 offen  lds
  s_add_u32 m0, s24, 102400
  s_add_u32 s26, s32, 4915328
  buffer_load_dwordx4 v45, s[12:15], s26 offen  lds
  s_add_u32 m0, s24, 103424
  s_add_u32 s26, s32, 4915456
  buffer_load_dwordx4 v45, s[12:15], s26 offen  lds
  v_add_u32 v49, 122880, v46
  v_add_u32 v50, 122880, v47
  v_add_u32 v51, 122880, v48
  ds_read_b64_tr_b16 a[96:97], v49 offset:0
  ds_read_b64_tr_b16 a[98:99], v49 offset:6144
  ds_read_b64_tr_b16 a[100:101], v49 offset:12288
  ds_read_b64_tr_b16 a[102:103], v49 offset:18432
  ds_read_b64_tr_b16 a[104:105], v50 offset:0
  ds_read_b64_tr_b16 a[106:107], v50 offset:6144
  ds_read_b64_tr_b16 a[108:109], v50 offset:12288
  ds_read_b64_tr_b16 a[110:111], v50 offset:18432
  ds_read_b64_tr_b16 a[112:113], v51 offset:0
  ds_read_b64_tr_b16 a[114:115], v51 offset:6144
  ds_read_b64_tr_b16 a[116:117], v51 offset:12288
  ds_read_b64_tr_b16 a[118:119], v51 offset:18432
  s_waitcnt lgkmcnt(0)
  s_waitcnt vmcnt(24)
  s_barrier
  s_add_u32 m0, s24, 122880
  s_add_u32 s26, s32, 5505024
  buffer_load_dwordx4 v45, s[8:11], s26 offen  lds
  s_add_u32 m0, s24, 123904
  s_add_u32 s26, s32, 5505152
  buffer_load_dwordx4 v45, s[8:11], s26 offen  lds
  s_add_u32 m0, s24, 124928
  s_add_u32 s26, s32, 5505280
  buffer_load_dwordx4 v45, s[8:11], s26 offen  lds
  s_add_u32 m0, s24, 125952
  s_add_u32 s26, s32, 5701632
  buffer_load_dwordx4 v45, s[8:11], s26 offen  lds
  s_add_u32 m0, s24, 126976
  s_add_u32 s26, s32, 5701760
  buffer_load_dwordx4 v45, s[8:11], s26 offen  lds
  s_add_u32 m0, s24, 128000
  s_add_u32 s26, s32, 5701888
  buffer_load_dwordx4 v45, s[8:11], s26 offen  lds
  v_add_u32 v49, 0, v46
  v_add_u32 v50, 0, v47
  v_add_u32 v51, 0, v48
  ds_read_b64_tr_b16 v[184:185], v49 offset:0
  ds_read_b64_tr_b16 v[186:187], v49 offset:6144
  ds_read_b64_tr_b16 v[188:189], v49 offset:12288
  ds_read_b64_tr_b16 v[190:191], v49 offset:18432
  ds_read_b64_tr_b16 v[192:193], v50 offset:0
  ds_read_b64_tr_b16 v[194:195], v50 offset:6144
  ds_read_b64_tr_b16 v[196:197], v50 offset:12288
  ds_read_b64_tr_b16 v[198:199], v50 offset:18432
  ds_read_b64_tr_b16 v[200:201], v51 offset:0
  ds_read_b64_tr_b16 v[202:203], v51 offset:6144
  ds_read_b64_tr_b16 v[204:205], v51 offset:12288
  ds_read_b64_tr_b16 v[206:207], v51 offset:18432
  s_waitcnt lgkmcnt(0)
  s_waitcnt vmcnt(24)
  s_barrier
  s_add_u32 m0, s24, 0
  s_add_u32 s26, s32, 5505024
  buffer_load_dwordx4 v45, s[12:15], s26 offen  lds
  s_add_u32 m0, s24, 1024
  s_add_u32 s26, s32, 5505152
  buffer_load_dwordx4 v45, s[12:15], s26 offen  lds
  s_add_u32 m0, s24, 2048
  s_add_u32 s26, s32, 5505280
  buffer_load_dwordx4 v45, s[12:15], s26 offen  lds
  s_add_u32 m0, s24, 3072
  s_add_u32 s26, s32, 5701632
  buffer_load_dwordx4 v45, s[12:15], s26 offen  lds
  s_add_u32 m0, s24, 4096
  s_add_u32 s26, s32, 5701760
  buffer_load_dwordx4 v45, s[12:15], s26 offen  lds
  s_add_u32 m0, s24, 5120
  s_add_u32 s26, s32, 5701888
  buffer_load_dwordx4 v45, s[12:15], s26 offen  lds
  v_add_u32 v49, 24576, v46
  v_add_u32 v50, 24576, v47
  v_add_u32 v51, 24576, v48
  ds_read_b64_tr_b16 a[120:121], v49 offset:0
  ds_read_b64_tr_b16 a[122:123], v49 offset:6144
  ds_read_b64_tr_b16 a[124:125], v49 offset:12288
  ds_read_b64_tr_b16 a[126:127], v49 offset:18432
  ds_read_b64_tr_b16 a[128:129], v50 offset:0
  ds_read_b64_tr_b16 a[130:131], v50 offset:6144
  ds_read_b64_tr_b16 a[132:133], v50 offset:12288
  ds_read_b64_tr_b16 a[134:135], v50 offset:18432
  ds_read_b64_tr_b16 a[136:137], v51 offset:0
  ds_read_b64_tr_b16 a[138:139], v51 offset:6144
  ds_read_b64_tr_b16 a[140:141], v51 offset:12288
  ds_read_b64_tr_b16 a[142:143], v51 offset:18432
  s_waitcnt lgkmcnt(0)
  s_waitcnt vmcnt(24)
  s_barrier
  s_add_u32 m0, s24, 24576
  s_add_u32 s26, s32, 6291456
  buffer_load_dwordx4 v45, s[8:11], s26 offen  lds
  s_add_u32 m0, s24, 25600
  s_add_u32 s26, s32, 6291584
  buffer_load_dwordx4 v45, s[8:11], s26 offen  lds
  s_add_u32 m0, s24, 26624
  s_add_u32 s26, s32, 6291712
  buffer_load_dwordx4 v45, s[8:11], s26 offen  lds
  s_add_u32 m0, s24, 27648
  s_add_u32 s26, s32, 6488064
  buffer_load_dwordx4 v45, s[8:11], s26 offen  lds
  s_add_u32 m0, s24, 28672
  s_add_u32 s26, s32, 6488192
  buffer_load_dwordx4 v45, s[8:11], s26 offen  lds
  s_add_u32 m0, s24, 29696
  s_add_u32 s26, s32, 6488320
  buffer_load_dwordx4 v45, s[8:11], s26 offen  lds
  v_add_u32 v49, 49152, v46
  v_add_u32 v50, 49152, v47
  v_add_u32 v51, 49152, v48
  ds_read_b64_tr_b16 v[208:209], v49 offset:0
  ds_read_b64_tr_b16 v[210:211], v49 offset:6144
  ds_read_b64_tr_b16 v[212:213], v49 offset:12288
  ds_read_b64_tr_b16 v[214:215], v49 offset:18432
  ds_read_b64_tr_b16 v[216:217], v50 offset:0
  ds_read_b64_tr_b16 v[218:219], v50 offset:6144
  ds_read_b64_tr_b16 v[220:221], v50 offset:12288
  ds_read_b64_tr_b16 v[222:223], v50 offset:18432
  ds_read_b64_tr_b16 v[224:225], v51 offset:0
  ds_read_b64_tr_b16 v[226:227], v51 offset:6144
  ds_read_b64_tr_b16 v[228:229], v51 offset:12288
  ds_read_b64_tr_b16 v[230:231], v51 offset:18432
  s_waitcnt lgkmcnt(0)
  s_waitcnt vmcnt(24)
  s_barrier
  s_add_u32 m0, s24, 49152
  s_add_u32 s26, s32, 6291456
  buffer_load_dwordx4 v45, s[12:15], s26 offen  lds
  s_add_u32 m0, s24, 50176
  s_add_u32 s26, s32, 6291584
  buffer_load_dwordx4 v45, s[12:15], s26 offen  lds
  s_add_u32 m0, s24, 51200
  s_add_u32 s26, s32, 6291712
  buffer_load_dwordx4 v45, s[12:15], s26 offen  lds
  s_add_u32 m0, s24, 52224
  s_add_u32 s26, s32, 6488064
  buffer_load_dwordx4 v45, s[12:15], s26 offen  lds
  s_add_u32 m0, s24, 53248
  s_add_u32 s26, s32, 6488192
  buffer_load_dwordx4 v45, s[12:15], s26 offen  lds
  s_add_u32 m0, s24, 54272
  s_add_u32 s26, s32, 6488320
  buffer_load_dwordx4 v45, s[12:15], s26 offen  lds
  v_add_u32 v49, 73728, v46
  v_add_u32 v50, 73728, v47
  v_add_u32 v51, 73728, v48
  ds_read_b64_tr_b16 a[144:145], v49 offset:0
  ds_read_b64_tr_b16 a[146:147], v49 offset:6144
  ds_read_b64_tr_b16 a[148:149], v49 offset:12288
  ds_read_b64_tr_b16 a[150:151], v49 offset:18432
  ds_read_b64_tr_b16 a[152:153], v50 offset:0
  ds_read_b64_tr_b16 a[154:155], v50 offset:6144
  ds_read_b64_tr_b16 a[156:157], v50 offset:12288
  ds_read_b64_tr_b16 a[158:159], v50 offset:18432
  ds_read_b64_tr_b16 a[160:161], v51 offset:0
  ds_read_b64_tr_b16 a[162:163], v51 offset:6144
  ds_read_b64_tr_b16 a[164:165], v51 offset:12288
  ds_read_b64_tr_b16 a[166:167], v51 offset:18432
  s_waitcnt lgkmcnt(0)
  s_waitcnt vmcnt(24)
  s_barrier
  s_add_u32 m0, s24, 73728
  s_add_u32 s26, s32, 7077888
  buffer_load_dwordx4 v45, s[8:11], s26 offen  lds
  s_add_u32 m0, s24, 74752
  s_add_u32 s26, s32, 7078016
  buffer_load_dwordx4 v45, s[8:11], s26 offen  lds
  s_add_u32 m0, s24, 75776
  s_add_u32 s26, s32, 7078144
  buffer_load_dwordx4 v45, s[8:11], s26 offen  lds
  s_add_u32 m0, s24, 76800
  s_add_u32 s26, s32, 7274496
  buffer_load_dwordx4 v45, s[8:11], s26 offen  lds
  s_add_u32 m0, s24, 77824
  s_add_u32 s26, s32, 7274624
  buffer_load_dwordx4 v45, s[8:11], s26 offen  lds
  s_add_u32 m0, s24, 78848
  s_add_u32 s26, s32, 7274752
  buffer_load_dwordx4 v45, s[8:11], s26 offen  lds
  v_add_u32 v49, 98304, v46
  v_add_u32 v50, 98304, v47
  v_add_u32 v51, 98304, v48
  ds_read_b64_tr_b16 v[232:233], v49 offset:0
  ds_read_b64_tr_b16 v[234:235], v49 offset:6144
  ds_read_b64_tr_b16 v[236:237], v49 offset:12288
  ds_read_b64_tr_b16 v[238:239], v49 offset:18432
  ds_read_b64_tr_b16 v[240:241], v50 offset:0
  ds_read_b64_tr_b16 v[242:243], v50 offset:6144
  ds_read_b64_tr_b16 v[244:245], v50 offset:12288
  ds_read_b64_tr_b16 v[246:247], v50 offset:18432
  ds_read_b64_tr_b16 v[248:249], v51 offset:0
  ds_read_b64_tr_b16 v[250:251], v51 offset:6144
  ds_read_b64_tr_b16 v[252:253], v51 offset:12288
  ds_read_b64_tr_b16 v[254:255], v51 offset:18432
  s_waitcnt lgkmcnt(0)
  s_waitcnt vmcnt(24)
  s_barrier
  s_add_u32 m0, s24, 98304
  s_add_u32 s26, s32, 7077888
  buffer_load_dwordx4 v45, s[12:15], s26 offen  lds
  s_add_u32 m0, s24, 99328
  s_add_u32 s26, s32, 7078016
  buffer_load_dwordx4 v45, s[12:15], s26 offen  lds
  s_add_u32 m0, s24, 100352
  s_add_u32 s26, s32, 7078144
  buffer_load_dwordx4 v45, s[12:15], s26 offen  lds
  s_add_u32 m0, s24, 101376
  s_add_u32 s26, s32, 7274496
  buffer_load_dwordx4 v45, s[12:15], s26 offen  lds
  s_add_u32 m0, s24, 102400
  s_add_u32 s26, s32, 7274624
  buffer_load_dwordx4 v45, s[12:15], s26 offen  lds
  s_add_u32 m0, s24, 103424
  s_add_u32 s26, s32, 7274752
  buffer_load_dwordx4 v45, s[12:15], s26 offen  lds
  v_add_u32 v49, 122880, v46
  v_add_u32 v50, 122880, v47
  v_add_u32 v51, 122880, v48
  ds_read_b64_tr_b16 a[168:169], v49 offset:0
  ds_read_b64_tr_b16 a[170:171], v49 offset:6144
  ds_read_b64_tr_b16 a[172:173], v49 offset:12288
  ds_read_b64_tr_b16 a[174:175], v49 offset:18432
  ds_read_b64_tr_b16 a[176:177], v50 offset:0
  ds_read_b64_tr_b16 a[178:179], v50 offset:6144
  ds_read_b64_tr_b16 a[180:181], v50 offset:12288
  ds_read_b64_tr_b16 a[182:183], v50 offset:18432
  ds_read_b64_tr_b16 a[184:185], v51 offset:0
  ds_read_b64_tr_b16 a[186:187], v51 offset:6144
  ds_read_b64_tr_b16 a[188:189], v51 offset:12288
  ds_read_b64_tr_b16 a[190:191], v51 offset:18432
  s_waitcnt lgkmcnt(0)
  s_waitcnt vmcnt(24)
  s_barrier
  v_add_u32 v49, 0, v46
  v_add_u32 v50, 0, v47
  v_add_u32 v51, 0, v48
  v_add_u32 v52, 0, v43
  ds_read_b64_tr_b16 v[76:77], v49 offset:0
  ds_read_b64_tr_b16 v[78:79], v49 offset:6144
  ds_read_b64_tr_b16 v[80:81], v49 offset:12288
  ds_read_b64_tr_b16 v[82:83], v49 offset:18432
  ds_read_b64_tr_b16 v[84:85], v50 offset:0
  ds_read_b64_tr_b16 v[86:87], v50 offset:6144
  ds_read_b64_tr_b16 v[88:89], v50 offset:12288
  ds_read_b64_tr_b16 v[90:91], v50 offset:18432
  ds_read_b64_tr_b16 v[92:93], v51 offset:0
  ds_read_b64_tr_b16 v[94:95], v51 offset:6144
  ds_read_b64_tr_b16 v[96:97], v51 offset:12288
  ds_read_b64_tr_b16 v[98:99], v51 offset:18432
  s_waitcnt lgkmcnt(0)
  s_barrier
  ds_write_b128 v52, v[76:79] offset:0
  ds_write_b128 v52, v[80:83] offset:1024
  ds_write_b128 v52, v[84:87] offset:2048
  ds_write_b128 v52, v[88:91] offset:3072
  ds_write_b128 v52, v[92:95] offset:4096
  ds_write_b128 v52, v[96:99] offset:5120
  s_waitcnt lgkmcnt(0)
  s_waitcnt vmcnt(18)
  s_barrier
  v_add_u32 v49, 24576, v46
  v_add_u32 v50, 24576, v47
  v_add_u32 v51, 24576, v48
  v_add_u32 v52, 24576, v43
  ds_read_b64_tr_b16 v[76:77], v49 offset:0
  ds_read_b64_tr_b16 v[78:79], v49 offset:6144
  ds_read_b64_tr_b16 v[80:81], v49 offset:12288
  ds_read_b64_tr_b16 v[82:83], v49 offset:18432
  ds_read_b64_tr_b16 v[84:85], v50 offset:0
  ds_read_b64_tr_b16 v[86:87], v50 offset:6144
  ds_read_b64_tr_b16 v[88:89], v50 offset:12288
  ds_read_b64_tr_b16 v[90:91], v50 offset:18432
  ds_read_b64_tr_b16 v[92:93], v51 offset:0
  ds_read_b64_tr_b16 v[94:95], v51 offset:6144
  ds_read_b64_tr_b16 v[96:97], v51 offset:12288
  ds_read_b64_tr_b16 v[98:99], v51 offset:18432
  s_waitcnt lgkmcnt(0)
  s_barrier
  ds_write_b128 v52, v[76:79] offset:0
  ds_write_b128 v52, v[80:83] offset:1024
  ds_write_b128 v52, v[84:87] offset:2048
  ds_write_b128 v52, v[88:91] offset:3072
  ds_write_b128 v52, v[92:95] offset:4096
  ds_write_b128 v52, v[96:99] offset:5120
  s_waitcnt lgkmcnt(0)
  s_waitcnt vmcnt(12)
  s_barrier
  v_add_u32 v49, 49152, v46
  v_add_u32 v50, 49152, v47
  v_add_u32 v51, 49152, v48
  v_add_u32 v52, 49152, v43
  ds_read_b64_tr_b16 v[76:77], v49 offset:0
  ds_read_b64_tr_b16 v[78:79], v49 offset:6144
  ds_read_b64_tr_b16 v[80:81], v49 offset:12288
  ds_read_b64_tr_b16 v[82:83], v49 offset:18432
  ds_read_b64_tr_b16 v[84:85], v50 offset:0
  ds_read_b64_tr_b16 v[86:87], v50 offset:6144
  ds_read_b64_tr_b16 v[88:89], v50 offset:12288
  ds_read_b64_tr_b16 v[90:91], v50 offset:18432
  ds_read_b64_tr_b16 v[92:93], v51 offset:0
  ds_read_b64_tr_b16 v[94:95], v51 offset:6144
  ds_read_b64_tr_b16 v[96:97], v51 offset:12288
  ds_read_b64_tr_b16 v[98:99], v51 offset:18432
  s_waitcnt lgkmcnt(0)
  s_barrier
  ds_write_b128 v52, v[76:79] offset:0
  ds_write_b128 v52, v[80:83] offset:1024
  ds_write_b128 v52, v[84:87] offset:2048
  ds_write_b128 v52, v[88:91] offset:3072
  ds_write_b128 v52, v[92:95] offset:4096
  ds_write_b128 v52, v[96:99] offset:5120
  s_waitcnt lgkmcnt(0)
  s_waitcnt vmcnt(6)
  s_barrier
  buffer_load_dword v72, off, s[96:99], 0 offset:128 sc1
  buffer_load_dword v73, off, s[96:99], s94 sc1
  v_add_u32 v49, 73728, v46
  v_add_u32 v50, 73728, v47
  v_add_u32 v51, 73728, v48
  v_add_u32 v52, 73728, v43
  ds_read_b64_tr_b16 v[76:77], v49 offset:0
  ds_read_b64_tr_b16 v[78:79], v49 offset:6144
  ds_read_b64_tr_b16 v[80:81], v49 offset:12288
  ds_read_b64_tr_b16 v[82:83], v49 offset:18432
  ds_read_b64_tr_b16 v[84:85], v50 offset:0
  ds_read_b64_tr_b16 v[86:87], v50 offset:6144
  ds_read_b64_tr_b16 v[88:89], v50 offset:12288
  ds_read_b64_tr_b16 v[90:91], v50 offset:18432
  ds_read_b64_tr_b16 v[92:93], v51 offset:0
  ds_read_b64_tr_b16 v[94:95], v51 offset:6144
  ds_read_b64_tr_b16 v[96:97], v51 offset:12288
  ds_read_b64_tr_b16 v[98:99], v51 offset:18432
  s_waitcnt lgkmcnt(0)
  s_barrier
  ds_write_b128 v52, v[76:79] offset:0
  ds_write_b128 v52, v[80:83] offset:1024
  ds_write_b128 v52, v[84:87] offset:2048
  ds_write_b128 v52, v[88:91] offset:3072
  ds_write_b128 v52, v[92:95] offset:4096
  ds_write_b128 v52, v[96:99] offset:5120
  s_waitcnt lgkmcnt(0)
  s_waitcnt vmcnt(2)
  s_barrier
  v_add_u32 v49, 98304, v46
  v_add_u32 v50, 98304, v47
  v_add_u32 v51, 98304, v48
  v_add_u32 v52, 98304, v43
  ds_read_b64_tr_b16 v[76:77], v49 offset:0
  ds_read_b64_tr_b16 v[78:79], v49 offset:6144
  ds_read_b64_tr_b16 v[80:81], v49 offset:12288
  ds_read_b64_tr_b16 v[82:83], v49 offset:18432
  ds_read_b64_tr_b16 v[84:85], v50 offset:0
  ds_read_b64_tr_b16 v[86:87], v50 offset:6144
  ds_read_b64_tr_b16 v[88:89], v50 offset:12288
  ds_read_b64_tr_b16 v[90:91], v50 offset:18432
  ds_read_b64_tr_b16 v[92:93], v51 offset:0
  ds_read_b64_tr_b16 v[94:95], v51 offset:6144
  ds_read_b64_tr_b16 v[96:97], v51 offset:12288
  ds_read_b64_tr_b16 v[98:99], v51 offset:18432
  s_waitcnt lgkmcnt(0)
  s_barrier
  ds_write_b128 v52, v[76:79] offset:0
  ds_write_b128 v52, v[80:83] offset:1024
  ds_write_b128 v52, v[84:87] offset:2048
  ds_write_b128 v52, v[88:91] offset:3072
  ds_write_b128 v52, v[92:95] offset:4096
  ds_write_b128 v52, v[96:99] offset:5120
  s_waitcnt lgkmcnt(0)
  s_waitcnt vmcnt(0)
  s_barrier
  v_mov_b32 v74, 163824
  s_cmp_lg_u32 s17, 0
  s_cbranch_scc1 L_wh4_b
  s_branch L_wh4_t
L_wh4:
  s_sleep 3
L_wh4_in:
  buffer_load_dword v72, off, s[96:99], 0 offset:128 sc1
  buffer_load_dword v73, off, s[96:99], s94 sc1
  s_add_u32 s39, s39, 1
  s_cmp_gt_u32 s39, 200000
  s_cbranch_scc1 L_exit
  s_waitcnt vmcnt(0)
L_wh4_t:
  v_readfirstlane_b32 s19, v72
  v_readfirstlane_b32 s74, v73
  s_nop 0
  s_and_b32 s22, s19, 255
  s_cmp_lt_u32 s22, 64
  s_cbranch_scc1 L_wh4
  s_and_b32 s22, s74, 255
  s_cmp_lt_u32 s22, 26
  s_cbranch_scc1 L_wh4
  ds_write_b64 v74, v[72:73]
  s_waitcnt lgkmcnt(0)
L_wh4_b:
  s_barrier
  ds_read_b64 v[72:73], v74
  s_waitcnt lgkmcnt(0)
  v_readfirstlane_b32 s19, v72
  v_readfirstlane_b32 s74, v73
  s_nop 0
  s_and_b32 s19, s19, 512
  s_lshl_b32 s19, s19, 4
  s_mul_i32 s22, s95, 26
  s_sub_u32 s74, s74, s22
  s_mul_i32 s22, s17, 6144
  v_lshlrev_b32 v4, 4, v1
  v_add_u32 v4, s22, v4
  v_add_u32 v5, 61440, v4
  s_mul_i32 s22, s17, 2560
  v_lshlrev_b32 v10, 4, v1
  v_add_u32 v10, s22, v10
  v_add_u32 v12, 147456, v10
  v_lshlrev_b32 v11, 3, v1
  v_add_u32 v11, s22, v11
  v_add_u32 v13, 147456, v11
  v_and_b32 v16, 1, v1
  v_cmp_eq_u32 vcc, 0, v16
  v_mov_b32 v16, 0xeeee
  v_mov_b32 v17, 0x4444
  v_cndmask_b32 v16, v16, v17, vcc
  v_lshlrev_b32 v30, 4, v1
  v_add_u32 v18, 147456, v30
  v_mul_u32_u24 v19, 176, v3
  v_lshl_add_u32 v19, v2, 4, v19
  s_mul_i32 s22, s17, 1408
  s_add_u32 s22, s22, 157696
  v_add_u32 v19, s22, v19
  v_lshrrev_b32 v31, 3, v1
  v_mul_u32_u24 v21, 176, v31
  v_add_u32 v21, 157696, v21
  v_and_b32 v15, 1, v1
  v_lshl_add_u32 v21, v15, 4, v21
  v_bfe_u32 v15, v1, 1, 1
  v_lshl_add_u32 v20, v15, 6, v21
  v_lshl_add_u32 v21, v15, 3, v21
  v_add_u32 v21, 128, v21
  v_bfe_u32 v15, v1, 2, 1
  v_lshl_add_u32 v20, v15, 5, v20
  s_and_b32 s22, s18, 7
  s_mul_i32 s22, s22, 640
  s_add_u32 s22, s22, 10240
  v_lshlrev_b32 v22, 8, v15
  v_lshl_add_u32 v22, v31, 5, v22
  v_and_b32 v15, 3, v1
  v_lshl_add_u32 v22, v15, 3, v22
  v_add_u32 v22, s22, v22
  v_lshlrev_b32 v23, 4, v31
  v_lshl_add_u32 v23, v15, 2, v23
  v_add_u32 v23, s22, v23
  v_add_u32 v23, 512, v23
  v_lshlrev_b32 v15, 1, v2
  v_sub_u32 v15, v3, v15
  v_mov_b32 v26, 0x3f80
  v_mov_b32 v27, 0x3f800000
  v_mov_b32 v6, 0
  v_cmp_eq_u32 vcc, 0, v15
  s_nop 1
  v_cndmask_b32 v6, v6, v26, vcc
  v_cmp_eq_u32 vcc, 1, v15
  s_nop 1
  v_cndmask_b32 v6, v6, v27, vcc
  v_mov_b32 v7, 0
  v_cmp_eq_u32 vcc, 8, v15
  s_nop 1
  v_cndmask_b32 v7, v7, v26, vcc
  v_cmp_eq_u32 vcc, 9, v15
  s_nop 1
  v_cndmask_b32 v7, v7, v27, vcc
  v_bfe_u32 v26, v1, 1, 3
  s_and_b32 s22, s17, 1
  s_lshl_b32 s22, s22, 3
  v_add_u32 v26, s22, v26
  v_and_b32 v27, 1, v1
  v_lshlrev_b32 v15, 2, v2
  v_lshl_add_u32 v15, v27, 1, v15
  v_sub_u32 v15, v26, v15
  v_cmp_le_i32 s[44:45], 0, v15
  v_cmp_le_i32 s[46:47], 1, v15
  s_nop 4
  s_cmp_ge_u32 s17, 2
  s_cselect_b64 s[48:49], s[44:45], 0
  s_cselect_b64 s[44:45], -1, s[44:45]
  s_cselect_b64 s[50:51], s[46:47], 0
  s_cselect_b64 s[46:47], -1, s[46:47]
  s_mul_i32 s22, s17, 5120
  s_add_u32 s22, s22, 122880
  v_add_u32 v17, s22, v30
  v_lshlrev_b32 v28, 4, v26
  v_lshl_add_u32 v28, v27, 3, v28
  v_lshl_add_u32 v31, v2, 8, v28
  s_lshr_b32 s22, s17, 1
  s_lshl_b32 s22, s22, 11
  s_add_u32 s22, s22, 122880
  v_add_u32 v0, s22, v31
  v_add_u32 v0, 1024, v0
  v_and_b32 v15, 1, v2
  v_lshlrev_b32 v14, 4, v26
  v_lshl_add_u32 v14, v15, 3, v14
  v_lshl_add_u32 v14, v27, 8, v14
  v_add_u32 v14, s22, v14
  v_add_u32 v14, 512, v14
  v_mov_b32 v3, v28
  s_mul_i32 s36, s18, 12288
  s_mul_i32 s22, s17, 3072
  s_add_u32 s36, s36, s22
  s_lshr_b32 s22, s17, 1
  s_lshl_b32 s37, s22, 15
  s_lshl_b32 s23, s18, 10
  s_add_u32 s37, s37, s23
  s_add_u32 s37, s37, 8388608
  s_lshl_b32 s38, s22, 13
  s_lshl_b32 s23, s18, 8
  s_add_u32 s38, s38, s23
  s_add_u32 s38, s38, 12582912
  v_and_b32 v2, 1, v1
  v_mul_u32_u24 v2, 49152, v2
  v_mov_b32 v1, v30
  s_mov_b32 s62, 0x3dd53b95
  s_mov_b32 s63, 0x3dd53b95
  s_mov_b32 s64, 0xff800000
  s_mov_b32 s65, 0xd04e79ff
  s_mov_b32 s66, 0x00ff00ff
  s_mov_b32 s67, 0x00ff00ff
  s_mov_b32 s68, 0x0f0f0f0f
  s_mov_b32 s69, 0x0f0f0f0f
  s_mov_b32 s70, 0
  s_mov_b32 s41, 0xff81ff81
  s_mov_b32 s39, 0
  s_mov_b32 s20, 0
  s_lshl_b32 s35, s18, 8
  s_add_u32 s35, s35, 7405568
  s_add_u32 s35, s35, s19
  s_lshl_b32 s22, s17, 6
  s_add_u32 s35, s35, s22
  s_add_u32 s72, s35, 65536
  v_mov_b32 v8, s41
  v_mov_b32 v9, s41
  v_add_u32 v30, 2816, v21
  s_and_b32 s73, s16, 3
  s_lshl_b32 s73, s73, 19
  s_add_u32 s73, s73, 4194304
  s_mov_b32 s31, 1
  s_cmp_ge_u32 s70, s31
  s_cbranch_scc1 L_A_f0_ok
L_A_f0:
  buffer_load_dword v15, v2, s[4:7], s35 offen sc1
  s_add_u32 s39, s39, 1
  s_cmp_gt_u32 s39, 200000
  s_cbranch_scc1 L_exit
  s_waitcnt vmcnt(0)
  v_readlane_b32 s70, v15, 0
  v_readlane_b32 s71, v15, 1
  s_nop 0
  s_min_u32 s70, s70, s71
  s_cmp_lt_u32 s70, s31
  s_cbranch_scc1 L_A_f0
L_A_f0_ok:
  s_add_u32 s23, s36, 25165824
  buffer_load_dwordx4 v[116:119], v1, s[4:7], s23 offen offset:0 sc1
  buffer_load_dwordx4 v[120:123], v1, s[4:7], s23 offen offset:1024 sc1
  buffer_load_dwordx4 v[124:127], v1, s[4:7], s23 offen offset:2048 sc1
  s_waitcnt vmcnt(0)
  s_cmp_lg_u32 s74, 0
  s_cbranch_scc1 L_A_safe
L_A_loop:
  s_add_u32 s31, s20, 2
  s_min_u32 s31, s31, 64
  s_cmp_ge_u32 s70, s31
  s_cbranch_scc1 L_A_fl_ok
L_A_fl:
  buffer_load_dword v15, v2, s[4:7], s35 offen sc1
  s_add_u32 s39, s39, 1
  s_cmp_gt_u32 s39, 200000
  s_cbranch_scc1 L_exit
  s_waitcnt vmcnt(0)
  v_readlane_b32 s70, v15, 0
  v_readlane_b32 s71, v15, 1
  s_nop 0
  s_min_u32 s70, s70, s71
  s_cmp_lt_u32 s70, s31
  s_cbranch_scc1 L_A_fl
L_A_fl_ok:
  v_mov_b64 v[104:105], v[116:117]
  v_mov_b64 v[106:107], v[120:121]
  v_mov_b64 v[108:109], v[118:119]
  v_mov_b64 v[110:111], v[122:123]
  v_mov_b64 v[112:113], v[124:125]
  v_mov_b64 v[114:115], v[126:127]
  s_add_u32 s40, s20, 0
  s_and_b32 s40, s40, 3
  s_lshl_b32 s40, s40, 17
  s_add_u32 s40, s40, s73
  s_add_u32 s22, s20, 3
  s_min_u32 s22, s22, 64
  s_cmp_lt_u32 s70, s22
  s_cselect_b32 s64, s35, 0xf0000000
  s_add_u32 s23, s20, 1
  s_min_u32 s23, s23, 63
  s_mul_i32 s23, s23, 393216
  s_add_u32 s23, s23, s36
  s_add_u32 s42, s23, 25165824
  s_mul_i32 s23, s20, 393216
  s_add_u32 s23, s23, s36
  s_add_u32 s43, s23, 50331648
  ds_read_b128 v[88:91], v4 offset:24576
  ds_read_b128 v[92:95], v4 offset:25600
  ds_read_b128 v[96:99], v4 offset:49152
  ds_read_b128 v[100:103], v4 offset:50176
  v_mov_b64 v[72:73], 0
  v_mov_b64 v[74:75], 0
  v_mov_b64 v[76:77], 0
  v_mov_b64 v[78:79], 0
  v_mov_b64 v[80:81], 0
  v_mov_b64 v[82:83], 0
  v_mov_b64 v[84:85], 0
  v_mov_b64 v[86:87], 0
  s_waitcnt lgkmcnt(0)
  s_waitcnt vmcnt(0)
  buffer_load_dwordx4 v[140:143], v10, s[4:7], s40 offen offset:0 sc1
  buffer_load_dwordx4 v[144:147], v10, s[4:7], s40 offen offset:1024 sc1
  buffer_load_dwordx2 v[148:149], v11, s[4:7], s40 offen offset:2048 sc1
  s_sleep 2
L_A_poll:
  buffer_load_dwordx4 v[128:131], v10, s[4:7], s40 offen offset:0 sc1
  buffer_load_dwordx4 v[132:135], v10, s[4:7], s40 offen offset:1024 sc1
  buffer_load_dwordx2 v[136:137], v11, s[4:7], s40 offen offset:2048 sc1
  s_add_u32 s39, s39, 1
  s_cmp_gt_u32 s39, 200000
  s_cbranch_scc1 L_exit
  s_waitcnt vmcnt(5)
  ds_write_b128 v12, v[140:143]
  v_max3_u32 v15, v140, v141, v142
  s_waitcnt vmcnt(4)
  ds_write_b128 v12, v[144:147] offset:1024
  v_max3_u32 v15, v15, v143, v144
  v_max3_u32 v15, v15, v145, v146
  s_waitcnt vmcnt(3)
  ds_write_b64 v13, v[148:149] offset:2048
  v_max3_u32 v15, v15, v147, v148
  v_max_u32 v15, v15, v149
  v_cmp_eq_u32 vcc, s41, v15
  s_cbranch_vccz L_A_poll_ok
  buffer_load_dwordx4 v[140:143], v10, s[4:7], s40 offen offset:0 sc1
  buffer_load_dwordx4 v[144:147], v10, s[4:7], s40 offen offset:1024 sc1
  buffer_load_dwordx2 v[148:149], v11, s[4:7], s40 offen offset:2048 sc1
  s_waitcnt vmcnt(5)
  ds_write_b128 v12, v[128:131]
  v_max3_u32 v15, v128, v129, v130
  s_waitcnt vmcnt(4)
  ds_write_b128 v12, v[132:135] offset:1024
  v_max3_u32 v15, v15, v131, v132
  v_max3_u32 v15, v15, v133, v134
  s_waitcnt vmcnt(3)
  ds_write_b64 v13, v[136:137] offset:2048
  v_max3_u32 v15, v15, v135, v136
  v_max_u32 v15, v15, v137
  v_cmp_eq_u32 vcc, s41, v15
  s_cbranch_vccnz L_A_poll
L_A_poll_ok:
  s_waitcnt lgkmcnt(0)
  s_barrier
  ds_read_b128 v[64:67], v18 offset:8192
  ds_read_b128 v[32:35], v18 offset:0
  ds_read_b128 v[36:39], v18 offset:1024
  ds_read_b128 v[40:43], v18 offset:2048
  ds_read_b128 v[68:71], v18 offset:9216
  ds_read_b128 v[44:47], v18 offset:3072
  s_waitcnt lgkmcnt(5)
  v_smfmac_f32_16x16x64_bf16 v[72:75], v[64:67], v[88:95], v16
  ds_read_b128 v[88:91], v5 offset:12288
  s_waitcnt lgkmcnt(5)
  v_smfmac_f32_16x16x64_bf16 v[72:75], v[32:35], a[0:7], v16
  ds_read_b128 v[92:95], v5 offset:13312
  v_smfmac_f32_16x16x64_bf16 v[76:79], v[32:35], a[192:199], v16
  ds_read_b128 v[48:51], v18 offset:4096
  s_waitcnt lgkmcnt(6)
  v_smfmac_f32_16x16x64_bf16 v[72:75], v[36:39], a[24:31], v16
  ds_read_b128 v[52:55], v18 offset:5120
  v_smfmac_f32_16x16x64_bf16 v[76:79], v[64:67], v[96:103], v16
  ds_read_b128 v[96:99], v5 offset:36864
  v_smfmac_f32_16x16x64_bf16 v[76:79], v[36:39], a[216:223], v16
  ds_read_b128 v[100:103], v5 offset:37888
  s_waitcnt lgkmcnt(8)
  v_smfmac_f32_16x16x64_bf16 v[72:75], v[40:43], a[48:55], v16
  ds_read_b128 v[60:63], v18 offset:7168
  v_smfmac_f32_16x16x64_bf16 v[76:79], v[40:43], a[240:247], v16
  s_waitcnt lgkmcnt(5)
  v_smfmac_f32_16x16x64_bf16 v[72:75], v[68:71], v[88:95], v16
  ds_read_b128 v[88:91], v4 offset:0
  v_smfmac_f32_16x16x64_bf16 v[72:75], v[44:47], a[72:79], v16
  ds_read_b128 v[92:95], v4 offset:1024
  v_smfmac_f32_16x16x64_bf16 v[76:79], v[44:47], v[160:167], v16
  ds_read_b128 v[56:59], v18 offset:6144
  s_waitcnt lgkmcnt(7)
  v_smfmac_f32_16x16x64_bf16 v[72:75], v[48:51], a[96:103], v16
  s_waitcnt lgkmcnt(4)
  v_smfmac_f32_16x16x64_bf16 v[76:79], v[68:71], v[96:103], v16
  ds_read_b128 v[96:99], v4 offset:26624
  v_smfmac_f32_16x16x64_bf16 v[76:79], v[48:51], v[184:191], v16
  ds_read_b128 v[100:103], v4 offset:27648
  s_waitcnt vmcnt(0)
  v_smfmac_f32_16x16x64_bf16 v[72:75], v[52:55], a[120:127], v16
  buffer_load_dwordx4 v[128:131], v1, s[4:7], s43 offen offset:0 sc1
  v_smfmac_f32_16x16x64_bf16 v[76:79], v[52:55], v[208:215], v16
  s_waitcnt lgkmcnt(3)
  v_smfmac_f32_16x16x64_bf16 v[76:79], v[60:63], v[88:95], v16
  ds_read_b128 v[88:91], v4 offset:51200
  s_waitcnt lgkmcnt(3)
  v_smfmac_f32_16x16x64_bf16 v[76:79], v[56:59], v[232:239], v16
  ds_read_b128 v[92:95], v4 offset:52224
  v_smfmac_f32_16x16x64_bf16 v[72:75], v[56:59], a[144:151], v16
  buffer_load_dwordx4 v[132:135], v1, s[4:7], s43 offen offset:1024 sc1
  v_smfmac_f32_16x16x64_bf16 v[72:75], v[60:63], a[168:175], v16
  s_waitcnt lgkmcnt(2)
  v_smfmac_f32_16x16x64_bf16 v[80:83], v[64:67], v[96:103], v16
  ds_read_b128 v[96:99], v5 offset:14336
  v_add_f32 v76, v76, v77
  v_smfmac_f32_16x16x64_bf16 v[80:83], v[32:35], a[8:15], v16
  ds_read_b128 v[100:103], v5 offset:15360
  v_add_f32 v78, v78, v79
  v_smfmac_f32_16x16x64_bf16 v[84:87], v[32:35], a[200:207], v16
  buffer_load_dwordx4 v[136:139], v1, s[4:7], s43 offen offset:2048 sc1
  v_cvt_pk_bf16_f32 v77, v76, v78
  v_smfmac_f32_16x16x64_bf16 v[80:83], v[36:39], a[32:39], v16
  s_waitcnt lgkmcnt(2)
  v_add_f32 v72, v72, v73
  v_smfmac_f32_16x16x64_bf16 v[84:87], v[64:67], v[88:95], v16
  ds_read_b128 v[88:91], v5 offset:38912
  v_add_f32 v74, v74, v75
  v_smfmac_f32_16x16x64_bf16 v[84:87], v[36:39], a[224:231], v16
  ds_read_b128 v[92:95], v5 offset:39936
  v_cvt_pk_bf16_f32 v76, v72, v74
  v_smfmac_f32_16x16x64_bf16 v[80:83], v[40:43], a[56:63], v16
  buffer_load_dwordx4 v[116:119], v1, s[4:7], s42 offen offset:0 sc1
  v_mfma_f32_16x16x16_bf16 v[72:75], v[76:77], v[6:7], 0
  v_smfmac_f32_16x16x64_bf16 v[84:87], v[40:43], a[248:255], v16
  s_waitcnt lgkmcnt(2)
  v_smfmac_f32_16x16x64_bf16 v[80:83], v[68:71], v[96:103], v16
  ds_read_b128 v[96:99], v4 offset:2048
  v_smfmac_f32_16x16x64_bf16 v[80:83], v[44:47], a[80:87], v16
  ds_read_b128 v[100:103], v4 offset:3072
  v_cvt_pk_bf16_f32 v24, v72, v73
  v_smfmac_f32_16x16x64_bf16 v[84:87], v[44:47], v[168:175], v16
  buffer_load_dwordx4 v[120:123], v1, s[4:7], s42 offen offset:1024 sc1
  v_cvt_pk_bf16_f32 v25, v74, v75
  v_smfmac_f32_16x16x64_bf16 v[80:83], v[48:51], a[104:111], v16
  s_waitcnt lgkmcnt(2)
  v_mov_b64 v[72:73], 0
  v_smfmac_f32_16x16x64_bf16 v[84:87], v[68:71], v[88:95], v16
  ds_read_b128 v[88:91], v4 offset:28672
  v_mov_b64 v[74:75], 0
  v_smfmac_f32_16x16x64_bf16 v[84:87], v[48:51], v[192:199], v16
  ds_read_b128 v[92:95], v4 offset:29696
  v_mov_b64 v[76:77], 0
  v_smfmac_f32_16x16x64_bf16 v[80:83], v[52:55], a[128:135], v16
  buffer_load_dwordx4 v[124:127], v1, s[4:7], s42 offen offset:2048 sc1
  v_mov_b64 v[78:79], 0
  v_smfmac_f32_16x16x64_bf16 v[84:87], v[52:55], v[216:223], v16
  s_waitcnt lgkmcnt(2)
  v_smfmac_f32_16x16x64_bf16 v[84:87], v[60:63], v[96:103], v16
  ds_read_b128 v[96:99], v4 offset:53248
  v_mov_b32 v140, s20
  v_smfmac_f32_16x16x64_bf16 v[84:87], v[56:59], v[240:247], v16
  ds_read_b128 v[100:103], v4 offset:54272
  v_smfmac_f32_16x16x64_bf16 v[80:83], v[56:59], a[152:159], v16
  s_mov_b64 exec, 1
  buffer_store_dword v140, v1, s[4:7], s72 offen sc1
  s_mov_b64 exec, -1
  v_smfmac_f32_16x16x64_bf16 v[80:83], v[60:63], a[176:183], v16
  s_waitcnt lgkmcnt(2)
  v_smfmac_f32_16x16x64_bf16 v[72:75], v[64:67], v[88:95], v16
  ds_read_b128 v[88:91], v5 offset:16384
  v_add_f32 v84, v84, v85
  v_smfmac_f32_16x16x64_bf16 v[72:75], v[32:35], a[16:23], v16
  ds_read_b128 v[92:95], v5 offset:17408
  v_add_f32 v86, v86, v87
  v_smfmac_f32_16x16x64_bf16 v[76:79], v[32:35], a[208:215], v16
  v_cvt_pk_bf16_f32 v85, v84, v86
  v_smfmac_f32_16x16x64_bf16 v[72:75], v[36:39], a[40:47], v16
  s_waitcnt lgkmcnt(2)
  v_add_f32 v80, v80, v81
  v_smfmac_f32_16x16x64_bf16 v[76:79], v[64:67], v[96:103], v16
  ds_read_b128 v[96:99], v5 offset:40960
  v_add_f32 v82, v82, v83
  v_smfmac_f32_16x16x64_bf16 v[76:79], v[36:39], a[232:239], v16
  ds_read_b128 v[100:103], v5 offset:41984
  v_cvt_pk_bf16_f32 v84, v80, v82
  v_smfmac_f32_16x16x64_bf16 v[72:75], v[40:43], a[64:71], v16
  v_mfma_f32_16x16x16_bf16 v[80:83], v[84:85], v[6:7], 0
  v_smfmac_f32_16x16x64_bf16 v[76:79], v[40:43], v[152:159], v16
  s_waitcnt lgkmcnt(2)
  v_smfmac_f32_16x16x64_bf16 v[72:75], v[68:71], v[88:95], v16
  ds_read_b128 v[88:91], v4 offset:4096
  v_smfmac_f32_16x16x64_bf16 v[72:75], v[44:47], a[88:95], v16
  ds_read_b128 v[92:95], v4 offset:5120
  v_cvt_pk_bf16_f32 v26, v80, v81
  v_smfmac_f32_16x16x64_bf16 v[76:79], v[44:47], v[176:183], v16
  v_cvt_pk_bf16_f32 v27, v82, v83
  v_smfmac_f32_16x16x64_bf16 v[72:75], v[48:51], a[112:119], v16
  s_waitcnt lgkmcnt(2)
  v_smfmac_f32_16x16x64_bf16 v[76:79], v[68:71], v[96:103], v16
  v_smfmac_f32_16x16x64_bf16 v[76:79], v[48:51], v[200:207], v16
  v_smfmac_f32_16x16x64_bf16 v[72:75], v[52:55], a[136:143], v16
  v_smfmac_f32_16x16x64_bf16 v[76:79], v[52:55], v[224:231], v16
  s_waitcnt lgkmcnt(0)
  v_smfmac_f32_16x16x64_bf16 v[76:79], v[60:63], v[88:95], v16
  v_smfmac_f32_16x16x64_bf16 v[76:79], v[56:59], v[248:255], v16
  v_smfmac_f32_16x16x64_bf16 v[72:75], v[56:59], a[160:167], v16
  v_smfmac_f32_16x16x64_bf16 v[72:75], v[60:63], a[184:191], v16
  v_add_f32 v76, v76, v77
  v_mfma_f32_16x16x32_bf16 v[140:143], v[24:27], v[24:27], 0
  v_add_f32 v78, v78, v79
  v_cvt_pk_bf16_f32 v77, v76, v78
  v_mfma_f32_16x16x32_bf16 v[144:147], v[104:107], v[24:27], 0
  v_add_f32 v72, v72, v73
  v_add_f32 v74, v74, v75
  v_cvt_pk_bf16_f32 v76, v72, v74
  s_nop 1
  v_mfma_f32_16x16x16_bf16 v[72:75], v[76:77], v[6:7], 0
  v_mfma_f32_16x16x32_bf16 v[148:151], v[108:111], v[24:27], 0
  s_nop 3
  v_cvt_pk_bf16_f32 v28, v72, v73
  v_cvt_pk_bf16_f32 v29, v74, v75
  s_nop 1
  v_mfma_f32_16x16x16_bf16 v[140:143], v[28:29], v[28:29], v[140:143]
  v_mfma_f32_16x16x16_bf16 v[144:147], v[112:113], v[28:29], v[144:147]
  v_mfma_f32_16x16x16_bf16 v[148:151], v[114:115], v[28:29], v[148:151]
  s_mov_b64 exec, s[66:67]
  ds_write_b128 v19, v[140:143] offset:96
  s_nop 1
  ds_write_b128 v19, v[144:147] offset:0
  s_nop 2
  ds_write_b128 v19, v[148:151] offset:64
  s_mov_b64 exec, -1
  s_cmp_lg_u32 s17, 0
  s_waitcnt lgkmcnt(0)
  s_barrier
  s_cbranch_scc1 L_A_x
  ds_read_b128 v[32:35], v20
  ds_read_b128 v[40:43], v20 offset:1408
  ds_read2_b64 v[36:39], v21 offset0:0 offset1:176
  ds_read_b128 v[44:47], v20 offset:2816
  ds_read_b128 v[48:51], v20 offset:4224
  ds_read2_b64 v[52:55], v30 offset0:0 offset1:176
  s_waitcnt lgkmcnt(4)
  v_pk_add_f32 v[32:33], v[32:33], v[40:41]
  v_pk_add_f32 v[34:35], v[34:35], v[42:43]
  s_waitcnt lgkmcnt(3)
  v_pk_add_f32 v[36:37], v[36:37], v[38:39]
  s_waitcnt lgkmcnt(2)
  v_pk_add_f32 v[32:33], v[32:33], v[44:45]
  v_pk_add_f32 v[34:35], v[34:35], v[46:47]
  s_waitcnt lgkmcnt(1)
  v_pk_add_f32 v[32:33], v[32:33], v[48:49]
  v_pk_add_f32 v[34:35], v[34:35], v[50:51]
  s_waitcnt lgkmcnt(0)
  v_pk_add_f32 v[36:37], v[36:37], v[52:53]
  v_max3_f32 v40, v32, v33, v34
  v_pk_add_f32 v[36:37], v[36:37], v[54:55]
  v_max_f32 v40, v40, v35
  v_max3_f32 v40, v40, v36, v37
  s_nop 1
  v_max_f32_dpp v40, v40, v40 quad_perm:[1,0,3,2] row_mask:0xf bank_mask:0xf
  s_nop 1
  v_max_f32_dpp v40, v40, v40 quad_perm:[2,3,0,1] row_mask:0xf bank_mask:0xf
  s_nop 1
  v_max_f32_dpp v40, v40, v40 row_half_mirror row_mask:0xf bank_mask:0xf
  v_mul_f32 v40, s62, v40
  v_pk_fma_f32 v[32:33], v[32:33], s[62:63], v[40:41] op_sel_hi:[1,1,0] neg_lo:[0,0,1] neg_hi:[0,0,1]
  v_pk_fma_f32 v[34:35], v[34:35], s[62:63], v[40:41] op_sel_hi:[1,1,0] neg_lo:[0,0,1] neg_hi:[0,0,1]
  v_pk_fma_f32 v[36:37], v[36:37], s[62:63], v[40:41] op_sel_hi:[1,1,0] neg_lo:[0,0,1] neg_hi:[0,0,1]
  v_exp_f32 v32, v32
  v_exp_f32 v33, v33
  v_exp_f32 v34, v34
  v_exp_f32 v35, v35
  v_exp_f32 v36, v36
  v_exp_f32 v37, v37
  v_pk_add_f32 v[40:41], v[32:33], v[34:35]
  v_pk_fma_f32 v[40:41], v[36:37], 0.5, v[40:41] op_sel_hi:[1,0,1]
  v_add_f32 v40, v40, v41
  s_nop 1
  v_add_f32_dpp v40, v40, v40 quad_perm:[1,0,3,2] row_mask:0xf bank_mask:0xf
  s_nop 1
  v_add_f32_dpp v40, v40, v40 quad_perm:[2,3,0,1] row_mask:0xf bank_mask:0xf
  s_nop 1
  v_add_f32_dpp v40, v40, v40 row_half_mirror row_mask:0xf bank_mask:0xf
  v_rcp_f32 v40, v40
  s_nop 0
  v_pk_mul_f32 v[32:33], v[32:33], v[40:41] op_sel_hi:[1,0]
  v_pk_mul_f32 v[34:35], v[34:35], v[40:41] op_sel_hi:[1,0]
  v_pk_mul_f32 v[36:37], v[36:37], v[40:41] op_sel_hi:[1,0]
  v_cvt_pk_bf16_f32 v32, v32, v33
  v_cvt_pk_bf16_f32 v33, v34, v35
  buffer_store_dwordx2 v[32:33], v22, s[4:7], s40 offen
  v_cvt_pk_bf16_f32 v34, v36, v37
  s_mov_b64 exec, s[68:69]
  buffer_store_dword v34, v23, s[4:7], s40 offen
  s_mov_b64 exec, -1
  s_waitcnt vmcnt(2)
  s_branch L_A_x1
L_A_x:
  s_waitcnt vmcnt(0)
L_A_x1:
  v_swap_b32 v130, v132
  v_swap_b32 v131, v133
  s_nop 1
  v_mfma_f32_16x16x32_bf16 v[44:47], v[24:27], v[128:131], 0
  v_mfma_f32_16x16x32_bf16 v[48:51], v[104:107], v[128:131], 0
  v_mfma_f32_16x16x32_bf16 v[52:55], v[24:27], v[132:135], 0
  v_mfma_f32_16x16x32_bf16 v[56:59], v[104:107], v[132:135], 0
  v_mfma_f32_16x16x32_bf16 v[60:63], v[108:111], v[132:135], 0
  v_mfma_f32_16x16x16_bf16 v[44:47], v[28:29], v[136:137], v[44:47]
  v_mfma_f32_16x16x16_bf16 v[48:51], v[112:113], v[136:137], v[48:51]
  v_mfma_f32_16x16x16_bf16 v[52:55], v[28:29], v[138:139], v[52:55]
  v_mfma_f32_16x16x16_bf16 v[56:59], v[112:113], v[138:139], v[56:59]
  v_mfma_f32_16x16x16_bf16 v[60:63], v[114:115], v[138:139], v[60:63]
  ds_write_b128 v17, v[44:47] offset:0
  ds_write_b128 v17, v[48:51] offset:1024
  ds_write_b128 v17, v[52:55] offset:2048
  s_nop 0
  ds_write_b128 v17, v[56:59] offset:3072
  s_nop 2
  ds_write_b128 v17, v[60:63] offset:4096
  s_waitcnt lgkmcnt(0)
  s_barrier
  ds_read2st64_b64 v[40:43], v0 offset0:0 offset1:2
  ds_read2st64_b64 v[44:47], v0 offset0:10 offset1:12
  ds_read2st64_b64 v[48:51], v0 offset0:20 offset1:22
  ds_read2st64_b64 v[52:55], v0 offset0:30 offset1:32
  ds_read2st64_b64 v[56:59], v14 offset0:0 offset1:10
  ds_read2st64_b64 v[60:63], v14 offset0:20 offset1:30
  s_lshl_b32 s33, s20, 16
  s_add_u32 s33, s33, s37
  s_lshl_b32 s34, s20, 14
  s_add_u32 s34, s34, s38
  v_mov_b32 v38, s65
  s_waitcnt lgkmcnt(4)
  v_pk_add_f32 v[32:33], v[40:41], v[44:45]
  v_pk_add_f32 v[34:35], v[42:43], v[46:47]
  s_waitcnt lgkmcnt(3)
  v_pk_add_f32 v[32:33], v[32:33], v[48:49]
  v_pk_add_f32 v[34:35], v[34:35], v[50:51]
  s_waitcnt lgkmcnt(2)
  v_pk_add_f32 v[32:33], v[32:33], v[52:53]
  v_pk_add_f32 v[34:35], v[34:35], v[54:55]
  s_waitcnt lgkmcnt(1)
  v_pk_add_f32 v[36:37], v[56:57], v[58:59]
  s_waitcnt lgkmcnt(0)
  v_pk_add_f32 v[60:61], v[60:61], v[62:63]
  v_pk_add_f32 v[36:37], v[36:37], v[60:61]
  v_cndmask_b32 v32, v38, v32, s[44:45]
  v_cndmask_b32 v33, v38, v33, s[46:47]
  v_cndmask_b32 v34, v38, v34, s[48:49]
  v_cndmask_b32 v35, v38, v35, s[50:51]
  v_max3_f32 v40, v32, v33, v34
  v_max3_f32 v42, v35, v36, v37
  v_max_f32 v40, v40, v42
  s_nop 1
  v_max_f32_dpp v40, v40, v40 quad_perm:[1,0,3,2] row_mask:0xf bank_mask:0xf
  v_mov_b32 v42, v40
  s_nop 1
  v_permlane16_swap_b32 v42, v40
  v_max_f32 v40, v40, v42
  v_mov_b32 v42, v40
  s_nop 1
  v_permlane32_swap_b32 v42, v40
  v_max_f32 v40, v40, v42
  v_mul_f32 v40, s62, v40
  v_pk_fma_f32 v[32:33], v[32:33], s[62:63], v[40:41] op_sel_hi:[1,1,0] neg_lo:[0,0,1] neg_hi:[0,0,1]
  v_pk_fma_f32 v[34:35], v[34:35], s[62:63], v[40:41] op_sel_hi:[1,1,0] neg_lo:[0,0,1] neg_hi:[0,0,1]
  v_pk_fma_f32 v[36:37], v[36:37], s[62:63], v[40:41] op_sel_hi:[1,1,0] neg_lo:[0,0,1] neg_hi:[0,0,1]
  v_exp_f32 v32, v32
  v_exp_f32 v33, v33
  v_exp_f32 v34, v34
  v_exp_f32 v35, v35
  v_exp_f32 v36, v36
  v_exp_f32 v37, v37
  v_pk_add_f32 v[40:41], v[32:33], v[34:35]
  v_pk_fma_f32 v[40:41], v[36:37], 0.5, v[40:41] op_sel_hi:[1,0,1]
  v_add_f32 v40, v40, v41
  s_nop 1
  v_add_f32_dpp v40, v40, v40 quad_perm:[1,0,3,2] row_mask:0xf bank_mask:0xf
  v_mov_b32 v42, v40
  s_nop 1
  v_permlane16_swap_b32 v42, v40
  v_add_f32 v40, v40, v42
  v_mov_b32 v42, v40
  s_nop 1
  v_permlane32_swap_b32 v42, v40
  v_add_f32 v40, v40, v42
  v_rcp_f32 v40, v40
  s_nop 0
  v_pk_mul_f32 v[32:33], v[32:33], v[40:41] op_sel_hi:[1,0]
  v_pk_mul_f32 v[34:35], v[34:35], v[40:41] op_sel_hi:[1,0]
  v_pk_mul_f32 v[36:37], v[36:37], v[40:41] op_sel_hi:[1,0]
  v_cvt_pk_bf16_f32 v32, v32, v33
  v_cvt_pk_bf16_f32 v33, v34, v35
  v_cvt_pk_bf16_f32 v34, v36, v37
  buffer_store_dwordx2 v[32:33], v31, s[4:7], s33 offen sc1
  s_nop 0
  v_permlane16_swap_b32 v34, v35
  s_mov_b64 exec, 0xffff
  buffer_store_dwordx2 v[34:35], v3, s[4:7], s34 offen sc1
  s_mov_b64 exec, -1
  s_cmp_lg_u32 s17, 0
  s_cbranch_scc1 L_A_next
  s_xor_b32 s23, s40, 262144
  buffer_store_dwordx2 v[8:9], v22, s[4:7], s23 offen
  s_mov_b64 exec, s[68:69]
  buffer_store_dword v8, v23, s[4:7], s23 offen
  s_mov_b64 exec, -1
L_A_next:
  s_add_u32 s20, s20, 1
  s_cmp_lt_u32 s20, 64
  s_cbranch_scc1 L_A_loop
  v_mov_b32 v15, s20
  s_waitcnt vmcnt(0)
  s_mov_b64 exec, 1
  buffer_store_dword v15, v1, s[4:7], s72 offen sc1
  s_mov_b64 exec, -1
  s_endpgm
L_A_safe:
L_A_loop_s:
  s_add_u32 s31, s20, 2
  s_min_u32 s31, s31, 64
  s_cmp_ge_u32 s70, s31
  s_cbranch_scc1 L_A_fl_ok_s
L_A_fl_s:
  buffer_load_dword v15, v2, s[4:7], s35 offen sc1
  s_add_u32 s39, s39, 1
  s_cmp_gt_u32 s39, 200000
  s_cbranch_scc1 L_exit
  s_waitcnt vmcnt(0)
  v_readlane_b32 s70, v15, 0
  v_readlane_b32 s71, v15, 1
  s_nop 0
  s_min_u32 s70, s70, s71
  s_cmp_lt_u32 s70, s31
  s_cbranch_scc1 L_A_fl_s
L_A_fl_ok_s:
  v_mov_b64 v[104:105], v[116:117]
  v_mov_b64 v[106:107], v[120:121]
  v_mov_b64 v[108:109], v[118:119]
  v_mov_b64 v[110:111], v[122:123]
  v_mov_b64 v[112:113], v[124:125]
  v_mov_b64 v[114:115], v[126:127]
  s_add_u32 s40, s20, 0
  s_and_b32 s40, s40, 3
  s_lshl_b32 s40, s40, 17
  s_add_u32 s40, s40, s73
  s_add_u32 s22, s20, 3
  s_min_u32 s22, s22, 64
  s_cmp_lt_u32 s70, s22
  s_cselect_b32 s64, s35, 0xf0000000
  s_add_u32 s23, s20, 1
  s_min_u32 s23, s23, 63
  s_mul_i32 s23, s23, 393216
  s_add_u32 s23, s23, s36
  s_add_u32 s42, s23, 25165824
  s_mul_i32 s23, s20, 393216
  s_add_u32 s23, s23, s36
  s_add_u32 s43, s23, 50331648
  ds_read_b128 v[88:91], v4 offset:24576
  ds_read_b128 v[92:95], v4 offset:25600
  ds_read_b128 v[96:99], v4 offset:49152
  ds_read_b128 v[100:103], v4 offset:50176
  v_mov_b64 v[72:73], 0
  v_mov_b64 v[74:75], 0
  v_mov_b64 v[76:77], 0
  v_mov_b64 v[78:79], 0
  v_mov_b64 v[80:81], 0
  v_mov_b64 v[82:83], 0
  v_mov_b64 v[84:85], 0
  v_mov_b64 v[86:87], 0
  s_waitcnt lgkmcnt(0)
  s_waitcnt vmcnt(0)
  buffer_load_dwordx4 v[140:143], v10, s[4:7], s40 offen offset:0 sc1
  buffer_load_dwordx4 v[144:147], v10, s[4:7], s40 offen offset:1024 sc1
  buffer_load_dwordx2 v[148:149], v11, s[4:7], s40 offen offset:2048 sc1
  s_sleep 2
L_A_poll_s:
  buffer_load_dwordx4 v[128:131], v10, s[4:7], s40 offen offset:0 sc1
  buffer_load_dwordx4 v[132:135], v10, s[4:7], s40 offen offset:1024 sc1
  buffer_load_dwordx2 v[136:137], v11, s[4:7], s40 offen offset:2048 sc1
  s_add_u32 s39, s39, 1
  s_cmp_gt_u32 s39, 200000
  s_cbranch_scc1 L_exit
  s_waitcnt vmcnt(5)
  ds_write_b128 v12, v[140:143]
  v_max3_u32 v15, v140, v141, v142
  s_waitcnt vmcnt(4)
  ds_write_b128 v12, v[144:147] offset:1024
  v_max3_u32 v15, v15, v143, v144
  v_max3_u32 v15, v15, v145, v146
  s_waitcnt vmcnt(3)
  ds_write_b64 v13, v[148:149] offset:2048
  v_max3_u32 v15, v15, v147, v148
  v_max_u32 v15, v15, v149
  v_cmp_eq_u32 vcc, s41, v15
  s_cbranch_vccz L_A_poll_ok_s
  buffer_load_dwordx4 v[140:143], v10, s[4:7], s40 offen offset:0 sc1
  buffer_load_dwordx4 v[144:147], v10, s[4:7], s40 offen offset:1024 sc1
  buffer_load_dwordx2 v[148:149], v11, s[4:7], s40 offen offset:2048 sc1
  s_waitcnt vmcnt(5)
  ds_write_b128 v12, v[128:131]
  v_max3_u32 v15, v128, v129, v130
  s_waitcnt vmcnt(4)
  ds_write_b128 v12, v[132:135] offset:1024
  v_max3_u32 v15, v15, v131, v132
  v_max3_u32 v15, v15, v133, v134
  s_waitcnt vmcnt(3)
  ds_write_b64 v13, v[136:137] offset:2048
  v_max3_u32 v15, v15, v135, v136
  v_max_u32 v15, v15, v137
  v_cmp_eq_u32 vcc, s41, v15
  s_cbranch_vccnz L_A_poll_s
L_A_poll_ok_s:
  s_waitcnt lgkmcnt(0)
  s_barrier
  ds_read_b128 v[64:67], v18 offset:8192
  ds_read_b128 v[32:35], v18 offset:0
  ds_read_b128 v[36:39], v18 offset:1024
  ds_read_b128 v[40:43], v18 offset:2048
  ds_read_b128 v[68:71], v18 offset:9216
  ds_read_b128 v[44:47], v18 offset:3072
  s_waitcnt lgkmcnt(5)
  v_smfmac_f32_16x16x64_bf16 v[72:75], v[64:67], v[88:95], v16
  ds_read_b128 v[88:91], v5 offset:12288
  s_waitcnt lgkmcnt(5)
  v_smfmac_f32_16x16x64_bf16 v[72:75], v[32:35], a[0:7], v16
  ds_read_b128 v[92:95], v5 offset:13312
  v_smfmac_f32_16x16x64_bf16 v[76:79], v[32:35], a[192:199], v16
  ds_read_b128 v[48:51], v18 offset:4096
  s_waitcnt lgkmcnt(6)
  v_smfmac_f32_16x16x64_bf16 v[72:75], v[36:39], a[24:31], v16
  ds_read_b128 v[52:55], v18 offset:5120
  v_smfmac_f32_16x16x64_bf16 v[76:79], v[64:67], v[96:103], v16
  ds_read_b128 v[96:99], v5 offset:36864
  v_smfmac_f32_16x16x64_bf16 v[76:79], v[36:39], a[216:223], v16
  ds_read_b128 v[100:103], v5 offset:37888
  s_waitcnt lgkmcnt(8)
  v_smfmac_f32_16x16x64_bf16 v[72:75], v[40:43], a[48:55], v16
  ds_read_b128 v[60:63], v18 offset:7168
  v_smfmac_f32_16x16x64_bf16 v[76:79], v[40:43], a[240:247], v16
  s_waitcnt lgkmcnt(5)
  v_smfmac_f32_16x16x64_bf16 v[72:75], v[68:71], v[88:95], v16
  ds_read_b128 v[88:91], v4 offset:0
  v_smfmac_f32_16x16x64_bf16 v[72:75], v[44:47], a[72:79], v16
  ds_read_b128 v[92:95], v4 offset:1024
  v_smfmac_f32_16x16x64_bf16 v[76:79], v[44:47], v[160:167], v16
  ds_read_b128 v[56:59], v18 offset:6144
  s_waitcnt lgkmcnt(7)
  v_smfmac_f32_16x16x64_bf16 v[72:75], v[48:51], a[96:103], v16
  s_waitcnt lgkmcnt(4)
  v_smfmac_f32_16x16x64_bf16 v[76:79], v[68:71], v[96:103], v16
  ds_read_b128 v[96:99], v4 offset:26624
  v_smfmac_f32_16x16x64_bf16 v[76:79], v[48:51], v[184:191], v16
  ds_read_b128 v[100:103], v4 offset:27648
  s_waitcnt vmcnt(0)
  v_smfmac_f32_16x16x64_bf16 v[72:75], v[52:55], a[120:127], v16
  buffer_load_dwordx4 v[128:131], v1, s[4:7], s43 offen offset:0 sc1
  v_smfmac_f32_16x16x64_bf16 v[76:79], v[52:55], v[208:215], v16
  s_waitcnt lgkmcnt(3)
  v_smfmac_f32_16x16x64_bf16 v[76:79], v[60:63], v[88:95], v16
  ds_read_b128 v[88:91], v4 offset:51200
  s_waitcnt lgkmcnt(3)
  v_smfmac_f32_16x16x64_bf16 v[76:79], v[56:59], v[232:239], v16
  ds_read_b128 v[92:95], v4 offset:52224
  v_smfmac_f32_16x16x64_bf16 v[72:75], v[56:59], a[144:151], v16
  buffer_load_dwordx4 v[132:135], v1, s[4:7], s43 offen offset:1024 sc1
  v_smfmac_f32_16x16x64_bf16 v[72:75], v[60:63], a[168:175], v16
  s_waitcnt lgkmcnt(2)
  v_smfmac_f32_16x16x64_bf16 v[80:83], v[64:67], v[96:103], v16
  ds_read_b128 v[96:99], v5 offset:14336
  v_add_f32 v76, v76, v77
  v_smfmac_f32_16x16x64_bf16 v[80:83], v[32:35], a[8:15], v16
  ds_read_b128 v[100:103], v5 offset:15360
  v_add_f32 v78, v78, v79
  v_smfmac_f32_16x16x64_bf16 v[84:87], v[32:35], a[200:207], v16
  buffer_load_dwordx4 v[136:139], v1, s[4:7], s43 offen offset:2048 sc1
  v_cvt_pk_bf16_f32 v77, v76, v78
  v_smfmac_f32_16x16x64_bf16 v[80:83], v[36:39], a[32:39], v16
  s_waitcnt lgkmcnt(2)
  v_add_f32 v72, v72, v73
  v_smfmac_f32_16x16x64_bf16 v[84:87], v[64:67], v[88:95], v16
  ds_read_b128 v[88:91], v5 offset:38912
  v_add_f32 v74, v74, v75
  v_smfmac_f32_16x16x64_bf16 v[84:87], v[36:39], a[224:231], v16
  ds_read_b128 v[92:95], v5 offset:39936
  v_cvt_pk_bf16_f32 v76, v72, v74
  v_smfmac_f32_16x16x64_bf16 v[80:83], v[40:43], a[56:63], v16
  buffer_load_dwordx4 v[116:119], v1, s[4:7], s42 offen offset:0 sc1
  v_mfma_f32_16x16x16_bf16 v[72:75], v[76:77], v[6:7], 0
  v_smfmac_f32_16x16x64_bf16 v[84:87], v[40:43], a[248:255], v16
  s_waitcnt lgkmcnt(2)
  v_smfmac_f32_16x16x64_bf16 v[80:83], v[68:71], v[96:103], v16
  ds_read_b128 v[96:99], v4 offset:2048
  v_smfmac_f32_16x16x64_bf16 v[80:83], v[44:47], a[80:87], v16
  ds_read_b128 v[100:103], v4 offset:3072
  v_cvt_pk_bf16_f32 v24, v72, v73
  v_smfmac_f32_16x16x64_bf16 v[84:87], v[44:47], v[168:175], v16
  buffer_load_dwordx4 v[120:123], v1, s[4:7], s42 offen offset:1024 sc1
  v_cvt_pk_bf16_f32 v25, v74, v75
  v_smfmac_f32_16x16x64_bf16 v[80:83], v[48:51], a[104:111], v16
  s_waitcnt lgkmcnt(2)
  v_mov_b64 v[72:73], 0
  v_smfmac_f32_16x16x64_bf16 v[84:87], v[68:71], v[88:95], v16
  ds_read_b128 v[88:91], v4 offset:28672
  v_mov_b64 v[74:75], 0
  v_smfmac_f32_16x16x64_bf16 v[84:87], v[48:51], v[192:199], v16
  ds_read_b128 v[92:95], v4 offset:29696
  v_mov_b64 v[76:77], 0
  v_smfmac_f32_16x16x64_bf16 v[80:83], v[52:55], a[128:135], v16
  buffer_load_dwordx4 v[124:127], v1, s[4:7], s42 offen offset:2048 sc1
  v_mov_b64 v[78:79], 0
  v_smfmac_f32_16x16x64_bf16 v[84:87], v[52:55], v[216:223], v16
  s_waitcnt lgkmcnt(2)
  v_smfmac_f32_16x16x64_bf16 v[84:87], v[60:63], v[96:103], v16
  ds_read_b128 v[96:99], v4 offset:53248
  v_mov_b32 v140, s20
  v_smfmac_f32_16x16x64_bf16 v[84:87], v[56:59], v[240:247], v16
  ds_read_b128 v[100:103], v4 offset:54272
  v_smfmac_f32_16x16x64_bf16 v[80:83], v[56:59], a[152:159], v16
  s_mov_b64 exec, 1
  buffer_store_dword v140, v1, s[4:7], s72 offen sc1
  s_mov_b64 exec, -1
  v_smfmac_f32_16x16x64_bf16 v[80:83], v[60:63], a[176:183], v16
  s_waitcnt lgkmcnt(2)
  v_smfmac_f32_16x16x64_bf16 v[72:75], v[64:67], v[88:95], v16
  ds_read_b128 v[88:91], v5 offset:16384
  v_add_f32 v84, v84, v85
  v_smfmac_f32_16x16x64_bf16 v[72:75], v[32:35], a[16:23], v16
  ds_read_b128 v[92:95], v5 offset:17408
  v_add_f32 v86, v86, v87
  v_smfmac_f32_16x16x64_bf16 v[76:79], v[32:35], a[208:215], v16
  v_cvt_pk_bf16_f32 v85, v84, v86
  v_smfmac_f32_16x16x64_bf16 v[72:75], v[36:39], a[40:47], v16
  s_waitcnt lgkmcnt(2)
  v_add_f32 v80, v80, v81
  v_smfmac_f32_16x16x64_bf16 v[76:79], v[64:67], v[96:103], v16
  ds_read_b128 v[96:99], v5 offset:40960
  v_add_f32 v82, v82, v83
  v_smfmac_f32_16x16x64_bf16 v[76:79], v[36:39], a[232:239], v16
  ds_read_b128 v[100:103], v5 offset:41984
  v_cvt_pk_bf16_f32 v84, v80, v82
  v_smfmac_f32_16x16x64_bf16 v[72:75], v[40:43], a[64:71], v16
  v_mfma_f32_16x16x16_bf16 v[80:83], v[84:85], v[6:7], 0
  v_smfmac_f32_16x16x64_bf16 v[76:79], v[40:43], v[152:159], v16
  s_waitcnt lgkmcnt(2)
  v_smfmac_f32_16x16x64_bf16 v[72:75], v[68:71], v[88:95], v16
  ds_read_b128 v[88:91], v4 offset:4096
  v_smfmac_f32_16x16x64_bf16 v[72:75], v[44:47], a[88:95], v16
  ds_read_b128 v[92:95], v4 offset:5120
  v_cvt_pk_bf16_f32 v26, v80, v81
  v_smfmac_f32_16x16x64_bf16 v[76:79], v[44:47], v[176:183], v16
  v_cvt_pk_bf16_f32 v27, v82, v83
  v_smfmac_f32_16x16x64_bf16 v[72:75], v[48:51], a[112:119], v16
  s_waitcnt lgkmcnt(2)
  v_smfmac_f32_16x16x64_bf16 v[76:79], v[68:71], v[96:103], v16
  v_smfmac_f32_16x16x64_bf16 v[76:79], v[48:51], v[200:207], v16
  v_smfmac_f32_16x16x64_bf16 v[72:75], v[52:55], a[136:143], v16
  v_smfmac_f32_16x16x64_bf16 v[76:79], v[52:55], v[224:231], v16
  s_waitcnt lgkmcnt(0)
  v_smfmac_f32_16x16x64_bf16 v[76:79], v[60:63], v[88:95], v16
  v_smfmac_f32_16x16x64_bf16 v[76:79], v[56:59], v[248:255], v16
  v_smfmac_f32_16x16x64_bf16 v[72:75], v[56:59], a[160:167], v16
  v_smfmac_f32_16x16x64_bf16 v[72:75], v[60:63], a[184:191], v16
  v_add_f32 v76, v76, v77
  v_mfma_f32_16x16x32_bf16 v[140:143], v[24:27], v[24:27], 0
  v_add_f32 v78, v78, v79
  v_cvt_pk_bf16_f32 v77, v76, v78
  v_mfma_f32_16x16x32_bf16 v[144:147], v[104:107], v[24:27], 0
  v_add_f32 v72, v72, v73
  v_add_f32 v74, v74, v75
  v_cvt_pk_bf16_f32 v76, v72, v74
  s_nop 1
  v_mfma_f32_16x16x16_bf16 v[72:75], v[76:77], v[6:7], 0
  v_mfma_f32_16x16x32_bf16 v[148:151], v[108:111], v[24:27], 0
  s_nop 3
  v_cvt_pk_bf16_f32 v28, v72, v73
  v_cvt_pk_bf16_f32 v29, v74, v75
  s_nop 1
  v_mfma_f32_16x16x16_bf16 v[140:143], v[28:29], v[28:29], v[140:143]
  v_mfma_f32_16x16x16_bf16 v[144:147], v[112:113], v[28:29], v[144:147]
  v_mfma_f32_16x16x16_bf16 v[148:151], v[114:115], v[28:29], v[148:151]
  s_mov_b64 exec, s[66:67]
  ds_write_b128 v19, v[140:143] offset:96
  s_nop 1
  ds_write_b128 v19, v[144:147] offset:0
  s_nop 2
  ds_write_b128 v19, v[148:151] offset:64
  s_mov_b64 exec, -1
  s_cmp_lg_u32 s17, 0
  s_waitcnt lgkmcnt(0)
  s_barrier
  s_cbranch_scc1 L_A_x_s
  ds_read_b128 v[32:35], v20
  ds_read_b128 v[40:43], v20 offset:1408
  ds_read2_b64 v[36:39], v21 offset0:0 offset1:176
  ds_read_b128 v[44:47], v20 offset:2816
  ds_read_b128 v[48:51], v20 offset:4224
  ds_read2_b64 v[52:55], v30 offset0:0 offset1:176
  s_waitcnt lgkmcnt(4)
  v_pk_add_f32 v[32:33], v[32:33], v[40:41]
  v_pk_add_f32 v[34:35], v[34:35], v[42:43]
  s_waitcnt lgkmcnt(3)
  v_pk_add_f32 v[36:37], v[36:37], v[38:39]
  s_waitcnt lgkmcnt(2)
  v_pk_add_f32 v[32:33], v[32:33], v[44:45]
  v_pk_add_f32 v[34:35], v[34:35], v[46:47]
  s_waitcnt lgkmcnt(1)
  v_pk_add_f32 v[32:33], v[32:33], v[48:49]
  v_pk_add_f32 v[34:35], v[34:35], v[50:51]
  s_waitcnt lgkmcnt(0)
  v_pk_add_f32 v[36:37], v[36:37], v[52:53]
  v_max3_f32 v40, v32, v33, v34
  v_pk_add_f32 v[36:37], v[36:37], v[54:55]
  v_max_f32 v40, v40, v35
  v_max3_f32 v40, v40, v36, v37
  s_nop 1
  v_max_f32_dpp v40, v40, v40 quad_perm:[1,0,3,2] row_mask:0xf bank_mask:0xf
  s_nop 1
  v_max_f32_dpp v40, v40, v40 quad_perm:[2,3,0,1] row_mask:0xf bank_mask:0xf
  s_nop 1
  v_max_f32_dpp v40, v40, v40 row_half_mirror row_mask:0xf bank_mask:0xf
  v_mul_f32 v40, s62, v40
  v_pk_fma_f32 v[32:33], v[32:33], s[62:63], v[40:41] op_sel_hi:[1,1,0] neg_lo:[0,0,1] neg_hi:[0,0,1]
  v_pk_fma_f32 v[34:35], v[34:35], s[62:63], v[40:41] op_sel_hi:[1,1,0] neg_lo:[0,0,1] neg_hi:[0,0,1]
  v_pk_fma_f32 v[36:37], v[36:37], s[62:63], v[40:41] op_sel_hi:[1,1,0] neg_lo:[0,0,1] neg_hi:[0,0,1]
  v_exp_f32 v32, v32
  v_exp_f32 v33, v33
  v_exp_f32 v34, v34
  v_exp_f32 v35, v35
  v_exp_f32 v36, v36
  v_exp_f32 v37, v37
  v_pk_add_f32 v[40:41], v[32:33], v[34:35]
  v_pk_fma_f32 v[40:41], v[36:37], 0.5, v[40:41] op_sel_hi:[1,0,1]
  v_add_f32 v40, v40, v41
  s_nop 1
  v_add_f32_dpp v40, v40, v40 quad_perm:[1,0,3,2] row_mask:0xf bank_mask:0xf
  s_nop 1
  v_add_f32_dpp v40, v40, v40 quad_perm:[2,3,0,1] row_mask:0xf bank_mask:0xf
  s_nop 1
  v_add_f32_dpp v40, v40, v40 row_half_mirror row_mask:0xf bank_mask:0xf
  v_rcp_f32 v40, v40
  s_nop 0
  v_pk_mul_f32 v[32:33], v[32:33], v[40:41] op_sel_hi:[1,0]
  v_pk_mul_f32 v[34:35], v[34:35], v[40:41] op_sel_hi:[1,0]
  v_pk_mul_f32 v[36:37], v[36:37], v[40:41] op_sel_hi:[1,0]
  v_cvt_pk_bf16_f32 v32, v32, v33
  v_cvt_pk_bf16_f32 v33, v34, v35
  buffer_store_dwordx2 v[32:33], v22, s[4:7], s40 offen sc1
  v_cvt_pk_bf16_f32 v34, v36, v37
  s_mov_b64 exec, s[68:69]
  buffer_store_dword v34, v23, s[4:7], s40 offen sc1
  s_mov_b64 exec, -1
  s_waitcnt vmcnt(2)
  s_branch L_A_x1_s
L_A_x_s:
  s_waitcnt vmcnt(0)
L_A_x1_s:
  v_swap_b32 v130, v132
  v_swap_b32 v131, v133
  s_nop 1
  v_mfma_f32_16x16x32_bf16 v[44:47], v[24:27], v[128:131], 0
  v_mfma_f32_16x16x32_bf16 v[48:51], v[104:107], v[128:131], 0
  v_mfma_f32_16x16x32_bf16 v[52:55], v[24:27], v[132:135], 0
  v_mfma_f32_16x16x32_bf16 v[56:59], v[104:107], v[132:135], 0
  v_mfma_f32_16x16x32_bf16 v[60:63], v[108:111], v[132:135], 0
  v_mfma_f32_16x16x16_bf16 v[44:47], v[28:29], v[136:137], v[44:47]
  v_mfma_f32_16x16x16_bf16 v[48:51], v[112:113], v[136:137], v[48:51]
  v_mfma_f32_16x16x16_bf16 v[52:55], v[28:29], v[138:139], v[52:55]
  v_mfma_f32_16x16x16_bf16 v[56:59], v[112:113], v[138:139], v[56:59]
  v_mfma_f32_16x16x16_bf16 v[60:63], v[114:115], v[138:139], v[60:63]
  ds_write_b128 v17, v[44:47] offset:0
  ds_write_b128 v17, v[48:51] offset:1024
  ds_write_b128 v17, v[52:55] offset:2048
  s_nop 0
  ds_write_b128 v17, v[56:59] offset:3072
  s_nop 2
  ds_write_b128 v17, v[60:63] offset:4096
  s_waitcnt lgkmcnt(0)
  s_barrier
  ds_read2st64_b64 v[40:43], v0 offset0:0 offset1:2
  ds_read2st64_b64 v[44:47], v0 offset0:10 offset1:12
  ds_read2st64_b64 v[48:51], v0 offset0:20 offset1:22
  ds_read2st64_b64 v[52:55], v0 offset0:30 offset1:32
  ds_read2st64_b64 v[56:59], v14 offset0:0 offset1:10
  ds_read2st64_b64 v[60:63], v14 offset0:20 offset1:30
  s_lshl_b32 s33, s20, 16
  s_add_u32 s33, s33, s37
  s_lshl_b32 s34, s20, 14
  s_add_u32 s34, s34, s38
  v_mov_b32 v38, s65
  s_waitcnt lgkmcnt(4)
  v_pk_add_f32 v[32:33], v[40:41], v[44:45]
  v_pk_add_f32 v[34:35], v[42:43], v[46:47]
  s_waitcnt lgkmcnt(3)
  v_pk_add_f32 v[32:33], v[32:33], v[48:49]
  v_pk_add_f32 v[34:35], v[34:35], v[50:51]
  s_waitcnt lgkmcnt(2)
  v_pk_add_f32 v[32:33], v[32:33], v[52:53]
  v_pk_add_f32 v[34:35], v[34:35], v[54:55]
  s_waitcnt lgkmcnt(1)
  v_pk_add_f32 v[36:37], v[56:57], v[58:59]
  s_waitcnt lgkmcnt(0)
  v_pk_add_f32 v[60:61], v[60:61], v[62:63]
  v_pk_add_f32 v[36:37], v[36:37], v[60:61]
  v_cndmask_b32 v32, v38, v32, s[44:45]
  v_cndmask_b32 v33, v38, v33, s[46:47]
  v_cndmask_b32 v34, v38, v34, s[48:49]
  v_cndmask_b32 v35, v38, v35, s[50:51]
  v_max3_f32 v40, v32, v33, v34
  v_max3_f32 v42, v35, v36, v37
  v_max_f32 v40, v40, v42
  s_nop 1
  v_max_f32_dpp v40, v40, v40 quad_perm:[1,0,3,2] row_mask:0xf bank_mask:0xf
  v_mov_b32 v42, v40
  s_nop 1
  v_permlane16_swap_b32 v42, v40
  v_max_f32 v40, v40, v42
  v_mov_b32 v42, v40
  s_nop 1
  v_permlane32_swap_b32 v42, v40
  v_max_f32 v40, v40, v42
  v_mul_f32 v40, s62, v40
  v_pk_fma_f32 v[32:33], v[32:33], s[62:63], v[40:41] op_sel_hi:[1,1,0] neg_lo:[0,0,1] neg_hi:[0,0,1]
  v_pk_fma_f32 v[34:35], v[34:35], s[62:63], v[40:41] op_sel_hi:[1,1,0] neg_lo:[0,0,1] neg_hi:[0,0,1]
  v_pk_fma_f32 v[36:37], v[36:37], s[62:63], v[40:41] op_sel_hi:[1,1,0] neg_lo:[0,0,1] neg_hi:[0,0,1]
  v_exp_f32 v32, v32
  v_exp_f32 v33, v33
  v_exp_f32 v34, v34
  v_exp_f32 v35, v35
  v_exp_f32 v36, v36
  v_exp_f32 v37, v37
  v_pk_add_f32 v[40:41], v[32:33], v[34:35]
  v_pk_fma_f32 v[40:41], v[36:37], 0.5, v[40:41] op_sel_hi:[1,0,1]
  v_add_f32 v40, v40, v41
  s_nop 1
  v_add_f32_dpp v40, v40, v40 quad_perm:[1,0,3,2] row_mask:0xf bank_mask:0xf
  v_mov_b32 v42, v40
  s_nop 1
  v_permlane16_swap_b32 v42, v40
  v_add_f32 v40, v40, v42
  v_mov_b32 v42, v40
  s_nop 1
  v_permlane32_swap_b32 v42, v40
  v_add_f32 v40, v40, v42
  v_rcp_f32 v40, v40
  s_nop 0
  v_pk_mul_f32 v[32:33], v[32:33], v[40:41] op_sel_hi:[1,0]
  v_pk_mul_f32 v[34:35], v[34:35], v[40:41] op_sel_hi:[1,0]
  v_pk_mul_f32 v[36:37], v[36:37], v[40:41] op_sel_hi:[1,0]
  v_cvt_pk_bf16_f32 v32, v32, v33
  v_cvt_pk_bf16_f32 v33, v34, v35
  v_cvt_pk_bf16_f32 v34, v36, v37
  buffer_store_dwordx2 v[32:33], v31, s[4:7], s33 offen sc1
  s_nop 0
  v_permlane16_swap_b32 v34, v35
  s_mov_b64 exec, 0xffff
  buffer_store_dwordx2 v[34:35], v3, s[4:7], s34 offen sc1
  s_mov_b64 exec, -1
  s_cmp_lg_u32 s17, 0
  s_cbranch_scc1 L_A_next_s
  s_xor_b32 s23, s40, 262144
  buffer_store_dwordx2 v[8:9], v22, s[4:7], s23 offen sc1
  s_mov_b64 exec, s[68:69]
  buffer_store_dword v8, v23, s[4:7], s23 offen sc1
  s_mov_b64 exec, -1
L_A_next_s:
  s_add_u32 s20, s20, 1
  s_cmp_lt_u32 s20, 64
  s_cbranch_scc1 L_A_loop_s
  v_mov_b32 v15, s20
  s_waitcnt vmcnt(0)
  s_mov_b64 exec, 1
  buffer_store_dword v15, v1, s[4:7], s72 offen sc1
  s_mov_b64 exec, -1
  s_endpgm
L_codeend:

.section .rodata,"a"
.p2align 6
.amdhsa_kernel adaLN_cond__memory_aug_recurrent_mem_tr__dense_activation_gelu__prompt_kernel
  .amdhsa_next_free_vgpr 512
  .amdhsa_next_free_sgpr 100
  .amdhsa_accum_offset 256
  .amdhsa_group_segment_fixed_size 0
  .amdhsa_kernarg_size 136
  .amdhsa_user_sgpr_count 2
  .amdhsa_user_sgpr_kernarg_segment_ptr 1
  .amdhsa_system_sgpr_workgroup_id_x 1
  .amdhsa_float_denorm_mode_32 3
.end_amdhsa_kernel
```
